```python
import torch

def _softmax(x, axis=-1):
    return torch.softmax(x, dim=axis)
def _gelu(x):
    return torch.nn.functional.gelu(x, approximate="tanh")
def _silu(x):
    return torch.nn.functional.silu(x)
def _sigmoid(x):
    return torch.sigmoid(x)
def _layernorm(x, axis=-1, eps=1e-5):
    m = x.mean(dim=axis, keepdim=True)
    v = x.var(dim=axis, keepdim=True, unbiased=False)
    return (x - m) / torch.sqrt(v + eps)
def _scatter_add(tgt, idx, src, axis=0):
    return tgt.clone().index_add_(axis, idx, src)
def _segment_sum(src, seg, n):
    out = torch.zeros((n,) + src.shape[1:], dtype=src.dtype)
    return out.index_add_(0, seg, src)
def _pad(x, pw):
    flat = tuple(v for pair in reversed(pw) for v in pair)
    return torch.nn.functional.pad(x, flat)

kernel_name = 'parallel_sum__softmax_full_mha__mixer_s_mlp__prompt'

def setup_inputs():

    _w = (lambda a: (lambda t: t.to(torch.bfloat16) if t.is_floating_point() else t)(torch.as_tensor(a)))
    def _A_setup():
        B, S, D = 1, 2048, 448
        return {
            "x": _w((lambda *s: torch.randn(*s, dtype=torch.bfloat16) * 0.05)(B, S, D)),
            "wqkv": _w((lambda *s: torch.randn(*s, dtype=torch.bfloat16) * 0.1)(D, 3 * D)),
            "wo": _w((lambda *s: torch.randn(*s, dtype=torch.bfloat16) * 0.05)(D, D)),
        }
    _A_in = _A_setup()

    def _B_setup():
        B, S, D, F = 1, 2048, 448, 1792
        return {
            "x":  _w((lambda *s: torch.randn(*s, dtype=torch.bfloat16) * 0.05)(B, S, D)),
            "w1": _w((lambda *s: torch.randn(*s, dtype=torch.bfloat16) * 1.6)(D, D) * (D ** -0.5)),
            "w2": _w((lambda *s: torch.randn(*s, dtype=torch.bfloat16) * 1.6)(D, D) * (D ** -0.5)),
            "w3": _w((lambda *s: torch.randn(*s, dtype=torch.bfloat16) * 1.6)(D, F) * (D ** -0.5)),
            "w4": _w((lambda *s: torch.randn(*s, dtype=torch.bfloat16) * 1.6)(F, D) * (F ** -0.5)),
        }
    _B_in = _B_setup()

    return {
        "A_x": _A_in["x"],
        "A_wqkv": _A_in["wqkv"],
        "A_wo": _A_in["wo"],
        "B_x": _B_in["x"],
        "B_w1": _B_in["w1"],
        "B_w2": _B_in["w2"],
        "B_w3": _B_in["w3"],
        "B_w4": _B_in["w4"],
    }

def reference(A_x, A_wqkv, A_wo, B_x, B_w1, B_w2, B_w3, B_w4):
    def _A_ref(x, wqkv, wo):
        B, S, D = x.shape
        H = 16; Dh = D // H
        qkv = (lambda x, *d: x.permute(*d))((x @ wqkv).reshape(B, S, 3, H, Dh), 2, 0, 3, 1, 4)
        q, k, v = qkv[0], qkv[1], qkv[2]
        scale = Dh ** -0.5
        scores = torch.einsum("bhqd,bhkd->bhqk", q, k) * scale
        p = _softmax(scores, axis=-1)
        o = torch.einsum("bhqk,bhkd->bhqd", p, v)
        return (lambda x, *d: x.permute(*d))(o, 0, 2, 1, 3).reshape(B, S, D) @ wo

    def _B_ref(x, w1, w2, w3, w4):
        B, S, D = x.shape
        h = _gelu(_layernorm(x, axis=-1) @ w1)
        c = D // 4
        g0 = _pad(h[:, :, 0*c:1*c], ((0, 0), (1, 0), (0, 0)))[:, :S, :]
        g1 = _pad(h[:, :, 1*c:2*c], ((0, 0), (0, 1), (0, 0)))[:, 1:, :]
        g2 = _pad(h[:, :, 2*c:3*c], ((0, 0), (2, 0), (0, 0)))[:, :S, :]
        g3 = _pad(h[:, :, 3*c:   ], ((0, 0), (0, 2), (0, 0)))[:, 2:, :]
        hs = torch.concatenate([g0, g1, g2, g3], axis=-1) @ w2
        x1 = x + hs
        h2 = _gelu(_layernorm(x1, axis=-1) @ w3) @ w4
        return x1 + h2

    x = A_x
    xn = _layernorm(x, axis=-1)
    return x + _A_ref(xn, A_wqkv, A_wo) + _B_ref(xn, B_w1, B_w2, B_w3, B_w4)
```

```asm
; @launch grid=(256,1,1) block=(512,1,1) lds=163840
.amdgcn_target "amdgcn-amd-amdhsa--gfx950"
.text
.globl parallel_sum__softmax_full_mha__mixer_s_mlp__prompt_kernel
.p2align 8
.type parallel_sum__softmax_full_mha__mixer_s_mlp__prompt_kernel,@function
parallel_sum__softmax_full_mha__mixer_s_mlp__prompt_kernel:
  s_cmp_ge_u32 s2, 256
  s_cbranch_scc1 parallel_sum__softmax_full_mha__mixer_s_mlp__prompt_kernel_done
  s_load_dwordx2 s[72:73], s[0:1], 72
  s_load_dwordx4 s[4:7], s[0:1], 0
  s_load_dwordx2 s[8:9], s[0:1], 32
  s_load_dwordx2 s[10:11], s[0:1], 80
  s_load_dwordx2 s[50:51], s[0:1], 16
  s_load_dwordx4 s[52:55], s[0:1], 40
  s_load_dwordx2 s[56:57], s[0:1], 56
  v_and_b32 v1, 63, v0
  v_lshrrev_b32 v5, 6, v0
  s_nop 0
  v_readfirstlane_b32 s29, v5
  s_lshr_b32 s74, s2, 3
  s_sub_u32 s74, s74, 1
  s_cmp_ge_u32 s74, 10
  s_cbranch_scc1 parallel_sum__softmax_full_mha__mixer_s_mlp__prompt_kernel_cpf
  s_cmp_lg_u32 s29, 0
  s_cbranch_scc1 parallel_sum__softmax_full_mha__mixer_s_mlp__prompt_kernel_cpf
  s_getpc_b64 s[58:59]
parallel_sum__softmax_full_mha__mixer_s_mlp__prompt_kernel_pc:
  s_sub_u32 s58, s58, parallel_sum__softmax_full_mha__mixer_s_mlp__prompt_kernel_pc-parallel_sum__softmax_full_mha__mixer_s_mlp__prompt_kernel
  s_subb_u32 s59, s59, 0
  s_lshl_b32 s74, s74, 13
  v_lshlrev_b32 v230, 7, v1
  v_add_u32 v230, s74, v230
  v_mov_b32 v231, parallel_sum__softmax_full_mha__mixer_s_mlp__prompt_kernel_done-parallel_sum__softmax_full_mha__mixer_s_mlp__prompt_kernel
  v_min_u32 v230, v230, v231
  global_load_dword v231, v230, s[58:59]
parallel_sum__softmax_full_mha__mixer_s_mlp__prompt_kernel_cpf:
  s_lshr_b32 s49, s29, 2
  s_and_b32 s29, s29, 3
  s_mov_b32 s3, 1
  s_and_b32 s34, s2, 7
  s_lshr_b32 s35, s2, 3
  s_and_b32 s24, s35, 3
  s_lshl_b32 s24, s24, 2
  s_and_b32 s36, s34, 3
  s_add_u32 s24, s24, s36
  s_lshr_b32 s25, s34, 2
  s_lshl_b32 s25, s25, 3
  s_lshr_b32 s36, s35, 2
  s_add_u32 s25, s25, s36
  s_lshr_b32 s26, s25, 2
  s_cmp_lt_u32 s25, 12
  s_movk_i32 s27, 896
  s_cselect_b32 s27, 2688, s27
  s_mov_b32 s18, 401408
  s_cselect_b32 s18, 1204224, s18
  s_cselect_b32 s28, 56, 64
  s_cselect_b32 s36, s25, 0
  s_sub_u32 s37, s25, 12
  s_cmp_lt_u32 s25, 12
  s_cselect_b32 s36, s25, s37
  s_mul_i32 s37, s36, 224
  s_mov_b32 s19, 0x20000
  s_lshr_b32 s30, s29, 1
  s_and_b32 s31, s29, 1
  s_lshl_b32 s32, s29, 12
  s_add_u32 s33, s32, 65536
  s_cmp_eq_u32 s49, 0
  s_cbranch_scc1 parallel_sum__softmax_full_mha__mixer_s_mlp__prompt_kernel_comp
  s_setprio 3
  v_lshrrev_b32 v5, 3, v1
  s_lshl_b32 s38, s24, 7
  s_lshl_b32 s39, s29, 5
  s_add_u32 s38, s38, s39
  v_add_u32 v5, s38, v5
  s_movk_i32 s39, 896
  v_mul_lo_u32 v5, v5, s39
  v_and_b32 v6, 7, v1
  v_lshrrev_b32 v7, 4, v1
  v_xor_b32 v6, v6, v7
  v_lshl_add_u32 v2, v6, 4, v5
  v_xor_b32 v3, 64, v2
  v_lshrrev_b32 v5, 4, v1
  s_lshl_b32 s38, s29, 4
  v_add_u32 v6, s38, v5
  v_mul_lo_u32 v6, v6, s27
  v_add_u32 v6, s37, v6
  v_bfe_u32 v7, v1, 2, 2
  v_xor_b32 v7, v7, v5
  v_lshlrev_b32 v7, 2, v7
  v_and_b32 v8, 3, v1
  v_or_b32 v7, v7, v8
  v_lshl_add_u32 v4, v7, 4, v6
  v_lshlrev_b32 v251, 4, v1
  s_lshl_b32 s47, s29, 10
  s_lshl_b32 s58, s35, 12
  s_add_u32 s58, s58, s47
  s_lshl_b32 s59, s2, 12
  s_add_u32 s59, s59, s47
  s_cmp_lt_u32 s25, 12
  s_waitcnt lgkmcnt(0)
  s_cselect_b32 s16, s6, s8
  s_cselect_b32 s17, s7, s9
  s_and_b32 s17, s17, 0xffff
  s_mov_b32 s12, s4
  s_and_b32 s13, s5, 0xffff
  s_mov_b32 s14, 1835008
  s_mov_b32 s15, 0x20000
  s_add_u32 m0, s32, 0
  s_mov_b32 s36, 0
  buffer_load_dwordx4 v2, s[12:15], s36 offen lds
  s_add_u32 m0, s33, 0
  s_mul_i32 s36, s27, 0
  buffer_load_dwordx4 v4, s[16:19], s36 offen lds
  s_add_u32 m0, s32, 1024
  s_mov_b32 s36, 7168
  buffer_load_dwordx4 v3, s[12:15], s36 offen lds
  s_add_u32 m0, s33, 1024
  s_mul_i32 s36, s27, 4
  buffer_load_dwordx4 v4, s[16:19], s36 offen lds
  s_add_u32 m0, s32, 2048
  s_mov_b32 s36, 14336
  buffer_load_dwordx4 v2, s[12:15], s36 offen lds
  s_add_u32 m0, s33, 2048
  s_mul_i32 s36, s27, 8
  buffer_load_dwordx4 v4, s[16:19], s36 offen lds
  s_add_u32 m0, s32, 3072
  s_mov_b32 s36, 21504
  buffer_load_dwordx4 v3, s[12:15], s36 offen lds
  s_add_u32 m0, s33, 3072
  s_mul_i32 s36, s27, 12
  buffer_load_dwordx4 v4, s[16:19], s36 offen lds
  s_add_u32 m0, s32, 16384
  s_mov_b32 s36, 128
  buffer_load_dwordx4 v2, s[12:15], s36 offen lds
  s_add_u32 m0, s33, 16384
  s_mul_i32 s36, s27, 64
  buffer_load_dwordx4 v4, s[16:19], s36 offen lds
  s_add_u32 m0, s32, 17408
  s_mov_b32 s36, 7296
  buffer_load_dwordx4 v3, s[12:15], s36 offen lds
  s_add_u32 m0, s33, 17408
  s_mul_i32 s36, s27, 68
  buffer_load_dwordx4 v4, s[16:19], s36 offen lds
  s_add_u32 m0, s32, 18432
  s_mov_b32 s36, 14464
  buffer_load_dwordx4 v2, s[12:15], s36 offen lds
  s_add_u32 m0, s33, 18432
  s_mul_i32 s36, s27, 72
  buffer_load_dwordx4 v4, s[16:19], s36 offen lds
  s_add_u32 m0, s32, 19456
  s_mov_b32 s36, 21632
  buffer_load_dwordx4 v3, s[12:15], s36 offen lds
  s_add_u32 m0, s33, 19456
  s_mul_i32 s36, s27, 76
  buffer_load_dwordx4 v4, s[16:19], s36 offen lds
  s_mov_b32 s20, s10
  s_and_b32 s21, s11, 0xffff
  s_mov_b32 s22, 22020096
  s_mov_b32 s23, 0x20000
  s_mov_b32 s60, s52
  s_and_b32 s61, s53, 0xffff
  s_mov_b32 s62, 401408
  s_mov_b32 s63, 0x20000
  s_mov_b32 s64, s54
  s_and_b32 s65, s55, 0xffff
  s_mov_b32 s66, 1605632
  s_mov_b32 s67, 0x20000
  s_mov_b32 s76, s56
  s_and_b32 s77, s57, 0xffff
  s_mov_b32 s78, 1605632
  s_mov_b32 s79, 0x20000
  s_mov_b32 s52, s50
  s_and_b32 s53, s51, 0xffff
  s_mov_b32 s54, 401408
  s_mov_b32 s55, 0x20000
  s_mov_b32 s68, s72
  s_and_b32 s69, s73, 0xffff
  s_mov_b32 s70, 256
  s_mov_b32 s71, 0x20000
  s_waitcnt vmcnt(8)
  s_barrier
  s_add_u32 m0, s32, 32768
  s_mov_b32 s36, 256
  buffer_load_dwordx4 v2, s[12:15], s36 offen lds
  s_add_u32 m0, s33, 32768
  s_mul_i32 s36, s27, 128
  buffer_load_dwordx4 v4, s[16:19], s36 offen lds
  s_add_u32 m0, s32, 33792
  s_mov_b32 s36, 7424
  buffer_load_dwordx4 v3, s[12:15], s36 offen lds
  s_add_u32 m0, s33, 33792
  s_mul_i32 s36, s27, 132
  buffer_load_dwordx4 v4, s[16:19], s36 offen lds
  s_add_u32 m0, s32, 34816
  s_mov_b32 s36, 14592
  buffer_load_dwordx4 v2, s[12:15], s36 offen lds
  s_add_u32 m0, s33, 34816
  s_mul_i32 s36, s27, 136
  buffer_load_dwordx4 v4, s[16:19], s36 offen lds
  s_add_u32 m0, s32, 35840
  s_mov_b32 s36, 21760
  buffer_load_dwordx4 v3, s[12:15], s36 offen lds
  s_add_u32 m0, s33, 35840
  s_mul_i32 s36, s27, 140
  buffer_load_dwordx4 v4, s[16:19], s36 offen lds
  s_waitcnt vmcnt(8)
  s_barrier
  s_add_u32 m0, s32, 49152
  s_mov_b32 s36, 384
  buffer_load_dwordx4 v2, s[12:15], s36 offen lds
  s_add_u32 m0, s33, 49152
  s_mul_i32 s36, s27, 192
  buffer_load_dwordx4 v4, s[16:19], s36 offen lds
  s_add_u32 m0, s32, 50176
  s_mov_b32 s36, 7552
  buffer_load_dwordx4 v3, s[12:15], s36 offen lds
  s_add_u32 m0, s33, 50176
  s_mul_i32 s36, s27, 196
  buffer_load_dwordx4 v4, s[16:19], s36 offen lds
  s_add_u32 m0, s32, 51200
  s_mov_b32 s36, 14720
  buffer_load_dwordx4 v2, s[12:15], s36 offen lds
  s_add_u32 m0, s33, 51200
  s_mul_i32 s36, s27, 200
  buffer_load_dwordx4 v4, s[16:19], s36 offen lds
  s_add_u32 m0, s32, 52224
  s_mov_b32 s36, 21888
  buffer_load_dwordx4 v3, s[12:15], s36 offen lds
  s_add_u32 m0, s33, 52224
  s_mul_i32 s36, s27, 204
  buffer_load_dwordx4 v4, s[16:19], s36 offen lds
  s_add_u32 m0, s32, 0
  s_mov_b32 s36, 512
  buffer_load_dwordx4 v2, s[12:15], s36 offen lds
  s_add_u32 m0, s33, 0
  s_mul_i32 s36, s27, 256
  buffer_load_dwordx4 v4, s[16:19], s36 offen lds
  s_add_u32 m0, s32, 1024
  s_mov_b32 s36, 7680
  buffer_load_dwordx4 v3, s[12:15], s36 offen lds
  s_add_u32 m0, s33, 1024
  s_mul_i32 s36, s27, 260
  buffer_load_dwordx4 v4, s[16:19], s36 offen lds
  s_add_u32 m0, s32, 2048
  s_mov_b32 s36, 14848
  buffer_load_dwordx4 v2, s[12:15], s36 offen lds
  s_add_u32 m0, s33, 2048
  s_mul_i32 s36, s27, 264
  buffer_load_dwordx4 v4, s[16:19], s36 offen lds
  s_add_u32 m0, s32, 3072
  s_mov_b32 s36, 22016
  buffer_load_dwordx4 v3, s[12:15], s36 offen lds
  s_add_u32 m0, s33, 3072
  s_mul_i32 s36, s27, 268
  buffer_load_dwordx4 v4, s[16:19], s36 offen lds
  s_waitcnt vmcnt(16)
  s_barrier
  s_add_u32 m0, s32, 16384
  s_mov_b32 s36, 640
  buffer_load_dwordx4 v2, s[12:15], s36 offen lds
  s_add_u32 m0, s33, 16384
  s_mul_i32 s36, s27, 320
  buffer_load_dwordx4 v4, s[16:19], s36 offen lds
  s_add_u32 m0, s32, 17408
  s_mov_b32 s36, 7808
  buffer_load_dwordx4 v3, s[12:15], s36 offen lds
  s_add_u32 m0, s33, 17408
  s_mul_i32 s36, s27, 324
  buffer_load_dwordx4 v4, s[16:19], s36 offen lds
  s_add_u32 m0, s32, 18432
  s_mov_b32 s36, 14976
  buffer_load_dwordx4 v2, s[12:15], s36 offen lds
  s_add_u32 m0, s33, 18432
  s_mul_i32 s36, s27, 328
  buffer_load_dwordx4 v4, s[16:19], s36 offen lds
  s_add_u32 m0, s32, 19456
  s_mov_b32 s36, 22144
  buffer_load_dwordx4 v3, s[12:15], s36 offen lds
  s_add_u32 m0, s33, 19456
  s_mul_i32 s36, s27, 332
  buffer_load_dwordx4 v4, s[16:19], s36 offen lds
  s_waitcnt vmcnt(16)
  s_barrier
  s_add_u32 m0, s32, 32768
  s_mov_b32 s36, 768
  buffer_load_dwordx4 v2, s[12:15], s36 offen lds
  s_add_u32 m0, s33, 32768
  s_mul_i32 s36, s27, 384
  buffer_load_dwordx4 v4, s[16:19], s36 offen lds
  s_add_u32 m0, s32, 33792
  s_mov_b32 s36, 7936
  buffer_load_dwordx4 v3, s[12:15], s36 offen lds
  s_add_u32 m0, s33, 33792
  s_mul_i32 s36, s27, 388
  buffer_load_dwordx4 v4, s[16:19], s36 offen lds
  s_add_u32 m0, s32, 34816
  s_mov_b32 s36, 15104
  buffer_load_dwordx4 v2, s[12:15], s36 offen lds
  s_add_u32 m0, s33, 34816
  s_mul_i32 s36, s27, 392
  buffer_load_dwordx4 v4, s[16:19], s36 offen lds
  s_add_u32 m0, s32, 35840
  s_mov_b32 s36, 22272
  buffer_load_dwordx4 v3, s[12:15], s36 offen lds
  s_add_u32 m0, s33, 35840
  s_mul_i32 s36, s27, 396
  buffer_load_dwordx4 v4, s[16:19], s36 offen lds
  s_add_u32 s47, s59, 0
  s_min_u32 s47, s47, 1604608
  buffer_load_dwordx4 v[252:255], v251, s[76:79], s47 offen
  s_add_u32 s47, s59, 1048576
  s_min_u32 s47, s47, 1604608
  buffer_load_dwordx4 v[252:255], v251, s[76:79], s47 offen
  s_add_u32 s47, s59, 0
  s_min_u32 s47, s47, 400384
  buffer_load_dwordx4 v[252:255], v251, s[52:55], s47 offen
  s_add_u32 s47, s58, 0
  s_min_u32 s47, s47, 1604608
  buffer_load_dwordx4 v[252:255], v251, s[64:67], s47 offen
  s_add_u32 s47, s58, 131072
  s_min_u32 s47, s47, 1604608
  buffer_load_dwordx4 v[252:255], v251, s[64:67], s47 offen
  s_waitcnt vmcnt(21)
  s_barrier
  s_add_u32 s47, s58, 262144
  s_min_u32 s47, s47, 1604608
  buffer_load_dwordx4 v[252:255], v251, s[64:67], s47 offen
  s_add_u32 s47, s58, 393216
  s_min_u32 s47, s47, 1604608
  buffer_load_dwordx4 v[252:255], v251, s[64:67], s47 offen
  s_add_u32 s47, s58, 524288
  s_min_u32 s47, s47, 1604608
  buffer_load_dwordx4 v[252:255], v251, s[64:67], s47 offen
  s_add_u32 s47, s58, 655360
  s_min_u32 s47, s47, 1604608
  buffer_load_dwordx4 v[252:255], v251, s[64:67], s47 offen
  s_add_u32 s47, s58, 786432
  s_min_u32 s47, s47, 1604608
  buffer_load_dwordx4 v[252:255], v251, s[64:67], s47 offen
  s_waitcnt vmcnt(18)
  s_barrier
  v_and_b32 v250, 31, v1
  v_lshlrev_b32 v249, 2, v250
  buffer_load_dword v250, v249, s[68:71], 0 offen sc1
  s_add_u32 s47, s58, 917504
  s_min_u32 s47, s47, 1604608
  buffer_load_dwordx4 v[252:255], v251, s[64:67], s47 offen
  s_add_u32 s47, s58, 1048576
  s_min_u32 s47, s47, 1604608
  buffer_load_dwordx4 v[252:255], v251, s[64:67], s47 offen
  s_add_u32 s47, s58, 1179648
  s_min_u32 s47, s47, 1604608
  buffer_load_dwordx4 v[252:255], v251, s[64:67], s47 offen
  s_add_u32 s47, s58, 1310720
  s_min_u32 s47, s47, 1604608
  buffer_load_dwordx4 v[252:255], v251, s[64:67], s47 offen
  s_add_u32 s47, s58, 1441792
  s_min_u32 s47, s47, 1604608
  buffer_load_dwordx4 v[252:255], v251, s[64:67], s47 offen
  s_waitcnt vmcnt(16)
  s_barrier
  s_add_u32 s47, s58, 1572864
  s_min_u32 s47, s47, 1604608
  buffer_load_dwordx4 v[252:255], v251, s[64:67], s47 offen
  s_add_u32 s47, s58, 0
  s_min_u32 s47, s47, 400384
  buffer_load_dwordx4 v[252:255], v251, s[60:63], s47 offen
  s_add_u32 s47, s58, 131072
  s_min_u32 s47, s47, 400384
  buffer_load_dwordx4 v[252:255], v251, s[60:63], s47 offen
  s_add_u32 s47, s58, 262144
  s_min_u32 s47, s47, 400384
  buffer_load_dwordx4 v[252:255], v251, s[60:63], s47 offen
  s_add_u32 s47, s58, 393216
  s_min_u32 s47, s47, 400384
  buffer_load_dwordx4 v[252:255], v251, s[60:63], s47 offen
  s_waitcnt vmcnt(10)
  v_cmp_ne_u32 vcc, s3, v250
  s_nop 0
  s_cmp_eq_u64 vcc, 0
  s_cbranch_scc1 arrok_1
  s_mov_b64 s[72:73], -1
  s_mov_b32 s36, 0
poll_2:
  buffer_load_dword v250, v249, s[68:71], 0 offen sc1
  s_add_u32 s36, s36, 1
  s_waitcnt vmcnt(0)
  v_cmp_ne_u32 vcc, s3, v250
  s_cmp_gt_u32 s36, 1048576
  s_cbranch_scc1 pollx_3
  s_and_b64 vcc, vcc, s[72:73]
  s_cbranch_scc0 pollx_3
  s_nop 15
  s_nop 15
  s_nop 15
  s_nop 15
  s_nop 15
  s_nop 15
  s_nop 15
  s_nop 15
  s_nop 15
  s_nop 15
  s_nop 15
  s_nop 15
  s_nop 15
  s_nop 15
  s_nop 15
  s_nop 15
  s_nop 15
  s_nop 15
  s_nop 15
  s_nop 15
  s_nop 15
  s_nop 15
  s_nop 15
  s_nop 15
  s_nop 15
  s_nop 15
  s_nop 15
  s_nop 15
  s_nop 15
  s_nop 15
  s_nop 15
  s_nop 15
  s_branch poll_2
pollx_3:
arrok_1:
  s_load_dwordx2 s[4:5], s[0:1], 0
  s_load_dwordx2 s[6:7], s[0:1], 16
  s_load_dwordx4 s[12:15], s[0:1], 40
  s_load_dwordx4 s[16:19], s[0:1], 56
  s_load_dwordx2 s[20:21], s[0:1], 80
  v_and_b32 v2, 63, v0
  v_lshrrev_b32 v5, 6, v0
  v_lshlrev_b32 v1, 4, v2
  v_readfirstlane_b32 s36, v5
  s_mov_b32 s33, 0
  s_waitcnt lgkmcnt(0)
  s_mov_b32 s8, s20
  s_and_b32 s9, s21, 0xffff
  s_mov_b32 s10, 22020096
  s_mov_b32 s11, 0x20000
  s_mov_b32 s40, s4
  s_and_b32 s41, s5, 0xffff
  s_mov_b32 s42, 1835008
  s_mov_b32 s43, 0x20000
  s_mov_b32 s56, s6
  s_and_b32 s57, s7, 0xffff
  s_mov_b32 s58, 401408
  s_mov_b32 s59, 0x20000
  s_mov_b32 s44, s12
  s_and_b32 s45, s13, 0xffff
  s_mov_b32 s46, 401408
  s_mov_b32 s47, 0x20000
  s_mov_b32 s48, s14
  s_and_b32 s49, s15, 0xffff
  s_mov_b32 s50, 1605632
  s_mov_b32 s51, 0x20000
  s_mov_b32 s52, s16
  s_and_b32 s53, s17, 0xffff
  s_mov_b32 s54, 1605632
  s_mov_b32 s55, 0x20000
  s_mov_b32 s60, s18
  s_and_b32 s61, s19, 0xffff
  s_mov_b32 s62, 1835008
  s_mov_b32 s63, 0x20000
  s_and_b32 s32, s36, 3
  s_and_b32 s12, s2, 7
  s_lshr_b32 s13, s2, 3
  s_and_b32 s64, s13, 3
  s_lshl_b32 s36, s12, 2
  s_add_u32 s64, s64, s36
  s_lshr_b32 s65, s13, 2
  s_and_b32 s66, s13, 1
  s_lshl_b32 s36, s12, 1
  s_add_u32 s66, s66, s36
  s_lshr_b32 s67, s13, 1
  s_and_b32 s30, s32, 1
  s_lshr_b32 s31, s32, 1
  s_movk_i32 s27, 896
  s_lshl_b32 s37, s65, 7
  v_lshrrev_b32 v6, 3, v2
  v_mul_lo_u32 v4, v6, s27
  v_bfe_u32 v6, v2, 4, 1
  v_lshlrev_b32 v6, 2, v6
  v_and_b32 v7, 7, v2
  v_xor_b32 v6, v6, v7
  v_lshl_add_u32 v4, v6, 4, v4
  v_add_u32 v4, s37, v4
  v_lshrrev_b32 v5, 4, v2
  s_movk_i32 s28, 3584
  v_mul_lo_u32 v6, v5, s28
  s_mul_i32 s37, s67, 224
  v_add_u32 v6, s37, v6
  v_bfe_u32 v7, v2, 2, 2
  v_xor_b32 v7, v7, v5
  v_lshlrev_b32 v7, 2, v7
  v_and_b32 v8, 3, v2
  v_or_b32 v7, v7, v8
  v_lshl_add_u32 v9, v7, 4, v6
  s_barrier
  v_mov_b32 v14, 159764
  s_mov_b32 s35, 0
lw_4:
  ds_read_b32 v15, v14
  s_add_u32 s35, s35, 1
  s_waitcnt lgkmcnt(0)
  v_readfirstlane_b32 s34, v15
  s_cmp_gt_u32 s35, 1048576
  s_cbranch_scc1 lwx_5
  s_cmp_lt_u32 s34, 4
  s_cbranch_scc1 lw_4
lwx_5:
  s_cmp_ge_u32 s13, 28
  s_cbranch_scc1 parallel_sum__softmax_full_mha__mixer_s_mlp__prompt_kernel_no1
  s_lshl_b32 s37, s65, 7
  v_lshrrev_b32 v6, 3, v2
  v_mul_lo_u32 v4, v6, s27
  v_bfe_u32 v6, v2, 4, 1
  v_lshlrev_b32 v6, 2, v6
  v_and_b32 v7, 7, v2
  v_xor_b32 v6, v6, v7
  v_lshl_add_u32 v4, v6, 4, v4
  v_add_u32 v4, s37, v4
  s_mul_i32 s38, s32, 14336
  s_add_u32 s38, s38, 0
  s_mul_i32 s39, s32, 100352
  s_add_u32 m0, s38, 0
  s_add_u32 s36, s39, 0
  buffer_load_dwordx4 v4, s[44:47], s36 offen lds
  s_add_u32 m0, s38, 1024
  s_add_u32 s36, s39, 7168
  buffer_load_dwordx4 v4, s[44:47], s36 offen lds
  s_add_u32 m0, s38, 2048
  s_add_u32 s36, s39, 14336
  buffer_load_dwordx4 v4, s[44:47], s36 offen lds
  s_add_u32 m0, s38, 3072
  s_add_u32 s36, s39, 21504
  buffer_load_dwordx4 v4, s[44:47], s36 offen lds
  s_add_u32 m0, s38, 4096
  s_add_u32 s36, s39, 28672
  buffer_load_dwordx4 v4, s[44:47], s36 offen lds
  s_add_u32 m0, s38, 5120
  s_add_u32 s36, s39, 35840
  buffer_load_dwordx4 v4, s[44:47], s36 offen lds
  s_add_u32 m0, s38, 6144
  s_add_u32 s36, s39, 43008
  buffer_load_dwordx4 v4, s[44:47], s36 offen lds
  s_add_u32 m0, s38, 7168
  s_add_u32 s36, s39, 50176
  buffer_load_dwordx4 v4, s[44:47], s36 offen lds
  s_add_u32 m0, s38, 8192
  s_add_u32 s36, s39, 57344
  buffer_load_dwordx4 v4, s[44:47], s36 offen lds
  s_add_u32 m0, s38, 9216
  s_add_u32 s36, s39, 64512
  buffer_load_dwordx4 v4, s[44:47], s36 offen lds
  s_add_u32 m0, s38, 10240
  s_add_u32 s36, s39, 71680
  buffer_load_dwordx4 v4, s[44:47], s36 offen lds
  s_add_u32 m0, s38, 11264
  s_add_u32 s36, s39, 78848
  buffer_load_dwordx4 v4, s[44:47], s36 offen lds
  s_add_u32 m0, s38, 12288
  s_add_u32 s36, s39, 86016
  buffer_load_dwordx4 v4, s[44:47], s36 offen lds
  s_add_u32 m0, s38, 13312
  s_add_u32 s36, s39, 93184
  buffer_load_dwordx4 v4, s[44:47], s36 offen lds
  s_lshl_b32 s68, s64, 1
  s_add_u32 s68, s68, s30
  s_mul_i32 s74, s68, 28672
  s_mul_i32 s37, s31, 14336
  s_add_u32 s74, s74, s37
  s_add_u32 s74, s74, 7340032
  s_mul_i32 s38, s32, 25600
  s_add_u32 m0, s38, 57344
  s_mul_i32 s39, s32, 358400
  s_add_u32 s39, s39, 0
  buffer_load_dwordx4 v9, s[48:51], s39 offen lds
  s_mul_i32 s38, s32, 25600
  s_add_u32 m0, s38, 58368
  s_mul_i32 s39, s32, 358400
  s_add_u32 s39, s39, 14336
  buffer_load_dwordx4 v9, s[48:51], s39 offen lds
  s_mul_i32 s38, s32, 25600
  s_add_u32 m0, s38, 59392
  s_mul_i32 s39, s32, 358400
  s_add_u32 s39, s39, 28672
  buffer_load_dwordx4 v9, s[48:51], s39 offen lds
  s_mul_i32 s38, s32, 25600
  s_add_u32 m0, s38, 60416
  s_mul_i32 s39, s32, 358400
  s_add_u32 s39, s39, 43008
  buffer_load_dwordx4 v9, s[48:51], s39 offen lds
  s_mul_i32 s38, s32, 25600
  s_add_u32 m0, s38, 61440
  s_mul_i32 s39, s32, 358400
  s_add_u32 s39, s39, 57344
  buffer_load_dwordx4 v9, s[48:51], s39 offen lds
  s_mul_i32 s38, s32, 25600
  s_add_u32 m0, s38, 62464
  s_mul_i32 s39, s32, 358400
  s_add_u32 s39, s39, 71680
  buffer_load_dwordx4 v9, s[48:51], s39 offen lds
  s_mul_i32 s38, s32, 25600
  s_add_u32 m0, s38, 63488
  s_mul_i32 s39, s32, 358400
  s_add_u32 s39, s39, 86016
  buffer_load_dwordx4 v9, s[48:51], s39 offen lds
  s_mul_i32 s38, s32, 25600
  s_add_u32 m0, s38, 64512
  s_mul_i32 s39, s32, 358400
  s_add_u32 s39, s39, 100352
  buffer_load_dwordx4 v9, s[48:51], s39 offen lds
  s_mul_i32 s38, s32, 25600
  s_add_u32 m0, s38, 65536
  s_mul_i32 s39, s32, 358400
  s_add_u32 s39, s39, 114688
  buffer_load_dwordx4 v9, s[48:51], s39 offen lds
  s_mul_i32 s38, s32, 25600
  s_add_u32 m0, s38, 66560
  s_mul_i32 s39, s32, 358400
  s_add_u32 s39, s39, 129024
  buffer_load_dwordx4 v9, s[48:51], s39 offen lds
  s_mul_i32 s38, s32, 25600
  s_add_u32 m0, s38, 67584
  s_mul_i32 s39, s32, 358400
  s_add_u32 s39, s39, 143360
  buffer_load_dwordx4 v9, s[48:51], s39 offen lds
  s_mul_i32 s38, s32, 25600
  s_add_u32 m0, s38, 68608
  s_mul_i32 s39, s32, 358400
  s_add_u32 s39, s39, 157696
  buffer_load_dwordx4 v9, s[48:51], s39 offen lds
  s_mul_i32 s38, s32, 25600
  s_add_u32 m0, s38, 69632
  s_mul_i32 s39, s32, 358400
  s_add_u32 s39, s39, 172032
  buffer_load_dwordx4 v9, s[48:51], s39 offen lds
  s_mul_i32 s38, s32, 25600
  s_add_u32 m0, s38, 70656
  s_mul_i32 s39, s32, 358400
  s_add_u32 s39, s39, 186368
  buffer_load_dwordx4 v9, s[48:51], s39 offen lds
  s_mul_i32 s38, s32, 25600
  s_add_u32 m0, s38, 71680
  s_mul_i32 s39, s32, 358400
  s_add_u32 s39, s39, 200704
  buffer_load_dwordx4 v9, s[48:51], s39 offen lds
  s_mul_i32 s38, s32, 25600
  s_add_u32 m0, s38, 72704
  s_mul_i32 s39, s32, 358400
  s_add_u32 s39, s39, 215040
  buffer_load_dwordx4 v9, s[48:51], s39 offen lds
  s_lshl_b32 s22, s68, 7
  s_add_u32 s22, s22, 929792
  v_min_u32 v3, 15, v2
  v_lshlrev_b32 v3, 2, v3
  v_add_u32 v3, s22, v3
  s_mov_b32 s24, 0xffff
  s_mov_b32 s25, 0
  s_mov_b32 s34, 0
poll_6:
  buffer_load_dword v56, v3, s[8:11], 0 offen sc1
  s_add_u32 s34, s34, 1
  s_waitcnt vmcnt(0)
  v_cmp_ne_u32 vcc, s3, v56
  s_cmp_gt_u32 s34, 1048576
  s_cbranch_scc1 pollx_7
  s_and_b64 vcc, vcc, s[24:25]
  s_cbranch_scc0 pollx_7
  s_nop 15
  s_nop 15
  s_nop 15
  s_nop 15
  s_nop 15
  s_nop 15
  s_nop 15
  s_nop 15
  s_nop 15
  s_nop 15
  s_nop 15
  s_nop 15
  s_nop 15
  s_nop 15
  s_nop 15
  s_nop 15
  s_nop 15
  s_nop 15
  s_nop 15
  s_nop 15
  s_nop 15
  s_nop 15
  s_nop 15
  s_nop 15
  s_nop 15
  s_nop 15
  s_nop 15
  s_nop 15
  s_nop 15
  s_nop 15
  s_nop 15
  s_nop 15
  s_branch poll_6
pollx_7:
  buffer_load_dwordx4 v[64:67], v1, s[8:11], s74 offen offset:0 sc1
  buffer_load_dwordx4 v[68:71], v1, s[8:11], s74 offen offset:1024 sc1
  buffer_load_dwordx4 v[72:75], v1, s[8:11], s74 offen offset:2048 sc1
  buffer_load_dwordx4 v[76:79], v1, s[8:11], s74 offen offset:3072 sc1
  s_add_u32 s74, s74, 4096
  buffer_load_dwordx4 v[80:83], v1, s[8:11], s74 offen offset:0 sc1
  buffer_load_dwordx4 v[84:87], v1, s[8:11], s74 offen offset:1024 sc1
  buffer_load_dwordx4 v[88:91], v1, s[8:11], s74 offen offset:2048 sc1
  buffer_load_dwordx4 v[92:95], v1, s[8:11], s74 offen offset:3072 sc1
  s_add_u32 s74, s74, 4096
  buffer_load_dwordx4 v[96:99], v1, s[8:11], s74 offen offset:0 sc1
  buffer_load_dwordx4 v[100:103], v1, s[8:11], s74 offen offset:1024 sc1
  buffer_load_dwordx4 v[104:107], v1, s[8:11], s74 offen offset:2048 sc1
  buffer_load_dwordx4 v[108:111], v1, s[8:11], s74 offen offset:3072 sc1
  s_add_u32 s74, s74, 4096
  buffer_load_dwordx4 v[112:115], v1, s[8:11], s74 offen offset:0 sc1
  buffer_load_dwordx4 v[116:119], v1, s[8:11], s74 offen offset:1024 sc1
  s_lshl_b32 s69, s68, 5
  s_lshl_b32 s70, s65, 7
  s_lshl_b32 s37, s31, 6
  s_add_u32 s70, s70, s37
  v_lshrrev_b32 v6, 2, v2
  v_add_u32 v6, s69, v6
  s_movk_i32 s36, 896
  v_mul_lo_u32 v50, v6, s36
  v_bfe_u32 v6, v2, 4, 2
  v_and_b32 v7, 3, v2
  v_xor_b32 v6, v6, v7
  v_lshl_add_u32 v50, v6, 4, v50
  v_add_u32 v50, s70, v50
  s_movk_i32 s36, 14336
  buffer_load_dwordx4 v[40:43], v50, s[40:43], 0 offen
  buffer_load_dwordx4 v[44:47], v50, s[40:43], s36 offen
  v_and_b32 v6, 31, v2
  v_add_u32 v6, s69, v6
  v_lshlrev_b32 v51, 3, v6
  s_xor_b32 s29, s31, 1
  s_mul_i32 s26, s31, 28672
  s_add_u32 s26, s26, 0
  v_lshrrev_b32 v6, 5, v2
  v_lshlrev_b32 v6, 2, v6
  v_bfe_u32 v7, v2, 2, 2
  v_add_u32 v6, v6, v7
  v_lshlrev_b32 v6, 7, v6
  v_bfe_u32 v7, v2, 3, 1
  v_xor_b32 v7, s31, v7
  v_lshl_add_u32 v6, v7, 6, v6
  v_bfe_u32 v7, v2, 4, 1
  v_lshl_add_u32 v6, v7, 5, v6
  v_and_b32 v7, 3, v2
  v_lshl_add_u32 v6, v7, 3, v6
  v_add_u32 v10, s26, v6
  v_lshrrev_b32 v6, 5, v2
  v_lshlrev_b32 v6, 2, v6
  v_bfe_u32 v7, v2, 2, 2
  v_add_u32 v6, v6, v7
  v_lshlrev_b32 v6, 7, v6
  v_bfe_u32 v7, v2, 3, 1
  v_xor_b32 v7, s29, v7
  v_lshl_add_u32 v6, v7, 6, v6
  v_bfe_u32 v7, v2, 4, 1
  v_lshl_add_u32 v6, v7, 5, v6
  v_and_b32 v7, 3, v2
  v_lshl_add_u32 v6, v7, 3, v6
  v_add_u32 v11, s26, v6
  v_lshrrev_b32 v5, 4, v2
  s_movk_i32 s28, 3584
  v_mul_lo_u32 v6, v5, s28
  s_mul_i32 s37, s67, 224
  v_add_u32 v6, s37, v6
  v_bfe_u32 v7, v2, 2, 2
  v_xor_b32 v7, v7, v5
  v_lshlrev_b32 v7, 2, v7
  v_and_b32 v8, 3, v2
  v_or_b32 v7, v7, v8
  v_lshl_add_u32 v9, v7, 4, v6
  v_mov_b32 v14, 159748
  v_mov_b32 v15, 1
  s_add_u32 s33, s33, 4
  s_waitcnt lgkmcnt(0)
  s_mov_b32 exec_lo, 1
  s_mov_b32 exec_hi, 0
  ds_add_u32 v14, v15
  s_mov_b32 exec_lo, -1
  s_mov_b32 exec_hi, -1
  s_mov_b32 s35, 0
sb_8:
  ds_read_b32 v15, v14
  s_add_u32 s35, s35, 1
  s_waitcnt lgkmcnt(0)
  v_readfirstlane_b32 s34, v15
  s_cmp_gt_u32 s35, 1048576
  s_cbranch_scc1 sbx_9
  s_cmp_lt_u32 s34, s33
  s_cbranch_scc1 sb_8
sbx_9:
  ds_read_b64_tr_b16 v[16:17], v10 offset:0
  ds_read_b64_tr_b16 v[18:19], v10 offset:1024
  ds_read_b64_tr_b16 v[20:21], v11 offset:0
  ds_read_b64_tr_b16 v[22:23], v11 offset:1024
  ds_read_b64_tr_b16 v[24:25], v10 offset:2048
  ds_read_b64_tr_b16 v[26:27], v10 offset:3072
  ds_read_b64_tr_b16 v[28:29], v11 offset:2048
  ds_read_b64_tr_b16 v[30:31], v11 offset:3072
  s_waitcnt vmcnt(15) lgkmcnt(6)
  v_mfma_f32_32x32x16_bf16 v[128:143], v[16:19], v[64:67], 0
  ds_read_b64_tr_b16 v[32:33], v10 offset:4096
  ds_read_b64_tr_b16 v[34:35], v10 offset:5120
  s_mov_b32 s36, 65536
  buffer_load_dwordx2 v[48:49], v51, s[8:11], s36 offen sc1
  s_waitcnt lgkmcnt(6)
  v_mfma_f32_32x32x16_bf16 v[144:159], v[20:23], v[64:67], 0
  ds_read_b64_tr_b16 v[36:37], v11 offset:4096
  ds_read_b64_tr_b16 v[38:39], v11 offset:5120
  s_mul_i32 s38, s32, 25600
  s_add_u32 m0, s38, 73728
  s_mul_i32 s39, s32, 358400
  s_add_u32 s39, s39, 229376
  buffer_load_dwordx4 v9, s[48:51], s39 offen lds
  s_waitcnt vmcnt(16) lgkmcnt(6)
  v_mfma_f32_32x32x16_bf16 v[128:143], v[24:27], v[68:71], v[128:143]
  ds_read_b64_tr_b16 v[16:17], v10 offset:6144
  ds_read_b64_tr_b16 v[18:19], v10 offset:7168
  s_mul_i32 s38, s32, 25600
  s_add_u32 m0, s38, 74752
  s_mul_i32 s39, s32, 358400
  s_add_u32 s39, s39, 243712
  buffer_load_dwordx4 v9, s[48:51], s39 offen lds
  s_waitcnt lgkmcnt(6)
  v_mfma_f32_32x32x16_bf16 v[144:159], v[28:31], v[68:71], v[144:159]
  ds_read_b64_tr_b16 v[20:21], v11 offset:6144
  ds_read_b64_tr_b16 v[22:23], v11 offset:7168
  s_mul_i32 s38, s32, 25600
  s_add_u32 m0, s38, 75776
  s_mul_i32 s39, s32, 358400
  s_add_u32 s39, s39, 258048
  buffer_load_dwordx4 v9, s[48:51], s39 offen lds
  s_waitcnt vmcnt(17) lgkmcnt(6)
  v_mfma_f32_32x32x16_bf16 v[128:143], v[32:35], v[72:75], v[128:143]
  ds_read_b64_tr_b16 v[24:25], v10 offset:8192
  ds_read_b64_tr_b16 v[26:27], v10 offset:9216
  s_mul_i32 s38, s32, 25600
  s_add_u32 m0, s38, 76800
  s_mul_i32 s39, s32, 358400
  s_add_u32 s39, s39, 272384
  buffer_load_dwordx4 v9, s[48:51], s39 offen lds
  s_waitcnt lgkmcnt(6)
  v_mfma_f32_32x32x16_bf16 v[144:159], v[36:39], v[72:75], v[144:159]
  ds_read_b64_tr_b16 v[28:29], v11 offset:8192
  ds_read_b64_tr_b16 v[30:31], v11 offset:9216
  s_mul_i32 s38, s32, 25600
  s_add_u32 m0, s38, 77824
  s_mul_i32 s39, s32, 358400
  s_add_u32 s39, s39, 286720
  buffer_load_dwordx4 v9, s[48:51], s39 offen lds
  s_waitcnt vmcnt(18) lgkmcnt(6)
  v_mfma_f32_32x32x16_bf16 v[128:143], v[16:19], v[76:79], v[128:143]
  ds_read_b64_tr_b16 v[32:33], v10 offset:10240
  ds_read_b64_tr_b16 v[34:35], v10 offset:11264
  s_mul_i32 s38, s32, 25600
  s_add_u32 m0, s38, 78848
  s_mul_i32 s39, s32, 358400
  s_add_u32 s39, s39, 301056
  buffer_load_dwordx4 v9, s[48:51], s39 offen lds
  s_waitcnt lgkmcnt(6)
  v_mfma_f32_32x32x16_bf16 v[144:159], v[20:23], v[76:79], v[144:159]
  ds_read_b64_tr_b16 v[36:37], v11 offset:10240
  ds_read_b64_tr_b16 v[38:39], v11 offset:11264
  s_mul_i32 s38, s32, 25600
  s_add_u32 m0, s38, 79872
  s_mul_i32 s39, s32, 358400
  s_add_u32 s39, s39, 315392
  buffer_load_dwordx4 v9, s[48:51], s39 offen lds
  s_waitcnt vmcnt(19) lgkmcnt(6)
  v_mfma_f32_32x32x16_bf16 v[128:143], v[24:27], v[80:83], v[128:143]
  ds_read_b64_tr_b16 v[16:17], v10 offset:12288
  ds_read_b64_tr_b16 v[18:19], v10 offset:13312
  s_mul_i32 s38, s32, 25600
  s_add_u32 m0, s38, 80896
  s_mul_i32 s39, s32, 358400
  s_add_u32 s39, s39, 329728
  buffer_load_dwordx4 v9, s[48:51], s39 offen lds
  s_waitcnt lgkmcnt(6)
  v_mfma_f32_32x32x16_bf16 v[144:159], v[28:31], v[80:83], v[144:159]
  ds_read_b64_tr_b16 v[20:21], v11 offset:12288
  ds_read_b64_tr_b16 v[22:23], v11 offset:13312
  s_mul_i32 s38, s32, 25600
  s_add_u32 m0, s38, 81920
  s_mul_i32 s39, s32, 358400
  s_add_u32 s39, s39, 344064
  buffer_load_dwordx4 v9, s[48:51], s39 offen lds
  s_waitcnt vmcnt(20) lgkmcnt(6)
  v_mfma_f32_32x32x16_bf16 v[128:143], v[32:35], v[84:87], v[128:143]
  ds_read_b64_tr_b16 v[24:25], v10 offset:14336
  ds_read_b64_tr_b16 v[26:27], v10 offset:15360
  s_waitcnt lgkmcnt(6)
  v_mfma_f32_32x32x16_bf16 v[144:159], v[36:39], v[84:87], v[144:159]
  ds_read_b64_tr_b16 v[28:29], v11 offset:14336
  ds_read_b64_tr_b16 v[30:31], v11 offset:15360
  s_waitcnt vmcnt(19) lgkmcnt(6)
  v_mfma_f32_32x32x16_bf16 v[128:143], v[16:19], v[88:91], v[128:143]
  ds_read_b64_tr_b16 v[32:33], v10 offset:16384
  ds_read_b64_tr_b16 v[34:35], v10 offset:17408
  s_waitcnt lgkmcnt(6)
  v_mfma_f32_32x32x16_bf16 v[144:159], v[20:23], v[88:91], v[144:159]
  ds_read_b64_tr_b16 v[36:37], v11 offset:16384
  ds_read_b64_tr_b16 v[38:39], v11 offset:17408
  s_waitcnt vmcnt(18) lgkmcnt(6)
  v_mfma_f32_32x32x16_bf16 v[128:143], v[24:27], v[92:95], v[128:143]
  ds_read_b64_tr_b16 v[16:17], v10 offset:18432
  ds_read_b64_tr_b16 v[18:19], v10 offset:19456
  s_waitcnt lgkmcnt(6)
  v_mfma_f32_32x32x16_bf16 v[144:159], v[28:31], v[92:95], v[144:159]
  ds_read_b64_tr_b16 v[20:21], v11 offset:18432
  ds_read_b64_tr_b16 v[22:23], v11 offset:19456
  s_waitcnt vmcnt(17) lgkmcnt(6)
  v_mfma_f32_32x32x16_bf16 v[128:143], v[32:35], v[96:99], v[128:143]
  ds_read_b64_tr_b16 v[24:25], v10 offset:20480
  ds_read_b64_tr_b16 v[26:27], v10 offset:21504
  s_waitcnt lgkmcnt(6)
  v_mfma_f32_32x32x16_bf16 v[144:159], v[36:39], v[96:99], v[144:159]
  ds_read_b64_tr_b16 v[28:29], v11 offset:20480
  ds_read_b64_tr_b16 v[30:31], v11 offset:21504
  s_waitcnt vmcnt(16) lgkmcnt(6)
  v_mfma_f32_32x32x16_bf16 v[128:143], v[16:19], v[100:103], v[128:143]
  ds_read_b64_tr_b16 v[32:33], v10 offset:22528
  ds_read_b64_tr_b16 v[34:35], v10 offset:23552
  s_waitcnt lgkmcnt(6)
  v_mfma_f32_32x32x16_bf16 v[144:159], v[20:23], v[100:103], v[144:159]
  ds_read_b64_tr_b16 v[36:37], v11 offset:22528
  ds_read_b64_tr_b16 v[38:39], v11 offset:23552
  s_waitcnt vmcnt(15) lgkmcnt(6)
  v_mfma_f32_32x32x16_bf16 v[128:143], v[24:27], v[104:107], v[128:143]
  ds_read_b64_tr_b16 v[16:17], v10 offset:24576
  ds_read_b64_tr_b16 v[18:19], v10 offset:25600
  s_waitcnt lgkmcnt(6)
  v_mfma_f32_32x32x16_bf16 v[144:159], v[28:31], v[104:107], v[144:159]
  ds_read_b64_tr_b16 v[20:21], v11 offset:24576
  ds_read_b64_tr_b16 v[22:23], v11 offset:25600
  s_waitcnt vmcnt(14) lgkmcnt(6)
  v_mfma_f32_32x32x16_bf16 v[128:143], v[32:35], v[108:111], v[128:143]
  ds_read_b64_tr_b16 v[24:25], v10 offset:26624
  ds_read_b64_tr_b16 v[26:27], v10 offset:27648
  s_waitcnt lgkmcnt(6)
  v_mfma_f32_32x32x16_bf16 v[144:159], v[36:39], v[108:111], v[144:159]
  ds_read_b64_tr_b16 v[28:29], v11 offset:26624
  ds_read_b64_tr_b16 v[30:31], v11 offset:27648
  s_waitcnt vmcnt(13) lgkmcnt(6)
  v_mfma_f32_32x32x16_bf16 v[128:143], v[16:19], v[112:115], v[128:143]
  s_waitcnt lgkmcnt(4)
  v_mfma_f32_32x32x16_bf16 v[144:159], v[20:23], v[112:115], v[144:159]
  s_waitcnt vmcnt(12) lgkmcnt(2)
  v_mfma_f32_32x32x16_bf16 v[128:143], v[24:27], v[116:119], v[128:143]
  s_waitcnt lgkmcnt(0)
  v_mfma_f32_32x32x16_bf16 v[144:159], v[28:31], v[116:119], v[144:159]
  s_xor_b32 s36, s32, 2
  s_lshl_b32 s36, s36, 12
  s_add_u32 s36, s36, 0
  v_add_u32 v12, s36, v1
  s_lshl_b32 s36, s32, 12
  s_add_u32 s36, s36, 0
  v_add_u32 v13, s36, v1
  s_waitcnt vmcnt(9)
  v_mov_b32 v14, 159748
  v_mov_b32 v15, 1
  s_add_u32 s33, s33, 4
  s_waitcnt lgkmcnt(0)
  s_mov_b32 exec_lo, 1
  s_mov_b32 exec_hi, 0
  ds_add_u32 v14, v15
  s_mov_b32 exec_lo, -1
  s_mov_b32 exec_hi, -1
  s_mov_b32 s35, 0
sb_10:
  ds_read_b32 v15, v14
  s_add_u32 s35, s35, 1
  s_waitcnt lgkmcnt(0)
  v_readfirstlane_b32 s34, v15
  s_cmp_gt_u32 s35, 1048576
  s_cbranch_scc1 sbx_11
  s_cmp_lt_u32 s34, s33
  s_cbranch_scc1 sb_10
sbx_11:
  s_lshl_b32 s36, s32, 11
  s_add_u32 s36, s36, 16384
  v_add_u32 v6, s36, v1
  v_and_b32 v7, 31, v2
  v_lshlrev_b32 v7, 6, v7
  v_bfe_u32 v8, v2, 2, 2
  ds_write_b128 v6, v[40:43]
  ds_write_b128 v6, v[44:47] offset:1024
  v_lshrrev_b32 v6, 5, v2
  v_xor_b32 v8, v8, v6
  v_lshl_add_u32 v7, v8, 4, v7
  v_add_u32 v7, s36, v7
  v_xor_b32 v8, 32, v7
  ds_read_b128 v[40:43], v7
  ds_read_b128 v[44:47], v8
  ds_write_b128 v12, v[144:147] offset:0
  ds_write_b128 v12, v[148:151] offset:1024
  ds_write_b128 v12, v[152:155] offset:2048
  ds_write_b128 v12, v[156:159] offset:3072
  v_mul_f32 v50, v48, v49
  v_sub_f32 v50, 0, v50
  s_waitcnt lgkmcnt(4)
  v_permlane32_swap_b32 v40, v42
  v_permlane32_swap_b32 v41, v43
  v_permlane32_swap_b32 v44, v46
  v_permlane32_swap_b32 v45, v47
  s_nop 1
  v_lshlrev_b32 v96, 16, v40
  v_and_b32 v97, 0xffff0000, v40
  v_lshlrev_b32 v98, 16, v41
  v_and_b32 v99, 0xffff0000, v41
  v_lshlrev_b32 v100, 16, v42
  v_and_b32 v101, 0xffff0000, v42
  v_lshlrev_b32 v102, 16, v43
  v_and_b32 v103, 0xffff0000, v43
  v_lshlrev_b32 v104, 16, v44
  v_and_b32 v105, 0xffff0000, v44
  v_lshlrev_b32 v106, 16, v45
  v_and_b32 v107, 0xffff0000, v45
  v_lshlrev_b32 v108, 16, v46
  v_and_b32 v109, 0xffff0000, v46
  v_lshlrev_b32 v110, 16, v47
  v_and_b32 v111, 0xffff0000, v47
  v_fma_f32 v96, v96, v49, v50
  v_fma_f32 v97, v97, v49, v50
  v_fma_f32 v98, v98, v49, v50
  v_fma_f32 v99, v99, v49, v50
  v_fma_f32 v100, v100, v49, v50
  v_fma_f32 v101, v101, v49, v50
  v_fma_f32 v102, v102, v49, v50
  v_fma_f32 v103, v103, v49, v50
  v_fma_f32 v104, v104, v49, v50
  v_fma_f32 v105, v105, v49, v50
  v_fma_f32 v106, v106, v49, v50
  v_fma_f32 v107, v107, v49, v50
  v_fma_f32 v108, v108, v49, v50
  v_fma_f32 v109, v109, v49, v50
  v_fma_f32 v110, v110, v49, v50
  v_fma_f32 v111, v111, v49, v50
  v_add_f32 v128, v128, v96
  v_add_f32 v129, v129, v97
  v_add_f32 v130, v130, v98
  v_add_f32 v131, v131, v99
  v_add_f32 v132, v132, v100
  v_add_f32 v133, v133, v101
  v_add_f32 v134, v134, v102
  v_add_f32 v135, v135, v103
  v_add_f32 v136, v136, v104
  v_add_f32 v137, v137, v105
  v_add_f32 v138, v138, v106
  v_add_f32 v139, v139, v107
  v_add_f32 v140, v140, v108
  v_add_f32 v141, v141, v109
  v_add_f32 v142, v142, v110
  v_add_f32 v143, v143, v111
  v_mov_b32 v14, 159748
  v_mov_b32 v15, 1
  s_add_u32 s33, s33, 4
  s_waitcnt lgkmcnt(0)
  s_mov_b32 exec_lo, 1
  s_mov_b32 exec_hi, 0
  ds_add_u32 v14, v15
  s_mov_b32 exec_lo, -1
  s_mov_b32 exec_hi, -1
  s_mov_b32 s35, 0
sb_12:
  ds_read_b32 v15, v14
  s_add_u32 s35, s35, 1
  s_waitcnt lgkmcnt(0)
  v_readfirstlane_b32 s34, v15
  s_cmp_gt_u32 s35, 1048576
  s_cbranch_scc1 sbx_13
  s_cmp_lt_u32 s34, s33
  s_cbranch_scc1 sb_12
sbx_13:
  ds_read_b128 v[144:147], v13 offset:0
  ds_read_b128 v[148:151], v13 offset:1024
  ds_read_b128 v[152:155], v13 offset:2048
  ds_read_b128 v[156:159], v13 offset:3072
  s_waitcnt lgkmcnt(3)
  v_add_f32 v128, v128, v144
  v_add_f32 v129, v129, v145
  v_add_f32 v130, v130, v146
  v_add_f32 v131, v131, v147
  s_waitcnt lgkmcnt(2)
  v_add_f32 v132, v132, v148
  v_add_f32 v133, v133, v149
  v_add_f32 v134, v134, v150
  v_add_f32 v135, v135, v151
  s_waitcnt lgkmcnt(1)
  v_add_f32 v136, v136, v152
  v_add_f32 v137, v137, v153
  v_add_f32 v138, v138, v154
  v_add_f32 v139, v139, v155
  s_waitcnt lgkmcnt(0)
  v_add_f32 v140, v140, v156
  v_add_f32 v141, v141, v157
  v_add_f32 v142, v142, v158
  v_add_f32 v143, v143, v159
  v_cvt_pk_bf16_f32 v56, v128, v129
  v_cvt_pk_bf16_f32 v57, v130, v131
  v_cvt_pk_bf16_f32 v58, v132, v133
  v_cvt_pk_bf16_f32 v59, v134, v135
  v_cvt_pk_bf16_f32 v60, v136, v137
  v_cvt_pk_bf16_f32 v61, v138, v139
  v_cvt_pk_bf16_f32 v62, v140, v141
  v_cvt_pk_bf16_f32 v63, v142, v143
  s_mul_i32 s36, s68, 28672
  s_lshl_b32 s37, s65, 12
  s_add_u32 s36, s36, s37
  s_lshl_b32 s37, s31, 11
  s_add_u32 s36, s36, s37
  s_add_u32 s36, s36, 9437184
  buffer_store_dwordx4 v[56:59], v1, s[8:11], s36 offen offset:0 sc1
  buffer_store_dwordx4 v[60:63], v1, s[8:11], s36 offen offset:1024 sc1
  v_mov_b32 v52, 0
  v_mov_b32 v53, 0
  v_mov_b32 v54, 0
  v_mov_b32 v55, 0
  v_add_f32 v52, v52, v128
  v_fma_f32 v53, v128, v128, v53
  v_add_f32 v54, v54, v129
  v_fma_f32 v55, v129, v129, v55
  v_add_f32 v52, v52, v130
  v_fma_f32 v53, v130, v130, v53
  v_add_f32 v54, v54, v131
  v_fma_f32 v55, v131, v131, v55
  v_add_f32 v52, v52, v132
  v_fma_f32 v53, v132, v132, v53
  v_add_f32 v54, v54, v133
  v_fma_f32 v55, v133, v133, v55
  v_add_f32 v52, v52, v134
  v_fma_f32 v53, v134, v134, v53
  v_add_f32 v54, v54, v135
  v_fma_f32 v55, v135, v135, v55
  v_add_f32 v52, v52, v136
  v_fma_f32 v53, v136, v136, v53
  v_add_f32 v54, v54, v137
  v_fma_f32 v55, v137, v137, v55
  v_add_f32 v52, v52, v138
  v_fma_f32 v53, v138, v138, v53
  v_add_f32 v54, v54, v139
  v_fma_f32 v55, v139, v139, v55
  v_add_f32 v52, v52, v140
  v_fma_f32 v53, v140, v140, v53
  v_add_f32 v54, v54, v141
  v_fma_f32 v55, v141, v141, v55
  v_add_f32 v52, v52, v142
  v_fma_f32 v53, v142, v142, v53
  v_add_f32 v54, v54, v143
  v_fma_f32 v55, v143, v143, v55
  v_add_f32 v52, v52, v54
  v_add_f32 v53, v53, v55
  v_mov_b32 v54, v52
  v_mov_b32 v55, v53
  s_nop 1
  v_permlane32_swap_b32 v54, v52
  v_permlane32_swap_b32 v55, v53
  s_nop 1
  v_add_f32 v54, v54, v52
  v_add_f32 v55, v55, v53
  s_mul_i32 s36, s68, 14
  s_lshl_b32 s37, s65, 1
  s_add_u32 s36, s36, s37
  s_add_u32 s36, s36, s31
  s_lshl_b32 s36, s36, 8
  s_add_u32 s36, s36, 131072
  v_and_b32 v6, 31, v2
  v_lshlrev_b32 v6, 3, v6
  s_mov_b32 exec_hi, 0
  buffer_store_dwordx2 v[54:55], v6, s[8:11], s36 offen sc1
  s_mov_b32 exec_hi, -1
  v_mov_b32 v14, 159752
  v_mov_b32 v15, 1
  s_waitcnt lgkmcnt(0)
  s_mov_b32 exec_lo, 1
  s_mov_b32 exec_hi, 0
  ds_add_u32 v14, v15
  s_mov_b32 exec_lo, -1
  s_mov_b32 exec_hi, -1
  s_lshl_b32 s26, s68, 11
  s_lshl_b32 s37, s65, 1
  s_add_u32 s37, s37, s31
  s_lshl_b32 s37, s37, 2
  s_add_u32 s26, s26, s37
  s_add_u32 s26, s26, 524288
  s_waitcnt vmcnt(0)
  v_lshlrev_b32 v14, 7, v2
  v_mov_b32 v15, s3
  s_mov_b32 exec_lo, 65535
  s_mov_b32 exec_hi, 0
  buffer_store_dword v15, v14, s[8:11], s26 offen sc1
  s_mov_b32 exec_lo, -1
  s_mov_b32 exec_hi, -1
  s_mul_i32 s38, s32, 3072
  s_add_u32 m0, s38, 32768
  s_mul_i32 s39, s32, 43008
  s_add_u32 s39, s39, 1433600
  buffer_load_dwordx4 v9, s[48:51], s39 offen lds
  s_mul_i32 s38, s32, 3072
  s_add_u32 m0, s38, 33792
  s_mul_i32 s39, s32, 43008
  s_add_u32 s39, s39, 1447936
  buffer_load_dwordx4 v9, s[48:51], s39 offen lds
  s_mul_i32 s38, s32, 3072
  s_add_u32 m0, s38, 34816
  s_mul_i32 s39, s32, 43008
  s_add_u32 s39, s39, 1462272
  buffer_load_dwordx4 v9, s[48:51], s39 offen lds
  s_branch parallel_sum__softmax_full_mha__mixer_s_mlp__prompt_kernel_g2
parallel_sum__softmax_full_mha__mixer_s_mlp__prompt_kernel_no1:
  v_mov_b32 v14, 159752
  v_mov_b32 v15, 1
  s_waitcnt lgkmcnt(0)
  s_mov_b32 exec_lo, 1
  s_mov_b32 exec_hi, 0
  ds_add_u32 v14, v15
  s_mov_b32 exec_lo, -1
  s_mov_b32 exec_hi, -1
  v_lshrrev_b32 v5, 4, v2
  s_movk_i32 s28, 3584
  v_mul_lo_u32 v6, v5, s28
  s_mul_i32 s37, s67, 224
  v_add_u32 v6, s37, v6
  v_bfe_u32 v7, v2, 2, 2
  v_xor_b32 v7, v7, v5
  v_lshlrev_b32 v7, 2, v7
  v_and_b32 v8, 3, v2
  v_or_b32 v7, v7, v8
  v_lshl_add_u32 v9, v7, 4, v6
  v_mov_b32 v14, 159764
  s_mov_b32 s35, 0
lw_14:
  ds_read_b32 v15, v14
  s_add_u32 s35, s35, 1
  s_waitcnt lgkmcnt(0)
  v_readfirstlane_b32 s34, v15
  s_cmp_gt_u32 s35, 1048576
  s_cbranch_scc1 lwx_15
  s_cmp_lt_u32 s34, 4
  s_cbranch_scc1 lw_14
lwx_15:
  s_mul_i32 s38, s32, 25600
  s_add_u32 m0, s38, 57344
  s_mul_i32 s39, s32, 358400
  s_add_u32 s39, s39, 0
  buffer_load_dwordx4 v9, s[48:51], s39 offen lds
  s_mul_i32 s38, s32, 25600
  s_add_u32 m0, s38, 58368
  s_mul_i32 s39, s32, 358400
  s_add_u32 s39, s39, 14336
  buffer_load_dwordx4 v9, s[48:51], s39 offen lds
  s_mul_i32 s38, s32, 25600
  s_add_u32 m0, s38, 59392
  s_mul_i32 s39, s32, 358400
  s_add_u32 s39, s39, 28672
  buffer_load_dwordx4 v9, s[48:51], s39 offen lds
  s_mul_i32 s38, s32, 25600
  s_add_u32 m0, s38, 60416
  s_mul_i32 s39, s32, 358400
  s_add_u32 s39, s39, 43008
  buffer_load_dwordx4 v9, s[48:51], s39 offen lds
  s_mul_i32 s38, s32, 25600
  s_add_u32 m0, s38, 61440
  s_mul_i32 s39, s32, 358400
  s_add_u32 s39, s39, 57344
  buffer_load_dwordx4 v9, s[48:51], s39 offen lds
  s_mul_i32 s38, s32, 25600
  s_add_u32 m0, s38, 62464
  s_mul_i32 s39, s32, 358400
  s_add_u32 s39, s39, 71680
  buffer_load_dwordx4 v9, s[48:51], s39 offen lds
  s_mul_i32 s38, s32, 25600
  s_add_u32 m0, s38, 63488
  s_mul_i32 s39, s32, 358400
  s_add_u32 s39, s39, 86016
  buffer_load_dwordx4 v9, s[48:51], s39 offen lds
  s_mul_i32 s38, s32, 25600
  s_add_u32 m0, s38, 64512
  s_mul_i32 s39, s32, 358400
  s_add_u32 s39, s39, 100352
  buffer_load_dwordx4 v9, s[48:51], s39 offen lds
  s_mul_i32 s38, s32, 25600
  s_add_u32 m0, s38, 65536
  s_mul_i32 s39, s32, 358400
  s_add_u32 s39, s39, 114688
  buffer_load_dwordx4 v9, s[48:51], s39 offen lds
  s_mul_i32 s38, s32, 25600
  s_add_u32 m0, s38, 66560
  s_mul_i32 s39, s32, 358400
  s_add_u32 s39, s39, 129024
  buffer_load_dwordx4 v9, s[48:51], s39 offen lds
  s_mul_i32 s38, s32, 25600
  s_add_u32 m0, s38, 67584
  s_mul_i32 s39, s32, 358400
  s_add_u32 s39, s39, 143360
  buffer_load_dwordx4 v9, s[48:51], s39 offen lds
  s_mul_i32 s38, s32, 25600
  s_add_u32 m0, s38, 68608
  s_mul_i32 s39, s32, 358400
  s_add_u32 s39, s39, 157696
  buffer_load_dwordx4 v9, s[48:51], s39 offen lds
  s_mul_i32 s38, s32, 25600
  s_add_u32 m0, s38, 69632
  s_mul_i32 s39, s32, 358400
  s_add_u32 s39, s39, 172032
  buffer_load_dwordx4 v9, s[48:51], s39 offen lds
  s_mul_i32 s38, s32, 25600
  s_add_u32 m0, s38, 70656
  s_mul_i32 s39, s32, 358400
  s_add_u32 s39, s39, 186368
  buffer_load_dwordx4 v9, s[48:51], s39 offen lds
  s_mul_i32 s38, s32, 25600
  s_add_u32 m0, s38, 71680
  s_mul_i32 s39, s32, 358400
  s_add_u32 s39, s39, 200704
  buffer_load_dwordx4 v9, s[48:51], s39 offen lds
  s_mul_i32 s38, s32, 25600
  s_add_u32 m0, s38, 72704
  s_mul_i32 s39, s32, 358400
  s_add_u32 s39, s39, 215040
  buffer_load_dwordx4 v9, s[48:51], s39 offen lds
  s_mul_i32 s38, s32, 25600
  s_add_u32 m0, s38, 73728
  s_mul_i32 s39, s32, 358400
  s_add_u32 s39, s39, 229376
  buffer_load_dwordx4 v9, s[48:51], s39 offen lds
  s_mul_i32 s38, s32, 25600
  s_add_u32 m0, s38, 74752
  s_mul_i32 s39, s32, 358400
  s_add_u32 s39, s39, 243712
  buffer_load_dwordx4 v9, s[48:51], s39 offen lds
  s_mul_i32 s38, s32, 25600
  s_add_u32 m0, s38, 75776
  s_mul_i32 s39, s32, 358400
  s_add_u32 s39, s39, 258048
  buffer_load_dwordx4 v9, s[48:51], s39 offen lds
  s_mul_i32 s38, s32, 25600
  s_add_u32 m0, s38, 76800
  s_mul_i32 s39, s32, 358400
  s_add_u32 s39, s39, 272384
  buffer_load_dwordx4 v9, s[48:51], s39 offen lds
  s_mul_i32 s38, s32, 25600
  s_add_u32 m0, s38, 77824
  s_mul_i32 s39, s32, 358400
  s_add_u32 s39, s39, 286720
  buffer_load_dwordx4 v9, s[48:51], s39 offen lds
  s_mul_i32 s38, s32, 25600
  s_add_u32 m0, s38, 78848
  s_mul_i32 s39, s32, 358400
  s_add_u32 s39, s39, 301056
  buffer_load_dwordx4 v9, s[48:51], s39 offen lds
  s_mul_i32 s38, s32, 25600
  s_add_u32 m0, s38, 79872
  s_mul_i32 s39, s32, 358400
  s_add_u32 s39, s39, 315392
  buffer_load_dwordx4 v9, s[48:51], s39 offen lds
  s_mul_i32 s38, s32, 25600
  s_add_u32 m0, s38, 80896
  s_mul_i32 s39, s32, 358400
  s_add_u32 s39, s39, 329728
  buffer_load_dwordx4 v9, s[48:51], s39 offen lds
  s_mul_i32 s38, s32, 25600
  s_add_u32 m0, s38, 81920
  s_mul_i32 s39, s32, 358400
  s_add_u32 s39, s39, 344064
  buffer_load_dwordx4 v9, s[48:51], s39 offen lds
  s_mul_i32 s38, s32, 3072
  s_add_u32 m0, s38, 32768
  s_mul_i32 s39, s32, 43008
  s_add_u32 s39, s39, 1433600
  buffer_load_dwordx4 v9, s[48:51], s39 offen lds
  s_mul_i32 s38, s32, 3072
  s_add_u32 m0, s38, 33792
  s_mul_i32 s39, s32, 43008
  s_add_u32 s39, s39, 1447936
  buffer_load_dwordx4 v9, s[48:51], s39 offen lds
  s_mul_i32 s38, s32, 3072
  s_add_u32 m0, s38, 34816
  s_mul_i32 s39, s32, 43008
  s_add_u32 s39, s39, 1462272
  buffer_load_dwordx4 v9, s[48:51], s39 offen lds
parallel_sum__softmax_full_mha__mixer_s_mlp__prompt_kernel_g2:
  s_lshl_b32 s71, s66, 2
  s_add_u32 s71, s71, s32
  s_lshl_b32 s22, s71, 4
  s_add_u32 s22, s22, s67
  s_lshl_b32 s22, s22, 7
  s_add_u32 s22, s22, 524288
  v_min_u32 v3, 15, v2
  v_lshlrev_b32 v3, 2, v3
  v_add_u32 v3, s22, v3
  s_mov_b32 s24, 0x3fff
  s_mov_b32 s25, 0
  v_lshrrev_b32 v6, 5, v2
  v_lshlrev_b32 v6, 2, v6
  v_bfe_u32 v7, v2, 2, 2
  v_add_u32 v6, v6, v7
  v_lshlrev_b32 v6, 8, v6
  v_bfe_u32 v8, v2, 4, 1
  v_lshl_add_u32 v6, v8, 5, v6
  v_and_b32 v8, 3, v2
  v_lshl_add_u32 v6, v8, 3, v6
  v_add_u32 v6, 32768, v6
  s_add_u32 s36, s32, 0
  s_and_b32 s36, s36, 3
  v_xor_b32 v8, s36, v7
  v_lshl_add_u32 v10, v8, 6, v6
  v_add_u32 v52, 0x10000, v10
  s_add_u32 s36, s32, 1
  s_and_b32 s36, s36, 3
  v_xor_b32 v8, s36, v7
  v_lshl_add_u32 v11, v8, 6, v6
  v_add_u32 v53, 0x10000, v11
  s_add_u32 s36, s32, 2
  s_and_b32 s36, s36, 3
  v_xor_b32 v8, s36, v7
  v_lshl_add_u32 v12, v8, 6, v6
  v_add_u32 v54, 0x10000, v12
  s_add_u32 s36, s32, 3
  s_and_b32 s36, s36, 3
  v_xor_b32 v8, s36, v7
  v_lshl_add_u32 v13, v8, 6, v6
  v_add_u32 v55, 0x10000, v13
  v_mov_b32 v48, 0x3f803f80
  v_mov_b32 v49, 0x3f803f80
  v_mov_b32 v50, 0x3f803f80
  v_mov_b32 v51, 0x3f803f80
  s_waitcnt vmcnt(0)
  v_mov_b32 v14, 159748
  v_mov_b32 v15, 1
  s_add_u32 s33, s33, 4
  s_waitcnt lgkmcnt(0)
  s_mov_b32 exec_lo, 1
  s_mov_b32 exec_hi, 0
  ds_add_u32 v14, v15
  s_mov_b32 exec_lo, -1
  s_mov_b32 exec_hi, -1
  s_mov_b32 s35, 0
sb_16:
  ds_read_b32 v15, v14
  s_add_u32 s35, s35, 1
  s_waitcnt lgkmcnt(0)
  v_readfirstlane_b32 s34, v15
  s_cmp_gt_u32 s35, 1048576
  s_cbranch_scc1 sbx_17
  s_cmp_lt_u32 s34, s33
  s_cbranch_scc1 sb_16
sbx_17:
  ds_read_b64_tr_b16 v[16:17], v10 offset:24576
  ds_read_b64_tr_b16 v[18:19], v10 offset:26624
  ds_read_b64_tr_b16 v[20:21], v10 offset:28672
  ds_read_b64_tr_b16 v[22:23], v10 offset:30720
  ds_read_b64_tr_b16 v[24:25], v10 offset:32768
  ds_read_b64_tr_b16 v[26:27], v10 offset:34816
  s_waitcnt lgkmcnt(4)
  v_mfma_f32_32x32x16_bf16 v[240:255], v[16:19], v[48:51], 0
  ds_read_b64_tr_b16 v[28:29], v10 offset:36864
  ds_read_b64_tr_b16 v[30:31], v10 offset:38912
  s_waitcnt lgkmcnt(4)
  v_mfma_f32_32x32x16_bf16 v[240:255], v[20:23], v[48:51], v[240:255]
  ds_read_b64_tr_b16 v[16:17], v10 offset:40960
  ds_read_b64_tr_b16 v[18:19], v10 offset:43008
  s_waitcnt lgkmcnt(4)
  v_mfma_f32_32x32x16_bf16 v[240:255], v[24:27], v[48:51], v[240:255]
  ds_read_b64_tr_b16 v[20:21], v10 offset:45056
  ds_read_b64_tr_b16 v[22:23], v10 offset:47104
  s_waitcnt lgkmcnt(4)
  v_mfma_f32_32x32x16_bf16 v[240:255], v[28:31], v[48:51], v[240:255]
  ds_read_b64_tr_b16 v[24:25], v10 offset:49152
  ds_read_b64_tr_b16 v[26:27], v10 offset:51200
  s_waitcnt lgkmcnt(4)
  v_mfma_f32_32x32x16_bf16 v[240:255], v[16:19], v[48:51], v[240:255]
  ds_read_b64_tr_b16 v[28:29], v10 offset:53248
  ds_read_b64_tr_b16 v[30:31], v10 offset:55296
  s_waitcnt lgkmcnt(4)
  v_mfma_f32_32x32x16_bf16 v[240:255], v[20:23], v[48:51], v[240:255]
  ds_read_b64_tr_b16 v[16:17], v10 offset:57344
  ds_read_b64_tr_b16 v[18:19], v10 offset:59392
  s_waitcnt lgkmcnt(4)
  v_mfma_f32_32x32x16_bf16 v[240:255], v[24:27], v[48:51], v[240:255]
  ds_read_b64_tr_b16 v[20:21], v10 offset:61440
  ds_read_b64_tr_b16 v[22:23], v10 offset:63488
  s_waitcnt lgkmcnt(4)
  v_mfma_f32_32x32x16_bf16 v[240:255], v[28:31], v[48:51], v[240:255]
  ds_read_b64_tr_b16 v[24:25], v52 offset:0
  ds_read_b64_tr_b16 v[26:27], v52 offset:2048
  s_waitcnt lgkmcnt(4)
  v_mfma_f32_32x32x16_bf16 v[240:255], v[16:19], v[48:51], v[240:255]
  ds_read_b64_tr_b16 v[28:29], v52 offset:4096
  ds_read_b64_tr_b16 v[30:31], v52 offset:6144
  s_waitcnt lgkmcnt(4)
  v_mfma_f32_32x32x16_bf16 v[240:255], v[20:23], v[48:51], v[240:255]
  ds_read_b64_tr_b16 v[16:17], v52 offset:8192
  ds_read_b64_tr_b16 v[18:19], v52 offset:10240
  s_waitcnt lgkmcnt(4)
  v_mfma_f32_32x32x16_bf16 v[240:255], v[24:27], v[48:51], v[240:255]
  ds_read_b64_tr_b16 v[20:21], v52 offset:12288
  ds_read_b64_tr_b16 v[22:23], v52 offset:14336
  s_waitcnt lgkmcnt(4)
  v_mfma_f32_32x32x16_bf16 v[240:255], v[28:31], v[48:51], v[240:255]
  ds_read_b64_tr_b16 v[24:25], v52 offset:16384
  ds_read_b64_tr_b16 v[26:27], v52 offset:18432
  s_waitcnt lgkmcnt(4)
  v_mfma_f32_32x32x16_bf16 v[240:255], v[16:19], v[48:51], v[240:255]
  ds_read_b64_tr_b16 v[28:29], v52 offset:20480
  ds_read_b64_tr_b16 v[30:31], v52 offset:22528
  s_waitcnt lgkmcnt(4)
  v_mfma_f32_32x32x16_bf16 v[240:255], v[20:23], v[48:51], v[240:255]
  ds_read_b64_tr_b16 v[16:17], v52 offset:24576
  ds_read_b64_tr_b16 v[18:19], v52 offset:26624
  s_waitcnt lgkmcnt(4)
  v_mfma_f32_32x32x16_bf16 v[240:255], v[24:27], v[48:51], v[240:255]
  ds_read_b64_tr_b16 v[20:21], v52 offset:28672
  ds_read_b64_tr_b16 v[22:23], v52 offset:30720
  s_waitcnt lgkmcnt(4)
  v_mfma_f32_32x32x16_bf16 v[240:255], v[28:31], v[48:51], v[240:255]
  ds_read_b64_tr_b16 v[24:25], v52 offset:32768
  ds_read_b64_tr_b16 v[26:27], v52 offset:34816
  s_waitcnt lgkmcnt(4)
  v_mfma_f32_32x32x16_bf16 v[240:255], v[16:19], v[48:51], v[240:255]
  ds_read_b64_tr_b16 v[28:29], v52 offset:36864
  ds_read_b64_tr_b16 v[30:31], v52 offset:38912
  s_waitcnt lgkmcnt(4)
  v_mfma_f32_32x32x16_bf16 v[240:255], v[20:23], v[48:51], v[240:255]
  ds_read_b64_tr_b16 v[16:17], v52 offset:40960
  ds_read_b64_tr_b16 v[18:19], v52 offset:43008
  s_waitcnt lgkmcnt(4)
  v_mfma_f32_32x32x16_bf16 v[240:255], v[24:27], v[48:51], v[240:255]
  ds_read_b64_tr_b16 v[20:21], v52 offset:45056
  ds_read_b64_tr_b16 v[22:23], v52 offset:47104
  s_waitcnt lgkmcnt(4)
  v_mfma_f32_32x32x16_bf16 v[240:255], v[28:31], v[48:51], v[240:255]
  ds_read_b64_tr_b16 v[24:25], v52 offset:49152
  ds_read_b64_tr_b16 v[26:27], v52 offset:51200
  s_waitcnt lgkmcnt(4)
  v_mfma_f32_32x32x16_bf16 v[240:255], v[16:19], v[48:51], v[240:255]
  ds_read_b64_tr_b16 v[28:29], v52 offset:53248
  ds_read_b64_tr_b16 v[30:31], v52 offset:55296
  s_waitcnt lgkmcnt(4)
  v_mfma_f32_32x32x16_bf16 v[240:255], v[20:23], v[48:51], v[240:255]
  ds_read_b64_tr_b16 v[16:17], v52 offset:57344
  ds_read_b64_tr_b16 v[18:19], v52 offset:59392
  s_waitcnt lgkmcnt(4)
  v_mfma_f32_32x32x16_bf16 v[240:255], v[24:27], v[48:51], v[240:255]
  ds_read_b64_tr_b16 v[20:21], v10 offset:0
  ds_read_b64_tr_b16 v[22:23], v10 offset:2048
  s_waitcnt lgkmcnt(4)
  v_mfma_f32_32x32x16_bf16 v[240:255], v[28:31], v[48:51], v[240:255]
  ds_read_b64_tr_b16 v[24:25], v10 offset:4096
  ds_read_b64_tr_b16 v[26:27], v10 offset:6144
  s_waitcnt lgkmcnt(4)
  v_mfma_f32_32x32x16_bf16 v[240:255], v[16:19], v[48:51], v[240:255]
  ds_read_b64_tr_b16 v[28:29], v10 offset:8192
  ds_read_b64_tr_b16 v[30:31], v10 offset:10240
  s_waitcnt lgkmcnt(4)
  v_mfma_f32_32x32x16_bf16 v[240:255], v[20:23], v[48:51], v[240:255]
  s_waitcnt lgkmcnt(2)
  v_mfma_f32_32x32x16_bf16 v[240:255], v[24:27], v[48:51], v[240:255]
  s_waitcnt lgkmcnt(0)
  v_mfma_f32_32x32x16_bf16 v[240:255], v[28:31], v[48:51], v[240:255]
  v_lshrrev_b32 v6, 5, v2
  v_lshlrev_b32 v6, 6, v6
  s_lshl_b32 s36, s32, 7
  s_add_u32 s36, s36, 160000
  v_add_u32 v7, s36, v6
  s_nop 7
  s_nop 3
  ds_write_b128 v7, v[240:243] offset:0
  ds_write_b128 v7, v[244:247] offset:16
  ds_write_b128 v7, v[248:251] offset:32
  ds_write_b128 v7, v[252:255] offset:48
  ds_read_b64_tr_b16 v[16:17], v10 offset:24576
  ds_read_b64_tr_b16 v[18:19], v10 offset:26624
  ds_read_b64_tr_b16 v[20:21], v11 offset:24576
  ds_read_b64_tr_b16 v[22:23], v11 offset:26624
  ds_read_b64_tr_b16 v[24:25], v12 offset:24576
  ds_read_b64_tr_b16 v[26:27], v12 offset:26624
  ds_read_b64_tr_b16 v[28:29], v13 offset:24576
  ds_read_b64_tr_b16 v[30:31], v13 offset:26624
  s_mul_i32 s36, s71, 28672
  s_add_u32 s36, s36, 9437184
  s_mul_i32 s37, s71, 3584
  s_add_u32 s37, s37, 131072
  v_and_b32 v6, 31, v2
  v_lshlrev_b32 v6, 3, v6
  v_lshrrev_b32 v7, 5, v2
  s_movk_i32 s38, 1792
  v_mul_lo_u32 v7, v7, s38
  v_add_u32 v6, v6, v7
  s_mov_b32 s34, 0
poll_18:
  buffer_load_dword v44, v3, s[8:11], 0 offen sc1
  s_add_u32 s34, s34, 1
  s_waitcnt vmcnt(0)
  v_cmp_ne_u32 vcc, s3, v44
  s_cmp_gt_u32 s34, 1048576
  s_cbranch_scc1 pollx_19
  s_and_b64 vcc, vcc, s[24:25]
  s_cbranch_scc0 pollx_19
  s_nop 15
  s_nop 15
  s_nop 15
  s_nop 15
  s_nop 15
  s_nop 15
  s_nop 15
  s_nop 15
  s_nop 15
  s_nop 15
  s_nop 15
  s_nop 15
  s_nop 15
  s_nop 15
  s_nop 15
  s_nop 15
  s_nop 15
  s_nop 15
  s_nop 15
  s_nop 15
  s_nop 15
  s_nop 15
  s_nop 15
  s_nop 15
  s_nop 15
  s_nop 15
  s_nop 15
  s_nop 15
  s_nop 15
  s_nop 15
  s_nop 15
  s_nop 15
  s_branch poll_18
pollx_19:
  buffer_load_dwordx4 v[128:131], v1, s[8:11], s36 offen offset:0 sc1
  buffer_load_dwordx4 v[132:135], v1, s[8:11], s36 offen offset:1024 sc1
  buffer_load_dwordx4 v[136:139], v1, s[8:11], s36 offen offset:2048 sc1
  buffer_load_dwordx4 v[140:143], v1, s[8:11], s36 offen offset:3072 sc1
  s_add_u32 s36, s36, 4096
  buffer_load_dwordx4 v[144:147], v1, s[8:11], s36 offen offset:0 sc1
  buffer_load_dwordx4 v[148:151], v1, s[8:11], s36 offen offset:1024 sc1
  buffer_load_dwordx4 v[152:155], v1, s[8:11], s36 offen offset:2048 sc1
  buffer_load_dwordx4 v[156:159], v1, s[8:11], s36 offen offset:3072 sc1
  s_waitcnt lgkmcnt(0)
  s_waitcnt vmcnt(7) lgkmcnt(6)
  v_mfma_f32_32x32x16_bf16 v[64:79], v[16:19], v[128:131], 0
  ds_read_b64_tr_b16 v[32:33], v10 offset:28672
  ds_read_b64_tr_b16 v[34:35], v10 offset:30720
  s_add_u32 s36, s36, 4096
  buffer_load_dwordx4 v[160:163], v1, s[8:11], s36 offen offset:0 sc1
  s_waitcnt lgkmcnt(6)
  v_mfma_f32_32x32x16_bf16 v[80:95], v[20:23], v[128:131], 0
  ds_read_b64_tr_b16 v[36:37], v11 offset:28672
  ds_read_b64_tr_b16 v[38:39], v11 offset:30720
  s_waitcnt lgkmcnt(6)
  v_mfma_f32_32x32x16_bf16 v[96:111], v[24:27], v[128:131], 0
  ds_read_b64_tr_b16 v[40:41], v12 offset:28672
  ds_read_b64_tr_b16 v[42:43], v12 offset:30720
  buffer_load_dwordx4 v[164:167], v1, s[8:11], s36 offen offset:1024 sc1
  s_waitcnt lgkmcnt(6)
  v_mfma_f32_32x32x16_bf16 v[112:127], v[28:31], v[128:131], 0
  ds_read_b64_tr_b16 v[44:45], v13 offset:28672
  ds_read_b64_tr_b16 v[46:47], v13 offset:30720
  s_waitcnt vmcnt(8) lgkmcnt(6)
  v_mfma_f32_32x32x16_bf16 v[64:79], v[32:35], v[132:135], v[64:79]
  ds_read_b64_tr_b16 v[16:17], v10 offset:32768
  ds_read_b64_tr_b16 v[18:19], v10 offset:34816
  buffer_load_dwordx4 v[168:171], v1, s[8:11], s36 offen offset:2048 sc1
  s_waitcnt lgkmcnt(6)
  v_mfma_f32_32x32x16_bf16 v[80:95], v[36:39], v[132:135], v[80:95]
  ds_read_b64_tr_b16 v[20:21], v11 offset:32768
  ds_read_b64_tr_b16 v[22:23], v11 offset:34816
  s_waitcnt lgkmcnt(6)
  v_mfma_f32_32x32x16_bf16 v[96:111], v[40:43], v[132:135], v[96:111]
  ds_read_b64_tr_b16 v[24:25], v12 offset:32768
  ds_read_b64_tr_b16 v[26:27], v12 offset:34816
  buffer_load_dwordx4 v[172:175], v1, s[8:11], s36 offen offset:3072 sc1
  s_waitcnt lgkmcnt(6)
  v_mfma_f32_32x32x16_bf16 v[112:127], v[44:47], v[132:135], v[112:127]
  ds_read_b64_tr_b16 v[28:29], v13 offset:32768
  ds_read_b64_tr_b16 v[30:31], v13 offset:34816
  s_waitcnt vmcnt(9) lgkmcnt(6)
  v_mfma_f32_32x32x16_bf16 v[64:79], v[16:19], v[136:139], v[64:79]
  ds_read_b64_tr_b16 v[32:33], v10 offset:36864
  ds_read_b64_tr_b16 v[34:35], v10 offset:38912
  s_add_u32 s36, s36, 4096
  buffer_load_dwordx4 v[176:179], v1, s[8:11], s36 offen offset:0 sc1
  s_waitcnt lgkmcnt(6)
  v_mfma_f32_32x32x16_bf16 v[80:95], v[20:23], v[136:139], v[80:95]
  ds_read_b64_tr_b16 v[36:37], v11 offset:36864
  ds_read_b64_tr_b16 v[38:39], v11 offset:38912
  s_waitcnt lgkmcnt(6)
  v_mfma_f32_32x32x16_bf16 v[96:111], v[24:27], v[136:139], v[96:111]
  ds_read_b64_tr_b16 v[40:41], v12 offset:36864
  ds_read_b64_tr_b16 v[42:43], v12 offset:38912
  buffer_load_dwordx4 v[180:183], v1, s[8:11], s36 offen offset:1024 sc1
  s_waitcnt lgkmcnt(6)
  v_mfma_f32_32x32x16_bf16 v[112:127], v[28:31], v[136:139], v[112:127]
  ds_read_b64_tr_b16 v[44:45], v13 offset:36864
  ds_read_b64_tr_b16 v[46:47], v13 offset:38912
  s_waitcnt vmcnt(10) lgkmcnt(6)
  v_mfma_f32_32x32x16_bf16 v[64:79], v[32:35], v[140:143], v[64:79]
  ds_read_b64_tr_b16 v[16:17], v10 offset:40960
  ds_read_b64_tr_b16 v[18:19], v10 offset:43008
  buffer_load_dwordx4 v[184:187], v1, s[8:11], s36 offen offset:2048 sc1
  s_waitcnt lgkmcnt(6)
  v_mfma_f32_32x32x16_bf16 v[80:95], v[36:39], v[140:143], v[80:95]
  ds_read_b64_tr_b16 v[20:21], v11 offset:40960
  ds_read_b64_tr_b16 v[22:23], v11 offset:43008
  s_waitcnt lgkmcnt(6)
  v_mfma_f32_32x32x16_bf16 v[96:111], v[40:43], v[140:143], v[96:111]
  ds_read_b64_tr_b16 v[24:25], v12 offset:40960
  ds_read_b64_tr_b16 v[26:27], v12 offset:43008
  buffer_load_dwordx4 v[188:191], v1, s[8:11], s36 offen offset:3072 sc1
  s_waitcnt lgkmcnt(6)
  v_mfma_f32_32x32x16_bf16 v[112:127], v[44:47], v[140:143], v[112:127]
  ds_read_b64_tr_b16 v[28:29], v13 offset:40960
  ds_read_b64_tr_b16 v[30:31], v13 offset:43008
  s_waitcnt vmcnt(11) lgkmcnt(6)
  v_mfma_f32_32x32x16_bf16 v[64:79], v[16:19], v[144:147], v[64:79]
  ds_read_b64_tr_b16 v[32:33], v10 offset:45056
  ds_read_b64_tr_b16 v[34:35], v10 offset:47104
  s_add_u32 s36, s36, 4096
  buffer_load_dwordx4 v[192:195], v1, s[8:11], s36 offen offset:0 sc1
  s_waitcnt lgkmcnt(6)
  v_mfma_f32_32x32x16_bf16 v[80:95], v[20:23], v[144:147], v[80:95]
  ds_read_b64_tr_b16 v[36:37], v11 offset:45056
  ds_read_b64_tr_b16 v[38:39], v11 offset:47104
  s_waitcnt lgkmcnt(6)
  v_mfma_f32_32x32x16_bf16 v[96:111], v[24:27], v[144:147], v[96:111]
  ds_read_b64_tr_b16 v[40:41], v12 offset:45056
  ds_read_b64_tr_b16 v[42:43], v12 offset:47104
  buffer_load_dwordx4 v[196:199], v1, s[8:11], s36 offen offset:1024 sc1
  s_waitcnt lgkmcnt(6)
  v_mfma_f32_32x32x16_bf16 v[112:127], v[28:31], v[144:147], v[112:127]
  ds_read_b64_tr_b16 v[44:45], v13 offset:45056
  ds_read_b64_tr_b16 v[46:47], v13 offset:47104
  s_waitcnt vmcnt(12) lgkmcnt(6)
  v_mfma_f32_32x32x16_bf16 v[64:79], v[32:35], v[148:151], v[64:79]
  ds_read_b64_tr_b16 v[16:17], v10 offset:49152
  ds_read_b64_tr_b16 v[18:19], v10 offset:51200
  buffer_load_dwordx4 v[200:203], v1, s[8:11], s36 offen offset:2048 sc1
  s_waitcnt lgkmcnt(6)
  v_mfma_f32_32x32x16_bf16 v[80:95], v[36:39], v[148:151], v[80:95]
  ds_read_b64_tr_b16 v[20:21], v11 offset:49152
  ds_read_b64_tr_b16 v[22:23], v11 offset:51200
  s_waitcnt lgkmcnt(6)
  v_mfma_f32_32x32x16_bf16 v[96:111], v[40:43], v[148:151], v[96:111]
  ds_read_b64_tr_b16 v[24:25], v12 offset:49152
  ds_read_b64_tr_b16 v[26:27], v12 offset:51200
  buffer_load_dwordx4 v[204:207], v1, s[8:11], s36 offen offset:3072 sc1
  s_waitcnt lgkmcnt(6)
  v_mfma_f32_32x32x16_bf16 v[112:127], v[44:47], v[148:151], v[112:127]
  ds_read_b64_tr_b16 v[28:29], v13 offset:49152
  ds_read_b64_tr_b16 v[30:31], v13 offset:51200
  s_waitcnt vmcnt(13) lgkmcnt(6)
  v_mfma_f32_32x32x16_bf16 v[64:79], v[16:19], v[152:155], v[64:79]
  ds_read_b64_tr_b16 v[32:33], v10 offset:53248
  ds_read_b64_tr_b16 v[34:35], v10 offset:55296
  s_add_u32 s36, s36, 4096
  buffer_load_dwordx4 v[208:211], v1, s[8:11], s36 offen offset:0 sc1
  s_waitcnt lgkmcnt(6)
  v_mfma_f32_32x32x16_bf16 v[80:95], v[20:23], v[152:155], v[80:95]
  ds_read_b64_tr_b16 v[36:37], v11 offset:53248
  ds_read_b64_tr_b16 v[38:39], v11 offset:55296
  s_waitcnt lgkmcnt(6)
  v_mfma_f32_32x32x16_bf16 v[96:111], v[24:27], v[152:155], v[96:111]
  ds_read_b64_tr_b16 v[40:41], v12 offset:53248
  ds_read_b64_tr_b16 v[42:43], v12 offset:55296
  buffer_load_dwordx4 v[212:215], v1, s[8:11], s36 offen offset:1024 sc1
  s_waitcnt lgkmcnt(6)
  v_mfma_f32_32x32x16_bf16 v[112:127], v[28:31], v[152:155], v[112:127]
  ds_read_b64_tr_b16 v[44:45], v13 offset:53248
  ds_read_b64_tr_b16 v[46:47], v13 offset:55296
  s_waitcnt vmcnt(14) lgkmcnt(6)
  v_mfma_f32_32x32x16_bf16 v[64:79], v[32:35], v[156:159], v[64:79]
  ds_read_b64_tr_b16 v[16:17], v10 offset:57344
  ds_read_b64_tr_b16 v[18:19], v10 offset:59392
  buffer_load_dwordx4 v[216:219], v1, s[8:11], s36 offen offset:2048 sc1
  s_waitcnt lgkmcnt(6)
  v_mfma_f32_32x32x16_bf16 v[80:95], v[36:39], v[156:159], v[80:95]
  ds_read_b64_tr_b16 v[20:21], v11 offset:57344
  ds_read_b64_tr_b16 v[22:23], v11 offset:59392
  s_waitcnt lgkmcnt(6)
  v_mfma_f32_32x32x16_bf16 v[96:111], v[40:43], v[156:159], v[96:111]
  ds_read_b64_tr_b16 v[24:25], v12 offset:57344
  ds_read_b64_tr_b16 v[26:27], v12 offset:59392
  buffer_load_dwordx4 v[220:223], v1, s[8:11], s36 offen offset:3072 sc1
  s_waitcnt lgkmcnt(6)
  v_mfma_f32_32x32x16_bf16 v[112:127], v[44:47], v[156:159], v[112:127]
  ds_read_b64_tr_b16 v[28:29], v13 offset:57344
  ds_read_b64_tr_b16 v[30:31], v13 offset:59392
  s_waitcnt vmcnt(15) lgkmcnt(6)
  v_mfma_f32_32x32x16_bf16 v[64:79], v[16:19], v[160:163], v[64:79]
  ds_read_b64_tr_b16 v[32:33], v10 offset:61440
  ds_read_b64_tr_b16 v[34:35], v10 offset:63488
  s_add_u32 s36, s36, 4096
  buffer_load_dwordx4 v[224:227], v1, s[8:11], s36 offen offset:0 sc1
  s_waitcnt lgkmcnt(6)
  v_mfma_f32_32x32x16_bf16 v[80:95], v[20:23], v[160:163], v[80:95]
  ds_read_b64_tr_b16 v[36:37], v11 offset:61440
  ds_read_b64_tr_b16 v[38:39], v11 offset:63488
  s_waitcnt lgkmcnt(6)
  v_mfma_f32_32x32x16_bf16 v[96:111], v[24:27], v[160:163], v[96:111]
  ds_read_b64_tr_b16 v[40:41], v12 offset:61440
  ds_read_b64_tr_b16 v[42:43], v12 offset:63488
  buffer_load_dwordx4 v[228:231], v1, s[8:11], s36 offen offset:1024 sc1
  s_waitcnt lgkmcnt(6)
  v_mfma_f32_32x32x16_bf16 v[112:127], v[28:31], v[160:163], v[112:127]
  ds_read_b64_tr_b16 v[44:45], v13 offset:61440
  ds_read_b64_tr_b16 v[46:47], v13 offset:63488
  s_waitcnt vmcnt(16) lgkmcnt(6)
  v_mfma_f32_32x32x16_bf16 v[64:79], v[32:35], v[164:167], v[64:79]
  ds_read_b64_tr_b16 v[16:17], v52 offset:0
  ds_read_b64_tr_b16 v[18:19], v52 offset:2048
  buffer_load_dwordx4 v[232:235], v1, s[8:11], s36 offen offset:2048 sc1
  s_waitcnt lgkmcnt(6)
  v_mfma_f32_32x32x16_bf16 v[80:95], v[36:39], v[164:167], v[80:95]
  ds_read_b64_tr_b16 v[20:21], v53 offset:0
  ds_read_b64_tr_b16 v[22:23], v53 offset:2048
  s_waitcnt lgkmcnt(6)
  v_mfma_f32_32x32x16_bf16 v[96:111], v[40:43], v[164:167], v[96:111]
  ds_read_b64_tr_b16 v[24:25], v54 offset:0
  ds_read_b64_tr_b16 v[26:27], v54 offset:2048
  buffer_load_dwordx4 v[236:239], v1, s[8:11], s36 offen offset:3072 sc1
  s_waitcnt lgkmcnt(6)
  v_mfma_f32_32x32x16_bf16 v[112:127], v[44:47], v[164:167], v[112:127]
  ds_read_b64_tr_b16 v[28:29], v55 offset:0
  ds_read_b64_tr_b16 v[30:31], v55 offset:2048
  s_waitcnt vmcnt(17) lgkmcnt(6)
  v_mfma_f32_32x32x16_bf16 v[64:79], v[16:19], v[168:171], v[64:79]
  ds_read_b64_tr_b16 v[32:33], v52 offset:4096
  ds_read_b64_tr_b16 v[34:35], v52 offset:6144
  buffer_load_dwordx2 v[240:241], v6, s[8:11], s37 offen offset:0 sc1
  buffer_load_dwordx2 v[242:243], v6, s[8:11], s37 offen offset:256 sc1
  buffer_load_dwordx2 v[244:245], v6, s[8:11], s37 offen offset:512 sc1
  buffer_load_dwordx2 v[246:247], v6, s[8:11], s37 offen offset:768 sc1
  buffer_load_dwordx2 v[248:249], v6, s[8:11], s37 offen offset:1024 sc1
  buffer_load_dwordx2 v[250:251], v6, s[8:11], s37 offen offset:1280 sc1
  buffer_load_dwordx2 v[252:253], v6, s[8:11], s37 offen offset:1536 sc1
  s_waitcnt lgkmcnt(6)
  v_mfma_f32_32x32x16_bf16 v[80:95], v[20:23], v[168:171], v[80:95]
  ds_read_b64_tr_b16 v[36:37], v53 offset:4096
  ds_read_b64_tr_b16 v[38:39], v53 offset:6144
  s_waitcnt lgkmcnt(6)
  v_mfma_f32_32x32x16_bf16 v[96:111], v[24:27], v[168:171], v[96:111]
  ds_read_b64_tr_b16 v[40:41], v54 offset:4096
  ds_read_b64_tr_b16 v[42:43], v54 offset:6144
  s_waitcnt lgkmcnt(6)
  v_mfma_f32_32x32x16_bf16 v[112:127], v[28:31], v[168:171], v[112:127]
  ds_read_b64_tr_b16 v[44:45], v55 offset:4096
  ds_read_b64_tr_b16 v[46:47], v55 offset:6144
  s_waitcnt vmcnt(23) lgkmcnt(6)
  v_mfma_f32_32x32x16_bf16 v[64:79], v[32:35], v[172:175], v[64:79]
  ds_read_b64_tr_b16 v[16:17], v52 offset:8192
  ds_read_b64_tr_b16 v[18:19], v52 offset:10240
  s_waitcnt lgkmcnt(6)
  v_mfma_f32_32x32x16_bf16 v[80:95], v[36:39], v[172:175], v[80:95]
  ds_read_b64_tr_b16 v[20:21], v53 offset:8192
  ds_read_b64_tr_b16 v[22:23], v53 offset:10240
  s_waitcnt lgkmcnt(6)
  v_mfma_f32_32x32x16_bf16 v[96:111], v[40:43], v[172:175], v[96:111]
  ds_read_b64_tr_b16 v[24:25], v54 offset:8192
  ds_read_b64_tr_b16 v[26:27], v54 offset:10240
  s_waitcnt lgkmcnt(6)
  v_mfma_f32_32x32x16_bf16 v[112:127], v[44:47], v[172:175], v[112:127]
  ds_read_b64_tr_b16 v[28:29], v55 offset:8192
  ds_read_b64_tr_b16 v[30:31], v55 offset:10240
  s_waitcnt vmcnt(22) lgkmcnt(6)
  v_mfma_f32_32x32x16_bf16 v[64:79], v[16:19], v[176:179], v[64:79]
  ds_read_b64_tr_b16 v[32:33], v52 offset:12288
  ds_read_b64_tr_b16 v[34:35], v52 offset:14336
  s_waitcnt lgkmcnt(6)
  v_mfma_f32_32x32x16_bf16 v[80:95], v[20:23], v[176:179], v[80:95]
  ds_read_b64_tr_b16 v[36:37], v53 offset:12288
  ds_read_b64_tr_b16 v[38:39], v53 offset:14336
  s_waitcnt lgkmcnt(6)
  v_mfma_f32_32x32x16_bf16 v[96:111], v[24:27], v[176:179], v[96:111]
  ds_read_b64_tr_b16 v[40:41], v54 offset:12288
  ds_read_b64_tr_b16 v[42:43], v54 offset:14336
  s_waitcnt lgkmcnt(6)
  v_mfma_f32_32x32x16_bf16 v[112:127], v[28:31], v[176:179], v[112:127]
  ds_read_b64_tr_b16 v[44:45], v55 offset:12288
  ds_read_b64_tr_b16 v[46:47], v55 offset:14336
  s_waitcnt vmcnt(21) lgkmcnt(6)
  v_mfma_f32_32x32x16_bf16 v[64:79], v[32:35], v[180:183], v[64:79]
  ds_read_b64_tr_b16 v[16:17], v52 offset:16384
  ds_read_b64_tr_b16 v[18:19], v52 offset:18432
  s_waitcnt lgkmcnt(6)
  v_mfma_f32_32x32x16_bf16 v[80:95], v[36:39], v[180:183], v[80:95]
  ds_read_b64_tr_b16 v[20:21], v53 offset:16384
  ds_read_b64_tr_b16 v[22:23], v53 offset:18432
  s_waitcnt lgkmcnt(6)
  v_mfma_f32_32x32x16_bf16 v[96:111], v[40:43], v[180:183], v[96:111]
  ds_read_b64_tr_b16 v[24:25], v54 offset:16384
  ds_read_b64_tr_b16 v[26:27], v54 offset:18432
  s_waitcnt lgkmcnt(6)
  v_mfma_f32_32x32x16_bf16 v[112:127], v[44:47], v[180:183], v[112:127]
  ds_read_b64_tr_b16 v[28:29], v55 offset:16384
  ds_read_b64_tr_b16 v[30:31], v55 offset:18432
  s_waitcnt vmcnt(20) lgkmcnt(6)
  v_mfma_f32_32x32x16_bf16 v[64:79], v[16:19], v[184:187], v[64:79]
  ds_read_b64_tr_b16 v[32:33], v52 offset:20480
  ds_read_b64_tr_b16 v[34:35], v52 offset:22528
  s_waitcnt lgkmcnt(6)
  v_mfma_f32_32x32x16_bf16 v[80:95], v[20:23], v[184:187], v[80:95]
  ds_read_b64_tr_b16 v[36:37], v53 offset:20480
  ds_read_b64_tr_b16 v[38:39], v53 offset:22528
  s_waitcnt lgkmcnt(6)
  v_mfma_f32_32x32x16_bf16 v[96:111], v[24:27], v[184:187], v[96:111]
  ds_read_b64_tr_b16 v[40:41], v54 offset:20480
  ds_read_b64_tr_b16 v[42:43], v54 offset:22528
  s_waitcnt lgkmcnt(6)
  v_mfma_f32_32x32x16_bf16 v[112:127], v[28:31], v[184:187], v[112:127]
  ds_read_b64_tr_b16 v[44:45], v55 offset:20480
  ds_read_b64_tr_b16 v[46:47], v55 offset:22528
  s_waitcnt vmcnt(19) lgkmcnt(6)
  v_mfma_f32_32x32x16_bf16 v[64:79], v[32:35], v[188:191], v[64:79]
  ds_read_b64_tr_b16 v[16:17], v52 offset:24576
  ds_read_b64_tr_b16 v[18:19], v52 offset:26624
  s_waitcnt lgkmcnt(6)
  v_mfma_f32_32x32x16_bf16 v[80:95], v[36:39], v[188:191], v[80:95]
  ds_read_b64_tr_b16 v[20:21], v53 offset:24576
  ds_read_b64_tr_b16 v[22:23], v53 offset:26624
  s_waitcnt lgkmcnt(6)
  v_mfma_f32_32x32x16_bf16 v[96:111], v[40:43], v[188:191], v[96:111]
  ds_read_b64_tr_b16 v[24:25], v54 offset:24576
  ds_read_b64_tr_b16 v[26:27], v54 offset:26624
  s_waitcnt lgkmcnt(6)
  v_mfma_f32_32x32x16_bf16 v[112:127], v[44:47], v[188:191], v[112:127]
  ds_read_b64_tr_b16 v[28:29], v55 offset:24576
  ds_read_b64_tr_b16 v[30:31], v55 offset:26624
  s_waitcnt vmcnt(18) lgkmcnt(6)
  v_mfma_f32_32x32x16_bf16 v[64:79], v[16:19], v[192:195], v[64:79]
  ds_read_b64_tr_b16 v[32:33], v52 offset:28672
  ds_read_b64_tr_b16 v[34:35], v52 offset:30720
  s_waitcnt lgkmcnt(6)
  v_mfma_f32_32x32x16_bf16 v[80:95], v[20:23], v[192:195], v[80:95]
  ds_read_b64_tr_b16 v[36:37], v53 offset:28672
  ds_read_b64_tr_b16 v[38:39], v53 offset:30720
  s_waitcnt lgkmcnt(6)
  v_mfma_f32_32x32x16_bf16 v[96:111], v[24:27], v[192:195], v[96:111]
  ds_read_b64_tr_b16 v[40:41], v54 offset:28672
  ds_read_b64_tr_b16 v[42:43], v54 offset:30720
  s_waitcnt lgkmcnt(6)
  v_mfma_f32_32x32x16_bf16 v[112:127], v[28:31], v[192:195], v[112:127]
  ds_read_b64_tr_b16 v[44:45], v55 offset:28672
  ds_read_b64_tr_b16 v[46:47], v55 offset:30720
  s_waitcnt vmcnt(17) lgkmcnt(6)
  v_mfma_f32_32x32x16_bf16 v[64:79], v[32:35], v[196:199], v[64:79]
  ds_read_b64_tr_b16 v[16:17], v52 offset:32768
  ds_read_b64_tr_b16 v[18:19], v52 offset:34816
  s_waitcnt lgkmcnt(6)
  v_mfma_f32_32x32x16_bf16 v[80:95], v[36:39], v[196:199], v[80:95]
  ds_read_b64_tr_b16 v[20:21], v53 offset:32768
  ds_read_b64_tr_b16 v[22:23], v53 offset:34816
  s_waitcnt lgkmcnt(6)
  v_mfma_f32_32x32x16_bf16 v[96:111], v[40:43], v[196:199], v[96:111]
  ds_read_b64_tr_b16 v[24:25], v54 offset:32768
  ds_read_b64_tr_b16 v[26:27], v54 offset:34816
  s_waitcnt lgkmcnt(6)
  v_mfma_f32_32x32x16_bf16 v[112:127], v[44:47], v[196:199], v[112:127]
  ds_read_b64_tr_b16 v[28:29], v55 offset:32768
  ds_read_b64_tr_b16 v[30:31], v55 offset:34816
  s_waitcnt vmcnt(16) lgkmcnt(6)
  v_mfma_f32_32x32x16_bf16 v[64:79], v[16:19], v[200:203], v[64:79]
  ds_read_b64_tr_b16 v[32:33], v52 offset:36864
  ds_read_b64_tr_b16 v[34:35], v52 offset:38912
  s_waitcnt lgkmcnt(6)
  v_mfma_f32_32x32x16_bf16 v[80:95], v[20:23], v[200:203], v[80:95]
  ds_read_b64_tr_b16 v[36:37], v53 offset:36864
  ds_read_b64_tr_b16 v[38:39], v53 offset:38912
  s_waitcnt lgkmcnt(6)
  v_mfma_f32_32x32x16_bf16 v[96:111], v[24:27], v[200:203], v[96:111]
  ds_read_b64_tr_b16 v[40:41], v54 offset:36864
  ds_read_b64_tr_b16 v[42:43], v54 offset:38912
  s_waitcnt lgkmcnt(6)
  v_mfma_f32_32x32x16_bf16 v[112:127], v[28:31], v[200:203], v[112:127]
  ds_read_b64_tr_b16 v[44:45], v55 offset:36864
  ds_read_b64_tr_b16 v[46:47], v55 offset:38912
  s_waitcnt vmcnt(15) lgkmcnt(6)
  v_mfma_f32_32x32x16_bf16 v[64:79], v[32:35], v[204:207], v[64:79]
  ds_read_b64_tr_b16 v[16:17], v52 offset:40960
  ds_read_b64_tr_b16 v[18:19], v52 offset:43008
  s_waitcnt lgkmcnt(6)
  v_mfma_f32_32x32x16_bf16 v[80:95], v[36:39], v[204:207], v[80:95]
  ds_read_b64_tr_b16 v[20:21], v53 offset:40960
  ds_read_b64_tr_b16 v[22:23], v53 offset:43008
  s_waitcnt lgkmcnt(6)
  v_mfma_f32_32x32x16_bf16 v[96:111], v[40:43], v[204:207], v[96:111]
  ds_read_b64_tr_b16 v[24:25], v54 offset:40960
  ds_read_b64_tr_b16 v[26:27], v54 offset:43008
  s_waitcnt lgkmcnt(6)
  v_mfma_f32_32x32x16_bf16 v[112:127], v[44:47], v[204:207], v[112:127]
  ds_read_b64_tr_b16 v[28:29], v55 offset:40960
  ds_read_b64_tr_b16 v[30:31], v55 offset:43008
  s_waitcnt vmcnt(14) lgkmcnt(6)
  v_mfma_f32_32x32x16_bf16 v[64:79], v[16:19], v[208:211], v[64:79]
  ds_read_b64_tr_b16 v[32:33], v52 offset:45056
  ds_read_b64_tr_b16 v[34:35], v52 offset:47104
  s_waitcnt lgkmcnt(6)
  v_mfma_f32_32x32x16_bf16 v[80:95], v[20:23], v[208:211], v[80:95]
  ds_read_b64_tr_b16 v[36:37], v53 offset:45056
  ds_read_b64_tr_b16 v[38:39], v53 offset:47104
  s_waitcnt lgkmcnt(6)
  v_mfma_f32_32x32x16_bf16 v[96:111], v[24:27], v[208:211], v[96:111]
  ds_read_b64_tr_b16 v[40:41], v54 offset:45056
  ds_read_b64_tr_b16 v[42:43], v54 offset:47104
  s_waitcnt lgkmcnt(6)
  v_mfma_f32_32x32x16_bf16 v[112:127], v[28:31], v[208:211], v[112:127]
  ds_read_b64_tr_b16 v[44:45], v55 offset:45056
  ds_read_b64_tr_b16 v[46:47], v55 offset:47104
  s_waitcnt vmcnt(13) lgkmcnt(6)
  v_mfma_f32_32x32x16_bf16 v[64:79], v[32:35], v[212:215], v[64:79]
  ds_read_b64_tr_b16 v[16:17], v52 offset:49152
  ds_read_b64_tr_b16 v[18:19], v52 offset:51200
  s_waitcnt lgkmcnt(6)
  v_mfma_f32_32x32x16_bf16 v[80:95], v[36:39], v[212:215], v[80:95]
  ds_read_b64_tr_b16 v[20:21], v53 offset:49152
  ds_read_b64_tr_b16 v[22:23], v53 offset:51200
  s_waitcnt lgkmcnt(6)
  v_mfma_f32_32x32x16_bf16 v[96:111], v[40:43], v[212:215], v[96:111]
  ds_read_b64_tr_b16 v[24:25], v54 offset:49152
  ds_read_b64_tr_b16 v[26:27], v54 offset:51200
  s_waitcnt lgkmcnt(6)
  v_mfma_f32_32x32x16_bf16 v[112:127], v[44:47], v[212:215], v[112:127]
  ds_read_b64_tr_b16 v[28:29], v55 offset:49152
  ds_read_b64_tr_b16 v[30:31], v55 offset:51200
  s_waitcnt vmcnt(12) lgkmcnt(6)
  v_mfma_f32_32x32x16_bf16 v[64:79], v[16:19], v[216:219], v[64:79]
  ds_read_b64_tr_b16 v[32:33], v52 offset:53248
  ds_read_b64_tr_b16 v[34:35], v52 offset:55296
  s_waitcnt lgkmcnt(6)
  v_mfma_f32_32x32x16_bf16 v[80:95], v[20:23], v[216:219], v[80:95]
  ds_read_b64_tr_b16 v[36:37], v53 offset:53248
  ds_read_b64_tr_b16 v[38:39], v53 offset:55296
  s_waitcnt lgkmcnt(6)
  v_mfma_f32_32x32x16_bf16 v[96:111], v[24:27], v[216:219], v[96:111]
  ds_read_b64_tr_b16 v[40:41], v54 offset:53248
  ds_read_b64_tr_b16 v[42:43], v54 offset:55296
  s_waitcnt lgkmcnt(6)
  v_mfma_f32_32x32x16_bf16 v[112:127], v[28:31], v[216:219], v[112:127]
  ds_read_b64_tr_b16 v[44:45], v55 offset:53248
  ds_read_b64_tr_b16 v[46:47], v55 offset:55296
  s_waitcnt vmcnt(11) lgkmcnt(6)
  v_mfma_f32_32x32x16_bf16 v[64:79], v[32:35], v[220:223], v[64:79]
  ds_read_b64_tr_b16 v[16:17], v52 offset:57344
  ds_read_b64_tr_b16 v[18:19], v52 offset:59392
  s_waitcnt lgkmcnt(6)
  v_mfma_f32_32x32x16_bf16 v[80:95], v[36:39], v[220:223], v[80:95]
  ds_read_b64_tr_b16 v[20:21], v53 offset:57344
  ds_read_b64_tr_b16 v[22:23], v53 offset:59392
  s_waitcnt lgkmcnt(6)
  v_mfma_f32_32x32x16_bf16 v[96:111], v[40:43], v[220:223], v[96:111]
  ds_read_b64_tr_b16 v[24:25], v54 offset:57344
  ds_read_b64_tr_b16 v[26:27], v54 offset:59392
  s_waitcnt lgkmcnt(6)
  v_mfma_f32_32x32x16_bf16 v[112:127], v[44:47], v[220:223], v[112:127]
  ds_read_b64_tr_b16 v[28:29], v55 offset:57344
  ds_read_b64_tr_b16 v[30:31], v55 offset:59392
  s_waitcnt vmcnt(10) lgkmcnt(6)
  v_mfma_f32_32x32x16_bf16 v[64:79], v[16:19], v[224:227], v[64:79]
  ds_read_b64_tr_b16 v[32:33], v10 offset:0
  ds_read_b64_tr_b16 v[34:35], v10 offset:2048
  s_waitcnt lgkmcnt(6)
  v_mfma_f32_32x32x16_bf16 v[80:95], v[20:23], v[224:227], v[80:95]
  ds_read_b64_tr_b16 v[36:37], v11 offset:0
  ds_read_b64_tr_b16 v[38:39], v11 offset:2048
  s_waitcnt lgkmcnt(6)
  v_mfma_f32_32x32x16_bf16 v[96:111], v[24:27], v[224:227], v[96:111]
  ds_read_b64_tr_b16 v[40:41], v12 offset:0
  ds_read_b64_tr_b16 v[42:43], v12 offset:2048
  s_waitcnt lgkmcnt(6)
  v_mfma_f32_32x32x16_bf16 v[112:127], v[28:31], v[224:227], v[112:127]
  ds_read_b64_tr_b16 v[44:45], v13 offset:0
  ds_read_b64_tr_b16 v[46:47], v13 offset:2048
  s_waitcnt vmcnt(9) lgkmcnt(6)
  v_mfma_f32_32x32x16_bf16 v[64:79], v[32:35], v[228:231], v[64:79]
  ds_read_b64_tr_b16 v[16:17], v10 offset:4096
  ds_read_b64_tr_b16 v[18:19], v10 offset:6144
  s_waitcnt lgkmcnt(6)
  v_mfma_f32_32x32x16_bf16 v[80:95], v[36:39], v[228:231], v[80:95]
  ds_read_b64_tr_b16 v[20:21], v11 offset:4096
  ds_read_b64_tr_b16 v[22:23], v11 offset:6144
  s_waitcnt lgkmcnt(6)
  v_mfma_f32_32x32x16_bf16 v[96:111], v[40:43], v[228:231], v[96:111]
  ds_read_b64_tr_b16 v[24:25], v12 offset:4096
  ds_read_b64_tr_b16 v[26:27], v12 offset:6144
  s_waitcnt lgkmcnt(6)
  v_mfma_f32_32x32x16_bf16 v[112:127], v[44:47], v[228:231], v[112:127]
  ds_read_b64_tr_b16 v[28:29], v13 offset:4096
  ds_read_b64_tr_b16 v[30:31], v13 offset:6144
  s_waitcnt vmcnt(8) lgkmcnt(6)
  v_mfma_f32_32x32x16_bf16 v[64:79], v[16:19], v[232:235], v[64:79]
  ds_read_b64_tr_b16 v[32:33], v10 offset:8192
  ds_read_b64_tr_b16 v[34:35], v10 offset:10240
  s_waitcnt lgkmcnt(6)
  v_mfma_f32_32x32x16_bf16 v[80:95], v[20:23], v[232:235], v[80:95]
  ds_read_b64_tr_b16 v[36:37], v11 offset:8192
  ds_read_b64_tr_b16 v[38:39], v11 offset:10240
  s_waitcnt lgkmcnt(6)
  v_mfma_f32_32x32x16_bf16 v[96:111], v[24:27], v[232:235], v[96:111]
  ds_read_b64_tr_b16 v[40:41], v12 offset:8192
  ds_read_b64_tr_b16 v[42:43], v12 offset:10240
  s_waitcnt lgkmcnt(6)
  v_mfma_f32_32x32x16_bf16 v[112:127], v[28:31], v[232:235], v[112:127]
  ds_read_b64_tr_b16 v[44:45], v13 offset:8192
  ds_read_b64_tr_b16 v[46:47], v13 offset:10240
  s_waitcnt vmcnt(7) lgkmcnt(6)
  v_mfma_f32_32x32x16_bf16 v[64:79], v[32:35], v[236:239], v[64:79]
  s_waitcnt lgkmcnt(4)
  v_mfma_f32_32x32x16_bf16 v[80:95], v[36:39], v[236:239], v[80:95]
  s_waitcnt lgkmcnt(2)
  v_mfma_f32_32x32x16_bf16 v[96:111], v[40:43], v[236:239], v[96:111]
  s_waitcnt lgkmcnt(0)
  v_mfma_f32_32x32x16_bf16 v[112:127], v[44:47], v[236:239], v[112:127]
  v_mov_b32 v14, 159748
  v_mov_b32 v15, 1
  s_add_u32 s33, s33, 4
  s_waitcnt lgkmcnt(0)
  s_mov_b32 exec_lo, 1
  s_mov_b32 exec_hi, 0
  ds_add_u32 v14, v15
  s_mov_b32 exec_lo, -1
  s_mov_b32 exec_hi, -1
  s_mov_b32 s35, 0
sb_20:
  ds_read_b32 v15, v14
  s_add_u32 s35, s35, 1
  s_waitcnt lgkmcnt(0)
  v_readfirstlane_b32 s34, v15
  s_cmp_gt_u32 s35, 1048576
  s_cbranch_scc1 sbx_21
  s_cmp_lt_u32 s34, s33
  s_cbranch_scc1 sb_20
sbx_21:
  s_mul_i32 s72, s32, 24576
  s_add_u32 s72, s72, 32768
  s_mul_i32 s73, s32, 401408
  s_waitcnt vmcnt(0)
  v_add_f32 v240, v240, v242
  v_add_f32 v241, v241, v243
  v_add_f32 v240, v240, v244
  v_add_f32 v241, v241, v245
  v_add_f32 v240, v240, v246
  v_add_f32 v241, v241, v247
  v_add_f32 v240, v240, v248
  v_add_f32 v241, v241, v249
  v_add_f32 v240, v240, v250
  v_add_f32 v241, v241, v251
  v_add_f32 v240, v240, v252
  v_add_f32 v241, v241, v253
  v_mov_b32 v46, v240
  v_mov_b32 v47, v241
  s_nop 1
  v_permlane32_swap_b32 v46, v240
  v_permlane32_swap_b32 v47, v241
  s_nop 1
  v_add_f32 v46, v46, v240
  v_add_f32 v47, v47, v241
  v_mul_f32 v46, 0x3b124925, v46
  v_mul_f32 v47, 0x3b124925, v47
  v_fma_f32 v47, -v46, v46, v47
  v_max_f32 v47, 0, v47
  v_add_f32 v47, 0x3727c5ac, v47
  v_rsq_f32 v52, v47
  s_nop 0
  v_mul_f32 v54, v46, v52
  v_sub_f32 v54, 0, v54
  v_mov_b32 v53, v52
  v_mov_b32 v55, v54
  v_lshrrev_b32 v6, 5, v2
  v_lshlrev_b32 v6, 6, v6
  s_add_u32 s36, s32, 0
  s_and_b32 s36, s36, 3
  s_lshl_b32 s36, s36, 7
  s_add_u32 s36, s36, 160000
  v_add_u32 v7, s36, v6
  ds_read_b128 v[128:131], v7 offset:0
  ds_read_b128 v[132:135], v7 offset:16
  ds_read_b128 v[136:139], v7 offset:32
  ds_read_b128 v[140:143], v7 offset:48
  s_add_u32 s36, s32, 1
  s_and_b32 s36, s36, 3
  s_lshl_b32 s36, s36, 7
  s_add_u32 s36, s36, 160000
  v_add_u32 v7, s36, v6
  ds_read_b128 v[144:147], v7 offset:0
  ds_read_b128 v[148:151], v7 offset:16
  ds_read_b128 v[152:155], v7 offset:32
  ds_read_b128 v[156:159], v7 offset:48
  s_add_u32 s36, s32, 2
  s_and_b32 s36, s36, 3
  s_lshl_b32 s36, s36, 7
  s_add_u32 s36, s36, 160000
  v_add_u32 v7, s36, v6
  ds_read_b128 v[160:163], v7 offset:0
  ds_read_b128 v[164:167], v7 offset:16
  ds_read_b128 v[168:171], v7 offset:32
  ds_read_b128 v[172:175], v7 offset:48
  s_add_u32 s36, s32, 3
  s_and_b32 s36, s36, 3
  s_lshl_b32 s36, s36, 7
  s_add_u32 s36, s36, 160000
  v_add_u32 v7, s36, v6
  ds_read_b128 v[176:179], v7 offset:0
  ds_read_b128 v[180:183], v7 offset:16
  ds_read_b128 v[184:187], v7 offset:32
  ds_read_b128 v[188:191], v7 offset:48
  v_mov_b32 v16, 0xc0135761
  v_mov_b32 v17, 0xc0135761
  v_mov_b32 v18, 0xbdd2d3e8
  v_mov_b32 v19, 0xbdd2d3e8
  v_mov_b32 v20, 1.0
  v_mov_b32 v21, 1.0
  v_sub_f32 v22, 0, v46
  v_mul_f32 v23, v16, v52
  v_mul_f32 v24, v52, v52
  v_mul_f32 v24, v24, v23
  v_mul_f32 v24, 0x3d372713, v24
  v_mul_f32 v25, v47, v52
  v_cmp_le_u32 vcc, 32, v2
  v_subrev_u32 v9, 3584, v4
  s_nop 0
  v_cndmask_b32 v9, v4, v9, vcc
  s_waitcnt lgkmcnt(0)
  s_cmp_ge_u32 s13, 28
  s_cbranch_scc1 g2epi_nodma_22
  v_fma_f32 v64, v128, v22, v64
  v_fma_f32 v65, v129, v22, v65
  v_fma_f32 v66, v130, v22, v66
  v_fma_f32 v67, v131, v22, v67
  v_fma_f32 v68, v132, v22, v68
  v_fma_f32 v69, v133, v22, v69
  v_fma_f32 v70, v134, v22, v70
  v_fma_f32 v71, v135, v22, v71
  v_fma_f32 v72, v136, v22, v72
  v_fma_f32 v73, v137, v22, v73
  v_fma_f32 v74, v138, v22, v74
  v_fma_f32 v75, v139, v22, v75
  v_fma_f32 v76, v140, v22, v76
  v_fma_f32 v77, v141, v22, v77
  v_fma_f32 v78, v142, v22, v78
  v_fma_f32 v79, v143, v22, v79
  s_add_u32 m0, s72, 0
  s_add_u32 s36, s73, 0
  buffer_load_dwordx4 v4, s[52:55], s36 offen lds
  s_add_u32 m0, s72, 1024
  s_add_u32 s36, s73, 7168
  buffer_load_dwordx4 v4, s[52:55], s36 offen lds
  v_mul_f32 v192, v64, v64
  v_mul_f32 v193, v65, v65
  v_mul_f32 v194, v66, v66
  v_mul_f32 v195, v67, v67
  v_mul_f32 v196, v68, v68
  v_mul_f32 v197, v69, v69
  v_mul_f32 v198, v70, v70
  v_mul_f32 v199, v71, v71
  v_mul_f32 v200, v72, v72
  v_mul_f32 v201, v73, v73
  v_mul_f32 v202, v74, v74
  v_mul_f32 v203, v75, v75
  v_mul_f32 v204, v76, v76
  v_mul_f32 v205, v77, v77
  v_mul_f32 v206, v78, v78
  v_mul_f32 v207, v79, v79
  s_add_u32 m0, s72, 2048
  s_add_u32 s36, s73, 14336
  buffer_load_dwordx4 v4, s[52:55], s36 offen lds
  s_add_u32 m0, s72, 3072
  s_add_u32 s36, s73, 21504
  buffer_load_dwordx4 v4, s[52:55], s36 offen lds
  v_fma_f32 v192, v192, v24, v23
  v_fma_f32 v193, v193, v24, v23
  v_fma_f32 v194, v194, v24, v23
  v_fma_f32 v195, v195, v24, v23
  v_fma_f32 v196, v196, v24, v23
  v_fma_f32 v197, v197, v24, v23
  v_fma_f32 v198, v198, v24, v23
  v_fma_f32 v199, v199, v24, v23
  v_fma_f32 v200, v200, v24, v23
  v_fma_f32 v201, v201, v24, v23
  v_fma_f32 v202, v202, v24, v23
  v_fma_f32 v203, v203, v24, v23
  v_fma_f32 v204, v204, v24, v23
  v_fma_f32 v205, v205, v24, v23
  v_fma_f32 v206, v206, v24, v23
  v_fma_f32 v207, v207, v24, v23
  s_add_u32 m0, s72, 4096
  s_add_u32 s36, s73, 28672
  buffer_load_dwordx4 v4, s[52:55], s36 offen lds
  s_add_u32 m0, s72, 5120
  s_add_u32 s36, s73, 35840
  buffer_load_dwordx4 v4, s[52:55], s36 offen lds
  v_mul_f32 v192, v192, v64
  v_mul_f32 v193, v193, v65
  v_mul_f32 v194, v194, v66
  v_mul_f32 v195, v195, v67
  v_mul_f32 v196, v196, v68
  v_mul_f32 v197, v197, v69
  v_mul_f32 v198, v198, v70
  v_mul_f32 v199, v199, v71
  v_mul_f32 v200, v200, v72
  v_mul_f32 v201, v201, v73
  v_mul_f32 v202, v202, v74
  v_mul_f32 v203, v203, v75
  v_mul_f32 v204, v204, v76
  v_mul_f32 v205, v205, v77
  v_mul_f32 v206, v206, v78
  v_mul_f32 v207, v207, v79
  v_exp_f32 v192, v192
  v_exp_f32 v193, v193
  v_exp_f32 v194, v194
  v_exp_f32 v195, v195
  v_exp_f32 v196, v196
  v_exp_f32 v197, v197
  v_exp_f32 v198, v198
  v_exp_f32 v199, v199
  s_add_u32 m0, s72, 6144
  s_add_u32 s36, s73, 43008
  buffer_load_dwordx4 v4, s[52:55], s36 offen lds
  s_add_u32 m0, s72, 7168
  s_add_u32 s36, s73, 50176
  buffer_load_dwordx4 v4, s[52:55], s36 offen lds
  v_exp_f32 v200, v200
  v_exp_f32 v201, v201
  v_exp_f32 v202, v202
  v_exp_f32 v203, v203
  v_exp_f32 v204, v204
  v_exp_f32 v205, v205
  v_exp_f32 v206, v206
  v_exp_f32 v207, v207
  s_add_u32 m0, s72, 8192
  s_add_u32 s36, s73, 57344
  buffer_load_dwordx4 v4, s[52:55], s36 offen lds
  s_add_u32 m0, s72, 9216
  s_add_u32 s36, s73, 64512
  buffer_load_dwordx4 v4, s[52:55], s36 offen lds
  v_fma_f32 v192, v192, v25, v25
  v_fma_f32 v193, v193, v25, v25
  v_fma_f32 v194, v194, v25, v25
  v_fma_f32 v195, v195, v25, v25
  v_fma_f32 v196, v196, v25, v25
  v_fma_f32 v197, v197, v25, v25
  v_fma_f32 v198, v198, v25, v25
  v_fma_f32 v199, v199, v25, v25
  v_fma_f32 v200, v200, v25, v25
  v_fma_f32 v201, v201, v25, v25
  v_fma_f32 v202, v202, v25, v25
  v_fma_f32 v203, v203, v25, v25
  v_fma_f32 v204, v204, v25, v25
  v_fma_f32 v205, v205, v25, v25
  v_fma_f32 v206, v206, v25, v25
  v_fma_f32 v207, v207, v25, v25
  v_rcp_f32 v192, v192
  v_rcp_f32 v193, v193
  v_rcp_f32 v194, v194
  v_rcp_f32 v195, v195
  v_rcp_f32 v196, v196
  v_rcp_f32 v197, v197
  v_rcp_f32 v198, v198
  v_rcp_f32 v199, v199
  s_add_u32 m0, s72, 10240
  s_add_u32 s36, s73, 71680
  buffer_load_dwordx4 v4, s[52:55], s36 offen lds
  s_add_u32 m0, s72, 11264
  s_add_u32 s36, s73, 78848
  buffer_load_dwordx4 v4, s[52:55], s36 offen lds
  v_rcp_f32 v200, v200
  v_rcp_f32 v201, v201
  v_rcp_f32 v202, v202
  v_rcp_f32 v203, v203
  v_rcp_f32 v204, v204
  v_rcp_f32 v205, v205
  v_rcp_f32 v206, v206
  v_rcp_f32 v207, v207
  v_mul_f32 v64, v64, v192
  v_mul_f32 v65, v65, v193
  v_mul_f32 v66, v66, v194
  v_mul_f32 v67, v67, v195
  v_mul_f32 v68, v68, v196
  v_mul_f32 v69, v69, v197
  v_mul_f32 v70, v70, v198
  v_mul_f32 v71, v71, v199
  v_mul_f32 v72, v72, v200
  v_mul_f32 v73, v73, v201
  v_mul_f32 v74, v74, v202
  v_mul_f32 v75, v75, v203
  v_mul_f32 v76, v76, v204
  v_mul_f32 v77, v77, v205
  v_mul_f32 v78, v78, v206
  v_mul_f32 v79, v79, v207
  v_cvt_pk_bf16_f32 v224, v64, v65
  v_cvt_pk_bf16_f32 v225, v66, v67
  v_cvt_pk_bf16_f32 v226, v68, v69
  v_cvt_pk_bf16_f32 v227, v70, v71
  v_cvt_pk_bf16_f32 v228, v72, v73
  v_cvt_pk_bf16_f32 v229, v74, v75
  v_cvt_pk_bf16_f32 v230, v76, v77
  v_cvt_pk_bf16_f32 v231, v78, v79
  s_add_u32 s37, s32, 0
  s_and_b32 s37, s37, 3
  s_lshl_b32 s38, s37, 11
  s_mul_i32 s39, s67, 7168
  s_add_u32 s38, s38, s39
  s_mul_i32 s39, s71, 114688
  s_add_u32 s38, s38, s39
  s_add_u32 s38, s38, 13631488
  buffer_store_dwordx4 v[224:227], v1, s[8:11], s38 offen sc1
  s_cmp_eq_u32 s37, 3
  s_cbranch_scc1 h2skip_24
  buffer_store_dwordx4 v[228:231], v1, s[8:11], s38 offen offset:1024 sc1
h2skip_24:
  v_fma_f32 v80, v144, v22, v80
  v_fma_f32 v81, v145, v22, v81
  v_fma_f32 v82, v146, v22, v82
  v_fma_f32 v83, v147, v22, v83
  v_fma_f32 v84, v148, v22, v84
  v_fma_f32 v85, v149, v22, v85
  v_fma_f32 v86, v150, v22, v86
  v_fma_f32 v87, v151, v22, v87
  v_fma_f32 v88, v152, v22, v88
  v_fma_f32 v89, v153, v22, v89
  v_fma_f32 v90, v154, v22, v90
  v_fma_f32 v91, v155, v22, v91
  v_fma_f32 v92, v156, v22, v92
  v_fma_f32 v93, v157, v22, v93
  v_fma_f32 v94, v158, v22, v94
  v_fma_f32 v95, v159, v22, v95
  s_add_u32 m0, s72, 12288
  s_add_u32 s36, s73, 86016
  buffer_load_dwordx4 v4, s[52:55], s36 offen lds
  s_add_u32 m0, s72, 13312
  s_add_u32 s36, s73, 93184
  buffer_load_dwordx4 v4, s[52:55], s36 offen lds
  v_mul_f32 v192, v80, v80
  v_mul_f32 v193, v81, v81
  v_mul_f32 v194, v82, v82
  v_mul_f32 v195, v83, v83
  v_mul_f32 v196, v84, v84
  v_mul_f32 v197, v85, v85
  v_mul_f32 v198, v86, v86
  v_mul_f32 v199, v87, v87
  v_mul_f32 v200, v88, v88
  v_mul_f32 v201, v89, v89
  v_mul_f32 v202, v90, v90
  v_mul_f32 v203, v91, v91
  v_mul_f32 v204, v92, v92
  v_mul_f32 v205, v93, v93
  v_mul_f32 v206, v94, v94
  v_mul_f32 v207, v95, v95
  s_add_u32 m0, s72, 14336
  s_add_u32 s36, s73, 100352
  buffer_load_dwordx4 v4, s[52:55], s36 offen lds
  s_add_u32 m0, s72, 15360
  s_add_u32 s36, s73, 107520
  buffer_load_dwordx4 v4, s[52:55], s36 offen lds
  v_fma_f32 v192, v192, v24, v23
  v_fma_f32 v193, v193, v24, v23
  v_fma_f32 v194, v194, v24, v23
  v_fma_f32 v195, v195, v24, v23
  v_fma_f32 v196, v196, v24, v23
  v_fma_f32 v197, v197, v24, v23
  v_fma_f32 v198, v198, v24, v23
  v_fma_f32 v199, v199, v24, v23
  v_fma_f32 v200, v200, v24, v23
  v_fma_f32 v201, v201, v24, v23
  v_fma_f32 v202, v202, v24, v23
  v_fma_f32 v203, v203, v24, v23
  v_fma_f32 v204, v204, v24, v23
  v_fma_f32 v205, v205, v24, v23
  v_fma_f32 v206, v206, v24, v23
  v_fma_f32 v207, v207, v24, v23
  s_add_u32 m0, s72, 16384
  s_add_u32 s36, s73, 114688
  buffer_load_dwordx4 v4, s[52:55], s36 offen lds
  s_add_u32 m0, s72, 17408
  s_add_u32 s36, s73, 121856
  buffer_load_dwordx4 v4, s[52:55], s36 offen lds
  v_mul_f32 v192, v192, v80
  v_mul_f32 v193, v193, v81
  v_mul_f32 v194, v194, v82
  v_mul_f32 v195, v195, v83
  v_mul_f32 v196, v196, v84
  v_mul_f32 v197, v197, v85
  v_mul_f32 v198, v198, v86
  v_mul_f32 v199, v199, v87
  v_mul_f32 v200, v200, v88
  v_mul_f32 v201, v201, v89
  v_mul_f32 v202, v202, v90
  v_mul_f32 v203, v203, v91
  v_mul_f32 v204, v204, v92
  v_mul_f32 v205, v205, v93
  v_mul_f32 v206, v206, v94
  v_mul_f32 v207, v207, v95
  v_exp_f32 v192, v192
  v_exp_f32 v193, v193
  v_exp_f32 v194, v194
  v_exp_f32 v195, v195
  v_exp_f32 v196, v196
  v_exp_f32 v197, v197
  v_exp_f32 v198, v198
  v_exp_f32 v199, v199
  s_add_u32 m0, s72, 18432
  s_add_u32 s36, s73, 129024
  buffer_load_dwordx4 v4, s[52:55], s36 offen lds
  s_add_u32 m0, s72, 19456
  s_add_u32 s36, s73, 136192
  buffer_load_dwordx4 v4, s[52:55], s36 offen lds
  v_exp_f32 v200, v200
  v_exp_f32 v201, v201
  v_exp_f32 v202, v202
  v_exp_f32 v203, v203
  v_exp_f32 v204, v204
  v_exp_f32 v205, v205
  v_exp_f32 v206, v206
  v_exp_f32 v207, v207
  s_add_u32 m0, s72, 20480
  s_add_u32 s36, s73, 143360
  buffer_load_dwordx4 v4, s[52:55], s36 offen lds
  s_add_u32 m0, s72, 21504
  s_add_u32 s36, s73, 150528
  buffer_load_dwordx4 v4, s[52:55], s36 offen lds
  v_fma_f32 v192, v192, v25, v25
  v_fma_f32 v193, v193, v25, v25
  v_fma_f32 v194, v194, v25, v25
  v_fma_f32 v195, v195, v25, v25
  v_fma_f32 v196, v196, v25, v25
  v_fma_f32 v197, v197, v25, v25
  v_fma_f32 v198, v198, v25, v25
  v_fma_f32 v199, v199, v25, v25
  v_fma_f32 v200, v200, v25, v25
  v_fma_f32 v201, v201, v25, v25
  v_fma_f32 v202, v202, v25, v25
  v_fma_f32 v203, v203, v25, v25
  v_fma_f32 v204, v204, v25, v25
  v_fma_f32 v205, v205, v25, v25
  v_fma_f32 v206, v206, v25, v25
  v_fma_f32 v207, v207, v25, v25
  v_rcp_f32 v192, v192
  v_rcp_f32 v193, v193
  v_rcp_f32 v194, v194
  v_rcp_f32 v195, v195
  v_rcp_f32 v196, v196
  v_rcp_f32 v197, v197
  v_rcp_f32 v198, v198
  v_rcp_f32 v199, v199
  s_add_u32 m0, s72, 22528
  s_add_u32 s36, s73, 157696
  buffer_load_dwordx4 v4, s[52:55], s36 offen lds
  s_add_u32 m0, s72, 23552
  s_add_u32 s36, s73, 164864
  buffer_load_dwordx4 v4, s[52:55], s36 offen lds
  v_rcp_f32 v200, v200
  v_rcp_f32 v201, v201
  v_rcp_f32 v202, v202
  v_rcp_f32 v203, v203
  v_rcp_f32 v204, v204
  v_rcp_f32 v205, v205
  v_rcp_f32 v206, v206
  v_rcp_f32 v207, v207
  v_mul_f32 v80, v80, v192
  v_mul_f32 v81, v81, v193
  v_mul_f32 v82, v82, v194
  v_mul_f32 v83, v83, v195
  v_mul_f32 v84, v84, v196
  v_mul_f32 v85, v85, v197
  v_mul_f32 v86, v86, v198
  v_mul_f32 v87, v87, v199
  v_mul_f32 v88, v88, v200
  v_mul_f32 v89, v89, v201
  v_mul_f32 v90, v90, v202
  v_mul_f32 v91, v91, v203
  v_mul_f32 v92, v92, v204
  v_mul_f32 v93, v93, v205
  v_mul_f32 v94, v94, v206
  v_mul_f32 v95, v95, v207
  v_cvt_pk_bf16_f32 v232, v80, v81
  v_cvt_pk_bf16_f32 v233, v82, v83
  v_cvt_pk_bf16_f32 v234, v84, v85
  v_cvt_pk_bf16_f32 v235, v86, v87
  v_cvt_pk_bf16_f32 v236, v88, v89
  v_cvt_pk_bf16_f32 v237, v90, v91
  v_cvt_pk_bf16_f32 v238, v92, v93
  v_cvt_pk_bf16_f32 v239, v94, v95
  s_add_u32 s37, s32, 1
  s_and_b32 s37, s37, 3
  s_lshl_b32 s38, s37, 11
  s_mul_i32 s39, s67, 7168
  s_add_u32 s38, s38, s39
  s_mul_i32 s39, s71, 114688
  s_add_u32 s38, s38, s39
  s_add_u32 s38, s38, 13631488
  buffer_store_dwordx4 v[232:235], v1, s[8:11], s38 offen sc1
  s_cmp_eq_u32 s37, 3
  s_cbranch_scc1 h2skip_25
  buffer_store_dwordx4 v[236:239], v1, s[8:11], s38 offen offset:1024 sc1
h2skip_25:
  v_fma_f32 v96, v160, v22, v96
  v_fma_f32 v97, v161, v22, v97
  v_fma_f32 v98, v162, v22, v98
  v_fma_f32 v99, v163, v22, v99
  v_fma_f32 v100, v164, v22, v100
  v_fma_f32 v101, v165, v22, v101
  v_fma_f32 v102, v166, v22, v102
  v_fma_f32 v103, v167, v22, v103
  v_fma_f32 v104, v168, v22, v104
  v_fma_f32 v105, v169, v22, v105
  v_fma_f32 v106, v170, v22, v106
  v_fma_f32 v107, v171, v22, v107
  v_fma_f32 v108, v172, v22, v108
  v_fma_f32 v109, v173, v22, v109
  v_fma_f32 v110, v174, v22, v110
  v_fma_f32 v111, v175, v22, v111
  v_mul_f32 v192, v96, v96
  v_mul_f32 v193, v97, v97
  v_mul_f32 v194, v98, v98
  v_mul_f32 v195, v99, v99
  v_mul_f32 v196, v100, v100
  v_mul_f32 v197, v101, v101
  v_mul_f32 v198, v102, v102
  v_mul_f32 v199, v103, v103
  v_mul_f32 v200, v104, v104
  v_mul_f32 v201, v105, v105
  v_mul_f32 v202, v106, v106
  v_mul_f32 v203, v107, v107
  v_mul_f32 v204, v108, v108
  v_mul_f32 v205, v109, v109
  v_mul_f32 v206, v110, v110
  v_mul_f32 v207, v111, v111
  v_fma_f32 v192, v192, v24, v23
  v_fma_f32 v193, v193, v24, v23
  v_fma_f32 v194, v194, v24, v23
  v_fma_f32 v195, v195, v24, v23
  v_fma_f32 v196, v196, v24, v23
  v_fma_f32 v197, v197, v24, v23
  v_fma_f32 v198, v198, v24, v23
  v_fma_f32 v199, v199, v24, v23
  v_fma_f32 v200, v200, v24, v23
  v_fma_f32 v201, v201, v24, v23
  v_fma_f32 v202, v202, v24, v23
  v_fma_f32 v203, v203, v24, v23
  v_fma_f32 v204, v204, v24, v23
  v_fma_f32 v205, v205, v24, v23
  v_fma_f32 v206, v206, v24, v23
  v_fma_f32 v207, v207, v24, v23
  v_mul_f32 v192, v192, v96
  v_mul_f32 v193, v193, v97
  v_mul_f32 v194, v194, v98
  v_mul_f32 v195, v195, v99
  v_mul_f32 v196, v196, v100
  v_mul_f32 v197, v197, v101
  v_mul_f32 v198, v198, v102
  v_mul_f32 v199, v199, v103
  v_mul_f32 v200, v200, v104
  v_mul_f32 v201, v201, v105
  v_mul_f32 v202, v202, v106
  v_mul_f32 v203, v203, v107
  v_mul_f32 v204, v204, v108
  v_mul_f32 v205, v205, v109
  v_mul_f32 v206, v206, v110
  v_mul_f32 v207, v207, v111
  v_exp_f32 v192, v192
  v_exp_f32 v193, v193
  v_exp_f32 v194, v194
  v_exp_f32 v195, v195
  v_exp_f32 v196, v196
  v_exp_f32 v197, v197
  v_exp_f32 v198, v198
  v_exp_f32 v199, v199
  v_exp_f32 v200, v200
  v_exp_f32 v201, v201
  v_exp_f32 v202, v202
  v_exp_f32 v203, v203
  v_exp_f32 v204, v204
  v_exp_f32 v205, v205
  v_exp_f32 v206, v206
  v_exp_f32 v207, v207
  v_fma_f32 v192, v192, v25, v25
  v_fma_f32 v193, v193, v25, v25
  v_fma_f32 v194, v194, v25, v25
  v_fma_f32 v195, v195, v25, v25
  v_fma_f32 v196, v196, v25, v25
  v_fma_f32 v197, v197, v25, v25
  v_fma_f32 v198, v198, v25, v25
  v_fma_f32 v199, v199, v25, v25
  v_fma_f32 v200, v200, v25, v25
  v_fma_f32 v201, v201, v25, v25
  v_fma_f32 v202, v202, v25, v25
  v_fma_f32 v203, v203, v25, v25
  v_fma_f32 v204, v204, v25, v25
  v_fma_f32 v205, v205, v25, v25
  v_fma_f32 v206, v206, v25, v25
  v_fma_f32 v207, v207, v25, v25
  v_rcp_f32 v192, v192
  v_rcp_f32 v193, v193
  v_rcp_f32 v194, v194
  v_rcp_f32 v195, v195
  v_rcp_f32 v196, v196
  v_rcp_f32 v197, v197
  v_rcp_f32 v198, v198
  v_rcp_f32 v199, v199
  v_rcp_f32 v200, v200
  v_rcp_f32 v201, v201
  v_rcp_f32 v202, v202
  v_rcp_f32 v203, v203
  v_rcp_f32 v204, v204
  v_rcp_f32 v205, v205
  v_rcp_f32 v206, v206
  v_rcp_f32 v207, v207
  v_mul_f32 v96, v96, v192
  v_mul_f32 v97, v97, v193
  v_mul_f32 v98, v98, v194
  v_mul_f32 v99, v99, v195
  v_mul_f32 v100, v100, v196
  v_mul_f32 v101, v101, v197
  v_mul_f32 v102, v102, v198
  v_mul_f32 v103, v103, v199
  v_mul_f32 v104, v104, v200
  v_mul_f32 v105, v105, v201
  v_mul_f32 v106, v106, v202
  v_mul_f32 v107, v107, v203
  v_mul_f32 v108, v108, v204
  v_mul_f32 v109, v109, v205
  v_mul_f32 v110, v110, v206
  v_mul_f32 v111, v111, v207
  v_cvt_pk_bf16_f32 v224, v96, v97
  v_cvt_pk_bf16_f32 v225, v98, v99
  v_cvt_pk_bf16_f32 v226, v100, v101
  v_cvt_pk_bf16_f32 v227, v102, v103
  v_cvt_pk_bf16_f32 v228, v104, v105
  v_cvt_pk_bf16_f32 v229, v106, v107
  v_cvt_pk_bf16_f32 v230, v108, v109
  v_cvt_pk_bf16_f32 v231, v110, v111
  s_add_u32 s37, s32, 2
  s_and_b32 s37, s37, 3
  s_lshl_b32 s38, s37, 11
  s_mul_i32 s39, s67, 7168
  s_add_u32 s38, s38, s39
  s_mul_i32 s39, s71, 114688
  s_add_u32 s38, s38, s39
  s_add_u32 s38, s38, 13631488
  buffer_store_dwordx4 v[224:227], v1, s[8:11], s38 offen sc1
  s_cmp_eq_u32 s37, 3
  s_cbranch_scc1 h2skip_26
  buffer_store_dwordx4 v[228:231], v1, s[8:11], s38 offen offset:1024 sc1
h2skip_26:
  v_fma_f32 v112, v176, v22, v112
  v_fma_f32 v113, v177, v22, v113
  v_fma_f32 v114, v178, v22, v114
  v_fma_f32 v115, v179, v22, v115
  v_fma_f32 v116, v180, v22, v116
  v_fma_f32 v117, v181, v22, v117
  v_fma_f32 v118, v182, v22, v118
  v_fma_f32 v119, v183, v22, v119
  v_fma_f32 v120, v184, v22, v120
  v_fma_f32 v121, v185, v22, v121
  v_fma_f32 v122, v186, v22, v122
  v_fma_f32 v123, v187, v22, v123
  v_fma_f32 v124, v188, v22, v124
  v_fma_f32 v125, v189, v22, v125
  v_fma_f32 v126, v190, v22, v126
  v_fma_f32 v127, v191, v22, v127
  v_mul_f32 v192, v112, v112
  v_mul_f32 v193, v113, v113
  v_mul_f32 v194, v114, v114
  v_mul_f32 v195, v115, v115
  v_mul_f32 v196, v116, v116
  v_mul_f32 v197, v117, v117
  v_mul_f32 v198, v118, v118
  v_mul_f32 v199, v119, v119
  v_mul_f32 v200, v120, v120
  v_mul_f32 v201, v121, v121
  v_mul_f32 v202, v122, v122
  v_mul_f32 v203, v123, v123
  v_mul_f32 v204, v124, v124
  v_mul_f32 v205, v125, v125
  v_mul_f32 v206, v126, v126
  v_mul_f32 v207, v127, v127
  v_fma_f32 v192, v192, v24, v23
  v_fma_f32 v193, v193, v24, v23
  v_fma_f32 v194, v194, v24, v23
  v_fma_f32 v195, v195, v24, v23
  v_fma_f32 v196, v196, v24, v23
  v_fma_f32 v197, v197, v24, v23
  v_fma_f32 v198, v198, v24, v23
  v_fma_f32 v199, v199, v24, v23
  v_fma_f32 v200, v200, v24, v23
  v_fma_f32 v201, v201, v24, v23
  v_fma_f32 v202, v202, v24, v23
  v_fma_f32 v203, v203, v24, v23
  v_fma_f32 v204, v204, v24, v23
  v_fma_f32 v205, v205, v24, v23
  v_fma_f32 v206, v206, v24, v23
  v_fma_f32 v207, v207, v24, v23
  v_mul_f32 v192, v192, v112
  v_mul_f32 v193, v193, v113
  v_mul_f32 v194, v194, v114
  v_mul_f32 v195, v195, v115
  v_mul_f32 v196, v196, v116
  v_mul_f32 v197, v197, v117
  v_mul_f32 v198, v198, v118
  v_mul_f32 v199, v199, v119
  v_mul_f32 v200, v200, v120
  v_mul_f32 v201, v201, v121
  v_mul_f32 v202, v202, v122
  v_mul_f32 v203, v203, v123
  v_mul_f32 v204, v204, v124
  v_mul_f32 v205, v205, v125
  v_mul_f32 v206, v206, v126
  v_mul_f32 v207, v207, v127
  v_exp_f32 v192, v192
  v_exp_f32 v193, v193
  v_exp_f32 v194, v194
  v_exp_f32 v195, v195
  v_exp_f32 v196, v196
  v_exp_f32 v197, v197
  v_exp_f32 v198, v198
  v_exp_f32 v199, v199
  v_exp_f32 v200, v200
  v_exp_f32 v201, v201
  v_exp_f32 v202, v202
  v_exp_f32 v203, v203
  v_exp_f32 v204, v204
  v_exp_f32 v205, v205
  v_exp_f32 v206, v206
  v_exp_f32 v207, v207
  v_fma_f32 v192, v192, v25, v25
  v_fma_f32 v193, v193, v25, v25
  v_fma_f32 v194, v194, v25, v25
  v_fma_f32 v195, v195, v25, v25
  v_fma_f32 v196, v196, v25, v25
  v_fma_f32 v197, v197, v25, v25
  v_fma_f32 v198, v198, v25, v25
  v_fma_f32 v199, v199, v25, v25
  v_fma_f32 v200, v200, v25, v25
  v_fma_f32 v201, v201, v25, v25
  v_fma_f32 v202, v202, v25, v25
  v_fma_f32 v203, v203, v25, v25
  v_fma_f32 v204, v204, v25, v25
  v_fma_f32 v205, v205, v25, v25
  v_fma_f32 v206, v206, v25, v25
  v_fma_f32 v207, v207, v25, v25
  v_rcp_f32 v192, v192
  v_rcp_f32 v193, v193
  v_rcp_f32 v194, v194
  v_rcp_f32 v195, v195
  v_rcp_f32 v196, v196
  v_rcp_f32 v197, v197
  v_rcp_f32 v198, v198
  v_rcp_f32 v199, v199
  v_rcp_f32 v200, v200
  v_rcp_f32 v201, v201
  v_rcp_f32 v202, v202
  v_rcp_f32 v203, v203
  v_rcp_f32 v204, v204
  v_rcp_f32 v205, v205
  v_rcp_f32 v206, v206
  v_rcp_f32 v207, v207
  v_mul_f32 v112, v112, v192
  v_mul_f32 v113, v113, v193
  v_mul_f32 v114, v114, v194
  v_mul_f32 v115, v115, v195
  v_mul_f32 v116, v116, v196
  v_mul_f32 v117, v117, v197
  v_mul_f32 v118, v118, v198
  v_mul_f32 v119, v119, v199
  v_mul_f32 v120, v120, v200
  v_mul_f32 v121, v121, v201
  v_mul_f32 v122, v122, v202
  v_mul_f32 v123, v123, v203
  v_mul_f32 v124, v124, v204
  v_mul_f32 v125, v125, v205
  v_mul_f32 v126, v126, v206
  v_mul_f32 v127, v127, v207
  v_cvt_pk_bf16_f32 v232, v112, v113
  v_cvt_pk_bf16_f32 v233, v114, v115
  v_cvt_pk_bf16_f32 v234, v116, v117
  v_cvt_pk_bf16_f32 v235, v118, v119
  v_cvt_pk_bf16_f32 v236, v120, v121
  v_cvt_pk_bf16_f32 v237, v122, v123
  v_cvt_pk_bf16_f32 v238, v124, v125
  v_cvt_pk_bf16_f32 v239, v126, v127
  s_add_u32 s37, s32, 3
  s_and_b32 s37, s37, 3
  s_lshl_b32 s38, s37, 11
  s_mul_i32 s39, s67, 7168
  s_add_u32 s38, s38, s39
  s_mul_i32 s39, s71, 114688
  s_add_u32 s38, s38, s39
  s_add_u32 s38, s38, 13631488
  buffer_store_dwordx4 v[232:235], v1, s[8:11], s38 offen sc1
  s_cmp_eq_u32 s37, 3
  s_cbranch_scc1 h2skip_27
  buffer_store_dwordx4 v[236:239], v1, s[8:11], s38 offen offset:1024 sc1
h2skip_27:
  s_branch g2epi_x_23
g2epi_nodma_22:
  v_fma_f32 v64, v128, v22, v64
  v_fma_f32 v65, v129, v22, v65
  v_fma_f32 v66, v130, v22, v66
  v_fma_f32 v67, v131, v22, v67
  v_fma_f32 v68, v132, v22, v68
  v_fma_f32 v69, v133, v22, v69
  v_fma_f32 v70, v134, v22, v70
  v_fma_f32 v71, v135, v22, v71
  v_fma_f32 v72, v136, v22, v72
  v_fma_f32 v73, v137, v22, v73
  v_fma_f32 v74, v138, v22, v74
  v_fma_f32 v75, v139, v22, v75
  v_fma_f32 v76, v140, v22, v76
  v_fma_f32 v77, v141, v22, v77
  v_fma_f32 v78, v142, v22, v78
  v_fma_f32 v79, v143, v22, v79
  v_mul_f32 v192, v64, v64
  v_mul_f32 v193, v65, v65
  v_mul_f32 v194, v66, v66
  v_mul_f32 v195, v67, v67
  v_mul_f32 v196, v68, v68
  v_mul_f32 v197, v69, v69
  v_mul_f32 v198, v70, v70
  v_mul_f32 v199, v71, v71
  v_mul_f32 v200, v72, v72
  v_mul_f32 v201, v73, v73
  v_mul_f32 v202, v74, v74
  v_mul_f32 v203, v75, v75
  v_mul_f32 v204, v76, v76
  v_mul_f32 v205, v77, v77
  v_mul_f32 v206, v78, v78
  v_mul_f32 v207, v79, v79
  v_fma_f32 v192, v192, v24, v23
  v_fma_f32 v193, v193, v24, v23
  v_fma_f32 v194, v194, v24, v23
  v_fma_f32 v195, v195, v24, v23
  v_fma_f32 v196, v196, v24, v23
  v_fma_f32 v197, v197, v24, v23
  v_fma_f32 v198, v198, v24, v23
  v_fma_f32 v199, v199, v24, v23
  v_fma_f32 v200, v200, v24, v23
  v_fma_f32 v201, v201, v24, v23
  v_fma_f32 v202, v202, v24, v23
  v_fma_f32 v203, v203, v24, v23
  v_fma_f32 v204, v204, v24, v23
  v_fma_f32 v205, v205, v24, v23
  v_fma_f32 v206, v206, v24, v23
  v_fma_f32 v207, v207, v24, v23
  v_mul_f32 v192, v192, v64
  v_mul_f32 v193, v193, v65
  v_mul_f32 v194, v194, v66
  v_mul_f32 v195, v195, v67
  v_mul_f32 v196, v196, v68
  v_mul_f32 v197, v197, v69
  v_mul_f32 v198, v198, v70
  v_mul_f32 v199, v199, v71
  v_mul_f32 v200, v200, v72
  v_mul_f32 v201, v201, v73
  v_mul_f32 v202, v202, v74
  v_mul_f32 v203, v203, v75
  v_mul_f32 v204, v204, v76
  v_mul_f32 v205, v205, v77
  v_mul_f32 v206, v206, v78
  v_mul_f32 v207, v207, v79
  v_exp_f32 v192, v192
  v_exp_f32 v193, v193
  v_exp_f32 v194, v194
  v_exp_f32 v195, v195
  v_exp_f32 v196, v196
  v_exp_f32 v197, v197
  v_exp_f32 v198, v198
  v_exp_f32 v199, v199
  v_exp_f32 v200, v200
  v_exp_f32 v201, v201
  v_exp_f32 v202, v202
  v_exp_f32 v203, v203
  v_exp_f32 v204, v204
  v_exp_f32 v205, v205
  v_exp_f32 v206, v206
  v_exp_f32 v207, v207
  v_fma_f32 v192, v192, v25, v25
  v_fma_f32 v193, v193, v25, v25
  v_fma_f32 v194, v194, v25, v25
  v_fma_f32 v195, v195, v25, v25
  v_fma_f32 v196, v196, v25, v25
  v_fma_f32 v197, v197, v25, v25
  v_fma_f32 v198, v198, v25, v25
  v_fma_f32 v199, v199, v25, v25
  v_fma_f32 v200, v200, v25, v25
  v_fma_f32 v201, v201, v25, v25
  v_fma_f32 v202, v202, v25, v25
  v_fma_f32 v203, v203, v25, v25
  v_fma_f32 v204, v204, v25, v25
  v_fma_f32 v205, v205, v25, v25
  v_fma_f32 v206, v206, v25, v25
  v_fma_f32 v207, v207, v25, v25
  v_rcp_f32 v192, v192
  v_rcp_f32 v193, v193
  v_rcp_f32 v194, v194
  v_rcp_f32 v195, v195
  v_rcp_f32 v196, v196
  v_rcp_f32 v197, v197
  v_rcp_f32 v198, v198
  v_rcp_f32 v199, v199
  v_rcp_f32 v200, v200
  v_rcp_f32 v201, v201
  v_rcp_f32 v202, v202
  v_rcp_f32 v203, v203
  v_rcp_f32 v204, v204
  v_rcp_f32 v205, v205
  v_rcp_f32 v206, v206
  v_rcp_f32 v207, v207
  v_mul_f32 v64, v64, v192
  v_mul_f32 v65, v65, v193
  v_mul_f32 v66, v66, v194
  v_mul_f32 v67, v67, v195
  v_mul_f32 v68, v68, v196
  v_mul_f32 v69, v69, v197
  v_mul_f32 v70, v70, v198
  v_mul_f32 v71, v71, v199
  v_mul_f32 v72, v72, v200
  v_mul_f32 v73, v73, v201
  v_mul_f32 v74, v74, v202
  v_mul_f32 v75, v75, v203
  v_mul_f32 v76, v76, v204
  v_mul_f32 v77, v77, v205
  v_mul_f32 v78, v78, v206
  v_mul_f32 v79, v79, v207
  v_cvt_pk_bf16_f32 v224, v64, v65
  v_cvt_pk_bf16_f32 v225, v66, v67
  v_cvt_pk_bf16_f32 v226, v68, v69
  v_cvt_pk_bf16_f32 v227, v70, v71
  v_cvt_pk_bf16_f32 v228, v72, v73
  v_cvt_pk_bf16_f32 v229, v74, v75
  v_cvt_pk_bf16_f32 v230, v76, v77
  v_cvt_pk_bf16_f32 v231, v78, v79
  s_add_u32 s37, s32, 0
  s_and_b32 s37, s37, 3
  s_lshl_b32 s38, s37, 11
  s_mul_i32 s39, s67, 7168
  s_add_u32 s38, s38, s39
  s_mul_i32 s39, s71, 114688
  s_add_u32 s38, s38, s39
  s_add_u32 s38, s38, 13631488
  buffer_store_dwordx4 v[224:227], v1, s[8:11], s38 offen sc1
  s_cmp_eq_u32 s37, 3
  s_cbranch_scc1 h2skip_28
  buffer_store_dwordx4 v[228:231], v1, s[8:11], s38 offen offset:1024 sc1
h2skip_28:
  v_fma_f32 v80, v144, v22, v80
  v_fma_f32 v81, v145, v22, v81
  v_fma_f32 v82, v146, v22, v82
  v_fma_f32 v83, v147, v22, v83
  v_fma_f32 v84, v148, v22, v84
  v_fma_f32 v85, v149, v22, v85
  v_fma_f32 v86, v150, v22, v86
  v_fma_f32 v87, v151, v22, v87
  v_fma_f32 v88, v152, v22, v88
  v_fma_f32 v89, v153, v22, v89
  v_fma_f32 v90, v154, v22, v90
  v_fma_f32 v91, v155, v22, v91
  v_fma_f32 v92, v156, v22, v92
  v_fma_f32 v93, v157, v22, v93
  v_fma_f32 v94, v158, v22, v94
  v_fma_f32 v95, v159, v22, v95
  v_mul_f32 v192, v80, v80
  v_mul_f32 v193, v81, v81
  v_mul_f32 v194, v82, v82
  v_mul_f32 v195, v83, v83
  v_mul_f32 v196, v84, v84
  v_mul_f32 v197, v85, v85
  v_mul_f32 v198, v86, v86
  v_mul_f32 v199, v87, v87
  v_mul_f32 v200, v88, v88
  v_mul_f32 v201, v89, v89
  v_mul_f32 v202, v90, v90
  v_mul_f32 v203, v91, v91
  v_mul_f32 v204, v92, v92
  v_mul_f32 v205, v93, v93
  v_mul_f32 v206, v94, v94
  v_mul_f32 v207, v95, v95
  v_fma_f32 v192, v192, v24, v23
  v_fma_f32 v193, v193, v24, v23
  v_fma_f32 v194, v194, v24, v23
  v_fma_f32 v195, v195, v24, v23
  v_fma_f32 v196, v196, v24, v23
  v_fma_f32 v197, v197, v24, v23
  v_fma_f32 v198, v198, v24, v23
  v_fma_f32 v199, v199, v24, v23
  v_fma_f32 v200, v200, v24, v23
  v_fma_f32 v201, v201, v24, v23
  v_fma_f32 v202, v202, v24, v23
  v_fma_f32 v203, v203, v24, v23
  v_fma_f32 v204, v204, v24, v23
  v_fma_f32 v205, v205, v24, v23
  v_fma_f32 v206, v206, v24, v23
  v_fma_f32 v207, v207, v24, v23
  v_mul_f32 v192, v192, v80
  v_mul_f32 v193, v193, v81
  v_mul_f32 v194, v194, v82
  v_mul_f32 v195, v195, v83
  v_mul_f32 v196, v196, v84
  v_mul_f32 v197, v197, v85
  v_mul_f32 v198, v198, v86
  v_mul_f32 v199, v199, v87
  v_mul_f32 v200, v200, v88
  v_mul_f32 v201, v201, v89
  v_mul_f32 v202, v202, v90
  v_mul_f32 v203, v203, v91
  v_mul_f32 v204, v204, v92
  v_mul_f32 v205, v205, v93
  v_mul_f32 v206, v206, v94
  v_mul_f32 v207, v207, v95
  v_exp_f32 v192, v192
  v_exp_f32 v193, v193
  v_exp_f32 v194, v194
  v_exp_f32 v195, v195
  v_exp_f32 v196, v196
  v_exp_f32 v197, v197
  v_exp_f32 v198, v198
  v_exp_f32 v199, v199
  v_exp_f32 v200, v200
  v_exp_f32 v201, v201
  v_exp_f32 v202, v202
  v_exp_f32 v203, v203
  v_exp_f32 v204, v204
  v_exp_f32 v205, v205
  v_exp_f32 v206, v206
  v_exp_f32 v207, v207
  v_fma_f32 v192, v192, v25, v25
  v_fma_f32 v193, v193, v25, v25
  v_fma_f32 v194, v194, v25, v25
  v_fma_f32 v195, v195, v25, v25
  v_fma_f32 v196, v196, v25, v25
  v_fma_f32 v197, v197, v25, v25
  v_fma_f32 v198, v198, v25, v25
  v_fma_f32 v199, v199, v25, v25
  v_fma_f32 v200, v200, v25, v25
  v_fma_f32 v201, v201, v25, v25
  v_fma_f32 v202, v202, v25, v25
  v_fma_f32 v203, v203, v25, v25
  v_fma_f32 v204, v204, v25, v25
  v_fma_f32 v205, v205, v25, v25
  v_fma_f32 v206, v206, v25, v25
  v_fma_f32 v207, v207, v25, v25
  v_rcp_f32 v192, v192
  v_rcp_f32 v193, v193
  v_rcp_f32 v194, v194
  v_rcp_f32 v195, v195
  v_rcp_f32 v196, v196
  v_rcp_f32 v197, v197
  v_rcp_f32 v198, v198
  v_rcp_f32 v199, v199
  v_rcp_f32 v200, v200
  v_rcp_f32 v201, v201
  v_rcp_f32 v202, v202
  v_rcp_f32 v203, v203
  v_rcp_f32 v204, v204
  v_rcp_f32 v205, v205
  v_rcp_f32 v206, v206
  v_rcp_f32 v207, v207
  v_mul_f32 v80, v80, v192
  v_mul_f32 v81, v81, v193
  v_mul_f32 v82, v82, v194
  v_mul_f32 v83, v83, v195
  v_mul_f32 v84, v84, v196
  v_mul_f32 v85, v85, v197
  v_mul_f32 v86, v86, v198
  v_mul_f32 v87, v87, v199
  v_mul_f32 v88, v88, v200
  v_mul_f32 v89, v89, v201
  v_mul_f32 v90, v90, v202
  v_mul_f32 v91, v91, v203
  v_mul_f32 v92, v92, v204
  v_mul_f32 v93, v93, v205
  v_mul_f32 v94, v94, v206
  v_mul_f32 v95, v95, v207
  v_cvt_pk_bf16_f32 v232, v80, v81
  v_cvt_pk_bf16_f32 v233, v82, v83
  v_cvt_pk_bf16_f32 v234, v84, v85
  v_cvt_pk_bf16_f32 v235, v86, v87
  v_cvt_pk_bf16_f32 v236, v88, v89
  v_cvt_pk_bf16_f32 v237, v90, v91
  v_cvt_pk_bf16_f32 v238, v92, v93
  v_cvt_pk_bf16_f32 v239, v94, v95
  s_add_u32 s37, s32, 1
  s_and_b32 s37, s37, 3
  s_lshl_b32 s38, s37, 11
  s_mul_i32 s39, s67, 7168
  s_add_u32 s38, s38, s39
  s_mul_i32 s39, s71, 114688
  s_add_u32 s38, s38, s39
  s_add_u32 s38, s38, 13631488
  buffer_store_dwordx4 v[232:235], v1, s[8:11], s38 offen sc1
  s_cmp_eq_u32 s37, 3
  s_cbranch_scc1 h2skip_29
  buffer_store_dwordx4 v[236:239], v1, s[8:11], s38 offen offset:1024 sc1
h2skip_29:
  v_fma_f32 v96, v160, v22, v96
  v_fma_f32 v97, v161, v22, v97
  v_fma_f32 v98, v162, v22, v98
  v_fma_f32 v99, v163, v22, v99
  v_fma_f32 v100, v164, v22, v100
  v_fma_f32 v101, v165, v22, v101
  v_fma_f32 v102, v166, v22, v102
  v_fma_f32 v103, v167, v22, v103
  v_fma_f32 v104, v168, v22, v104
  v_fma_f32 v105, v169, v22, v105
  v_fma_f32 v106, v170, v22, v106
  v_fma_f32 v107, v171, v22, v107
  v_fma_f32 v108, v172, v22, v108
  v_fma_f32 v109, v173, v22, v109
  v_fma_f32 v110, v174, v22, v110
  v_fma_f32 v111, v175, v22, v111
  v_mul_f32 v192, v96, v96
  v_mul_f32 v193, v97, v97
  v_mul_f32 v194, v98, v98
  v_mul_f32 v195, v99, v99
  v_mul_f32 v196, v100, v100
  v_mul_f32 v197, v101, v101
  v_mul_f32 v198, v102, v102
  v_mul_f32 v199, v103, v103
  v_mul_f32 v200, v104, v104
  v_mul_f32 v201, v105, v105
  v_mul_f32 v202, v106, v106
  v_mul_f32 v203, v107, v107
  v_mul_f32 v204, v108, v108
  v_mul_f32 v205, v109, v109
  v_mul_f32 v206, v110, v110
  v_mul_f32 v207, v111, v111
  v_fma_f32 v192, v192, v24, v23
  v_fma_f32 v193, v193, v24, v23
  v_fma_f32 v194, v194, v24, v23
  v_fma_f32 v195, v195, v24, v23
  v_fma_f32 v196, v196, v24, v23
  v_fma_f32 v197, v197, v24, v23
  v_fma_f32 v198, v198, v24, v23
  v_fma_f32 v199, v199, v24, v23
  v_fma_f32 v200, v200, v24, v23
  v_fma_f32 v201, v201, v24, v23
  v_fma_f32 v202, v202, v24, v23
  v_fma_f32 v203, v203, v24, v23
  v_fma_f32 v204, v204, v24, v23
  v_fma_f32 v205, v205, v24, v23
  v_fma_f32 v206, v206, v24, v23
  v_fma_f32 v207, v207, v24, v23
  v_mul_f32 v192, v192, v96
  v_mul_f32 v193, v193, v97
  v_mul_f32 v194, v194, v98
  v_mul_f32 v195, v195, v99
  v_mul_f32 v196, v196, v100
  v_mul_f32 v197, v197, v101
  v_mul_f32 v198, v198, v102
  v_mul_f32 v199, v199, v103
  v_mul_f32 v200, v200, v104
  v_mul_f32 v201, v201, v105
  v_mul_f32 v202, v202, v106
  v_mul_f32 v203, v203, v107
  v_mul_f32 v204, v204, v108
  v_mul_f32 v205, v205, v109
  v_mul_f32 v206, v206, v110
  v_mul_f32 v207, v207, v111
  v_exp_f32 v192, v192
  v_exp_f32 v193, v193
  v_exp_f32 v194, v194
  v_exp_f32 v195, v195
  v_exp_f32 v196, v196
  v_exp_f32 v197, v197
  v_exp_f32 v198, v198
  v_exp_f32 v199, v199
  v_exp_f32 v200, v200
  v_exp_f32 v201, v201
  v_exp_f32 v202, v202
  v_exp_f32 v203, v203
  v_exp_f32 v204, v204
  v_exp_f32 v205, v205
  v_exp_f32 v206, v206
  v_exp_f32 v207, v207
  v_fma_f32 v192, v192, v25, v25
  v_fma_f32 v193, v193, v25, v25
  v_fma_f32 v194, v194, v25, v25
  v_fma_f32 v195, v195, v25, v25
  v_fma_f32 v196, v196, v25, v25
  v_fma_f32 v197, v197, v25, v25
  v_fma_f32 v198, v198, v25, v25
  v_fma_f32 v199, v199, v25, v25
  v_fma_f32 v200, v200, v25, v25
  v_fma_f32 v201, v201, v25, v25
  v_fma_f32 v202, v202, v25, v25
  v_fma_f32 v203, v203, v25, v25
  v_fma_f32 v204, v204, v25, v25
  v_fma_f32 v205, v205, v25, v25
  v_fma_f32 v206, v206, v25, v25
  v_fma_f32 v207, v207, v25, v25
  v_rcp_f32 v192, v192
  v_rcp_f32 v193, v193
  v_rcp_f32 v194, v194
  v_rcp_f32 v195, v195
  v_rcp_f32 v196, v196
  v_rcp_f32 v197, v197
  v_rcp_f32 v198, v198
  v_rcp_f32 v199, v199
  v_rcp_f32 v200, v200
  v_rcp_f32 v201, v201
  v_rcp_f32 v202, v202
  v_rcp_f32 v203, v203
  v_rcp_f32 v204, v204
  v_rcp_f32 v205, v205
  v_rcp_f32 v206, v206
  v_rcp_f32 v207, v207
  v_mul_f32 v96, v96, v192
  v_mul_f32 v97, v97, v193
  v_mul_f32 v98, v98, v194
  v_mul_f32 v99, v99, v195
  v_mul_f32 v100, v100, v196
  v_mul_f32 v101, v101, v197
  v_mul_f32 v102, v102, v198
  v_mul_f32 v103, v103, v199
  v_mul_f32 v104, v104, v200
  v_mul_f32 v105, v105, v201
  v_mul_f32 v106, v106, v202
  v_mul_f32 v107, v107, v203
  v_mul_f32 v108, v108, v204
  v_mul_f32 v109, v109, v205
  v_mul_f32 v110, v110, v206
  v_mul_f32 v111, v111, v207
  v_cvt_pk_bf16_f32 v224, v96, v97
  v_cvt_pk_bf16_f32 v225, v98, v99
  v_cvt_pk_bf16_f32 v226, v100, v101
  v_cvt_pk_bf16_f32 v227, v102, v103
  v_cvt_pk_bf16_f32 v228, v104, v105
  v_cvt_pk_bf16_f32 v229, v106, v107
  v_cvt_pk_bf16_f32 v230, v108, v109
  v_cvt_pk_bf16_f32 v231, v110, v111
  s_add_u32 s37, s32, 2
  s_and_b32 s37, s37, 3
  s_lshl_b32 s38, s37, 11
  s_mul_i32 s39, s67, 7168
  s_add_u32 s38, s38, s39
  s_mul_i32 s39, s71, 114688
  s_add_u32 s38, s38, s39
  s_add_u32 s38, s38, 13631488
  buffer_store_dwordx4 v[224:227], v1, s[8:11], s38 offen sc1
  s_cmp_eq_u32 s37, 3
  s_cbranch_scc1 h2skip_30
  buffer_store_dwordx4 v[228:231], v1, s[8:11], s38 offen offset:1024 sc1
h2skip_30:
  v_fma_f32 v112, v176, v22, v112
  v_fma_f32 v113, v177, v22, v113
  v_fma_f32 v114, v178, v22, v114
  v_fma_f32 v115, v179, v22, v115
  v_fma_f32 v116, v180, v22, v116
  v_fma_f32 v117, v181, v22, v117
  v_fma_f32 v118, v182, v22, v118
  v_fma_f32 v119, v183, v22, v119
  v_fma_f32 v120, v184, v22, v120
  v_fma_f32 v121, v185, v22, v121
  v_fma_f32 v122, v186, v22, v122
  v_fma_f32 v123, v187, v22, v123
  v_fma_f32 v124, v188, v22, v124
  v_fma_f32 v125, v189, v22, v125
  v_fma_f32 v126, v190, v22, v126
  v_fma_f32 v127, v191, v22, v127
  v_mul_f32 v192, v112, v112
  v_mul_f32 v193, v113, v113
  v_mul_f32 v194, v114, v114
  v_mul_f32 v195, v115, v115
  v_mul_f32 v196, v116, v116
  v_mul_f32 v197, v117, v117
  v_mul_f32 v198, v118, v118
  v_mul_f32 v199, v119, v119
  v_mul_f32 v200, v120, v120
  v_mul_f32 v201, v121, v121
  v_mul_f32 v202, v122, v122
  v_mul_f32 v203, v123, v123
  v_mul_f32 v204, v124, v124
  v_mul_f32 v205, v125, v125
  v_mul_f32 v206, v126, v126
  v_mul_f32 v207, v127, v127
  v_fma_f32 v192, v192, v24, v23
  v_fma_f32 v193, v193, v24, v23
  v_fma_f32 v194, v194, v24, v23
  v_fma_f32 v195, v195, v24, v23
  v_fma_f32 v196, v196, v24, v23
  v_fma_f32 v197, v197, v24, v23
  v_fma_f32 v198, v198, v24, v23
  v_fma_f32 v199, v199, v24, v23
  v_fma_f32 v200, v200, v24, v23
  v_fma_f32 v201, v201, v24, v23
  v_fma_f32 v202, v202, v24, v23
  v_fma_f32 v203, v203, v24, v23
  v_fma_f32 v204, v204, v24, v23
  v_fma_f32 v205, v205, v24, v23
  v_fma_f32 v206, v206, v24, v23
  v_fma_f32 v207, v207, v24, v23
  v_mul_f32 v192, v192, v112
  v_mul_f32 v193, v193, v113
  v_mul_f32 v194, v194, v114
  v_mul_f32 v195, v195, v115
  v_mul_f32 v196, v196, v116
  v_mul_f32 v197, v197, v117
  v_mul_f32 v198, v198, v118
  v_mul_f32 v199, v199, v119
  v_mul_f32 v200, v200, v120
  v_mul_f32 v201, v201, v121
  v_mul_f32 v202, v202, v122
  v_mul_f32 v203, v203, v123
  v_mul_f32 v204, v204, v124
  v_mul_f32 v205, v205, v125
  v_mul_f32 v206, v206, v126
  v_mul_f32 v207, v207, v127
  v_exp_f32 v192, v192
  v_exp_f32 v193, v193
  v_exp_f32 v194, v194
  v_exp_f32 v195, v195
  v_exp_f32 v196, v196
  v_exp_f32 v197, v197
  v_exp_f32 v198, v198
  v_exp_f32 v199, v199
  v_exp_f32 v200, v200
  v_exp_f32 v201, v201
  v_exp_f32 v202, v202
  v_exp_f32 v203, v203
  v_exp_f32 v204, v204
  v_exp_f32 v205, v205
  v_exp_f32 v206, v206
  v_exp_f32 v207, v207
  v_fma_f32 v192, v192, v25, v25
  v_fma_f32 v193, v193, v25, v25
  v_fma_f32 v194, v194, v25, v25
  v_fma_f32 v195, v195, v25, v25
  v_fma_f32 v196, v196, v25, v25
  v_fma_f32 v197, v197, v25, v25
  v_fma_f32 v198, v198, v25, v25
  v_fma_f32 v199, v199, v25, v25
  v_fma_f32 v200, v200, v25, v25
  v_fma_f32 v201, v201, v25, v25
  v_fma_f32 v202, v202, v25, v25
  v_fma_f32 v203, v203, v25, v25
  v_fma_f32 v204, v204, v25, v25
  v_fma_f32 v205, v205, v25, v25
  v_fma_f32 v206, v206, v25, v25
  v_fma_f32 v207, v207, v25, v25
  v_rcp_f32 v192, v192
  v_rcp_f32 v193, v193
  v_rcp_f32 v194, v194
  v_rcp_f32 v195, v195
  v_rcp_f32 v196, v196
  v_rcp_f32 v197, v197
  v_rcp_f32 v198, v198
  v_rcp_f32 v199, v199
  v_rcp_f32 v200, v200
  v_rcp_f32 v201, v201
  v_rcp_f32 v202, v202
  v_rcp_f32 v203, v203
  v_rcp_f32 v204, v204
  v_rcp_f32 v205, v205
  v_rcp_f32 v206, v206
  v_rcp_f32 v207, v207
  v_mul_f32 v112, v112, v192
  v_mul_f32 v113, v113, v193
  v_mul_f32 v114, v114, v194
  v_mul_f32 v115, v115, v195
  v_mul_f32 v116, v116, v196
  v_mul_f32 v117, v117, v197
  v_mul_f32 v118, v118, v198
  v_mul_f32 v119, v119, v199
  v_mul_f32 v120, v120, v200
  v_mul_f32 v121, v121, v201
  v_mul_f32 v122, v122, v202
  v_mul_f32 v123, v123, v203
  v_mul_f32 v124, v124, v204
  v_mul_f32 v125, v125, v205
  v_mul_f32 v126, v126, v206
  v_mul_f32 v127, v127, v207
  v_cvt_pk_bf16_f32 v232, v112, v113
  v_cvt_pk_bf16_f32 v233, v114, v115
  v_cvt_pk_bf16_f32 v234, v116, v117
  v_cvt_pk_bf16_f32 v235, v118, v119
  v_cvt_pk_bf16_f32 v236, v120, v121
  v_cvt_pk_bf16_f32 v237, v122, v123
  v_cvt_pk_bf16_f32 v238, v124, v125
  v_cvt_pk_bf16_f32 v239, v126, v127
  s_add_u32 s37, s32, 3
  s_and_b32 s37, s37, 3
  s_lshl_b32 s38, s37, 11
  s_mul_i32 s39, s67, 7168
  s_add_u32 s38, s38, s39
  s_mul_i32 s39, s71, 114688
  s_add_u32 s38, s38, s39
  s_add_u32 s38, s38, 13631488
  buffer_store_dwordx4 v[232:235], v1, s[8:11], s38 offen sc1
  s_cmp_eq_u32 s37, 3
  s_cbranch_scc1 h2skip_31
  buffer_store_dwordx4 v[236:239], v1, s[8:11], s38 offen offset:1024 sc1
h2skip_31:
g2epi_x_23:
  s_mov_b32 s26, s71
  s_and_b32 s37, s26, 1
  s_lshl_b32 s37, s37, 2
  s_and_b32 s38, s67, 3
  s_add_u32 s37, s37, s38
  s_lshl_b32 s37, s37, 2
  s_lshr_b32 s26, s26, 1
  s_lshl_b32 s26, s26, 12
  s_lshr_b32 s38, s67, 2
  s_lshl_b32 s38, s38, 7
  s_add_u32 s26, s26, s37
  s_add_u32 s26, s26, s38
  s_add_u32 s26, s26, 655360
  s_waitcnt vmcnt(0)
  v_lshlrev_b32 v14, 9, v2
  v_mov_b32 v15, s3
  s_mov_b32 exec_lo, 127
  s_mov_b32 exec_hi, 0
  buffer_store_dword v15, v14, s[8:11], s26 offen sc1
  s_mov_b32 exec_lo, -1
  s_mov_b32 exec_hi, -1
  s_cmp_ge_u32 s13, 28
  s_cbranch_scc1 parallel_sum__softmax_full_mha__mixer_s_mlp__prompt_kernel_bend
  v_mov_b32 v24, v56
  v_mov_b32 v25, v57
  v_mov_b32 v26, v58
  v_mov_b32 v27, v59
  v_mov_b32 v28, v60
  v_mov_b32 v29, v61
  v_mov_b32 v30, v62
  v_mov_b32 v31, v63
  s_xor_b32 s29, s31, 1
  v_lshrrev_b32 v6, 5, v2
  v_lshlrev_b32 v6, 2, v6
  v_bfe_u32 v7, v2, 2, 2
  v_add_u32 v6, v6, v7
  v_lshlrev_b32 v6, 7, v6
  v_bfe_u32 v7, v2, 3, 1
  v_xor_b32 v7, s31, v7
  v_lshl_add_u32 v6, v7, 6, v6
  v_bfe_u32 v7, v2, 4, 1
  v_lshl_add_u32 v6, v7, 5, v6
  v_and_b32 v7, 3, v2
  v_lshl_add_u32 v6, v7, 3, v6
  v_add_u32 v10, s72, v6
  v_lshrrev_b32 v6, 5, v2
  v_lshlrev_b32 v6, 2, v6
  v_bfe_u32 v7, v2, 2, 2
  v_add_u32 v6, v6, v7
  v_lshlrev_b32 v6, 7, v6
  v_bfe_u32 v7, v2, 3, 1
  v_xor_b32 v7, s29, v7
  v_lshl_add_u32 v6, v7, 6, v6
  v_bfe_u32 v7, v2, 4, 1
  v_lshl_add_u32 v6, v7, 5, v6
  v_and_b32 v7, 3, v2
  v_lshl_add_u32 v6, v7, 3, v6
  v_add_u32 v11, s72, v6
  ds_read_b64_tr_b16 v[96:97], v10 offset:0
  ds_read_b64_tr_b16 v[98:99], v10 offset:1024
  ds_read_b64_tr_b16 v[100:101], v11 offset:0
  ds_read_b64_tr_b16 v[102:103], v11 offset:1024
  ds_read_b64_tr_b16 v[104:105], v10 offset:2048
  ds_read_b64_tr_b16 v[106:107], v10 offset:3072
  ds_read_b64_tr_b16 v[108:109], v11 offset:2048
  ds_read_b64_tr_b16 v[110:111], v11 offset:3072
  ds_read_b64_tr_b16 v[112:113], v10 offset:4096
  ds_read_b64_tr_b16 v[114:115], v10 offset:5120
  ds_read_b64_tr_b16 v[116:117], v11 offset:4096
  ds_read_b64_tr_b16 v[118:119], v11 offset:5120
  ds_read_b64_tr_b16 v[120:121], v10 offset:6144
  ds_read_b64_tr_b16 v[122:123], v10 offset:7168
  ds_read_b64_tr_b16 v[124:125], v11 offset:6144
  ds_read_b64_tr_b16 v[126:127], v11 offset:7168
  ds_read_b64_tr_b16 v[128:129], v10 offset:8192
  ds_read_b64_tr_b16 v[130:131], v10 offset:9216
  ds_read_b64_tr_b16 v[132:133], v11 offset:8192
  ds_read_b64_tr_b16 v[134:135], v11 offset:9216
  ds_read_b64_tr_b16 v[136:137], v10 offset:10240
  ds_read_b64_tr_b16 v[138:139], v10 offset:11264
  ds_read_b64_tr_b16 v[140:141], v11 offset:10240
  ds_read_b64_tr_b16 v[142:143], v11 offset:11264
  ds_read_b64_tr_b16 v[144:145], v10 offset:12288
  ds_read_b64_tr_b16 v[146:147], v10 offset:13312
  ds_read_b64_tr_b16 v[148:149], v11 offset:12288
  ds_read_b64_tr_b16 v[150:151], v11 offset:13312
  ds_read_b64_tr_b16 v[152:153], v10 offset:14336
  ds_read_b64_tr_b16 v[154:155], v10 offset:15360
  ds_read_b64_tr_b16 v[156:157], v11 offset:14336
  ds_read_b64_tr_b16 v[158:159], v11 offset:15360
  s_waitcnt lgkmcnt(0)
  s_add_u32 m0, s72, 0
  s_add_u32 s36, s73, 172032
  buffer_load_dwordx4 v4, s[52:55], s36 offen lds
  s_add_u32 m0, s72, 1024
  s_add_u32 s36, s73, 179200
  buffer_load_dwordx4 v4, s[52:55], s36 offen lds
  s_add_u32 m0, s72, 2048
  s_add_u32 s36, s73, 186368
  buffer_load_dwordx4 v4, s[52:55], s36 offen lds
  s_add_u32 m0, s72, 3072
  s_add_u32 s36, s73, 193536
  buffer_load_dwordx4 v4, s[52:55], s36 offen lds
  s_add_u32 m0, s72, 4096
  s_add_u32 s36, s73, 200704
  buffer_load_dwordx4 v4, s[52:55], s36 offen lds
  s_add_u32 m0, s72, 5120
  s_add_u32 s36, s73, 207872
  buffer_load_dwordx4 v4, s[52:55], s36 offen lds
  s_add_u32 m0, s72, 6144
  s_add_u32 s36, s73, 215040
  buffer_load_dwordx4 v4, s[52:55], s36 offen lds
  s_add_u32 m0, s72, 7168
  s_add_u32 s36, s73, 222208
  buffer_load_dwordx4 v4, s[52:55], s36 offen lds
  s_add_u32 m0, s72, 8192
  s_add_u32 s36, s73, 229376
  buffer_load_dwordx4 v4, s[52:55], s36 offen lds
  s_add_u32 m0, s72, 9216
  s_add_u32 s36, s73, 236544
  buffer_load_dwordx4 v4, s[52:55], s36 offen lds
  s_add_u32 m0, s72, 10240
  s_add_u32 s36, s73, 243712
  buffer_load_dwordx4 v4, s[52:55], s36 offen lds
  s_add_u32 m0, s72, 11264
  s_add_u32 s36, s73, 250880
  buffer_load_dwordx4 v4, s[52:55], s36 offen lds
  s_add_u32 m0, s72, 12288
  s_add_u32 s36, s73, 258048
  buffer_load_dwordx4 v4, s[52:55], s36 offen lds
  s_add_u32 m0, s72, 13312
  s_add_u32 s36, s73, 265216
  buffer_load_dwordx4 v4, s[52:55], s36 offen lds
  s_add_u32 m0, s72, 14336
  s_add_u32 s36, s73, 272384
  buffer_load_dwordx4 v4, s[52:55], s36 offen lds
  s_add_u32 m0, s72, 15360
  s_add_u32 s36, s73, 279552
  buffer_load_dwordx4 v4, s[52:55], s36 offen lds
  s_lshl_b32 s22, s64, 3
  s_add_u32 s22, s22, s65
  s_lshl_b32 s22, s22, 2
  s_add_u32 s22, s22, s32
  s_lshl_b32 s22, s22, 7
  s_add_u32 s22, s22, 655360
  v_min_u32 v3, 15, v2
  v_lshlrev_b32 v3, 2, v3
  v_add_u32 v3, s22, v3
  s_mov_b32 s24, 0xff
  s_mov_b32 s25, 0
  v_cmp_lt_u32 vcc, 7, v2
  v_mov_b32 v14, 131040
  v_cndmask_b32 v14, 0, v14, vcc
  v_add_u32 v3, v3, v14
  s_mov_b32 s24, 0xffff
  s_lshl_b32 s74, s64, 1
  s_xor_b32 s36, s30, 0
  s_add_u32 s36, s36, s74
  s_mul_i32 s76, s36, 114688
  s_mul_i32 s37, s32, 28672
  s_add_u32 s76, s76, s37
  s_add_u32 s76, s76, 13631488
  s_lshl_b32 s78, s36, 15
  s_lshl_b32 s37, s32, 13
  s_add_u32 s78, s78, s37
  s_add_u32 s78, s78, 11534336
  s_xor_b32 s36, s30, 1
  s_add_u32 s36, s36, s74
  s_mul_i32 s77, s36, 114688
  s_mul_i32 s37, s32, 28672
  s_add_u32 s77, s77, s37
  s_add_u32 s77, s77, 13631488
  s_lshl_b32 s79, s36, 15
  s_lshl_b32 s37, s32, 13
  s_add_u32 s79, s79, s37
  s_add_u32 s79, s79, 11534336
  s_mov_b32 s34, 0
poll_32:
  buffer_load_dword v92, v3, s[8:11], 0 offen sc1
  s_add_u32 s34, s34, 1
  s_waitcnt vmcnt(0)
  v_cmp_ne_u32 vcc, s3, v92
  s_cmp_gt_u32 s34, 1048576
  s_cbranch_scc1 pollx_33
  s_and_b64 vcc, vcc, s[24:25]
  s_cbranch_scc0 pollx_33
  s_nop 15
  s_nop 15
  s_nop 15
  s_nop 15
  s_nop 15
  s_nop 15
  s_nop 15
  s_nop 15
  s_nop 15
  s_nop 15
  s_nop 15
  s_nop 15
  s_nop 15
  s_nop 15
  s_nop 15
  s_nop 15
  s_nop 15
  s_nop 15
  s_nop 15
  s_nop 15
  s_nop 15
  s_nop 15
  s_nop 15
  s_nop 15
  s_nop 15
  s_nop 15
  s_nop 15
  s_nop 15
  s_nop 15
  s_nop 15
  s_nop 15
  s_nop 15
  s_branch poll_32
pollx_33:
  s_add_u32 s36, s76, 0
  buffer_load_dwordx4 v[160:163], v1, s[8:11], s36 offen offset:0 sc1
  buffer_load_dwordx4 v[168:171], v1, s[8:11], s36 offen offset:1024 sc1
  buffer_load_dwordx4 v[176:179], v1, s[8:11], s36 offen offset:2048 sc1
  buffer_load_dwordx4 v[184:187], v1, s[8:11], s36 offen offset:3072 sc1
  s_add_u32 s37, s77, 0
  buffer_load_dwordx4 v[164:167], v1, s[8:11], s37 offen offset:0 sc1
  buffer_load_dwordx4 v[172:175], v1, s[8:11], s37 offen offset:1024 sc1
  buffer_load_dwordx4 v[180:183], v1, s[8:11], s37 offen offset:2048 sc1
  buffer_load_dwordx4 v[188:191], v1, s[8:11], s37 offen offset:3072 sc1
  s_add_u32 s36, s76, 4096
  buffer_load_dwordx4 v[192:195], v1, s[8:11], s36 offen offset:0 sc1
  buffer_load_dwordx4 v[200:203], v1, s[8:11], s36 offen offset:1024 sc1
  buffer_load_dwordx4 v[208:211], v1, s[8:11], s36 offen offset:2048 sc1
  buffer_load_dwordx4 v[216:219], v1, s[8:11], s36 offen offset:3072 sc1
  s_add_u32 s37, s77, 4096
  buffer_load_dwordx4 v[196:199], v1, s[8:11], s37 offen offset:0 sc1
  buffer_load_dwordx4 v[204:207], v1, s[8:11], s37 offen offset:1024 sc1
  buffer_load_dwordx4 v[212:215], v1, s[8:11], s37 offen offset:2048 sc1
  buffer_load_dwordx4 v[220:223], v1, s[8:11], s37 offen offset:3072 sc1
  s_add_u32 s36, s76, 8192
  buffer_load_dwordx4 v[224:227], v1, s[8:11], s36 offen offset:0 sc1
  buffer_load_dwordx4 v[232:235], v1, s[8:11], s36 offen offset:1024 sc1
  buffer_load_dwordx4 v[240:243], v1, s[8:11], s36 offen offset:2048 sc1
  buffer_load_dwordx4 v[248:251], v1, s[8:11], s36 offen offset:3072 sc1
  s_add_u32 s37, s77, 8192
  buffer_load_dwordx4 v[228:231], v1, s[8:11], s37 offen offset:0 sc1
  buffer_load_dwordx4 v[236:239], v1, s[8:11], s37 offen offset:1024 sc1
  buffer_load_dwordx4 v[244:247], v1, s[8:11], s37 offen offset:2048 sc1
  buffer_load_dwordx4 v[252:255], v1, s[8:11], s37 offen offset:3072 sc1
  v_lshrrev_b32 v6, 2, v2
  v_add_u32 v6, s69, v6
  s_movk_i32 s36, 896
  v_mul_lo_u32 v8, v6, s36
  v_bfe_u32 v6, v2, 4, 2
  v_and_b32 v7, 3, v2
  v_xor_b32 v6, v6, v7
  v_lshl_add_u32 v8, v6, 4, v8
  v_add_u32 v8, s70, v8
  s_movk_i32 s36, 14336
  buffer_load_dwordx4 v[16:19], v8, s[40:43], 0 offen
  buffer_load_dwordx4 v[20:23], v8, s[40:43], s36 offen
  s_setprio 0
  s_waitcnt vmcnt(18)
  v_mfma_f32_32x32x16_bf16 v[32:47], v[96:99], v[160:163], 0
  v_mfma_f32_32x32x16_bf16 v[48:63], v[96:99], v[164:167], 0
  v_mfma_f32_32x32x16_bf16 v[64:79], v[100:103], v[160:163], 0
  v_mfma_f32_32x32x16_bf16 v[80:95], v[100:103], v[164:167], 0
  v_mfma_f32_32x32x16_bf16 v[32:47], v[104:107], v[168:171], v[32:47]
  v_mfma_f32_32x32x16_bf16 v[48:63], v[104:107], v[172:175], v[48:63]
  v_mfma_f32_32x32x16_bf16 v[64:79], v[108:111], v[168:171], v[64:79]
  v_mfma_f32_32x32x16_bf16 v[80:95], v[108:111], v[172:175], v[80:95]
  v_mfma_f32_32x32x16_bf16 v[32:47], v[112:115], v[176:179], v[32:47]
  v_mfma_f32_32x32x16_bf16 v[48:63], v[112:115], v[180:183], v[48:63]
  v_mfma_f32_32x32x16_bf16 v[64:79], v[116:119], v[176:179], v[64:79]
  v_mfma_f32_32x32x16_bf16 v[80:95], v[116:119], v[180:183], v[80:95]
  v_mfma_f32_32x32x16_bf16 v[32:47], v[120:123], v[184:187], v[32:47]
  v_mfma_f32_32x32x16_bf16 v[48:63], v[120:123], v[188:191], v[48:63]
  v_mfma_f32_32x32x16_bf16 v[64:79], v[124:127], v[184:187], v[64:79]
  v_mfma_f32_32x32x16_bf16 v[80:95], v[124:127], v[188:191], v[80:95]
  s_waitcnt vmcnt(10)
  v_mfma_f32_32x32x16_bf16 v[32:47], v[128:131], v[192:195], v[32:47]
  s_add_u32 s36, s76, 12288
  buffer_load_dwordx4 v[160:163], v1, s[8:11], s36 offen offset:0 sc1
  buffer_load_dwordx4 v[168:171], v1, s[8:11], s36 offen offset:1024 sc1
  v_mfma_f32_32x32x16_bf16 v[48:63], v[128:131], v[196:199], v[48:63]
  buffer_load_dwordx4 v[176:179], v1, s[8:11], s36 offen offset:2048 sc1
  buffer_load_dwordx4 v[184:187], v1, s[8:11], s36 offen offset:3072 sc1
  v_mfma_f32_32x32x16_bf16 v[64:79], v[132:135], v[192:195], v[64:79]
  s_add_u32 s37, s77, 12288
  buffer_load_dwordx4 v[164:167], v1, s[8:11], s37 offen offset:0 sc1
  buffer_load_dwordx4 v[172:175], v1, s[8:11], s37 offen offset:1024 sc1
  v_mfma_f32_32x32x16_bf16 v[80:95], v[132:135], v[196:199], v[80:95]
  buffer_load_dwordx4 v[180:183], v1, s[8:11], s37 offen offset:2048 sc1
  buffer_load_dwordx4 v[188:191], v1, s[8:11], s37 offen offset:3072 sc1
  v_mfma_f32_32x32x16_bf16 v[32:47], v[136:139], v[200:203], v[32:47]
  v_mfma_f32_32x32x16_bf16 v[48:63], v[136:139], v[204:207], v[48:63]
  v_mfma_f32_32x32x16_bf16 v[64:79], v[140:143], v[200:203], v[64:79]
  v_mfma_f32_32x32x16_bf16 v[80:95], v[140:143], v[204:207], v[80:95]
  v_mfma_f32_32x32x16_bf16 v[32:47], v[144:147], v[208:211], v[32:47]
  v_mfma_f32_32x32x16_bf16 v[48:63], v[144:147], v[212:215], v[48:63]
  ds_read_b64_tr_b16 v[112:113], v10 offset:16384
  ds_read_b64_tr_b16 v[114:115], v10 offset:17408
  v_mfma_f32_32x32x16_bf16 v[64:79], v[148:151], v[208:211], v[64:79]
  v_mfma_f32_32x32x16_bf16 v[80:95], v[148:151], v[212:215], v[80:95]
  ds_read_b64_tr_b16 v[116:117], v11 offset:16384
  ds_read_b64_tr_b16 v[118:119], v11 offset:17408
  v_mfma_f32_32x32x16_bf16 v[32:47], v[152:155], v[216:219], v[32:47]
  v_mfma_f32_32x32x16_bf16 v[48:63], v[152:155], v[220:223], v[48:63]
  ds_read_b64_tr_b16 v[96:97], v10 offset:18432
  ds_read_b64_tr_b16 v[98:99], v10 offset:19456
  v_mfma_f32_32x32x16_bf16 v[64:79], v[156:159], v[216:219], v[64:79]
  v_mfma_f32_32x32x16_bf16 v[80:95], v[156:159], v[220:223], v[80:95]
  ds_read_b64_tr_b16 v[100:101], v11 offset:18432
  ds_read_b64_tr_b16 v[102:103], v11 offset:19456
  s_waitcnt vmcnt(10)
  s_waitcnt lgkmcnt(6)
  v_mfma_f32_32x32x16_bf16 v[32:47], v[112:115], v[224:227], v[32:47]
  s_add_u32 s36, s76, 16384
  buffer_load_dwordx4 v[128:131], v1, s[8:11], s36 offen offset:0 sc1
  buffer_load_dwordx4 v[136:139], v1, s[8:11], s36 offen offset:1024 sc1
  v_mfma_f32_32x32x16_bf16 v[48:63], v[112:115], v[228:231], v[48:63]
  ds_read_b64_tr_b16 v[104:105], v10 offset:20480
  ds_read_b64_tr_b16 v[106:107], v10 offset:21504
  buffer_load_dwordx4 v[144:147], v1, s[8:11], s36 offen offset:2048 sc1
  buffer_load_dwordx4 v[152:155], v1, s[8:11], s36 offen offset:3072 sc1
  s_waitcnt lgkmcnt(6)
  v_mfma_f32_32x32x16_bf16 v[64:79], v[116:119], v[224:227], v[64:79]
  s_add_u32 s37, s77, 16384
  buffer_load_dwordx4 v[132:135], v1, s[8:11], s37 offen offset:0 sc1
  buffer_load_dwordx4 v[140:143], v1, s[8:11], s37 offen offset:1024 sc1
  v_mfma_f32_32x32x16_bf16 v[80:95], v[116:119], v[228:231], v[80:95]
  ds_read_b64_tr_b16 v[108:109], v11 offset:20480
  ds_read_b64_tr_b16 v[110:111], v11 offset:21504
  buffer_load_dwordx4 v[148:151], v1, s[8:11], s37 offen offset:2048 sc1
  buffer_load_dwordx4 v[156:159], v1, s[8:11], s37 offen offset:3072 sc1
  s_waitcnt lgkmcnt(6)
  v_mfma_f32_32x32x16_bf16 v[32:47], v[96:99], v[232:235], v[32:47]
  s_add_u32 s36, s76, 20480
  buffer_load_dwordx4 v[192:195], v1, s[8:11], s36 offen offset:0 sc1
  buffer_load_dwordx4 v[200:203], v1, s[8:11], s36 offen offset:1024 sc1
  v_mfma_f32_32x32x16_bf16 v[48:63], v[96:99], v[236:239], v[48:63]
  ds_read_b64_tr_b16 v[112:113], v10 offset:22528
  ds_read_b64_tr_b16 v[114:115], v10 offset:23552
  buffer_load_dwordx4 v[208:211], v1, s[8:11], s36 offen offset:2048 sc1
  buffer_load_dwordx4 v[216:219], v1, s[8:11], s36 offen offset:3072 sc1
  s_waitcnt lgkmcnt(6)
  v_mfma_f32_32x32x16_bf16 v[64:79], v[100:103], v[232:235], v[64:79]
  s_add_u32 s37, s77, 20480
  buffer_load_dwordx4 v[196:199], v1, s[8:11], s37 offen offset:0 sc1
  buffer_load_dwordx4 v[204:207], v1, s[8:11], s37 offen offset:1024 sc1
  v_mfma_f32_32x32x16_bf16 v[80:95], v[100:103], v[236:239], v[80:95]
  ds_read_b64_tr_b16 v[116:117], v11 offset:22528
  ds_read_b64_tr_b16 v[118:119], v11 offset:23552
  buffer_load_dwordx4 v[212:215], v1, s[8:11], s37 offen offset:2048 sc1
  buffer_load_dwordx4 v[220:223], v1, s[8:11], s37 offen offset:3072 sc1
  s_waitcnt lgkmcnt(6)
  v_mfma_f32_32x32x16_bf16 v[32:47], v[104:107], v[240:243], v[32:47]
  v_mfma_f32_32x32x16_bf16 v[48:63], v[104:107], v[244:247], v[48:63]
  ds_read_b64_tr_b16 v[96:97], v10 offset:0
  ds_read_b64_tr_b16 v[98:99], v10 offset:1024
  s_waitcnt lgkmcnt(6)
  v_mfma_f32_32x32x16_bf16 v[64:79], v[108:111], v[240:243], v[64:79]
  v_mfma_f32_32x32x16_bf16 v[80:95], v[108:111], v[244:247], v[80:95]
  ds_read_b64_tr_b16 v[100:101], v11 offset:0
  ds_read_b64_tr_b16 v[102:103], v11 offset:1024
  s_waitcnt lgkmcnt(6)
  v_mfma_f32_32x32x16_bf16 v[32:47], v[112:115], v[248:251], v[32:47]
  v_mfma_f32_32x32x16_bf16 v[48:63], v[112:115], v[252:255], v[48:63]
  ds_read_b64_tr_b16 v[104:105], v10 offset:2048
  ds_read_b64_tr_b16 v[106:107], v10 offset:3072
  s_waitcnt lgkmcnt(6)
  v_mfma_f32_32x32x16_bf16 v[64:79], v[116:119], v[248:251], v[64:79]
  v_mfma_f32_32x32x16_bf16 v[80:95], v[116:119], v[252:255], v[80:95]
  ds_read_b64_tr_b16 v[108:109], v11 offset:2048
  ds_read_b64_tr_b16 v[110:111], v11 offset:3072
  s_waitcnt vmcnt(16)
  s_waitcnt lgkmcnt(6)
  v_mfma_f32_32x32x16_bf16 v[32:47], v[96:99], v[160:163], v[32:47]
  s_add_u32 m0, s72, 16384
  s_add_u32 s36, s73, 286720
  buffer_load_dwordx4 v4, s[52:55], s36 offen lds
  s_add_u32 m0, s72, 17408
  s_add_u32 s36, s73, 293888
  buffer_load_dwordx4 v4, s[52:55], s36 offen lds
  v_mfma_f32_32x32x16_bf16 v[48:63], v[96:99], v[164:167], v[48:63]
  ds_read_b64_tr_b16 v[112:113], v10 offset:4096
  ds_read_b64_tr_b16 v[114:115], v10 offset:5120
  s_add_u32 m0, s72, 18432
  s_add_u32 s36, s73, 301056
  buffer_load_dwordx4 v4, s[52:55], s36 offen lds
  s_add_u32 m0, s72, 19456
  s_add_u32 s36, s73, 308224
  buffer_load_dwordx4 v4, s[52:55], s36 offen lds
  s_waitcnt lgkmcnt(6)
  v_mfma_f32_32x32x16_bf16 v[64:79], v[100:103], v[160:163], v[64:79]
  s_add_u32 m0, s72, 20480
  s_add_u32 s36, s73, 315392
  buffer_load_dwordx4 v4, s[52:55], s36 offen lds
  s_add_u32 m0, s72, 21504
  s_add_u32 s36, s73, 322560
  buffer_load_dwordx4 v4, s[52:55], s36 offen lds
  v_mfma_f32_32x32x16_bf16 v[80:95], v[100:103], v[164:167], v[80:95]
  ds_read_b64_tr_b16 v[116:117], v11 offset:4096
  ds_read_b64_tr_b16 v[118:119], v11 offset:5120
  s_add_u32 m0, s72, 22528
  s_add_u32 s36, s73, 329728
  buffer_load_dwordx4 v4, s[52:55], s36 offen lds
  s_add_u32 m0, s72, 23552
  s_add_u32 s36, s73, 336896
  buffer_load_dwordx4 v4, s[52:55], s36 offen lds
  s_waitcnt lgkmcnt(6)
  v_mfma_f32_32x32x16_bf16 v[32:47], v[104:107], v[168:171], v[32:47]
  s_add_u32 s36, s76, 24576
  buffer_load_dwordx4 v[224:227], v1, s[8:11], s36 offen offset:0 sc1
  buffer_load_dwordx4 v[232:235], v1, s[8:11], s36 offen offset:1024 sc1
  v_mfma_f32_32x32x16_bf16 v[48:63], v[104:107], v[172:175], v[48:63]
  ds_read_b64_tr_b16 v[96:97], v10 offset:6144
  ds_read_b64_tr_b16 v[98:99], v10 offset:7168
  buffer_load_dwordx4 v[240:243], v1, s[8:11], s36 offen offset:2048 sc1
  buffer_load_dwordx4 v[248:251], v1, s[8:11], s36 offen offset:3072 sc1
  s_waitcnt lgkmcnt(6)
  v_mfma_f32_32x32x16_bf16 v[64:79], v[108:111], v[168:171], v[64:79]
  s_add_u32 s37, s77, 24576
  buffer_load_dwordx4 v[228:231], v1, s[8:11], s37 offen offset:0 sc1
  buffer_load_dwordx4 v[236:239], v1, s[8:11], s37 offen offset:1024 sc1
  v_mfma_f32_32x32x16_bf16 v[80:95], v[108:111], v[172:175], v[80:95]
  ds_read_b64_tr_b16 v[100:101], v11 offset:6144
  ds_read_b64_tr_b16 v[102:103], v11 offset:7168
  buffer_load_dwordx4 v[244:247], v1, s[8:11], s37 offen offset:2048 sc1
  buffer_load_dwordx4 v[252:255], v1, s[8:11], s37 offen offset:3072 sc1
  s_waitcnt lgkmcnt(6)
  v_mfma_f32_32x32x16_bf16 v[32:47], v[112:115], v[176:179], v[32:47]
  v_mfma_f32_32x32x16_bf16 v[48:63], v[112:115], v[180:183], v[48:63]
  ds_read_b64_tr_b16 v[104:105], v10 offset:8192
  ds_read_b64_tr_b16 v[106:107], v10 offset:9216
  s_waitcnt lgkmcnt(6)
  v_mfma_f32_32x32x16_bf16 v[64:79], v[116:119], v[176:179], v[64:79]
  v_mfma_f32_32x32x16_bf16 v[80:95], v[116:119], v[180:183], v[80:95]
  ds_read_b64_tr_b16 v[108:109], v11 offset:8192
  ds_read_b64_tr_b16 v[110:111], v11 offset:9216
  s_waitcnt lgkmcnt(6)
  v_mfma_f32_32x32x16_bf16 v[32:47], v[96:99], v[184:187], v[32:47]
  v_mfma_f32_32x32x16_bf16 v[48:63], v[96:99], v[188:191], v[48:63]
  ds_read_b64_tr_b16 v[112:113], v10 offset:10240
  ds_read_b64_tr_b16 v[114:115], v10 offset:11264
  s_waitcnt lgkmcnt(6)
  v_mfma_f32_32x32x16_bf16 v[64:79], v[100:103], v[184:187], v[64:79]
  v_mfma_f32_32x32x16_bf16 v[80:95], v[100:103], v[188:191], v[80:95]
  ds_read_b64_tr_b16 v[116:117], v11 offset:10240
  ds_read_b64_tr_b16 v[118:119], v11 offset:11264
  s_waitcnt vmcnt(24)
  s_waitcnt lgkmcnt(6)
  v_mfma_f32_32x32x16_bf16 v[32:47], v[104:107], v[128:131], v[32:47]
  s_add_u32 m0, s72, 0
  s_add_u32 s36, s73, 344064
  buffer_load_dwordx4 v4, s[52:55], s36 offen lds
  s_add_u32 m0, s72, 1024
  s_add_u32 s36, s73, 351232
  buffer_load_dwordx4 v4, s[52:55], s36 offen lds
  v_mfma_f32_32x32x16_bf16 v[48:63], v[104:107], v[132:135], v[48:63]
  ds_read_b64_tr_b16 v[96:97], v10 offset:12288
  ds_read_b64_tr_b16 v[98:99], v10 offset:13312
  s_add_u32 m0, s72, 2048
  s_add_u32 s36, s73, 358400
  buffer_load_dwordx4 v4, s[52:55], s36 offen lds
  s_add_u32 m0, s72, 3072
  s_add_u32 s36, s73, 365568
  buffer_load_dwordx4 v4, s[52:55], s36 offen lds
  s_waitcnt lgkmcnt(6)
  v_mfma_f32_32x32x16_bf16 v[64:79], v[108:111], v[128:131], v[64:79]
  s_add_u32 m0, s72, 4096
  s_add_u32 s36, s73, 372736
  buffer_load_dwordx4 v4, s[52:55], s36 offen lds
  s_add_u32 m0, s72, 5120
  s_add_u32 s36, s73, 379904
  buffer_load_dwordx4 v4, s[52:55], s36 offen lds
  v_mfma_f32_32x32x16_bf16 v[80:95], v[108:111], v[132:135], v[80:95]
  ds_read_b64_tr_b16 v[100:101], v11 offset:12288
  ds_read_b64_tr_b16 v[102:103], v11 offset:13312
  s_add_u32 m0, s72, 6144
  s_add_u32 s36, s73, 387072
  buffer_load_dwordx4 v4, s[52:55], s36 offen lds
  s_add_u32 m0, s72, 7168
  s_add_u32 s36, s73, 394240
  buffer_load_dwordx4 v4, s[52:55], s36 offen lds
  s_waitcnt lgkmcnt(6)
  v_mfma_f32_32x32x16_bf16 v[32:47], v[112:115], v[136:139], v[32:47]
  v_mfma_f32_32x32x16_bf16 v[48:63], v[112:115], v[140:143], v[48:63]
  ds_read_b64_tr_b16 v[104:105], v10 offset:14336
  ds_read_b64_tr_b16 v[106:107], v10 offset:15360
  s_waitcnt lgkmcnt(6)
  v_mfma_f32_32x32x16_bf16 v[64:79], v[116:119], v[136:139], v[64:79]
  v_mfma_f32_32x32x16_bf16 v[80:95], v[116:119], v[140:143], v[80:95]
  ds_read_b64_tr_b16 v[108:109], v11 offset:14336
  ds_read_b64_tr_b16 v[110:111], v11 offset:15360
  s_waitcnt vmcnt(16)
  s_waitcnt lgkmcnt(6)
  v_mfma_f32_32x32x16_bf16 v[32:47], v[96:99], v[144:147], v[32:47]
  v_mfma_f32_32x32x16_bf16 v[48:63], v[96:99], v[148:151], v[48:63]
  ds_read_b64_tr_b16 v[112:113], v10 offset:16384
  ds_read_b64_tr_b16 v[114:115], v10 offset:17408
  s_waitcnt lgkmcnt(6)
  v_mfma_f32_32x32x16_bf16 v[64:79], v[100:103], v[144:147], v[64:79]
  v_mfma_f32_32x32x16_bf16 v[80:95], v[100:103], v[148:151], v[80:95]
  ds_read_b64_tr_b16 v[116:117], v11 offset:16384
  ds_read_b64_tr_b16 v[118:119], v11 offset:17408
  s_waitcnt lgkmcnt(6)
  v_mfma_f32_32x32x16_bf16 v[32:47], v[104:107], v[152:155], v[32:47]
  v_mfma_f32_32x32x16_bf16 v[48:63], v[104:107], v[156:159], v[48:63]
  ds_read_b64_tr_b16 v[96:97], v10 offset:18432
  ds_read_b64_tr_b16 v[98:99], v10 offset:19456
  s_waitcnt lgkmcnt(6)
  v_mfma_f32_32x32x16_bf16 v[64:79], v[108:111], v[152:155], v[64:79]
  v_mfma_f32_32x32x16_bf16 v[80:95], v[108:111], v[156:159], v[80:95]
  ds_read_b64_tr_b16 v[100:101], v11 offset:18432
  ds_read_b64_tr_b16 v[102:103], v11 offset:19456
  s_waitcnt lgkmcnt(6)
  v_mfma_f32_32x32x16_bf16 v[32:47], v[112:115], v[192:195], v[32:47]
  s_add_u32 m0, s72, 8192
  s_mul_i32 s36, s32, 100352
  s_add_u32 s36, s36, 0
  buffer_load_dwordx4 v4, s[56:59], s36 offen lds
  s_add_u32 m0, s72, 9216
  s_mul_i32 s36, s32, 100352
  s_add_u32 s36, s36, 7168
  buffer_load_dwordx4 v4, s[56:59], s36 offen lds
  v_mfma_f32_32x32x16_bf16 v[48:63], v[112:115], v[196:199], v[48:63]
  ds_read_b64_tr_b16 v[104:105], v10 offset:20480
  ds_read_b64_tr_b16 v[106:107], v10 offset:21504
  s_add_u32 m0, s72, 10240
  s_mul_i32 s36, s32, 100352
  s_add_u32 s36, s36, 14336
  buffer_load_dwordx4 v4, s[56:59], s36 offen lds
  s_add_u32 m0, s72, 11264
  s_mul_i32 s36, s32, 100352
  s_add_u32 s36, s36, 21504
  buffer_load_dwordx4 v4, s[56:59], s36 offen lds
  s_waitcnt lgkmcnt(6)
  v_mfma_f32_32x32x16_bf16 v[64:79], v[116:119], v[192:195], v[64:79]
  s_add_u32 m0, s72, 12288
  s_mul_i32 s36, s32, 100352
  s_add_u32 s36, s36, 25088
  buffer_load_dwordx4 v4, s[56:59], s36 offen lds
  s_add_u32 m0, s72, 13312
  s_mul_i32 s36, s32, 100352
  s_add_u32 s36, s36, 32256
  buffer_load_dwordx4 v4, s[56:59], s36 offen lds
  v_mfma_f32_32x32x16_bf16 v[80:95], v[116:119], v[196:199], v[80:95]
  ds_read_b64_tr_b16 v[108:109], v11 offset:20480
  ds_read_b64_tr_b16 v[110:111], v11 offset:21504
  s_add_u32 m0, s72, 14336
  s_mul_i32 s36, s32, 100352
  s_add_u32 s36, s36, 39424
  buffer_load_dwordx4 v4, s[56:59], s36 offen lds
  s_add_u32 m0, s72, 15360
  s_mul_i32 s36, s32, 100352
  s_add_u32 s36, s36, 46592
  buffer_load_dwordx4 v4, s[56:59], s36 offen lds
  s_waitcnt lgkmcnt(6)
  v_mfma_f32_32x32x16_bf16 v[32:47], v[96:99], v[200:203], v[32:47]
  v_mfma_f32_32x32x16_bf16 v[48:63], v[96:99], v[204:207], v[48:63]
  ds_read_b64_tr_b16 v[112:113], v10 offset:22528
  ds_read_b64_tr_b16 v[114:115], v10 offset:23552
  s_waitcnt lgkmcnt(6)
  v_mfma_f32_32x32x16_bf16 v[64:79], v[100:103], v[200:203], v[64:79]
  v_mfma_f32_32x32x16_bf16 v[80:95], v[100:103], v[204:207], v[80:95]
  ds_read_b64_tr_b16 v[116:117], v11 offset:22528
  ds_read_b64_tr_b16 v[118:119], v11 offset:23552
  s_waitcnt vmcnt(8)
  s_waitcnt lgkmcnt(6)
  v_mfma_f32_32x32x16_bf16 v[32:47], v[104:107], v[208:211], v[32:47]
  v_mfma_f32_32x32x16_bf16 v[48:63], v[104:107], v[212:215], v[48:63]
  ds_read_b64_tr_b16 v[96:97], v10 offset:0
  ds_read_b64_tr_b16 v[98:99], v10 offset:1024
  s_waitcnt lgkmcnt(6)
  v_mfma_f32_32x32x16_bf16 v[64:79], v[108:111], v[208:211], v[64:79]
  v_mfma_f32_32x32x16_bf16 v[80:95], v[108:111], v[212:215], v[80:95]
  ds_read_b64_tr_b16 v[100:101], v11 offset:0
  ds_read_b64_tr_b16 v[102:103], v11 offset:1024
  s_waitcnt lgkmcnt(6)
  v_mfma_f32_32x32x16_bf16 v[32:47], v[112:115], v[216:219], v[32:47]
  v_mfma_f32_32x32x16_bf16 v[48:63], v[112:115], v[220:223], v[48:63]
  ds_read_b64_tr_b16 v[104:105], v10 offset:2048
  ds_read_b64_tr_b16 v[106:107], v10 offset:3072
  s_waitcnt lgkmcnt(6)
  v_mfma_f32_32x32x16_bf16 v[64:79], v[116:119], v[216:219], v[64:79]
  v_mfma_f32_32x32x16_bf16 v[80:95], v[116:119], v[220:223], v[80:95]
  ds_read_b64_tr_b16 v[108:109], v11 offset:2048
  ds_read_b64_tr_b16 v[110:111], v11 offset:3072
  s_waitcnt lgkmcnt(6)
  v_mfma_f32_32x32x16_bf16 v[32:47], v[96:99], v[224:227], v[32:47]
  s_add_u32 m0, s72, 16384
  s_mul_i32 s36, s32, 100352
  s_add_u32 s36, s36, 50176
  buffer_load_dwordx4 v4, s[56:59], s36 offen lds
  s_add_u32 m0, s72, 17408
  s_mul_i32 s36, s32, 100352
  s_add_u32 s36, s36, 57344
  buffer_load_dwordx4 v4, s[56:59], s36 offen lds
  v_mfma_f32_32x32x16_bf16 v[48:63], v[96:99], v[228:231], v[48:63]
  ds_read_b64_tr_b16 v[112:113], v10 offset:4096
  ds_read_b64_tr_b16 v[114:115], v10 offset:5120
  s_add_u32 m0, s72, 18432
  s_mul_i32 s36, s32, 100352
  s_add_u32 s36, s36, 64512
  buffer_load_dwordx4 v4, s[56:59], s36 offen lds
  s_add_u32 m0, s72, 19456
  s_mul_i32 s36, s32, 100352
  s_add_u32 s36, s36, 71680
  buffer_load_dwordx4 v4, s[56:59], s36 offen lds
  s_waitcnt lgkmcnt(6)
  v_mfma_f32_32x32x16_bf16 v[64:79], v[100:103], v[224:227], v[64:79]
  s_add_u32 m0, s72, 20480
  s_mul_i32 s36, s32, 100352
  s_add_u32 s36, s36, 75264
  buffer_load_dwordx4 v4, s[56:59], s36 offen lds
  s_add_u32 m0, s72, 21504
  s_mul_i32 s36, s32, 100352
  s_add_u32 s36, s36, 82432
  buffer_load_dwordx4 v4, s[56:59], s36 offen lds
  v_mfma_f32_32x32x16_bf16 v[80:95], v[100:103], v[228:231], v[80:95]
  ds_read_b64_tr_b16 v[116:117], v11 offset:4096
  ds_read_b64_tr_b16 v[118:119], v11 offset:5120
  s_add_u32 m0, s72, 22528
  s_mul_i32 s36, s32, 100352
  s_add_u32 s36, s36, 89600
  buffer_load_dwordx4 v4, s[56:59], s36 offen lds
  s_add_u32 m0, s72, 23552
  s_mul_i32 s36, s32, 100352
  s_add_u32 s36, s36, 96768
  buffer_load_dwordx4 v9, s[56:59], s36 offen lds
  s_waitcnt lgkmcnt(6)
  v_mfma_f32_32x32x16_bf16 v[32:47], v[104:107], v[232:235], v[32:47]
  v_mfma_f32_32x32x16_bf16 v[48:63], v[104:107], v[236:239], v[48:63]
  ds_read_b64_tr_b16 v[96:97], v10 offset:6144
  ds_read_b64_tr_b16 v[98:99], v10 offset:7168
  s_waitcnt lgkmcnt(6)
  v_mfma_f32_32x32x16_bf16 v[64:79], v[108:111], v[232:235], v[64:79]
  v_mfma_f32_32x32x16_bf16 v[80:95], v[108:111], v[236:239], v[80:95]
  ds_read_b64_tr_b16 v[100:101], v11 offset:6144
  ds_read_b64_tr_b16 v[102:103], v11 offset:7168
  s_waitcnt vmcnt(8)
  s_waitcnt lgkmcnt(6)
  v_mfma_f32_32x32x16_bf16 v[32:47], v[112:115], v[240:243], v[32:47]
  v_mfma_f32_32x32x16_bf16 v[48:63], v[112:115], v[244:247], v[48:63]
  ds_read_b64_tr_b16 v[104:105], v10 offset:8192
  ds_read_b64_tr_b16 v[106:107], v10 offset:9216
  s_waitcnt lgkmcnt(6)
  v_mfma_f32_32x32x16_bf16 v[64:79], v[116:119], v[240:243], v[64:79]
  v_mfma_f32_32x32x16_bf16 v[80:95], v[116:119], v[244:247], v[80:95]
  ds_read_b64_tr_b16 v[108:109], v11 offset:8192
  ds_read_b64_tr_b16 v[110:111], v11 offset:9216
  s_waitcnt lgkmcnt(6)
  v_mfma_f32_32x32x16_bf16 v[32:47], v[96:99], v[248:251], v[32:47]
  v_mfma_f32_32x32x16_bf16 v[48:63], v[96:99], v[252:255], v[48:63]
  ds_read_b64_tr_b16 v[112:113], v10 offset:10240
  ds_read_b64_tr_b16 v[114:115], v10 offset:11264
  s_waitcnt lgkmcnt(6)
  v_mfma_f32_32x32x16_bf16 v[64:79], v[100:103], v[248:251], v[64:79]
  v_mfma_f32_32x32x16_bf16 v[80:95], v[100:103], v[252:255], v[80:95]
  ds_read_b64_tr_b16 v[116:117], v11 offset:10240
  ds_read_b64_tr_b16 v[118:119], v11 offset:11264
  s_add_u32 s36, s78, 0
  buffer_load_dwordx4 v[160:163], v1, s[8:11], s36 offen offset:0 sc1
  buffer_load_dwordx4 v[168:171], v1, s[8:11], s36 offen offset:1024 sc1
  buffer_load_dwordx4 v[176:179], v1, s[8:11], s36 offen offset:2048 sc1
  buffer_load_dwordx4 v[184:187], v1, s[8:11], s36 offen offset:3072 sc1
  s_add_u32 s37, s79, 0
  buffer_load_dwordx4 v[164:167], v1, s[8:11], s37 offen offset:0 sc1
  buffer_load_dwordx4 v[172:175], v1, s[8:11], s37 offen offset:1024 sc1
  buffer_load_dwordx4 v[180:183], v1, s[8:11], s37 offen offset:2048 sc1
  buffer_load_dwordx4 v[188:191], v1, s[8:11], s37 offen offset:3072 sc1
  s_add_u32 s36, s78, 4096
  buffer_load_dwordx4 v[128:131], v1, s[8:11], s36 offen offset:0 sc1
  buffer_load_dwordx4 v[136:139], v1, s[8:11], s36 offen offset:1024 sc1
  buffer_load_dwordx4 v[144:147], v1, s[8:11], s36 offen offset:2048 sc1
  buffer_load_dwordx4 v[152:155], v1, s[8:11], s36 offen offset:3072 sc1
  s_add_u32 s37, s79, 4096
  buffer_load_dwordx4 v[132:135], v1, s[8:11], s37 offen offset:0 sc1
  buffer_load_dwordx4 v[140:143], v1, s[8:11], s37 offen offset:1024 sc1
  buffer_load_dwordx4 v[148:151], v1, s[8:11], s37 offen offset:2048 sc1
  buffer_load_dwordx4 v[156:159], v1, s[8:11], s37 offen offset:3072 sc1
  s_lshl_b32 s36, s32, 11
  s_add_u32 s36, s36, 131072
  v_add_u32 v5, s36, v1
  v_and_b32 v6, 31, v2
  v_lshlrev_b32 v6, 6, v6
  v_bfe_u32 v7, v2, 2, 2
  ds_write_b128 v5, v[16:19]
  ds_write_b128 v5, v[20:23] offset:1024
  v_lshrrev_b32 v5, 5, v2
  v_xor_b32 v7, v7, v5
  v_lshl_add_u32 v6, v7, 4, v6
  v_add_u32 v6, s36, v6
  v_xor_b32 v7, 32, v6
  ds_read_b128 v[16:19], v6
  ds_read_b128 v[20:23], v7
  s_waitcnt lgkmcnt(0)
  v_permlane32_swap_b32 v16, v18
  v_permlane32_swap_b32 v17, v19
  v_permlane32_swap_b32 v20, v22
  v_permlane32_swap_b32 v21, v23
  s_nop 1
  s_nop 7
  s_nop 7
  v_lshlrev_b32 v192, 16, v16
  v_and_b32 v193, 0xffff0000, v16
  v_lshlrev_b32 v194, 16, v17
  v_and_b32 v195, 0xffff0000, v17
  v_lshlrev_b32 v196, 16, v18
  v_and_b32 v197, 0xffff0000, v18
  v_lshlrev_b32 v198, 16, v19
  v_and_b32 v199, 0xffff0000, v19
  v_lshlrev_b32 v200, 16, v20
  v_and_b32 v201, 0xffff0000, v20
  v_lshlrev_b32 v202, 16, v21
  v_and_b32 v203, 0xffff0000, v21
  v_lshlrev_b32 v204, 16, v22
  v_and_b32 v205, 0xffff0000, v22
  v_lshlrev_b32 v206, 16, v23
  v_and_b32 v207, 0xffff0000, v23
  v_lshlrev_b32 v208, 16, v24
  v_and_b32 v209, 0xffff0000, v24
  v_lshlrev_b32 v210, 16, v25
  v_and_b32 v211, 0xffff0000, v25
  v_lshlrev_b32 v212, 16, v26
  v_and_b32 v213, 0xffff0000, v26
  v_lshlrev_b32 v214, 16, v27
  v_and_b32 v215, 0xffff0000, v27
  v_lshlrev_b32 v216, 16, v28
  v_and_b32 v217, 0xffff0000, v28
  v_lshlrev_b32 v218, 16, v29
  v_and_b32 v219, 0xffff0000, v29
  v_lshlrev_b32 v220, 16, v30
  v_and_b32 v221, 0xffff0000, v30
  v_lshlrev_b32 v222, 16, v31
  v_and_b32 v223, 0xffff0000, v31
  v_add_f32 v192, v192, v208
  v_add_f32 v193, v193, v209
  v_add_f32 v194, v194, v210
  v_add_f32 v195, v195, v211
  v_add_f32 v196, v196, v212
  v_add_f32 v197, v197, v213
  v_add_f32 v198, v198, v214
  v_add_f32 v199, v199, v215
  v_add_f32 v200, v200, v216
  v_add_f32 v201, v201, v217
  v_add_f32 v202, v202, v218
  v_add_f32 v203, v203, v219
  v_add_f32 v204, v204, v220
  v_add_f32 v205, v205, v221
  v_add_f32 v206, v206, v222
  v_add_f32 v207, v207, v223
  v_add_f32 v32, v32, v192
  v_add_f32 v33, v33, v193
  v_add_f32 v34, v34, v194
  v_add_f32 v35, v35, v195
  v_add_f32 v36, v36, v196
  v_add_f32 v37, v37, v197
  v_add_f32 v38, v38, v198
  v_add_f32 v39, v39, v199
  v_add_f32 v40, v40, v200
  v_add_f32 v41, v41, v201
  v_add_f32 v42, v42, v202
  v_add_f32 v43, v43, v203
  v_add_f32 v44, v44, v204
  v_add_f32 v45, v45, v205
  v_add_f32 v46, v46, v206
  v_add_f32 v47, v47, v207
  v_and_b32 v14, 31, v2
  v_add_u32 v14, s69, v14
  s_movk_i32 s36, 896
  v_mul_lo_u32 v6, v14, s36
  v_lshrrev_b32 v15, 5, v2
  v_lshl_add_u32 v6, v15, 4, v6
  v_add_u32 v6, s70, v6
  s_waitcnt vmcnt(8)
  s_mov_b32 s34, 0
oc_34:
  v_max3_u32 v14, v160, v161, v162
  v_max3_u32 v15, v163, v164, v165
  v_max3_u32 v14, v14, v166, v167
  v_max3_u32 v15, v15, v168, v169
  v_max3_u32 v14, v14, v170, v171
  v_max3_u32 v15, v15, v172, v173
  v_max3_u32 v14, v14, v174, v175
  v_max3_u32 v15, v15, v176, v177
  v_max3_u32 v14, v14, v178, v179
  v_max3_u32 v15, v15, v180, v181
  v_max3_u32 v14, v14, v182, v183
  v_max3_u32 v15, v15, v184, v185
  v_max3_u32 v14, v14, v186, v187
  v_max3_u32 v15, v15, v188, v189
  v_max3_u32 v14, v14, v190, v191
  v_max_u32 v14, v14, v15
  v_cmp_eq_u32 vcc, -1, v14
  s_nop 0
  s_cmp_eq_u64 vcc, 0
  s_cbranch_scc1 ocx_35
  s_add_u32 s34, s34, 1
  s_cmp_gt_u32 s34, 1048576
  s_cbranch_scc1 ocx_35
  s_setprio 0
  s_add_u32 s36, s78, 0
  buffer_load_dwordx4 v[160:163], v1, s[8:11], s36 offen offset:0 sc1
  buffer_load_dwordx4 v[168:171], v1, s[8:11], s36 offen offset:1024 sc1
  buffer_load_dwordx4 v[176:179], v1, s[8:11], s36 offen offset:2048 sc1
  buffer_load_dwordx4 v[184:187], v1, s[8:11], s36 offen offset:3072 sc1
  s_add_u32 s37, s79, 0
  buffer_load_dwordx4 v[164:167], v1, s[8:11], s37 offen offset:0 sc1
  buffer_load_dwordx4 v[172:175], v1, s[8:11], s37 offen offset:1024 sc1
  buffer_load_dwordx4 v[180:183], v1, s[8:11], s37 offen offset:2048 sc1
  buffer_load_dwordx4 v[188:191], v1, s[8:11], s37 offen offset:3072 sc1
  s_waitcnt vmcnt(0)
  s_branch oc_34
ocx_35:
  s_setprio 3
  s_waitcnt lgkmcnt(6)
  v_mfma_f32_32x32x16_bf16 v[32:47], v[104:107], v[160:163], v[32:47]
  v_mfma_f32_32x32x16_bf16 v[48:63], v[104:107], v[164:167], v[48:63]
  ds_read_b64_tr_b16 v[96:97], v10 offset:12288
  ds_read_b64_tr_b16 v[98:99], v10 offset:13312
  s_waitcnt lgkmcnt(6)
  v_mfma_f32_32x32x16_bf16 v[64:79], v[108:111], v[160:163], v[64:79]
  v_mfma_f32_32x32x16_bf16 v[80:95], v[108:111], v[164:167], v[80:95]
  ds_read_b64_tr_b16 v[100:101], v11 offset:12288
  ds_read_b64_tr_b16 v[102:103], v11 offset:13312
  s_waitcnt lgkmcnt(6)
  v_mfma_f32_32x32x16_bf16 v[32:47], v[112:115], v[168:171], v[32:47]
  v_mfma_f32_32x32x16_bf16 v[48:63], v[112:115], v[172:175], v[48:63]
  ds_read_b64_tr_b16 v[104:105], v10 offset:14336
  ds_read_b64_tr_b16 v[106:107], v10 offset:15360
  s_waitcnt lgkmcnt(6)
  v_mfma_f32_32x32x16_bf16 v[64:79], v[116:119], v[168:171], v[64:79]
  v_mfma_f32_32x32x16_bf16 v[80:95], v[116:119], v[172:175], v[80:95]
  ds_read_b64_tr_b16 v[108:109], v11 offset:14336
  ds_read_b64_tr_b16 v[110:111], v11 offset:15360
  s_waitcnt lgkmcnt(6)
  v_mfma_f32_32x32x16_bf16 v[32:47], v[96:99], v[176:179], v[32:47]
  v_mfma_f32_32x32x16_bf16 v[48:63], v[96:99], v[180:183], v[48:63]
  ds_read_b64_tr_b16 v[112:113], v10 offset:16384
  ds_read_b64_tr_b16 v[114:115], v10 offset:17408
  s_waitcnt lgkmcnt(6)
  v_mfma_f32_32x32x16_bf16 v[64:79], v[100:103], v[176:179], v[64:79]
  v_mfma_f32_32x32x16_bf16 v[80:95], v[100:103], v[180:183], v[80:95]
  ds_read_b64_tr_b16 v[116:117], v11 offset:16384
  ds_read_b64_tr_b16 v[118:119], v11 offset:17408
  s_waitcnt lgkmcnt(6)
  v_mfma_f32_32x32x16_bf16 v[32:47], v[104:107], v[184:187], v[32:47]
  v_mfma_f32_32x32x16_bf16 v[48:63], v[104:107], v[188:191], v[48:63]
  ds_read_b64_tr_b16 v[96:97], v10 offset:18432
  ds_read_b64_tr_b16 v[98:99], v10 offset:19456
  s_waitcnt lgkmcnt(6)
  v_mfma_f32_32x32x16_bf16 v[64:79], v[108:111], v[184:187], v[64:79]
  v_mfma_f32_32x32x16_bf16 v[80:95], v[108:111], v[188:191], v[80:95]
  ds_read_b64_tr_b16 v[100:101], v11 offset:18432
  ds_read_b64_tr_b16 v[102:103], v11 offset:19456
  s_waitcnt vmcnt(0)
  s_mov_b32 s34, 0
oc_36:
  v_max3_u32 v14, v128, v129, v130
  v_max3_u32 v15, v131, v132, v133
  v_max3_u32 v14, v14, v134, v135
  v_max3_u32 v15, v15, v136, v137
  v_max3_u32 v14, v14, v138, v139
  v_max3_u32 v15, v15, v140, v141
  v_max3_u32 v14, v14, v142, v143
  v_max3_u32 v15, v15, v144, v145
  v_max3_u32 v14, v14, v146, v147
  v_max3_u32 v15, v15, v148, v149
  v_max3_u32 v14, v14, v150, v151
  v_max3_u32 v15, v15, v152, v153
  v_max3_u32 v14, v14, v154, v155
  v_max3_u32 v15, v15, v156, v157
  v_max3_u32 v14, v14, v158, v159
  v_max_u32 v14, v14, v15
  v_cmp_eq_u32 vcc, -1, v14
  s_nop 0
  s_cmp_eq_u64 vcc, 0
  s_cbranch_scc1 ocx_37
  s_add_u32 s34, s34, 1
  s_cmp_gt_u32 s34, 1048576
  s_cbranch_scc1 ocx_37
  s_setprio 0
  s_add_u32 s36, s78, 4096
  buffer_load_dwordx4 v[128:131], v1, s[8:11], s36 offen offset:0 sc1
  buffer_load_dwordx4 v[136:139], v1, s[8:11], s36 offen offset:1024 sc1
  buffer_load_dwordx4 v[144:147], v1, s[8:11], s36 offen offset:2048 sc1
  buffer_load_dwordx4 v[152:155], v1, s[8:11], s36 offen offset:3072 sc1
  s_add_u32 s37, s79, 4096
  buffer_load_dwordx4 v[132:135], v1, s[8:11], s37 offen offset:0 sc1
  buffer_load_dwordx4 v[140:143], v1, s[8:11], s37 offen offset:1024 sc1
  buffer_load_dwordx4 v[148:151], v1, s[8:11], s37 offen offset:2048 sc1
  buffer_load_dwordx4 v[156:159], v1, s[8:11], s37 offen offset:3072 sc1
  s_waitcnt vmcnt(0)
  s_branch oc_36
ocx_37:
  s_setprio 3
  s_waitcnt lgkmcnt(6)
  v_mfma_f32_32x32x16_bf16 v[32:47], v[112:115], v[128:131], v[32:47]
  v_mfma_f32_32x32x16_bf16 v[48:63], v[112:115], v[132:135], v[48:63]
  ds_read_b64_tr_b16 v[104:105], v10 offset:20480
  ds_read_b64_tr_b16 v[106:107], v10 offset:21504
  s_waitcnt lgkmcnt(6)
  v_mfma_f32_32x32x16_bf16 v[64:79], v[116:119], v[128:131], v[64:79]
  v_mfma_f32_32x32x16_bf16 v[80:95], v[116:119], v[132:135], v[80:95]
  ds_read_b64_tr_b16 v[108:109], v11 offset:20480
  ds_read_b64_tr_b16 v[110:111], v11 offset:21504
  s_waitcnt lgkmcnt(6)
  v_mfma_f32_32x32x16_bf16 v[32:47], v[96:99], v[136:139], v[32:47]
  v_mfma_f32_32x32x16_bf16 v[48:63], v[96:99], v[140:143], v[48:63]
  ds_read_b64_tr_b16 v[112:113], v10 offset:22528
  ds_read_b64_tr_b16 v[114:115], v10 offset:23552
  s_waitcnt lgkmcnt(6)
  v_mfma_f32_32x32x16_bf16 v[64:79], v[100:103], v[136:139], v[64:79]
  v_mfma_f32_32x32x16_bf16 v[80:95], v[100:103], v[140:143], v[80:95]
  ds_read_b64_tr_b16 v[116:117], v11 offset:22528
  ds_read_b64_tr_b16 v[118:119], v11 offset:23552
  s_waitcnt lgkmcnt(6)
  v_mfma_f32_32x32x16_bf16 v[32:47], v[104:107], v[144:147], v[32:47]
  v_mfma_f32_32x32x16_bf16 v[48:63], v[104:107], v[148:151], v[48:63]
  s_waitcnt lgkmcnt(4)
  v_mfma_f32_32x32x16_bf16 v[64:79], v[108:111], v[144:147], v[64:79]
  v_mfma_f32_32x32x16_bf16 v[80:95], v[108:111], v[148:151], v[80:95]
  s_waitcnt lgkmcnt(2)
  v_mfma_f32_32x32x16_bf16 v[32:47], v[112:115], v[152:155], v[32:47]
  v_mfma_f32_32x32x16_bf16 v[48:63], v[112:115], v[156:159], v[48:63]
  s_waitcnt lgkmcnt(0)
  v_mfma_f32_32x32x16_bf16 v[64:79], v[116:119], v[152:155], v[64:79]
  v_mfma_f32_32x32x16_bf16 v[80:95], v[116:119], v[156:159], v[80:95]
  s_nop 7
  s_nop 3
  v_mov_b32 v14, 159748
  v_mov_b32 v15, 1
  s_add_u32 s33, s33, 4
  s_waitcnt lgkmcnt(0)
  s_mov_b32 exec_lo, 1
  s_mov_b32 exec_hi, 0
  ds_add_u32 v14, v15
  s_mov_b32 exec_lo, -1
  s_mov_b32 exec_hi, -1
  s_mov_b32 s35, 0
sb_38:
  ds_read_b32 v15, v14
  s_add_u32 s35, s35, 1
  s_waitcnt lgkmcnt(0)
  v_readfirstlane_b32 s34, v15
  s_cmp_gt_u32 s35, 1048576
  s_cbranch_scc1 sbx_39
  s_cmp_lt_u32 s34, s33
  s_cbranch_scc1 sb_38
sbx_39:
  s_xor_b32 s36, s32, 1
  s_mul_i32 s36, s36, 12288
  s_add_u32 s36, s36, 32768
  v_add_u32 v12, s36, v1
  ds_write_b128 v12, v[48:51] offset:0
  ds_write_b128 v12, v[52:55] offset:1024
  ds_write_b128 v12, v[56:59] offset:2048
  ds_write_b128 v12, v[60:63] offset:3072
  s_xor_b32 s36, s32, 2
  s_mul_i32 s36, s36, 12288
  s_add_u32 s36, s36, 36864
  v_add_u32 v12, s36, v1
  ds_write_b128 v12, v[64:67] offset:0
  ds_write_b128 v12, v[68:71] offset:1024
  ds_write_b128 v12, v[72:75] offset:2048
  ds_write_b128 v12, v[76:79] offset:3072
  s_xor_b32 s36, s32, 3
  s_mul_i32 s36, s36, 12288
  s_add_u32 s36, s36, 40960
  v_add_u32 v12, s36, v1
  ds_write_b128 v12, v[80:83] offset:0
  ds_write_b128 v12, v[84:87] offset:1024
  ds_write_b128 v12, v[88:91] offset:2048
  ds_write_b128 v12, v[92:95] offset:3072
  s_mul_i32 s36, s32, 12288
  s_add_u32 s36, s36, 32768
  v_add_u32 v13, s36, v1
  v_mov_b32 v14, 159748
  v_mov_b32 v15, 1
  s_add_u32 s33, s33, 4
  s_waitcnt lgkmcnt(0)
  s_mov_b32 exec_lo, 1
  s_mov_b32 exec_hi, 0
  ds_add_u32 v14, v15
  s_mov_b32 exec_lo, -1
  s_mov_b32 exec_hi, -1
  s_mov_b32 s35, 0
sb_40:
  ds_read_b32 v15, v14
  s_add_u32 s35, s35, 1
  s_waitcnt lgkmcnt(0)
  v_readfirstlane_b32 s34, v15
  s_cmp_gt_u32 s35, 1048576
  s_cbranch_scc1 sbx_41
  s_cmp_lt_u32 s34, s33
  s_cbranch_scc1 sb_40
sbx_41:
  ds_read_b128 v[48:51], v13 offset:0
  ds_read_b128 v[52:55], v13 offset:1024
  ds_read_b128 v[56:59], v13 offset:2048
  ds_read_b128 v[60:63], v13 offset:3072
  ds_read_b128 v[64:67], v13 offset:4096
  ds_read_b128 v[68:71], v13 offset:5120
  ds_read_b128 v[72:75], v13 offset:6144
  ds_read_b128 v[76:79], v13 offset:7168
  ds_read_b128 v[80:83], v13 offset:8192
  ds_read_b128 v[84:87], v13 offset:9216
  ds_read_b128 v[88:91], v13 offset:10240
  ds_read_b128 v[92:95], v13 offset:11264
  s_waitcnt lgkmcnt(8)
  v_add_f32 v32, v32, v48
  v_add_f32 v33, v33, v49
  v_add_f32 v34, v34, v50
  v_add_f32 v35, v35, v51
  v_add_f32 v36, v36, v52
  v_add_f32 v37, v37, v53
  v_add_f32 v38, v38, v54
  v_add_f32 v39, v39, v55
  v_add_f32 v40, v40, v56
  v_add_f32 v41, v41, v57
  v_add_f32 v42, v42, v58
  v_add_f32 v43, v43, v59
  v_add_f32 v44, v44, v60
  v_add_f32 v45, v45, v61
  v_add_f32 v46, v46, v62
  v_add_f32 v47, v47, v63
  s_waitcnt lgkmcnt(4)
  v_add_f32 v32, v32, v64
  v_add_f32 v33, v33, v65
  v_add_f32 v34, v34, v66
  v_add_f32 v35, v35, v67
  v_add_f32 v36, v36, v68
  v_add_f32 v37, v37, v69
  v_add_f32 v38, v38, v70
  v_add_f32 v39, v39, v71
  v_add_f32 v40, v40, v72
  v_add_f32 v41, v41, v73
  v_add_f32 v42, v42, v74
  v_add_f32 v43, v43, v75
  v_add_f32 v44, v44, v76
  v_add_f32 v45, v45, v77
  v_add_f32 v46, v46, v78
  v_add_f32 v47, v47, v79
  s_waitcnt lgkmcnt(0)
  v_add_f32 v32, v32, v80
  v_add_f32 v33, v33, v81
  v_add_f32 v34, v34, v82
  v_add_f32 v35, v35, v83
  v_add_f32 v36, v36, v84
  v_add_f32 v37, v37, v85
  v_add_f32 v38, v38, v86
  v_add_f32 v39, v39, v87
  v_add_f32 v40, v40, v88
  v_add_f32 v41, v41, v89
  v_add_f32 v42, v42, v90
  v_add_f32 v43, v43, v91
  v_add_f32 v44, v44, v92
  v_add_f32 v45, v45, v93
  v_add_f32 v46, v46, v94
  v_add_f32 v47, v47, v95
  v_cvt_pk_bf16_f32 v112, v32, v33
  v_cvt_pk_bf16_f32 v113, v34, v35
  v_cvt_pk_bf16_f32 v114, v36, v37
  v_cvt_pk_bf16_f32 v115, v38, v39
  v_cvt_pk_bf16_f32 v116, v40, v41
  v_cvt_pk_bf16_f32 v117, v42, v43
  v_cvt_pk_bf16_f32 v118, v44, v45
  v_cvt_pk_bf16_f32 v119, v46, v47
  v_permlane32_swap_b32 v112, v114
  v_permlane32_swap_b32 v113, v115
  v_permlane32_swap_b32 v116, v118
  v_permlane32_swap_b32 v117, v119
  buffer_store_dwordx4 v[112:115], v6, s[60:63], 0 offen offset:0
  buffer_store_dwordx4 v[116:119], v6, s[60:63], 0 offen offset:32
parallel_sum__softmax_full_mha__mixer_s_mlp__prompt_kernel_bend:
  s_branch parallel_sum__softmax_full_mha__mixer_s_mlp__prompt_kernel_done
parallel_sum__softmax_full_mha__mixer_s_mlp__prompt_kernel_comp:
  s_waitcnt lgkmcnt(0)
  s_mov_b32 s20, s10
  s_and_b32 s21, s11, 0xffff
  s_mov_b32 s22, 22020096
  s_mov_b32 s23, 0x20000
  s_mov_b32 s60, s52
  s_and_b32 s61, s53, 0xffff
  s_mov_b32 s62, 401408
  s_mov_b32 s63, 0x20000
  s_mov_b32 s64, s54
  s_and_b32 s65, s55, 0xffff
  s_mov_b32 s66, 1605632
  s_mov_b32 s67, 0x20000
  s_mov_b32 s76, s56
  s_and_b32 s77, s57, 0xffff
  s_mov_b32 s78, 1605632
  s_mov_b32 s79, 0x20000
  s_mov_b32 s52, s50
  s_and_b32 s53, s51, 0xffff
  s_mov_b32 s54, 401408
  s_mov_b32 s55, 0x20000
  s_mov_b32 s68, s72
  s_and_b32 s69, s73, 0xffff
  s_mov_b32 s70, 256
  s_mov_b32 s71, 0x20000
  v_mov_b32 v8, 0
  v_mov_b32 v9, 0
  v_mov_b32 v10, 0
  v_mov_b32 v11, 0
  s_cmp_ge_u32 s2, 8
  s_cbranch_scc1 parallel_sum__softmax_full_mha__mixer_s_mlp__prompt_kernel_nz
  s_lshl_b32 s36, s2, 2
  s_add_u32 s36, s36, s29
  s_mul_i32 s36, s36, 14336
  s_add_u32 s36, s36, 524288
  v_lshrrev_b32 v5, 2, v1
  v_lshlrev_b32 v5, 7, v5
  v_and_b32 v6, 3, v1
  v_lshl_add_u32 v5, v6, 4, v5
  buffer_store_dwordx4 v[8:11], v5, s[20:23], s36 offen sc1
  s_add_u32 s36, s36, 2048
  buffer_store_dwordx4 v[8:11], v5, s[20:23], s36 offen sc1
  s_add_u32 s36, s36, 2048
  buffer_store_dwordx4 v[8:11], v5, s[20:23], s36 offen sc1
  s_add_u32 s36, s36, 2048
  buffer_store_dwordx4 v[8:11], v5, s[20:23], s36 offen sc1
  s_add_u32 s36, s36, 2048
  buffer_store_dwordx4 v[8:11], v5, s[20:23], s36 offen sc1
  s_add_u32 s36, s36, 2048
  buffer_store_dwordx4 v[8:11], v5, s[20:23], s36 offen sc1
  s_add_u32 s36, s36, 2048
  buffer_store_dwordx4 v[8:11], v5, s[20:23], s36 offen sc1
parallel_sum__softmax_full_mha__mixer_s_mlp__prompt_kernel_nz:
  s_cmp_lg_u32 s29, 0
  s_cbranch_scc1 parallel_sum__softmax_full_mha__mixer_s_mlp__prompt_kernel_nl
  v_mov_b32 v5, 159744
  v_lshl_add_u32 v5, v1, 2, v5
  ds_write_b32 v5, v8
parallel_sum__softmax_full_mha__mixer_s_mlp__prompt_kernel_nl:
  s_lshl_b32 s40, s30, 1
  s_add_u32 s41, s40, 1
  s_add_u32 s40, s40, s31
  s_sub_u32 s41, s41, s31
  s_lshl_b32 s42, s31, 1
  s_add_u32 s43, s42, 1
  s_add_u32 s42, s42, s30
  s_sub_u32 s43, s43, s30
  v_and_b32 v5, 31, v1
  v_lshrrev_b32 v6, 5, v1
  v_bfe_u32 v7, v1, 1, 3
  v_add_u32 v18, 0, v6
  v_xor_b32 v18, v18, v7
  v_lshlrev_b32 v18, 4, v18
  v_lshl_add_u32 v18, v5, 7, v18
  s_lshl_b32 s36, s40, 12
  v_add_u32 v8, s36, v18
  s_lshl_b32 s36, s41, 12
  v_add_u32 v12, s36, v18
  v_add_u32 v18, 2, v6
  v_xor_b32 v18, v18, v7
  v_lshlrev_b32 v18, 4, v18
  v_lshl_add_u32 v18, v5, 7, v18
  s_lshl_b32 s36, s40, 12
  v_add_u32 v9, s36, v18
  s_lshl_b32 s36, s41, 12
  v_add_u32 v13, s36, v18
  v_add_u32 v18, 4, v6
  v_xor_b32 v18, v18, v7
  v_lshlrev_b32 v18, 4, v18
  v_lshl_add_u32 v18, v5, 7, v18
  s_lshl_b32 s36, s40, 12
  v_add_u32 v10, s36, v18
  s_lshl_b32 s36, s41, 12
  v_add_u32 v14, s36, v18
  v_add_u32 v18, 6, v6
  v_xor_b32 v18, v18, v7
  v_lshlrev_b32 v18, 4, v18
  v_lshl_add_u32 v18, v5, 7, v18
  s_lshl_b32 s36, s40, 12
  v_add_u32 v11, s36, v18
  s_lshl_b32 s36, s41, 12
  v_add_u32 v15, s36, v18
  v_bfe_u32 v5, v1, 2, 2
  v_lshl_add_u32 v18, v6, 3, v5
  v_lshlrev_b32 v18, 8, v18
  v_add_u32 v18, 65536, v18
  v_bfe_u32 v7, v1, 4, 1
  v_lshlrev_b32 v7, 5, v7
  v_and_b32 v19, 3, v1
  v_lshl_add_u32 v7, v19, 3, v7
  s_mul_i32 s36, s42, s28
  v_add_u32 v19, s36, v7
  v_lshrrev_b32 v20, 6, v19
  v_xor_b32 v20, v20, v5
  v_lshlrev_b32 v20, 6, v20
  v_and_b32 v19, 63, v19
  v_add_u32 v19, v19, v20
  v_add_u32 v16, v18, v19
  s_mul_i32 s36, s43, s28
  v_add_u32 v19, s36, v7
  v_lshrrev_b32 v20, 6, v19
  v_xor_b32 v20, v20, v5
  v_lshlrev_b32 v20, 6, v20
  v_and_b32 v19, 63, v19
  v_add_u32 v19, v19, v20
  v_add_u32 v17, v18, v19
  v_mov_b32 v52, 0
  v_mov_b32 v53, 0
  v_mov_b32 v54, 0
  v_mov_b32 v55, 0
  v_mov_b32 v56, 0
  v_mov_b32 v57, 0
  v_mov_b32 v58, 0
  v_mov_b32 v59, 0
  v_mov_b32 v60, 0
  v_mov_b32 v61, 0
  v_mov_b32 v62, 0
  v_mov_b32 v63, 0
  s_mov_b32 s44, 0x3f803f80
  v_and_b32 v240, 3, v1
  v_bfe_u32 v241, v1, 2, 1
  v_bfe_u32 v242, v1, 4, 1
  v_xor_b32 v241, v241, v242
  v_or_b32 v240, v240, v241
  v_cmp_eq_u32 vcc, 0, v240
  v_mov_b32 v241, s44
  v_cndmask_b32 v244, 0, v241, vcc
  v_cndmask_b32 v245, 0, v241, vcc
  v_cndmask_b32 v246, 0, v241, vcc
  v_cndmask_b32 v247, 0, v241, vcc
  s_mov_b32 s45, 0xffff0000
  s_cmp_eq_u32 s26, 2
  s_cbranch_scc1 parallel_sum__softmax_full_mha__mixer_s_mlp__prompt_kernel_v
  s_barrier
  ds_read_b128 v[20:23], v8 offset:0
  ds_read_b128 v[24:27], v12 offset:0
  ds_read_b64_tr_b16 v[28:29], v16 offset:0
  ds_read_b64_tr_b16 v[30:31], v16 offset:1024
  ds_read_b64_tr_b16 v[32:33], v17 offset:0
  ds_read_b64_tr_b16 v[34:35], v17 offset:1024
  s_waitcnt lgkmcnt(0)
  v_mfma_f32_32x32x16_bf16 v[64:79], v[28:31], v[20:23], 0
  ds_read_b128 v[36:39], v9 offset:0
  ds_read_b64_tr_b16 v[44:45], v16 offset:4096
  ds_read_b64_tr_b16 v[46:47], v16 offset:5120
  v_and_b32 v241, s45, v20
  v_lshlrev_b32 v240, 16, v20
  v_fmac_f32 v57, v241, v241
  v_fmac_f32 v56, v240, v240
  v_mfma_f32_32x32x16_bf16 v[80:95], v[32:35], v[20:23], 0
  ds_read_b64_tr_b16 v[48:49], v17 offset:4096
  ds_read_b64_tr_b16 v[50:51], v17 offset:5120
  v_and_b32 v243, s45, v21
  v_lshlrev_b32 v242, 16, v21
  v_fmac_f32 v57, v243, v243
  v_fmac_f32 v56, v242, v242
  v_mfma_f32_16x16x32_bf16 v[52:55], v[244:247], v[20:23], v[52:55]
  v_mfma_f32_32x32x16_bf16 v[96:111], v[28:31], v[24:27], 0
  ds_read_b128 v[40:43], v13 offset:0
  v_and_b32 v241, s45, v22
  v_lshlrev_b32 v240, 16, v22
  v_fmac_f32 v57, v241, v241
  v_fmac_f32 v56, v240, v240
  v_mfma_f32_32x32x16_bf16 v[112:127], v[32:35], v[24:27], 0
  v_and_b32 v243, s45, v23
  v_lshlrev_b32 v242, 16, v23
  v_fmac_f32 v57, v243, v243
  v_fmac_f32 v56, v242, v242
  v_mfma_f32_16x16x32_bf16 v[60:63], v[244:247], v[28:31], v[60:63]
  s_waitcnt lgkmcnt(3)
  v_mfma_f32_32x32x16_bf16 v[64:79], v[44:47], v[36:39], v[64:79]
  ds_read_b128 v[20:23], v10 offset:0
  ds_read_b64_tr_b16 v[28:29], v16 offset:8192
  ds_read_b64_tr_b16 v[30:31], v16 offset:9216
  v_and_b32 v241, s45, v36
  v_lshlrev_b32 v240, 16, v36
  v_fmac_f32 v57, v241, v241
  v_fmac_f32 v56, v240, v240
  s_waitcnt lgkmcnt(4)
  v_mfma_f32_32x32x16_bf16 v[80:95], v[48:51], v[36:39], v[80:95]
  ds_read_b64_tr_b16 v[32:33], v17 offset:8192
  ds_read_b64_tr_b16 v[34:35], v17 offset:9216
  v_and_b32 v243, s45, v37
  v_lshlrev_b32 v242, 16, v37
  v_fmac_f32 v57, v243, v243
  v_fmac_f32 v56, v242, v242
  v_mfma_f32_16x16x32_bf16 v[52:55], v[244:247], v[36:39], v[52:55]
  s_waitcnt lgkmcnt(5)
  v_mfma_f32_32x32x16_bf16 v[96:111], v[44:47], v[40:43], v[96:111]
  ds_read_b128 v[24:27], v14 offset:0
  v_and_b32 v241, s45, v38
  v_lshlrev_b32 v240, 16, v38
  v_fmac_f32 v57, v241, v241
  v_fmac_f32 v56, v240, v240
  v_mfma_f32_32x32x16_bf16 v[112:127], v[48:51], v[40:43], v[112:127]
  v_and_b32 v243, s45, v39
  v_lshlrev_b32 v242, 16, v39
  v_fmac_f32 v57, v243, v243
  v_fmac_f32 v56, v242, v242
  v_mfma_f32_16x16x32_bf16 v[60:63], v[244:247], v[44:47], v[60:63]
  s_waitcnt lgkmcnt(3)
  v_mfma_f32_32x32x16_bf16 v[64:79], v[28:31], v[20:23], v[64:79]
  ds_read_b128 v[36:39], v11 offset:0
  ds_read_b64_tr_b16 v[44:45], v16 offset:12288
  ds_read_b64_tr_b16 v[46:47], v16 offset:13312
  v_and_b32 v241, s45, v20
  v_lshlrev_b32 v240, 16, v20
  v_fmac_f32 v57, v241, v241
  v_fmac_f32 v56, v240, v240
  s_waitcnt lgkmcnt(4)
  v_mfma_f32_32x32x16_bf16 v[80:95], v[32:35], v[20:23], v[80:95]
  ds_read_b64_tr_b16 v[48:49], v17 offset:12288
  ds_read_b64_tr_b16 v[50:51], v17 offset:13312
  v_and_b32 v243, s45, v21
  v_lshlrev_b32 v242, 16, v21
  v_fmac_f32 v57, v243, v243
  v_fmac_f32 v56, v242, v242
  v_mfma_f32_16x16x32_bf16 v[52:55], v[244:247], v[20:23], v[52:55]
  s_waitcnt lgkmcnt(5)
  v_mfma_f32_32x32x16_bf16 v[96:111], v[28:31], v[24:27], v[96:111]
  ds_read_b128 v[40:43], v15 offset:0
  v_and_b32 v241, s45, v22
  v_lshlrev_b32 v240, 16, v22
  v_fmac_f32 v57, v241, v241
  v_fmac_f32 v56, v240, v240
  v_mfma_f32_32x32x16_bf16 v[112:127], v[32:35], v[24:27], v[112:127]
  v_and_b32 v243, s45, v23
  v_lshlrev_b32 v242, 16, v23
  v_fmac_f32 v57, v243, v243
  v_fmac_f32 v56, v242, v242
  v_mfma_f32_16x16x32_bf16 v[60:63], v[244:247], v[28:31], v[60:63]
  s_cmp_ge_u32 s2, 8
  s_cbranch_scc1 na_42
  s_lshl_b32 s36, s2, 4
  s_lshl_b32 s37, s29, 2
  s_add_u32 s36, s36, s37
  v_mov_b32 v248, 0
  v_mov_b32 v249, 1
  s_waitcnt vmcnt(0)
  s_mov_b32 exec_lo, 1
  s_mov_b32 exec_hi, 0
  buffer_store_dword v249, v248, s[68:71], s36 offen sc1
  s_mov_b32 exec_lo, -1
  s_mov_b32 exec_hi, -1
na_42:
  s_waitcnt lgkmcnt(0)
  s_barrier
  v_mfma_f32_32x32x16_bf16 v[64:79], v[44:47], v[36:39], v[64:79]
  ds_read_b128 v[20:23], v8 offset:16384
  ds_read_b64_tr_b16 v[28:29], v16 offset:16384
  ds_read_b64_tr_b16 v[30:31], v16 offset:17408
  v_and_b32 v241, s45, v36
  v_lshlrev_b32 v240, 16, v36
  v_fmac_f32 v57, v241, v241
  v_fmac_f32 v56, v240, v240
  v_mfma_f32_32x32x16_bf16 v[80:95], v[48:51], v[36:39], v[80:95]
  ds_read_b64_tr_b16 v[32:33], v17 offset:16384
  ds_read_b64_tr_b16 v[34:35], v17 offset:17408
  v_and_b32 v243, s45, v37
  v_lshlrev_b32 v242, 16, v37
  v_fmac_f32 v57, v243, v243
  v_fmac_f32 v56, v242, v242
  v_mfma_f32_16x16x32_bf16 v[52:55], v[244:247], v[36:39], v[52:55]
  v_mfma_f32_32x32x16_bf16 v[96:111], v[44:47], v[40:43], v[96:111]
  ds_read_b128 v[24:27], v12 offset:16384
  v_and_b32 v241, s45, v38
  v_lshlrev_b32 v240, 16, v38
  v_fmac_f32 v57, v241, v241
  v_fmac_f32 v56, v240, v240
  v_mfma_f32_32x32x16_bf16 v[112:127], v[48:51], v[40:43], v[112:127]
  v_and_b32 v243, s45, v39
  v_lshlrev_b32 v242, 16, v39
  v_fmac_f32 v57, v243, v243
  v_fmac_f32 v56, v242, v242
  v_mfma_f32_16x16x32_bf16 v[60:63], v[244:247], v[44:47], v[60:63]
  s_waitcnt lgkmcnt(3)
  v_mfma_f32_32x32x16_bf16 v[64:79], v[28:31], v[20:23], v[64:79]
  ds_read_b128 v[36:39], v9 offset:16384
  ds_read_b64_tr_b16 v[44:45], v16 offset:20480
  ds_read_b64_tr_b16 v[46:47], v16 offset:21504
  v_and_b32 v241, s45, v20
  v_lshlrev_b32 v240, 16, v20
  v_fmac_f32 v57, v241, v241
  v_fmac_f32 v56, v240, v240
  s_waitcnt lgkmcnt(4)
  v_mfma_f32_32x32x16_bf16 v[80:95], v[32:35], v[20:23], v[80:95]
  ds_read_b64_tr_b16 v[48:49], v17 offset:20480
  ds_read_b64_tr_b16 v[50:51], v17 offset:21504
  v_and_b32 v243, s45, v21
  v_lshlrev_b32 v242, 16, v21
  v_fmac_f32 v57, v243, v243
  v_fmac_f32 v56, v242, v242
  v_mfma_f32_16x16x32_bf16 v[52:55], v[244:247], v[20:23], v[52:55]
  s_waitcnt lgkmcnt(5)
  v_mfma_f32_32x32x16_bf16 v[96:111], v[28:31], v[24:27], v[96:111]
  ds_read_b128 v[40:43], v13 offset:16384
  v_and_b32 v241, s45, v22
  v_lshlrev_b32 v240, 16, v22
  v_fmac_f32 v57, v241, v241
  v_fmac_f32 v56, v240, v240
  v_mfma_f32_32x32x16_bf16 v[112:127], v[32:35], v[24:27], v[112:127]
  v_and_b32 v243, s45, v23
  v_lshlrev_b32 v242, 16, v23
  v_fmac_f32 v57, v243, v243
  v_fmac_f32 v56, v242, v242
  v_mfma_f32_16x16x32_bf16 v[60:63], v[244:247], v[28:31], v[60:63]
  s_waitcnt lgkmcnt(3)
  v_mfma_f32_32x32x16_bf16 v[64:79], v[44:47], v[36:39], v[64:79]
  ds_read_b128 v[20:23], v10 offset:16384
  ds_read_b64_tr_b16 v[28:29], v16 offset:24576
  ds_read_b64_tr_b16 v[30:31], v16 offset:25600
  v_and_b32 v241, s45, v36
  v_lshlrev_b32 v240, 16, v36
  v_fmac_f32 v57, v241, v241
  v_fmac_f32 v56, v240, v240
  s_waitcnt lgkmcnt(4)
  v_mfma_f32_32x32x16_bf16 v[80:95], v[48:51], v[36:39], v[80:95]
  ds_read_b64_tr_b16 v[32:33], v17 offset:24576
  ds_read_b64_tr_b16 v[34:35], v17 offset:25600
  v_and_b32 v243, s45, v37
  v_lshlrev_b32 v242, 16, v37
  v_fmac_f32 v57, v243, v243
  v_fmac_f32 v56, v242, v242
  v_mfma_f32_16x16x32_bf16 v[52:55], v[244:247], v[36:39], v[52:55]
  s_waitcnt lgkmcnt(5)
  v_mfma_f32_32x32x16_bf16 v[96:111], v[44:47], v[40:43], v[96:111]
  ds_read_b128 v[24:27], v14 offset:16384
  v_and_b32 v241, s45, v38
  v_lshlrev_b32 v240, 16, v38
  v_fmac_f32 v57, v241, v241
  v_fmac_f32 v56, v240, v240
  v_mfma_f32_32x32x16_bf16 v[112:127], v[48:51], v[40:43], v[112:127]
  v_and_b32 v243, s45, v39
  v_lshlrev_b32 v242, 16, v39
  v_fmac_f32 v57, v243, v243
  v_fmac_f32 v56, v242, v242
  v_mfma_f32_16x16x32_bf16 v[60:63], v[244:247], v[44:47], v[60:63]
  s_waitcnt lgkmcnt(3)
  v_mfma_f32_32x32x16_bf16 v[64:79], v[28:31], v[20:23], v[64:79]
  ds_read_b128 v[36:39], v11 offset:16384
  ds_read_b64_tr_b16 v[44:45], v16 offset:28672
  ds_read_b64_tr_b16 v[46:47], v16 offset:29696
  v_and_b32 v241, s45, v20
  v_lshlrev_b32 v240, 16, v20
  v_fmac_f32 v57, v241, v241
  v_fmac_f32 v56, v240, v240
  s_waitcnt lgkmcnt(4)
  v_mfma_f32_32x32x16_bf16 v[80:95], v[32:35], v[20:23], v[80:95]
  ds_read_b64_tr_b16 v[48:49], v17 offset:28672
  ds_read_b64_tr_b16 v[50:51], v17 offset:29696
  v_and_b32 v243, s45, v21
  v_lshlrev_b32 v242, 16, v21
  v_fmac_f32 v57, v243, v243
  v_fmac_f32 v56, v242, v242
  v_mfma_f32_16x16x32_bf16 v[52:55], v[244:247], v[20:23], v[52:55]
  s_waitcnt lgkmcnt(5)
  v_mfma_f32_32x32x16_bf16 v[96:111], v[28:31], v[24:27], v[96:111]
  ds_read_b128 v[40:43], v15 offset:16384
  v_and_b32 v241, s45, v22
  v_lshlrev_b32 v240, 16, v22
  v_fmac_f32 v57, v241, v241
  v_fmac_f32 v56, v240, v240
  v_mfma_f32_32x32x16_bf16 v[112:127], v[32:35], v[24:27], v[112:127]
  v_and_b32 v243, s45, v23
  v_lshlrev_b32 v242, 16, v23
  v_fmac_f32 v57, v243, v243
  v_fmac_f32 v56, v242, v242
  v_mfma_f32_16x16x32_bf16 v[60:63], v[244:247], v[28:31], v[60:63]
  s_waitcnt lgkmcnt(0)
  s_barrier
  v_mfma_f32_32x32x16_bf16 v[64:79], v[44:47], v[36:39], v[64:79]
  ds_read_b128 v[20:23], v8 offset:32768
  ds_read_b64_tr_b16 v[28:29], v16 offset:32768
  ds_read_b64_tr_b16 v[30:31], v16 offset:33792
  v_and_b32 v241, s45, v36
  v_lshlrev_b32 v240, 16, v36
  v_fmac_f32 v57, v241, v241
  v_fmac_f32 v56, v240, v240
  v_mfma_f32_32x32x16_bf16 v[80:95], v[48:51], v[36:39], v[80:95]
  ds_read_b64_tr_b16 v[32:33], v17 offset:32768
  ds_read_b64_tr_b16 v[34:35], v17 offset:33792
  v_and_b32 v243, s45, v37
  v_lshlrev_b32 v242, 16, v37
  v_fmac_f32 v57, v243, v243
  v_fmac_f32 v56, v242, v242
  v_mfma_f32_16x16x32_bf16 v[52:55], v[244:247], v[36:39], v[52:55]
  v_mfma_f32_32x32x16_bf16 v[96:111], v[44:47], v[40:43], v[96:111]
  ds_read_b128 v[24:27], v12 offset:32768
  v_and_b32 v241, s45, v38
  v_lshlrev_b32 v240, 16, v38
  v_fmac_f32 v57, v241, v241
  v_fmac_f32 v56, v240, v240
  v_mfma_f32_32x32x16_bf16 v[112:127], v[48:51], v[40:43], v[112:127]
  v_and_b32 v243, s45, v39
  v_lshlrev_b32 v242, 16, v39
  v_fmac_f32 v57, v243, v243
  v_fmac_f32 v56, v242, v242
  v_mfma_f32_16x16x32_bf16 v[60:63], v[244:247], v[44:47], v[60:63]
  s_waitcnt lgkmcnt(3)
  v_mfma_f32_32x32x16_bf16 v[64:79], v[28:31], v[20:23], v[64:79]
  ds_read_b128 v[36:39], v9 offset:32768
  ds_read_b64_tr_b16 v[44:45], v16 offset:36864
  ds_read_b64_tr_b16 v[46:47], v16 offset:37888
  v_and_b32 v241, s45, v20
  v_lshlrev_b32 v240, 16, v20
  v_fmac_f32 v57, v241, v241
  v_fmac_f32 v56, v240, v240
  s_waitcnt lgkmcnt(4)
  v_mfma_f32_32x32x16_bf16 v[80:95], v[32:35], v[20:23], v[80:95]
  ds_read_b64_tr_b16 v[48:49], v17 offset:36864
  ds_read_b64_tr_b16 v[50:51], v17 offset:37888
  v_and_b32 v243, s45, v21
  v_lshlrev_b32 v242, 16, v21
  v_fmac_f32 v57, v243, v243
  v_fmac_f32 v56, v242, v242
  v_mfma_f32_16x16x32_bf16 v[52:55], v[244:247], v[20:23], v[52:55]
  s_waitcnt lgkmcnt(5)
  v_mfma_f32_32x32x16_bf16 v[96:111], v[28:31], v[24:27], v[96:111]
  ds_read_b128 v[40:43], v13 offset:32768
  v_and_b32 v241, s45, v22
  v_lshlrev_b32 v240, 16, v22
  v_fmac_f32 v57, v241, v241
  v_fmac_f32 v56, v240, v240
  v_mfma_f32_32x32x16_bf16 v[112:127], v[32:35], v[24:27], v[112:127]
  v_and_b32 v243, s45, v23
  v_lshlrev_b32 v242, 16, v23
  v_fmac_f32 v57, v243, v243
  v_fmac_f32 v56, v242, v242
  v_mfma_f32_16x16x32_bf16 v[60:63], v[244:247], v[28:31], v[60:63]
  s_waitcnt lgkmcnt(3)
  v_mfma_f32_32x32x16_bf16 v[64:79], v[44:47], v[36:39], v[64:79]
  ds_read_b128 v[20:23], v10 offset:32768
  ds_read_b64_tr_b16 v[28:29], v16 offset:40960
  ds_read_b64_tr_b16 v[30:31], v16 offset:41984
  v_and_b32 v241, s45, v36
  v_lshlrev_b32 v240, 16, v36
  v_fmac_f32 v57, v241, v241
  v_fmac_f32 v56, v240, v240
  s_waitcnt lgkmcnt(4)
  v_mfma_f32_32x32x16_bf16 v[80:95], v[48:51], v[36:39], v[80:95]
  ds_read_b64_tr_b16 v[32:33], v17 offset:40960
  ds_read_b64_tr_b16 v[34:35], v17 offset:41984
  v_and_b32 v243, s45, v37
  v_lshlrev_b32 v242, 16, v37
  v_fmac_f32 v57, v243, v243
  v_fmac_f32 v56, v242, v242
  v_mfma_f32_16x16x32_bf16 v[52:55], v[244:247], v[36:39], v[52:55]
  s_waitcnt lgkmcnt(5)
  v_mfma_f32_32x32x16_bf16 v[96:111], v[44:47], v[40:43], v[96:111]
  ds_read_b128 v[24:27], v14 offset:32768
  v_and_b32 v241, s45, v38
  v_lshlrev_b32 v240, 16, v38
  v_fmac_f32 v57, v241, v241
  v_fmac_f32 v56, v240, v240
  v_mfma_f32_32x32x16_bf16 v[112:127], v[48:51], v[40:43], v[112:127]
  v_and_b32 v243, s45, v39
  v_lshlrev_b32 v242, 16, v39
  v_fmac_f32 v57, v243, v243
  v_fmac_f32 v56, v242, v242
  v_mfma_f32_16x16x32_bf16 v[60:63], v[244:247], v[44:47], v[60:63]
  s_waitcnt lgkmcnt(3)
  v_mfma_f32_32x32x16_bf16 v[64:79], v[28:31], v[20:23], v[64:79]
  ds_read_b128 v[36:39], v11 offset:32768
  ds_read_b64_tr_b16 v[44:45], v16 offset:45056
  ds_read_b64_tr_b16 v[46:47], v16 offset:46080
  v_and_b32 v241, s45, v20
  v_lshlrev_b32 v240, 16, v20
  v_fmac_f32 v57, v241, v241
  v_fmac_f32 v56, v240, v240
  s_waitcnt lgkmcnt(4)
  v_mfma_f32_32x32x16_bf16 v[80:95], v[32:35], v[20:23], v[80:95]
  ds_read_b64_tr_b16 v[48:49], v17 offset:45056
  ds_read_b64_tr_b16 v[50:51], v17 offset:46080
  v_and_b32 v243, s45, v21
  v_lshlrev_b32 v242, 16, v21
  v_fmac_f32 v57, v243, v243
  v_fmac_f32 v56, v242, v242
  v_mfma_f32_16x16x32_bf16 v[52:55], v[244:247], v[20:23], v[52:55]
  s_waitcnt lgkmcnt(5)
  v_mfma_f32_32x32x16_bf16 v[96:111], v[28:31], v[24:27], v[96:111]
  ds_read_b128 v[40:43], v15 offset:32768
  v_and_b32 v241, s45, v22
  v_lshlrev_b32 v240, 16, v22
  v_fmac_f32 v57, v241, v241
  v_fmac_f32 v56, v240, v240
  v_mfma_f32_32x32x16_bf16 v[112:127], v[32:35], v[24:27], v[112:127]
  v_and_b32 v243, s45, v23
  v_lshlrev_b32 v242, 16, v23
  v_fmac_f32 v57, v243, v243
  v_fmac_f32 v56, v242, v242
  v_mfma_f32_16x16x32_bf16 v[60:63], v[244:247], v[28:31], v[60:63]
  s_waitcnt lgkmcnt(0)
  s_barrier
  v_mfma_f32_32x32x16_bf16 v[64:79], v[44:47], v[36:39], v[64:79]
  ds_read_b128 v[20:23], v8 offset:49152
  ds_read_b64_tr_b16 v[28:29], v16 offset:49152
  ds_read_b64_tr_b16 v[30:31], v16 offset:50176
  v_and_b32 v241, s45, v36
  v_lshlrev_b32 v240, 16, v36
  v_fmac_f32 v57, v241, v241
  v_fmac_f32 v56, v240, v240
  v_mfma_f32_32x32x16_bf16 v[80:95], v[48:51], v[36:39], v[80:95]
  ds_read_b64_tr_b16 v[32:33], v17 offset:49152
  ds_read_b64_tr_b16 v[34:35], v17 offset:50176
  v_and_b32 v243, s45, v37
  v_lshlrev_b32 v242, 16, v37
  v_fmac_f32 v57, v243, v243
  v_fmac_f32 v56, v242, v242
  v_mfma_f32_16x16x32_bf16 v[52:55], v[244:247], v[36:39], v[52:55]
  v_mfma_f32_32x32x16_bf16 v[96:111], v[44:47], v[40:43], v[96:111]
  ds_read_b128 v[24:27], v12 offset:49152
  v_and_b32 v241, s45, v38
  v_lshlrev_b32 v240, 16, v38
  v_fmac_f32 v57, v241, v241
  v_fmac_f32 v56, v240, v240
  v_mfma_f32_32x32x16_bf16 v[112:127], v[48:51], v[40:43], v[112:127]
  v_and_b32 v243, s45, v39
  v_lshlrev_b32 v242, 16, v39
  v_fmac_f32 v57, v243, v243
  v_fmac_f32 v56, v242, v242
  v_mfma_f32_16x16x32_bf16 v[60:63], v[244:247], v[44:47], v[60:63]
  s_waitcnt lgkmcnt(3)
  v_mfma_f32_32x32x16_bf16 v[64:79], v[28:31], v[20:23], v[64:79]
  ds_read_b128 v[36:39], v9 offset:49152
  ds_read_b64_tr_b16 v[44:45], v16 offset:53248
  ds_read_b64_tr_b16 v[46:47], v16 offset:54272
  v_and_b32 v241, s45, v20
  v_lshlrev_b32 v240, 16, v20
  v_fmac_f32 v57, v241, v241
  v_fmac_f32 v56, v240, v240
  s_waitcnt lgkmcnt(4)
  v_mfma_f32_32x32x16_bf16 v[80:95], v[32:35], v[20:23], v[80:95]
  ds_read_b64_tr_b16 v[48:49], v17 offset:53248
  ds_read_b64_tr_b16 v[50:51], v17 offset:54272
  v_and_b32 v243, s45, v21
  v_lshlrev_b32 v242, 16, v21
  v_fmac_f32 v57, v243, v243
  v_fmac_f32 v56, v242, v242
  v_mfma_f32_16x16x32_bf16 v[52:55], v[244:247], v[20:23], v[52:55]
  s_waitcnt lgkmcnt(5)
  v_mfma_f32_32x32x16_bf16 v[96:111], v[28:31], v[24:27], v[96:111]
  ds_read_b128 v[40:43], v13 offset:49152
  v_and_b32 v241, s45, v22
  v_lshlrev_b32 v240, 16, v22
  v_fmac_f32 v57, v241, v241
  v_fmac_f32 v56, v240, v240
  v_mfma_f32_32x32x16_bf16 v[112:127], v[32:35], v[24:27], v[112:127]
  v_and_b32 v243, s45, v23
  v_lshlrev_b32 v242, 16, v23
  v_fmac_f32 v57, v243, v243
  v_fmac_f32 v56, v242, v242
  v_mfma_f32_16x16x32_bf16 v[60:63], v[244:247], v[28:31], v[60:63]
  s_waitcnt lgkmcnt(3)
  v_mfma_f32_32x32x16_bf16 v[64:79], v[44:47], v[36:39], v[64:79]
  ds_read_b128 v[20:23], v10 offset:49152
  ds_read_b64_tr_b16 v[28:29], v16 offset:57344
  ds_read_b64_tr_b16 v[30:31], v16 offset:58368
  v_and_b32 v241, s45, v36
  v_lshlrev_b32 v240, 16, v36
  v_fmac_f32 v57, v241, v241
  v_fmac_f32 v56, v240, v240
  s_waitcnt lgkmcnt(4)
  v_mfma_f32_32x32x16_bf16 v[80:95], v[48:51], v[36:39], v[80:95]
  ds_read_b64_tr_b16 v[32:33], v17 offset:57344
  ds_read_b64_tr_b16 v[34:35], v17 offset:58368
  v_and_b32 v243, s45, v37
  v_lshlrev_b32 v242, 16, v37
  v_fmac_f32 v57, v243, v243
  v_fmac_f32 v56, v242, v242
  v_mfma_f32_16x16x32_bf16 v[52:55], v[244:247], v[36:39], v[52:55]
  s_waitcnt lgkmcnt(5)
  v_mfma_f32_32x32x16_bf16 v[96:111], v[44:47], v[40:43], v[96:111]
  ds_read_b128 v[24:27], v14 offset:49152
  v_and_b32 v241, s45, v38
  v_lshlrev_b32 v240, 16, v38
  v_fmac_f32 v57, v241, v241
  v_fmac_f32 v56, v240, v240
  v_mfma_f32_32x32x16_bf16 v[112:127], v[48:51], v[40:43], v[112:127]
  v_and_b32 v243, s45, v39
  v_lshlrev_b32 v242, 16, v39
  v_fmac_f32 v57, v243, v243
  v_fmac_f32 v56, v242, v242
  v_mfma_f32_16x16x32_bf16 v[60:63], v[244:247], v[44:47], v[60:63]
  s_waitcnt lgkmcnt(3)
  v_mfma_f32_32x32x16_bf16 v[64:79], v[28:31], v[20:23], v[64:79]
  ds_read_b128 v[36:39], v11 offset:49152
  ds_read_b64_tr_b16 v[44:45], v16 offset:61440
  ds_read_b64_tr_b16 v[46:47], v16 offset:62464
  v_and_b32 v241, s45, v20
  v_lshlrev_b32 v240, 16, v20
  v_fmac_f32 v57, v241, v241
  v_fmac_f32 v56, v240, v240
  s_waitcnt lgkmcnt(4)
  v_mfma_f32_32x32x16_bf16 v[80:95], v[32:35], v[20:23], v[80:95]
  ds_read_b64_tr_b16 v[48:49], v17 offset:61440
  ds_read_b64_tr_b16 v[50:51], v17 offset:62464
  v_and_b32 v243, s45, v21
  v_lshlrev_b32 v242, 16, v21
  v_fmac_f32 v57, v243, v243
  v_fmac_f32 v56, v242, v242
  v_mfma_f32_16x16x32_bf16 v[52:55], v[244:247], v[20:23], v[52:55]
  s_waitcnt lgkmcnt(5)
  v_mfma_f32_32x32x16_bf16 v[96:111], v[28:31], v[24:27], v[96:111]
  ds_read_b128 v[40:43], v15 offset:49152
  v_and_b32 v241, s45, v22
  v_lshlrev_b32 v240, 16, v22
  v_fmac_f32 v57, v241, v241
  v_fmac_f32 v56, v240, v240
  v_mfma_f32_32x32x16_bf16 v[112:127], v[32:35], v[24:27], v[112:127]
  v_and_b32 v243, s45, v23
  v_lshlrev_b32 v242, 16, v23
  v_fmac_f32 v57, v243, v243
  v_fmac_f32 v56, v242, v242
  v_mfma_f32_16x16x32_bf16 v[60:63], v[244:247], v[28:31], v[60:63]
  s_waitcnt lgkmcnt(0)
  s_barrier
  v_mfma_f32_32x32x16_bf16 v[64:79], v[44:47], v[36:39], v[64:79]
  ds_read_b128 v[20:23], v8 offset:0
  ds_read_b64_tr_b16 v[28:29], v16 offset:0
  ds_read_b64_tr_b16 v[30:31], v16 offset:1024
  v_and_b32 v241, s45, v36
  v_lshlrev_b32 v240, 16, v36
  v_fmac_f32 v57, v241, v241
  v_fmac_f32 v56, v240, v240
  v_mfma_f32_32x32x16_bf16 v[80:95], v[48:51], v[36:39], v[80:95]
  ds_read_b64_tr_b16 v[32:33], v17 offset:0
  ds_read_b64_tr_b16 v[34:35], v17 offset:1024
  v_and_b32 v243, s45, v37
  v_lshlrev_b32 v242, 16, v37
  v_fmac_f32 v57, v243, v243
  v_fmac_f32 v56, v242, v242
  v_mfma_f32_16x16x32_bf16 v[52:55], v[244:247], v[36:39], v[52:55]
  v_mfma_f32_32x32x16_bf16 v[96:111], v[44:47], v[40:43], v[96:111]
  ds_read_b128 v[24:27], v12 offset:0
  v_and_b32 v241, s45, v38
  v_lshlrev_b32 v240, 16, v38
  v_fmac_f32 v57, v241, v241
  v_fmac_f32 v56, v240, v240
  v_mfma_f32_32x32x16_bf16 v[112:127], v[48:51], v[40:43], v[112:127]
  v_and_b32 v243, s45, v39
  v_lshlrev_b32 v242, 16, v39
  v_fmac_f32 v57, v243, v243
  v_fmac_f32 v56, v242, v242
  v_mfma_f32_16x16x32_bf16 v[60:63], v[244:247], v[44:47], v[60:63]
  s_waitcnt lgkmcnt(3)
  v_mfma_f32_32x32x16_bf16 v[64:79], v[28:31], v[20:23], v[64:79]
  ds_read_b128 v[36:39], v9 offset:0
  ds_read_b64_tr_b16 v[44:45], v16 offset:4096
  ds_read_b64_tr_b16 v[46:47], v16 offset:5120
  v_and_b32 v241, s45, v20
  v_lshlrev_b32 v240, 16, v20
  v_fmac_f32 v57, v241, v241
  v_fmac_f32 v56, v240, v240
  s_waitcnt lgkmcnt(4)
  v_mfma_f32_32x32x16_bf16 v[80:95], v[32:35], v[20:23], v[80:95]
  ds_read_b64_tr_b16 v[48:49], v17 offset:4096
  ds_read_b64_tr_b16 v[50:51], v17 offset:5120
  v_and_b32 v243, s45, v21
  v_lshlrev_b32 v242, 16, v21
  v_fmac_f32 v57, v243, v243
  v_fmac_f32 v56, v242, v242
  v_mfma_f32_16x16x32_bf16 v[52:55], v[244:247], v[20:23], v[52:55]
  s_waitcnt lgkmcnt(5)
  v_mfma_f32_32x32x16_bf16 v[96:111], v[28:31], v[24:27], v[96:111]
  ds_read_b128 v[40:43], v13 offset:0
  v_and_b32 v241, s45, v22
  v_lshlrev_b32 v240, 16, v22
  v_fmac_f32 v57, v241, v241
  v_fmac_f32 v56, v240, v240
  v_mfma_f32_32x32x16_bf16 v[112:127], v[32:35], v[24:27], v[112:127]
  v_and_b32 v243, s45, v23
  v_lshlrev_b32 v242, 16, v23
  v_fmac_f32 v57, v243, v243
  v_fmac_f32 v56, v242, v242
  v_mfma_f32_16x16x32_bf16 v[60:63], v[244:247], v[28:31], v[60:63]
  s_waitcnt lgkmcnt(3)
  v_mfma_f32_32x32x16_bf16 v[64:79], v[44:47], v[36:39], v[64:79]
  ds_read_b128 v[20:23], v10 offset:0
  ds_read_b64_tr_b16 v[28:29], v16 offset:8192
  ds_read_b64_tr_b16 v[30:31], v16 offset:9216
  v_and_b32 v241, s45, v36
  v_lshlrev_b32 v240, 16, v36
  v_fmac_f32 v57, v241, v241
  v_fmac_f32 v56, v240, v240
  s_waitcnt lgkmcnt(4)
  v_mfma_f32_32x32x16_bf16 v[80:95], v[48:51], v[36:39], v[80:95]
  ds_read_b64_tr_b16 v[32:33], v17 offset:8192
  ds_read_b64_tr_b16 v[34:35], v17 offset:9216
  v_and_b32 v243, s45, v37
  v_lshlrev_b32 v242, 16, v37
  v_fmac_f32 v57, v243, v243
  v_fmac_f32 v56, v242, v242
  v_mfma_f32_16x16x32_bf16 v[52:55], v[244:247], v[36:39], v[52:55]
  s_waitcnt lgkmcnt(5)
  v_mfma_f32_32x32x16_bf16 v[96:111], v[44:47], v[40:43], v[96:111]
  ds_read_b128 v[24:27], v14 offset:0
  v_and_b32 v241, s45, v38
  v_lshlrev_b32 v240, 16, v38
  v_fmac_f32 v57, v241, v241
  v_fmac_f32 v56, v240, v240
  v_mfma_f32_32x32x16_bf16 v[112:127], v[48:51], v[40:43], v[112:127]
  v_and_b32 v243, s45, v39
  v_lshlrev_b32 v242, 16, v39
  v_fmac_f32 v57, v243, v243
  v_fmac_f32 v56, v242, v242
  v_mfma_f32_16x16x32_bf16 v[60:63], v[244:247], v[44:47], v[60:63]
  s_waitcnt lgkmcnt(3)
  v_mfma_f32_32x32x16_bf16 v[64:79], v[28:31], v[20:23], v[64:79]
  ds_read_b128 v[36:39], v11 offset:0
  ds_read_b64_tr_b16 v[44:45], v16 offset:12288
  ds_read_b64_tr_b16 v[46:47], v16 offset:13312
  v_and_b32 v241, s45, v20
  v_lshlrev_b32 v240, 16, v20
  v_fmac_f32 v57, v241, v241
  v_fmac_f32 v56, v240, v240
  s_waitcnt lgkmcnt(4)
  v_mfma_f32_32x32x16_bf16 v[80:95], v[32:35], v[20:23], v[80:95]
  ds_read_b64_tr_b16 v[48:49], v17 offset:12288
  ds_read_b64_tr_b16 v[50:51], v17 offset:13312
  v_and_b32 v243, s45, v21
  v_lshlrev_b32 v242, 16, v21
  v_fmac_f32 v57, v243, v243
  v_fmac_f32 v56, v242, v242
  v_mfma_f32_16x16x32_bf16 v[52:55], v[244:247], v[20:23], v[52:55]
  s_waitcnt lgkmcnt(5)
  v_mfma_f32_32x32x16_bf16 v[96:111], v[28:31], v[24:27], v[96:111]
  ds_read_b128 v[40:43], v15 offset:0
  v_and_b32 v241, s45, v22
  v_lshlrev_b32 v240, 16, v22
  v_fmac_f32 v57, v241, v241
  v_fmac_f32 v56, v240, v240
  v_mfma_f32_32x32x16_bf16 v[112:127], v[32:35], v[24:27], v[112:127]
  v_and_b32 v243, s45, v23
  v_lshlrev_b32 v242, 16, v23
  v_fmac_f32 v57, v243, v243
  v_fmac_f32 v56, v242, v242
  v_mfma_f32_16x16x32_bf16 v[60:63], v[244:247], v[28:31], v[60:63]
  s_waitcnt lgkmcnt(0)
  s_barrier
  v_mfma_f32_32x32x16_bf16 v[64:79], v[44:47], v[36:39], v[64:79]
  ds_read_b128 v[20:23], v8 offset:16384
  ds_read_b64_tr_b16 v[28:29], v16 offset:16384
  ds_read_b64_tr_b16 v[30:31], v16 offset:17408
  v_and_b32 v241, s45, v36
  v_lshlrev_b32 v240, 16, v36
  v_fmac_f32 v57, v241, v241
  v_fmac_f32 v56, v240, v240
  v_mfma_f32_32x32x16_bf16 v[80:95], v[48:51], v[36:39], v[80:95]
  ds_read_b64_tr_b16 v[32:33], v17 offset:16384
  ds_read_b64_tr_b16 v[34:35], v17 offset:17408
  v_and_b32 v243, s45, v37
  v_lshlrev_b32 v242, 16, v37
  v_fmac_f32 v57, v243, v243
  v_fmac_f32 v56, v242, v242
  v_mfma_f32_16x16x32_bf16 v[52:55], v[244:247], v[36:39], v[52:55]
  v_mfma_f32_32x32x16_bf16 v[96:111], v[44:47], v[40:43], v[96:111]
  ds_read_b128 v[24:27], v12 offset:16384
  v_and_b32 v241, s45, v38
  v_lshlrev_b32 v240, 16, v38
  v_fmac_f32 v57, v241, v241
  v_fmac_f32 v56, v240, v240
  v_mfma_f32_32x32x16_bf16 v[112:127], v[48:51], v[40:43], v[112:127]
  v_and_b32 v243, s45, v39
  v_lshlrev_b32 v242, 16, v39
  v_fmac_f32 v57, v243, v243
  v_fmac_f32 v56, v242, v242
  v_mfma_f32_16x16x32_bf16 v[60:63], v[244:247], v[44:47], v[60:63]
  s_waitcnt lgkmcnt(3)
  v_mfma_f32_32x32x16_bf16 v[64:79], v[28:31], v[20:23], v[64:79]
  ds_read_b128 v[36:39], v9 offset:16384
  ds_read_b64_tr_b16 v[44:45], v16 offset:20480
  ds_read_b64_tr_b16 v[46:47], v16 offset:21504
  v_and_b32 v241, s45, v20
  v_lshlrev_b32 v240, 16, v20
  v_fmac_f32 v57, v241, v241
  v_fmac_f32 v56, v240, v240
  s_waitcnt lgkmcnt(4)
  v_mfma_f32_32x32x16_bf16 v[80:95], v[32:35], v[20:23], v[80:95]
  ds_read_b64_tr_b16 v[48:49], v17 offset:20480
  ds_read_b64_tr_b16 v[50:51], v17 offset:21504
  v_and_b32 v243, s45, v21
  v_lshlrev_b32 v242, 16, v21
  v_fmac_f32 v57, v243, v243
  v_fmac_f32 v56, v242, v242
  v_mfma_f32_16x16x32_bf16 v[52:55], v[244:247], v[20:23], v[52:55]
  s_waitcnt lgkmcnt(5)
  v_mfma_f32_32x32x16_bf16 v[96:111], v[28:31], v[24:27], v[96:111]
  ds_read_b128 v[40:43], v13 offset:16384
  v_and_b32 v241, s45, v22
  v_lshlrev_b32 v240, 16, v22
  v_fmac_f32 v57, v241, v241
  v_fmac_f32 v56, v240, v240
  v_mfma_f32_32x32x16_bf16 v[112:127], v[32:35], v[24:27], v[112:127]
  v_and_b32 v243, s45, v23
  v_lshlrev_b32 v242, 16, v23
  v_fmac_f32 v57, v243, v243
  v_fmac_f32 v56, v242, v242
  v_mfma_f32_16x16x32_bf16 v[60:63], v[244:247], v[28:31], v[60:63]
  s_waitcnt lgkmcnt(3)
  v_mfma_f32_32x32x16_bf16 v[64:79], v[44:47], v[36:39], v[64:79]
  ds_read_b128 v[20:23], v10 offset:16384
  ds_read_b64_tr_b16 v[28:29], v16 offset:24576
  ds_read_b64_tr_b16 v[30:31], v16 offset:25600
  v_and_b32 v241, s45, v36
  v_lshlrev_b32 v240, 16, v36
  v_fmac_f32 v57, v241, v241
  v_fmac_f32 v56, v240, v240
  s_waitcnt lgkmcnt(4)
  v_mfma_f32_32x32x16_bf16 v[80:95], v[48:51], v[36:39], v[80:95]
  ds_read_b64_tr_b16 v[32:33], v17 offset:24576
  ds_read_b64_tr_b16 v[34:35], v17 offset:25600
  v_and_b32 v243, s45, v37
  v_lshlrev_b32 v242, 16, v37
  v_fmac_f32 v57, v243, v243
  v_fmac_f32 v56, v242, v242
  v_mfma_f32_16x16x32_bf16 v[52:55], v[244:247], v[36:39], v[52:55]
  s_waitcnt lgkmcnt(5)
  v_mfma_f32_32x32x16_bf16 v[96:111], v[44:47], v[40:43], v[96:111]
  ds_read_b128 v[24:27], v14 offset:16384
  v_and_b32 v241, s45, v38
  v_lshlrev_b32 v240, 16, v38
  v_fmac_f32 v57, v241, v241
  v_fmac_f32 v56, v240, v240
  v_mfma_f32_32x32x16_bf16 v[112:127], v[48:51], v[40:43], v[112:127]
  v_and_b32 v243, s45, v39
  v_lshlrev_b32 v242, 16, v39
  v_fmac_f32 v57, v243, v243
  v_fmac_f32 v56, v242, v242
  v_mfma_f32_16x16x32_bf16 v[60:63], v[244:247], v[44:47], v[60:63]
  s_waitcnt lgkmcnt(3)
  v_mfma_f32_32x32x16_bf16 v[64:79], v[28:31], v[20:23], v[64:79]
  ds_read_b128 v[36:39], v11 offset:16384
  ds_read_b64_tr_b16 v[44:45], v16 offset:28672
  ds_read_b64_tr_b16 v[46:47], v16 offset:29696
  v_and_b32 v241, s45, v20
  v_lshlrev_b32 v240, 16, v20
  v_fmac_f32 v57, v241, v241
  v_fmac_f32 v56, v240, v240
  s_waitcnt lgkmcnt(4)
  v_mfma_f32_32x32x16_bf16 v[80:95], v[32:35], v[20:23], v[80:95]
  ds_read_b64_tr_b16 v[48:49], v17 offset:28672
  ds_read_b64_tr_b16 v[50:51], v17 offset:29696
  v_and_b32 v243, s45, v21
  v_lshlrev_b32 v242, 16, v21
  v_fmac_f32 v57, v243, v243
  v_fmac_f32 v56, v242, v242
  v_mfma_f32_16x16x32_bf16 v[52:55], v[244:247], v[20:23], v[52:55]
  s_waitcnt lgkmcnt(5)
  v_mfma_f32_32x32x16_bf16 v[96:111], v[28:31], v[24:27], v[96:111]
  ds_read_b128 v[40:43], v15 offset:16384
  v_and_b32 v241, s45, v22
  v_lshlrev_b32 v240, 16, v22
  v_fmac_f32 v57, v241, v241
  v_fmac_f32 v56, v240, v240
  v_mfma_f32_32x32x16_bf16 v[112:127], v[32:35], v[24:27], v[112:127]
  v_and_b32 v243, s45, v23
  v_lshlrev_b32 v242, 16, v23
  v_fmac_f32 v57, v243, v243
  v_fmac_f32 v56, v242, v242
  v_mfma_f32_16x16x32_bf16 v[60:63], v[244:247], v[28:31], v[60:63]
  s_waitcnt lgkmcnt(0)
  s_barrier
  v_mfma_f32_32x32x16_bf16 v[64:79], v[44:47], v[36:39], v[64:79]
  ds_read_b128 v[20:23], v8 offset:32768
  ds_read_b64_tr_b16 v[28:29], v16 offset:32768
  ds_read_b64_tr_b16 v[30:31], v16 offset:33792
  v_and_b32 v241, s45, v36
  v_lshlrev_b32 v240, 16, v36
  v_fmac_f32 v57, v241, v241
  v_fmac_f32 v56, v240, v240
  v_mfma_f32_32x32x16_bf16 v[80:95], v[48:51], v[36:39], v[80:95]
  ds_read_b64_tr_b16 v[32:33], v17 offset:32768
  ds_read_b64_tr_b16 v[34:35], v17 offset:33792
  v_and_b32 v243, s45, v37
  v_lshlrev_b32 v242, 16, v37
  v_fmac_f32 v57, v243, v243
  v_fmac_f32 v56, v242, v242
  v_mfma_f32_16x16x32_bf16 v[52:55], v[244:247], v[36:39], v[52:55]
  v_mfma_f32_32x32x16_bf16 v[96:111], v[44:47], v[40:43], v[96:111]
  ds_read_b128 v[24:27], v12 offset:32768
  v_and_b32 v241, s45, v38
  v_lshlrev_b32 v240, 16, v38
  v_fmac_f32 v57, v241, v241
  v_fmac_f32 v56, v240, v240
  v_mfma_f32_32x32x16_bf16 v[112:127], v[48:51], v[40:43], v[112:127]
  v_and_b32 v243, s45, v39
  v_lshlrev_b32 v242, 16, v39
  v_fmac_f32 v57, v243, v243
  v_fmac_f32 v56, v242, v242
  v_mfma_f32_16x16x32_bf16 v[60:63], v[244:247], v[44:47], v[60:63]
  s_waitcnt lgkmcnt(3)
  v_mfma_f32_32x32x16_bf16 v[64:79], v[28:31], v[20:23], v[64:79]
  ds_read_b128 v[36:39], v9 offset:32768
  ds_read_b64_tr_b16 v[44:45], v16 offset:36864
  ds_read_b64_tr_b16 v[46:47], v16 offset:37888
  v_and_b32 v241, s45, v20
  v_lshlrev_b32 v240, 16, v20
  v_fmac_f32 v57, v241, v241
  v_fmac_f32 v56, v240, v240
  s_waitcnt lgkmcnt(4)
  v_mfma_f32_32x32x16_bf16 v[80:95], v[32:35], v[20:23], v[80:95]
  ds_read_b64_tr_b16 v[48:49], v17 offset:36864
  ds_read_b64_tr_b16 v[50:51], v17 offset:37888
  v_and_b32 v243, s45, v21
  v_lshlrev_b32 v242, 16, v21
  v_fmac_f32 v57, v243, v243
  v_fmac_f32 v56, v242, v242
  v_mfma_f32_16x16x32_bf16 v[52:55], v[244:247], v[20:23], v[52:55]
  s_waitcnt lgkmcnt(5)
  v_mfma_f32_32x32x16_bf16 v[96:111], v[28:31], v[24:27], v[96:111]
  ds_read_b128 v[40:43], v13 offset:32768
  v_and_b32 v241, s45, v22
  v_lshlrev_b32 v240, 16, v22
  v_fmac_f32 v57, v241, v241
  v_fmac_f32 v56, v240, v240
  v_mfma_f32_32x32x16_bf16 v[112:127], v[32:35], v[24:27], v[112:127]
  v_and_b32 v243, s45, v23
  v_lshlrev_b32 v242, 16, v23
  v_fmac_f32 v57, v243, v243
  v_fmac_f32 v56, v242, v242
  v_mfma_f32_16x16x32_bf16 v[60:63], v[244:247], v[28:31], v[60:63]
  s_waitcnt lgkmcnt(3)
  v_mfma_f32_32x32x16_bf16 v[64:79], v[44:47], v[36:39], v[64:79]
  ds_read_b128 v[20:23], v10 offset:32768
  ds_read_b64_tr_b16 v[28:29], v16 offset:40960
  ds_read_b64_tr_b16 v[30:31], v16 offset:41984
  v_and_b32 v241, s45, v36
  v_lshlrev_b32 v240, 16, v36
  v_fmac_f32 v57, v241, v241
  v_fmac_f32 v56, v240, v240
  s_waitcnt lgkmcnt(4)
  v_mfma_f32_32x32x16_bf16 v[80:95], v[48:51], v[36:39], v[80:95]
  ds_read_b64_tr_b16 v[32:33], v17 offset:40960
  ds_read_b64_tr_b16 v[34:35], v17 offset:41984
  v_and_b32 v243, s45, v37
  v_lshlrev_b32 v242, 16, v37
  v_fmac_f32 v57, v243, v243
  v_fmac_f32 v56, v242, v242
  v_mfma_f32_16x16x32_bf16 v[52:55], v[244:247], v[36:39], v[52:55]
  s_waitcnt lgkmcnt(5)
  v_mfma_f32_32x32x16_bf16 v[96:111], v[44:47], v[40:43], v[96:111]
  ds_read_b128 v[24:27], v14 offset:32768
  v_and_b32 v241, s45, v38
  v_lshlrev_b32 v240, 16, v38
  v_fmac_f32 v57, v241, v241
  v_fmac_f32 v56, v240, v240
  v_mfma_f32_32x32x16_bf16 v[112:127], v[48:51], v[40:43], v[112:127]
  v_and_b32 v243, s45, v39
  v_lshlrev_b32 v242, 16, v39
  v_fmac_f32 v57, v243, v243
  v_fmac_f32 v56, v242, v242
  v_mfma_f32_16x16x32_bf16 v[60:63], v[244:247], v[44:47], v[60:63]
  s_waitcnt lgkmcnt(3)
  v_mfma_f32_32x32x16_bf16 v[64:79], v[28:31], v[20:23], v[64:79]
  ds_read_b128 v[36:39], v11 offset:32768
  ds_read_b64_tr_b16 v[44:45], v16 offset:45056
  ds_read_b64_tr_b16 v[46:47], v16 offset:46080
  v_and_b32 v241, s45, v20
  v_lshlrev_b32 v240, 16, v20
  v_fmac_f32 v57, v241, v241
  v_fmac_f32 v56, v240, v240
  s_waitcnt lgkmcnt(4)
  v_mfma_f32_32x32x16_bf16 v[80:95], v[32:35], v[20:23], v[80:95]
  ds_read_b64_tr_b16 v[48:49], v17 offset:45056
  ds_read_b64_tr_b16 v[50:51], v17 offset:46080
  v_and_b32 v243, s45, v21
  v_lshlrev_b32 v242, 16, v21
  v_fmac_f32 v57, v243, v243
  v_fmac_f32 v56, v242, v242
  v_mfma_f32_16x16x32_bf16 v[52:55], v[244:247], v[20:23], v[52:55]
  s_waitcnt lgkmcnt(5)
  v_mfma_f32_32x32x16_bf16 v[96:111], v[28:31], v[24:27], v[96:111]
  ds_read_b128 v[40:43], v15 offset:32768
  v_and_b32 v241, s45, v22
  v_lshlrev_b32 v240, 16, v22
  v_fmac_f32 v57, v241, v241
  v_fmac_f32 v56, v240, v240
  v_mfma_f32_32x32x16_bf16 v[112:127], v[32:35], v[24:27], v[112:127]
  v_and_b32 v243, s45, v23
  v_lshlrev_b32 v242, 16, v23
  v_fmac_f32 v57, v243, v243
  v_fmac_f32 v56, v242, v242
  v_mfma_f32_16x16x32_bf16 v[60:63], v[244:247], v[28:31], v[60:63]
  s_waitcnt lgkmcnt(3)
  v_mfma_f32_32x32x16_bf16 v[64:79], v[44:47], v[36:39], v[64:79]
  v_and_b32 v241, s45, v36
  v_lshlrev_b32 v240, 16, v36
  v_fmac_f32 v57, v241, v241
  v_fmac_f32 v56, v240, v240
  s_waitcnt lgkmcnt(1)
  v_mfma_f32_32x32x16_bf16 v[80:95], v[48:51], v[36:39], v[80:95]
  v_and_b32 v243, s45, v37
  v_lshlrev_b32 v242, 16, v37
  v_fmac_f32 v57, v243, v243
  v_fmac_f32 v56, v242, v242
  v_mfma_f32_16x16x32_bf16 v[52:55], v[244:247], v[36:39], v[52:55]
  s_waitcnt lgkmcnt(0)
  v_mfma_f32_32x32x16_bf16 v[96:111], v[44:47], v[40:43], v[96:111]
  v_and_b32 v241, s45, v38
  v_lshlrev_b32 v240, 16, v38
  v_fmac_f32 v57, v241, v241
  v_fmac_f32 v56, v240, v240
  v_mfma_f32_32x32x16_bf16 v[112:127], v[48:51], v[40:43], v[112:127]
  v_and_b32 v243, s45, v39
  v_lshlrev_b32 v242, 16, v39
  v_fmac_f32 v57, v243, v243
  v_fmac_f32 v56, v242, v242
  v_mfma_f32_16x16x32_bf16 v[60:63], v[244:247], v[44:47], v[60:63]
  s_branch parallel_sum__softmax_full_mha__mixer_s_mlp__prompt_kernel_ep
parallel_sum__softmax_full_mha__mixer_s_mlp__prompt_kernel_v:
  s_barrier
  ds_read_b128 v[20:23], v8 offset:0
  ds_read_b128 v[24:27], v12 offset:0
  ds_read_b64_tr_b16 v[28:29], v16 offset:0
  ds_read_b64_tr_b16 v[30:31], v16 offset:1024
  ds_read_b64_tr_b16 v[32:33], v17 offset:0
  ds_read_b64_tr_b16 v[34:35], v17 offset:1024
  s_waitcnt lgkmcnt(0)
  v_mfma_f32_32x32x16_bf16 v[64:79], v[20:23], v[28:31], 0
  ds_read_b128 v[36:39], v9 offset:0
  ds_read_b64_tr_b16 v[44:45], v16 offset:4096
  ds_read_b64_tr_b16 v[46:47], v16 offset:5120
  v_and_b32 v241, s45, v20
  v_lshlrev_b32 v240, 16, v20
  v_fmac_f32 v57, v241, v241
  v_fmac_f32 v56, v240, v240
  v_mfma_f32_32x32x16_bf16 v[80:95], v[20:23], v[32:35], 0
  ds_read_b64_tr_b16 v[48:49], v17 offset:4096
  ds_read_b64_tr_b16 v[50:51], v17 offset:5120
  v_and_b32 v243, s45, v21
  v_lshlrev_b32 v242, 16, v21
  v_fmac_f32 v57, v243, v243
  v_fmac_f32 v56, v242, v242
  v_mfma_f32_16x16x32_bf16 v[52:55], v[244:247], v[20:23], v[52:55]
  v_mfma_f32_32x32x16_bf16 v[96:111], v[24:27], v[28:31], 0
  ds_read_b128 v[40:43], v13 offset:0
  v_and_b32 v241, s45, v22
  v_lshlrev_b32 v240, 16, v22
  v_fmac_f32 v57, v241, v241
  v_fmac_f32 v56, v240, v240
  v_mfma_f32_32x32x16_bf16 v[112:127], v[24:27], v[32:35], 0
  v_and_b32 v243, s45, v23
  v_lshlrev_b32 v242, 16, v23
  v_fmac_f32 v57, v243, v243
  v_fmac_f32 v56, v242, v242
  v_mfma_f32_16x16x32_bf16 v[60:63], v[244:247], v[28:31], v[60:63]
  s_waitcnt lgkmcnt(3)
  v_mfma_f32_32x32x16_bf16 v[64:79], v[36:39], v[44:47], v[64:79]
  ds_read_b128 v[20:23], v10 offset:0
  ds_read_b64_tr_b16 v[28:29], v16 offset:8192
  ds_read_b64_tr_b16 v[30:31], v16 offset:9216
  v_and_b32 v241, s45, v36
  v_lshlrev_b32 v240, 16, v36
  v_fmac_f32 v57, v241, v241
  v_fmac_f32 v56, v240, v240
  s_waitcnt lgkmcnt(4)
  v_mfma_f32_32x32x16_bf16 v[80:95], v[36:39], v[48:51], v[80:95]
  ds_read_b64_tr_b16 v[32:33], v17 offset:8192
  ds_read_b64_tr_b16 v[34:35], v17 offset:9216
  v_and_b32 v243, s45, v37
  v_lshlrev_b32 v242, 16, v37
  v_fmac_f32 v57, v243, v243
  v_fmac_f32 v56, v242, v242
  v_mfma_f32_16x16x32_bf16 v[52:55], v[244:247], v[36:39], v[52:55]
  s_waitcnt lgkmcnt(5)
  v_mfma_f32_32x32x16_bf16 v[96:111], v[40:43], v[44:47], v[96:111]
  ds_read_b128 v[24:27], v14 offset:0
  v_and_b32 v241, s45, v38
  v_lshlrev_b32 v240, 16, v38
  v_fmac_f32 v57, v241, v241
  v_fmac_f32 v56, v240, v240
  v_mfma_f32_32x32x16_bf16 v[112:127], v[40:43], v[48:51], v[112:127]
  v_and_b32 v243, s45, v39
  v_lshlrev_b32 v242, 16, v39
  v_fmac_f32 v57, v243, v243
  v_fmac_f32 v56, v242, v242
  v_mfma_f32_16x16x32_bf16 v[60:63], v[244:247], v[44:47], v[60:63]
  s_waitcnt lgkmcnt(3)
  v_mfma_f32_32x32x16_bf16 v[64:79], v[20:23], v[28:31], v[64:79]
  ds_read_b128 v[36:39], v11 offset:0
  ds_read_b64_tr_b16 v[44:45], v16 offset:12288
  ds_read_b64_tr_b16 v[46:47], v16 offset:13312
  v_and_b32 v241, s45, v20
  v_lshlrev_b32 v240, 16, v20
  v_fmac_f32 v57, v241, v241
  v_fmac_f32 v56, v240, v240
  s_waitcnt lgkmcnt(4)
  v_mfma_f32_32x32x16_bf16 v[80:95], v[20:23], v[32:35], v[80:95]
  ds_read_b64_tr_b16 v[48:49], v17 offset:12288
  ds_read_b64_tr_b16 v[50:51], v17 offset:13312
  v_and_b32 v243, s45, v21
  v_lshlrev_b32 v242, 16, v21
  v_fmac_f32 v57, v243, v243
  v_fmac_f32 v56, v242, v242
  v_mfma_f32_16x16x32_bf16 v[52:55], v[244:247], v[20:23], v[52:55]
  s_waitcnt lgkmcnt(5)
  v_mfma_f32_32x32x16_bf16 v[96:111], v[24:27], v[28:31], v[96:111]
  ds_read_b128 v[40:43], v15 offset:0
  v_and_b32 v241, s45, v22
  v_lshlrev_b32 v240, 16, v22
  v_fmac_f32 v57, v241, v241
  v_fmac_f32 v56, v240, v240
  v_mfma_f32_32x32x16_bf16 v[112:127], v[24:27], v[32:35], v[112:127]
  v_and_b32 v243, s45, v23
  v_lshlrev_b32 v242, 16, v23
  v_fmac_f32 v57, v243, v243
  v_fmac_f32 v56, v242, v242
  v_mfma_f32_16x16x32_bf16 v[60:63], v[244:247], v[28:31], v[60:63]
  s_cmp_ge_u32 s2, 8
  s_cbranch_scc1 na_43
  s_lshl_b32 s36, s2, 4
  s_lshl_b32 s37, s29, 2
  s_add_u32 s36, s36, s37
  v_mov_b32 v248, 0
  v_mov_b32 v249, 1
  s_waitcnt vmcnt(0)
  s_mov_b32 exec_lo, 1
  s_mov_b32 exec_hi, 0
  buffer_store_dword v249, v248, s[68:71], s36 offen sc1
  s_mov_b32 exec_lo, -1
  s_mov_b32 exec_hi, -1
na_43:
  s_waitcnt lgkmcnt(0)
  s_barrier
  v_mfma_f32_32x32x16_bf16 v[64:79], v[36:39], v[44:47], v[64:79]
  ds_read_b128 v[20:23], v8 offset:16384
  ds_read_b64_tr_b16 v[28:29], v16 offset:16384
  ds_read_b64_tr_b16 v[30:31], v16 offset:17408
  v_and_b32 v241, s45, v36
  v_lshlrev_b32 v240, 16, v36
  v_fmac_f32 v57, v241, v241
  v_fmac_f32 v56, v240, v240
  v_mfma_f32_32x32x16_bf16 v[80:95], v[36:39], v[48:51], v[80:95]
  ds_read_b64_tr_b16 v[32:33], v17 offset:16384
  ds_read_b64_tr_b16 v[34:35], v17 offset:17408
  v_and_b32 v243, s45, v37
  v_lshlrev_b32 v242, 16, v37
  v_fmac_f32 v57, v243, v243
  v_fmac_f32 v56, v242, v242
  v_mfma_f32_16x16x32_bf16 v[52:55], v[244:247], v[36:39], v[52:55]
  v_mfma_f32_32x32x16_bf16 v[96:111], v[40:43], v[44:47], v[96:111]
  ds_read_b128 v[24:27], v12 offset:16384
  v_and_b32 v241, s45, v38
  v_lshlrev_b32 v240, 16, v38
  v_fmac_f32 v57, v241, v241
  v_fmac_f32 v56, v240, v240
  v_mfma_f32_32x32x16_bf16 v[112:127], v[40:43], v[48:51], v[112:127]
  v_and_b32 v243, s45, v39
  v_lshlrev_b32 v242, 16, v39
  v_fmac_f32 v57, v243, v243
  v_fmac_f32 v56, v242, v242
  v_mfma_f32_16x16x32_bf16 v[60:63], v[244:247], v[44:47], v[60:63]
  s_waitcnt lgkmcnt(3)
  v_mfma_f32_32x32x16_bf16 v[64:79], v[20:23], v[28:31], v[64:79]
  ds_read_b128 v[36:39], v9 offset:16384
  ds_read_b64_tr_b16 v[44:45], v16 offset:20480
  ds_read_b64_tr_b16 v[46:47], v16 offset:21504
  v_and_b32 v241, s45, v20
  v_lshlrev_b32 v240, 16, v20
  v_fmac_f32 v57, v241, v241
  v_fmac_f32 v56, v240, v240
  s_waitcnt lgkmcnt(4)
  v_mfma_f32_32x32x16_bf16 v[80:95], v[20:23], v[32:35], v[80:95]
  ds_read_b64_tr_b16 v[48:49], v17 offset:20480
  ds_read_b64_tr_b16 v[50:51], v17 offset:21504
  v_and_b32 v243, s45, v21
  v_lshlrev_b32 v242, 16, v21
  v_fmac_f32 v57, v243, v243
  v_fmac_f32 v56, v242, v242
  v_mfma_f32_16x16x32_bf16 v[52:55], v[244:247], v[20:23], v[52:55]
  s_waitcnt lgkmcnt(5)
  v_mfma_f32_32x32x16_bf16 v[96:111], v[24:27], v[28:31], v[96:111]
  ds_read_b128 v[40:43], v13 offset:16384
  v_and_b32 v241, s45, v22
  v_lshlrev_b32 v240, 16, v22
  v_fmac_f32 v57, v241, v241
  v_fmac_f32 v56, v240, v240
  v_mfma_f32_32x32x16_bf16 v[112:127], v[24:27], v[32:35], v[112:127]
  v_and_b32 v243, s45, v23
  v_lshlrev_b32 v242, 16, v23
  v_fmac_f32 v57, v243, v243
  v_fmac_f32 v56, v242, v242
  v_mfma_f32_16x16x32_bf16 v[60:63], v[244:247], v[28:31], v[60:63]
  s_waitcnt lgkmcnt(3)
  v_mfma_f32_32x32x16_bf16 v[64:79], v[36:39], v[44:47], v[64:79]
  ds_read_b128 v[20:23], v10 offset:16384
  ds_read_b64_tr_b16 v[28:29], v16 offset:24576
  ds_read_b64_tr_b16 v[30:31], v16 offset:25600
  v_and_b32 v241, s45, v36
  v_lshlrev_b32 v240, 16, v36
  v_fmac_f32 v57, v241, v241
  v_fmac_f32 v56, v240, v240
  s_waitcnt lgkmcnt(4)
  v_mfma_f32_32x32x16_bf16 v[80:95], v[36:39], v[48:51], v[80:95]
  ds_read_b64_tr_b16 v[32:33], v17 offset:24576
  ds_read_b64_tr_b16 v[34:35], v17 offset:25600
  v_and_b32 v243, s45, v37
  v_lshlrev_b32 v242, 16, v37
  v_fmac_f32 v57, v243, v243
  v_fmac_f32 v56, v242, v242
  v_mfma_f32_16x16x32_bf16 v[52:55], v[244:247], v[36:39], v[52:55]
  s_waitcnt lgkmcnt(5)
  v_mfma_f32_32x32x16_bf16 v[96:111], v[40:43], v[44:47], v[96:111]
  ds_read_b128 v[24:27], v14 offset:16384
  v_and_b32 v241, s45, v38
  v_lshlrev_b32 v240, 16, v38
  v_fmac_f32 v57, v241, v241
  v_fmac_f32 v56, v240, v240
  v_mfma_f32_32x32x16_bf16 v[112:127], v[40:43], v[48:51], v[112:127]
  v_and_b32 v243, s45, v39
  v_lshlrev_b32 v242, 16, v39
  v_fmac_f32 v57, v243, v243
  v_fmac_f32 v56, v242, v242
  v_mfma_f32_16x16x32_bf16 v[60:63], v[244:247], v[44:47], v[60:63]
  s_waitcnt lgkmcnt(3)
  v_mfma_f32_32x32x16_bf16 v[64:79], v[20:23], v[28:31], v[64:79]
  ds_read_b128 v[36:39], v11 offset:16384
  ds_read_b64_tr_b16 v[44:45], v16 offset:28672
  ds_read_b64_tr_b16 v[46:47], v16 offset:29696
  v_and_b32 v241, s45, v20
  v_lshlrev_b32 v240, 16, v20
  v_fmac_f32 v57, v241, v241
  v_fmac_f32 v56, v240, v240
  s_waitcnt lgkmcnt(4)
  v_mfma_f32_32x32x16_bf16 v[80:95], v[20:23], v[32:35], v[80:95]
  ds_read_b64_tr_b16 v[48:49], v17 offset:28672
  ds_read_b64_tr_b16 v[50:51], v17 offset:29696
  v_and_b32 v243, s45, v21
  v_lshlrev_b32 v242, 16, v21
  v_fmac_f32 v57, v243, v243
  v_fmac_f32 v56, v242, v242
  v_mfma_f32_16x16x32_bf16 v[52:55], v[244:247], v[20:23], v[52:55]
  s_waitcnt lgkmcnt(5)
  v_mfma_f32_32x32x16_bf16 v[96:111], v[24:27], v[28:31], v[96:111]
  ds_read_b128 v[40:43], v15 offset:16384
  v_and_b32 v241, s45, v22
  v_lshlrev_b32 v240, 16, v22
  v_fmac_f32 v57, v241, v241
  v_fmac_f32 v56, v240, v240
  v_mfma_f32_32x32x16_bf16 v[112:127], v[24:27], v[32:35], v[112:127]
  v_and_b32 v243, s45, v23
  v_lshlrev_b32 v242, 16, v23
  v_fmac_f32 v57, v243, v243
  v_fmac_f32 v56, v242, v242
  v_mfma_f32_16x16x32_bf16 v[60:63], v[244:247], v[28:31], v[60:63]
  s_waitcnt lgkmcnt(0)
  s_barrier
  v_mfma_f32_32x32x16_bf16 v[64:79], v[36:39], v[44:47], v[64:79]
  ds_read_b128 v[20:23], v8 offset:32768
  ds_read_b64_tr_b16 v[28:29], v16 offset:32768
  ds_read_b64_tr_b16 v[30:31], v16 offset:33792
  v_and_b32 v241, s45, v36
  v_lshlrev_b32 v240, 16, v36
  v_fmac_f32 v57, v241, v241
  v_fmac_f32 v56, v240, v240
  v_mfma_f32_32x32x16_bf16 v[80:95], v[36:39], v[48:51], v[80:95]
  ds_read_b64_tr_b16 v[32:33], v17 offset:32768
  ds_read_b64_tr_b16 v[34:35], v17 offset:33792
  v_and_b32 v243, s45, v37
  v_lshlrev_b32 v242, 16, v37
  v_fmac_f32 v57, v243, v243
  v_fmac_f32 v56, v242, v242
  v_mfma_f32_16x16x32_bf16 v[52:55], v[244:247], v[36:39], v[52:55]
  v_mfma_f32_32x32x16_bf16 v[96:111], v[40:43], v[44:47], v[96:111]
  ds_read_b128 v[24:27], v12 offset:32768
  v_and_b32 v241, s45, v38
  v_lshlrev_b32 v240, 16, v38
  v_fmac_f32 v57, v241, v241
  v_fmac_f32 v56, v240, v240
  v_mfma_f32_32x32x16_bf16 v[112:127], v[40:43], v[48:51], v[112:127]
  v_and_b32 v243, s45, v39
  v_lshlrev_b32 v242, 16, v39
  v_fmac_f32 v57, v243, v243
  v_fmac_f32 v56, v242, v242
  v_mfma_f32_16x16x32_bf16 v[60:63], v[244:247], v[44:47], v[60:63]
  s_waitcnt lgkmcnt(3)
  v_mfma_f32_32x32x16_bf16 v[64:79], v[20:23], v[28:31], v[64:79]
  ds_read_b128 v[36:39], v9 offset:32768
  ds_read_b64_tr_b16 v[44:45], v16 offset:36864
  ds_read_b64_tr_b16 v[46:47], v16 offset:37888
  v_and_b32 v241, s45, v20
  v_lshlrev_b32 v240, 16, v20
  v_fmac_f32 v57, v241, v241
  v_fmac_f32 v56, v240, v240
  s_waitcnt lgkmcnt(4)
  v_mfma_f32_32x32x16_bf16 v[80:95], v[20:23], v[32:35], v[80:95]
  ds_read_b64_tr_b16 v[48:49], v17 offset:36864
  ds_read_b64_tr_b16 v[50:51], v17 offset:37888
  v_and_b32 v243, s45, v21
  v_lshlrev_b32 v242, 16, v21
  v_fmac_f32 v57, v243, v243
  v_fmac_f32 v56, v242, v242
  v_mfma_f32_16x16x32_bf16 v[52:55], v[244:247], v[20:23], v[52:55]
  s_waitcnt lgkmcnt(5)
  v_mfma_f32_32x32x16_bf16 v[96:111], v[24:27], v[28:31], v[96:111]
  ds_read_b128 v[40:43], v13 offset:32768
  v_and_b32 v241, s45, v22
  v_lshlrev_b32 v240, 16, v22
  v_fmac_f32 v57, v241, v241
  v_fmac_f32 v56, v240, v240
  v_mfma_f32_32x32x16_bf16 v[112:127], v[24:27], v[32:35], v[112:127]
  v_and_b32 v243, s45, v23
  v_lshlrev_b32 v242, 16, v23
  v_fmac_f32 v57, v243, v243
  v_fmac_f32 v56, v242, v242
  v_mfma_f32_16x16x32_bf16 v[60:63], v[244:247], v[28:31], v[60:63]
  s_waitcnt lgkmcnt(3)
  v_mfma_f32_32x32x16_bf16 v[64:79], v[36:39], v[44:47], v[64:79]
  ds_read_b128 v[20:23], v10 offset:32768
  ds_read_b64_tr_b16 v[28:29], v16 offset:40960
  ds_read_b64_tr_b16 v[30:31], v16 offset:41984
  v_and_b32 v241, s45, v36
  v_lshlrev_b32 v240, 16, v36
  v_fmac_f32 v57, v241, v241
  v_fmac_f32 v56, v240, v240
  s_waitcnt lgkmcnt(4)
  v_mfma_f32_32x32x16_bf16 v[80:95], v[36:39], v[48:51], v[80:95]
  ds_read_b64_tr_b16 v[32:33], v17 offset:40960
  ds_read_b64_tr_b16 v[34:35], v17 offset:41984
  v_and_b32 v243, s45, v37
  v_lshlrev_b32 v242, 16, v37
  v_fmac_f32 v57, v243, v243
  v_fmac_f32 v56, v242, v242
  v_mfma_f32_16x16x32_bf16 v[52:55], v[244:247], v[36:39], v[52:55]
  s_waitcnt lgkmcnt(5)
  v_mfma_f32_32x32x16_bf16 v[96:111], v[40:43], v[44:47], v[96:111]
  ds_read_b128 v[24:27], v14 offset:32768
  v_and_b32 v241, s45, v38
  v_lshlrev_b32 v240, 16, v38
  v_fmac_f32 v57, v241, v241
  v_fmac_f32 v56, v240, v240
  v_mfma_f32_32x32x16_bf16 v[112:127], v[40:43], v[48:51], v[112:127]
  v_and_b32 v243, s45, v39
  v_lshlrev_b32 v242, 16, v39
  v_fmac_f32 v57, v243, v243
  v_fmac_f32 v56, v242, v242
  v_mfma_f32_16x16x32_bf16 v[60:63], v[244:247], v[44:47], v[60:63]
  s_waitcnt lgkmcnt(3)
  v_mfma_f32_32x32x16_bf16 v[64:79], v[20:23], v[28:31], v[64:79]
  ds_read_b128 v[36:39], v11 offset:32768
  ds_read_b64_tr_b16 v[44:45], v16 offset:45056
  ds_read_b64_tr_b16 v[46:47], v16 offset:46080
  v_and_b32 v241, s45, v20
  v_lshlrev_b32 v240, 16, v20
  v_fmac_f32 v57, v241, v241
  v_fmac_f32 v56, v240, v240
  s_waitcnt lgkmcnt(4)
  v_mfma_f32_32x32x16_bf16 v[80:95], v[20:23], v[32:35], v[80:95]
  ds_read_b64_tr_b16 v[48:49], v17 offset:45056
  ds_read_b64_tr_b16 v[50:51], v17 offset:46080
  v_and_b32 v243, s45, v21
  v_lshlrev_b32 v242, 16, v21
  v_fmac_f32 v57, v243, v243
  v_fmac_f32 v56, v242, v242
  v_mfma_f32_16x16x32_bf16 v[52:55], v[244:247], v[20:23], v[52:55]
  s_waitcnt lgkmcnt(5)
  v_mfma_f32_32x32x16_bf16 v[96:111], v[24:27], v[28:31], v[96:111]
  ds_read_b128 v[40:43], v15 offset:32768
  v_and_b32 v241, s45, v22
  v_lshlrev_b32 v240, 16, v22
  v_fmac_f32 v57, v241, v241
  v_fmac_f32 v56, v240, v240
  v_mfma_f32_32x32x16_bf16 v[112:127], v[24:27], v[32:35], v[112:127]
  v_and_b32 v243, s45, v23
  v_lshlrev_b32 v242, 16, v23
  v_fmac_f32 v57, v243, v243
  v_fmac_f32 v56, v242, v242
  v_mfma_f32_16x16x32_bf16 v[60:63], v[244:247], v[28:31], v[60:63]
  s_waitcnt lgkmcnt(0)
  s_barrier
  v_mfma_f32_32x32x16_bf16 v[64:79], v[36:39], v[44:47], v[64:79]
  ds_read_b128 v[20:23], v8 offset:49152
  ds_read_b64_tr_b16 v[28:29], v16 offset:49152
  ds_read_b64_tr_b16 v[30:31], v16 offset:50176
  v_and_b32 v241, s45, v36
  v_lshlrev_b32 v240, 16, v36
  v_fmac_f32 v57, v241, v241
  v_fmac_f32 v56, v240, v240
  v_mfma_f32_32x32x16_bf16 v[80:95], v[36:39], v[48:51], v[80:95]
  ds_read_b64_tr_b16 v[32:33], v17 offset:49152
  ds_read_b64_tr_b16 v[34:35], v17 offset:50176
  v_and_b32 v243, s45, v37
  v_lshlrev_b32 v242, 16, v37
  v_fmac_f32 v57, v243, v243
  v_fmac_f32 v56, v242, v242
  v_mfma_f32_16x16x32_bf16 v[52:55], v[244:247], v[36:39], v[52:55]
  v_mfma_f32_32x32x16_bf16 v[96:111], v[40:43], v[44:47], v[96:111]
  ds_read_b128 v[24:27], v12 offset:49152
  v_and_b32 v241, s45, v38
  v_lshlrev_b32 v240, 16, v38
  v_fmac_f32 v57, v241, v241
  v_fmac_f32 v56, v240, v240
  v_mfma_f32_32x32x16_bf16 v[112:127], v[40:43], v[48:51], v[112:127]
  v_and_b32 v243, s45, v39
  v_lshlrev_b32 v242, 16, v39
  v_fmac_f32 v57, v243, v243
  v_fmac_f32 v56, v242, v242
  v_mfma_f32_16x16x32_bf16 v[60:63], v[244:247], v[44:47], v[60:63]
  s_waitcnt lgkmcnt(3)
  v_mfma_f32_32x32x16_bf16 v[64:79], v[20:23], v[28:31], v[64:79]
  ds_read_b128 v[36:39], v9 offset:49152
  ds_read_b64_tr_b16 v[44:45], v16 offset:53248
  ds_read_b64_tr_b16 v[46:47], v16 offset:54272
  v_and_b32 v241, s45, v20
  v_lshlrev_b32 v240, 16, v20
  v_fmac_f32 v57, v241, v241
  v_fmac_f32 v56, v240, v240
  s_waitcnt lgkmcnt(4)
  v_mfma_f32_32x32x16_bf16 v[80:95], v[20:23], v[32:35], v[80:95]
  ds_read_b64_tr_b16 v[48:49], v17 offset:53248
  ds_read_b64_tr_b16 v[50:51], v17 offset:54272
  v_and_b32 v243, s45, v21
  v_lshlrev_b32 v242, 16, v21
  v_fmac_f32 v57, v243, v243
  v_fmac_f32 v56, v242, v242
  v_mfma_f32_16x16x32_bf16 v[52:55], v[244:247], v[20:23], v[52:55]
  s_waitcnt lgkmcnt(5)
  v_mfma_f32_32x32x16_bf16 v[96:111], v[24:27], v[28:31], v[96:111]
  ds_read_b128 v[40:43], v13 offset:49152
  v_and_b32 v241, s45, v22
  v_lshlrev_b32 v240, 16, v22
  v_fmac_f32 v57, v241, v241
  v_fmac_f32 v56, v240, v240
  v_mfma_f32_32x32x16_bf16 v[112:127], v[24:27], v[32:35], v[112:127]
  v_and_b32 v243, s45, v23
  v_lshlrev_b32 v242, 16, v23
  v_fmac_f32 v57, v243, v243
  v_fmac_f32 v56, v242, v242
  v_mfma_f32_16x16x32_bf16 v[60:63], v[244:247], v[28:31], v[60:63]
  s_waitcnt lgkmcnt(3)
  v_mfma_f32_32x32x16_bf16 v[64:79], v[36:39], v[44:47], v[64:79]
  ds_read_b128 v[20:23], v10 offset:49152
  ds_read_b64_tr_b16 v[28:29], v16 offset:57344
  ds_read_b64_tr_b16 v[30:31], v16 offset:58368
  v_and_b32 v241, s45, v36
  v_lshlrev_b32 v240, 16, v36
  v_fmac_f32 v57, v241, v241
  v_fmac_f32 v56, v240, v240
  s_waitcnt lgkmcnt(4)
  v_mfma_f32_32x32x16_bf16 v[80:95], v[36:39], v[48:51], v[80:95]
  ds_read_b64_tr_b16 v[32:33], v17 offset:57344
  ds_read_b64_tr_b16 v[34:35], v17 offset:58368
  v_and_b32 v243, s45, v37
  v_lshlrev_b32 v242, 16, v37
  v_fmac_f32 v57, v243, v243
  v_fmac_f32 v56, v242, v242
  v_mfma_f32_16x16x32_bf16 v[52:55], v[244:247], v[36:39], v[52:55]
  s_waitcnt lgkmcnt(5)
  v_mfma_f32_32x32x16_bf16 v[96:111], v[40:43], v[44:47], v[96:111]
  ds_read_b128 v[24:27], v14 offset:49152
  v_and_b32 v241, s45, v38
  v_lshlrev_b32 v240, 16, v38
  v_fmac_f32 v57, v241, v241
  v_fmac_f32 v56, v240, v240
  v_mfma_f32_32x32x16_bf16 v[112:127], v[40:43], v[48:51], v[112:127]
  v_and_b32 v243, s45, v39
  v_lshlrev_b32 v242, 16, v39
  v_fmac_f32 v57, v243, v243
  v_fmac_f32 v56, v242, v242
  v_mfma_f32_16x16x32_bf16 v[60:63], v[244:247], v[44:47], v[60:63]
  s_waitcnt lgkmcnt(3)
  v_mfma_f32_32x32x16_bf16 v[64:79], v[20:23], v[28:31], v[64:79]
  ds_read_b128 v[36:39], v11 offset:49152
  ds_read_b64_tr_b16 v[44:45], v16 offset:61440
  ds_read_b64_tr_b16 v[46:47], v16 offset:62464
  v_and_b32 v241, s45, v20
  v_lshlrev_b32 v240, 16, v20
  v_fmac_f32 v57, v241, v241
  v_fmac_f32 v56, v240, v240
  s_waitcnt lgkmcnt(4)
  v_mfma_f32_32x32x16_bf16 v[80:95], v[20:23], v[32:35], v[80:95]
  ds_read_b64_tr_b16 v[48:49], v17 offset:61440
  ds_read_b64_tr_b16 v[50:51], v17 offset:62464
  v_and_b32 v243, s45, v21
  v_lshlrev_b32 v242, 16, v21
  v_fmac_f32 v57, v243, v243
  v_fmac_f32 v56, v242, v242
  v_mfma_f32_16x16x32_bf16 v[52:55], v[244:247], v[20:23], v[52:55]
  s_waitcnt lgkmcnt(5)
  v_mfma_f32_32x32x16_bf16 v[96:111], v[24:27], v[28:31], v[96:111]
  ds_read_b128 v[40:43], v15 offset:49152
  v_and_b32 v241, s45, v22
  v_lshlrev_b32 v240, 16, v22
  v_fmac_f32 v57, v241, v241
  v_fmac_f32 v56, v240, v240
  v_mfma_f32_32x32x16_bf16 v[112:127], v[24:27], v[32:35], v[112:127]
  v_and_b32 v243, s45, v23
  v_lshlrev_b32 v242, 16, v23
  v_fmac_f32 v57, v243, v243
  v_fmac_f32 v56, v242, v242
  v_mfma_f32_16x16x32_bf16 v[60:63], v[244:247], v[28:31], v[60:63]
  s_waitcnt lgkmcnt(0)
  s_barrier
  v_mfma_f32_32x32x16_bf16 v[64:79], v[36:39], v[44:47], v[64:79]
  ds_read_b128 v[20:23], v8 offset:0
  ds_read_b64_tr_b16 v[28:29], v16 offset:0
  ds_read_b64_tr_b16 v[30:31], v16 offset:1024
  v_and_b32 v241, s45, v36
  v_lshlrev_b32 v240, 16, v36
  v_fmac_f32 v57, v241, v241
  v_fmac_f32 v56, v240, v240
  v_mfma_f32_32x32x16_bf16 v[80:95], v[36:39], v[48:51], v[80:95]
  ds_read_b64_tr_b16 v[32:33], v17 offset:0
  ds_read_b64_tr_b16 v[34:35], v17 offset:1024
  v_and_b32 v243, s45, v37
  v_lshlrev_b32 v242, 16, v37
  v_fmac_f32 v57, v243, v243
  v_fmac_f32 v56, v242, v242
  v_mfma_f32_16x16x32_bf16 v[52:55], v[244:247], v[36:39], v[52:55]
  v_mfma_f32_32x32x16_bf16 v[96:111], v[40:43], v[44:47], v[96:111]
  ds_read_b128 v[24:27], v12 offset:0
  v_and_b32 v241, s45, v38
  v_lshlrev_b32 v240, 16, v38
  v_fmac_f32 v57, v241, v241
  v_fmac_f32 v56, v240, v240
  v_mfma_f32_32x32x16_bf16 v[112:127], v[40:43], v[48:51], v[112:127]
  v_and_b32 v243, s45, v39
  v_lshlrev_b32 v242, 16, v39
  v_fmac_f32 v57, v243, v243
  v_fmac_f32 v56, v242, v242
  v_mfma_f32_16x16x32_bf16 v[60:63], v[244:247], v[44:47], v[60:63]
  s_waitcnt lgkmcnt(3)
  v_mfma_f32_32x32x16_bf16 v[64:79], v[20:23], v[28:31], v[64:79]
  ds_read_b128 v[36:39], v9 offset:0
  ds_read_b64_tr_b16 v[44:45], v16 offset:4096
  ds_read_b64_tr_b16 v[46:47], v16 offset:5120
  v_and_b32 v241, s45, v20
  v_lshlrev_b32 v240, 16, v20
  v_fmac_f32 v57, v241, v241
  v_fmac_f32 v56, v240, v240
  s_waitcnt lgkmcnt(4)
  v_mfma_f32_32x32x16_bf16 v[80:95], v[20:23], v[32:35], v[80:95]
  ds_read_b64_tr_b16 v[48:49], v17 offset:4096
  ds_read_b64_tr_b16 v[50:51], v17 offset:5120
  v_and_b32 v243, s45, v21
  v_lshlrev_b32 v242, 16, v21
  v_fmac_f32 v57, v243, v243
  v_fmac_f32 v56, v242, v242
  v_mfma_f32_16x16x32_bf16 v[52:55], v[244:247], v[20:23], v[52:55]
  s_waitcnt lgkmcnt(5)
  v_mfma_f32_32x32x16_bf16 v[96:111], v[24:27], v[28:31], v[96:111]
  ds_read_b128 v[40:43], v13 offset:0
  v_and_b32 v241, s45, v22
  v_lshlrev_b32 v240, 16, v22
  v_fmac_f32 v57, v241, v241
  v_fmac_f32 v56, v240, v240
  v_mfma_f32_32x32x16_bf16 v[112:127], v[24:27], v[32:35], v[112:127]
  v_and_b32 v243, s45, v23
  v_lshlrev_b32 v242, 16, v23
  v_fmac_f32 v57, v243, v243
  v_fmac_f32 v56, v242, v242
  v_mfma_f32_16x16x32_bf16 v[60:63], v[244:247], v[28:31], v[60:63]
  s_waitcnt lgkmcnt(3)
  v_mfma_f32_32x32x16_bf16 v[64:79], v[36:39], v[44:47], v[64:79]
  ds_read_b128 v[20:23], v10 offset:0
  ds_read_b64_tr_b16 v[28:29], v16 offset:8192
  ds_read_b64_tr_b16 v[30:31], v16 offset:9216
  v_and_b32 v241, s45, v36
  v_lshlrev_b32 v240, 16, v36
  v_fmac_f32 v57, v241, v241
  v_fmac_f32 v56, v240, v240
  s_waitcnt lgkmcnt(4)
  v_mfma_f32_32x32x16_bf16 v[80:95], v[36:39], v[48:51], v[80:95]
  ds_read_b64_tr_b16 v[32:33], v17 offset:8192
  ds_read_b64_tr_b16 v[34:35], v17 offset:9216
  v_and_b32 v243, s45, v37
  v_lshlrev_b32 v242, 16, v37
  v_fmac_f32 v57, v243, v243
  v_fmac_f32 v56, v242, v242
  v_mfma_f32_16x16x32_bf16 v[52:55], v[244:247], v[36:39], v[52:55]
  s_waitcnt lgkmcnt(5)
  v_mfma_f32_32x32x16_bf16 v[96:111], v[40:43], v[44:47], v[96:111]
  ds_read_b128 v[24:27], v14 offset:0
  v_and_b32 v241, s45, v38
  v_lshlrev_b32 v240, 16, v38
  v_fmac_f32 v57, v241, v241
  v_fmac_f32 v56, v240, v240
  v_mfma_f32_32x32x16_bf16 v[112:127], v[40:43], v[48:51], v[112:127]
  v_and_b32 v243, s45, v39
  v_lshlrev_b32 v242, 16, v39
  v_fmac_f32 v57, v243, v243
  v_fmac_f32 v56, v242, v242
  v_mfma_f32_16x16x32_bf16 v[60:63], v[244:247], v[44:47], v[60:63]
  s_waitcnt lgkmcnt(3)
  v_mfma_f32_32x32x16_bf16 v[64:79], v[20:23], v[28:31], v[64:79]
  ds_read_b128 v[36:39], v11 offset:0
  ds_read_b64_tr_b16 v[44:45], v16 offset:12288
  ds_read_b64_tr_b16 v[46:47], v16 offset:13312
  v_and_b32 v241, s45, v20
  v_lshlrev_b32 v240, 16, v20
  v_fmac_f32 v57, v241, v241
  v_fmac_f32 v56, v240, v240
  s_waitcnt lgkmcnt(4)
  v_mfma_f32_32x32x16_bf16 v[80:95], v[20:23], v[32:35], v[80:95]
  ds_read_b64_tr_b16 v[48:49], v17 offset:12288
  ds_read_b64_tr_b16 v[50:51], v17 offset:13312
  v_and_b32 v243, s45, v21
  v_lshlrev_b32 v242, 16, v21
  v_fmac_f32 v57, v243, v243
  v_fmac_f32 v56, v242, v242
  v_mfma_f32_16x16x32_bf16 v[52:55], v[244:247], v[20:23], v[52:55]
  s_waitcnt lgkmcnt(5)
  v_mfma_f32_32x32x16_bf16 v[96:111], v[24:27], v[28:31], v[96:111]
  ds_read_b128 v[40:43], v15 offset:0
  v_and_b32 v241, s45, v22
  v_lshlrev_b32 v240, 16, v22
  v_fmac_f32 v57, v241, v241
  v_fmac_f32 v56, v240, v240
  v_mfma_f32_32x32x16_bf16 v[112:127], v[24:27], v[32:35], v[112:127]
  v_and_b32 v243, s45, v23
  v_lshlrev_b32 v242, 16, v23
  v_fmac_f32 v57, v243, v243
  v_fmac_f32 v56, v242, v242
  v_mfma_f32_16x16x32_bf16 v[60:63], v[244:247], v[28:31], v[60:63]
  s_waitcnt lgkmcnt(0)
  s_barrier
  v_mfma_f32_32x32x16_bf16 v[64:79], v[36:39], v[44:47], v[64:79]
  ds_read_b128 v[20:23], v8 offset:16384
  ds_read_b64_tr_b16 v[28:29], v16 offset:16384
  ds_read_b64_tr_b16 v[30:31], v16 offset:17408
  v_and_b32 v241, s45, v36
  v_lshlrev_b32 v240, 16, v36
  v_fmac_f32 v57, v241, v241
  v_fmac_f32 v56, v240, v240
  v_mfma_f32_32x32x16_bf16 v[80:95], v[36:39], v[48:51], v[80:95]
  ds_read_b64_tr_b16 v[32:33], v17 offset:16384
  ds_read_b64_tr_b16 v[34:35], v17 offset:17408
  v_and_b32 v243, s45, v37
  v_lshlrev_b32 v242, 16, v37
  v_fmac_f32 v57, v243, v243
  v_fmac_f32 v56, v242, v242
  v_mfma_f32_16x16x32_bf16 v[52:55], v[244:247], v[36:39], v[52:55]
  v_mfma_f32_32x32x16_bf16 v[96:111], v[40:43], v[44:47], v[96:111]
  ds_read_b128 v[24:27], v12 offset:16384
  v_and_b32 v241, s45, v38
  v_lshlrev_b32 v240, 16, v38
  v_fmac_f32 v57, v241, v241
  v_fmac_f32 v56, v240, v240
  v_mfma_f32_32x32x16_bf16 v[112:127], v[40:43], v[48:51], v[112:127]
  v_and_b32 v243, s45, v39
  v_lshlrev_b32 v242, 16, v39
  v_fmac_f32 v57, v243, v243
  v_fmac_f32 v56, v242, v242
  v_mfma_f32_16x16x32_bf16 v[60:63], v[244:247], v[44:47], v[60:63]
  s_waitcnt lgkmcnt(3)
  v_mfma_f32_32x32x16_bf16 v[64:79], v[20:23], v[28:31], v[64:79]
  ds_read_b128 v[36:39], v9 offset:16384
  ds_read_b64_tr_b16 v[44:45], v16 offset:20480
  ds_read_b64_tr_b16 v[46:47], v16 offset:21504
  v_and_b32 v241, s45, v20
  v_lshlrev_b32 v240, 16, v20
  v_fmac_f32 v57, v241, v241
  v_fmac_f32 v56, v240, v240
  s_waitcnt lgkmcnt(4)
  v_mfma_f32_32x32x16_bf16 v[80:95], v[20:23], v[32:35], v[80:95]
  ds_read_b64_tr_b16 v[48:49], v17 offset:20480
  ds_read_b64_tr_b16 v[50:51], v17 offset:21504
  v_and_b32 v243, s45, v21
  v_lshlrev_b32 v242, 16, v21
  v_fmac_f32 v57, v243, v243
  v_fmac_f32 v56, v242, v242
  v_mfma_f32_16x16x32_bf16 v[52:55], v[244:247], v[20:23], v[52:55]
  s_waitcnt lgkmcnt(5)
  v_mfma_f32_32x32x16_bf16 v[96:111], v[24:27], v[28:31], v[96:111]
  ds_read_b128 v[40:43], v13 offset:16384
  v_and_b32 v241, s45, v22
  v_lshlrev_b32 v240, 16, v22
  v_fmac_f32 v57, v241, v241
  v_fmac_f32 v56, v240, v240
  v_mfma_f32_32x32x16_bf16 v[112:127], v[24:27], v[32:35], v[112:127]
  v_and_b32 v243, s45, v23
  v_lshlrev_b32 v242, 16, v23
  v_fmac_f32 v57, v243, v243
  v_fmac_f32 v56, v242, v242
  v_mfma_f32_16x16x32_bf16 v[60:63], v[244:247], v[28:31], v[60:63]
  s_waitcnt lgkmcnt(3)
  v_mfma_f32_32x32x16_bf16 v[64:79], v[36:39], v[44:47], v[64:79]
  ds_read_b128 v[20:23], v10 offset:16384
  ds_read_b64_tr_b16 v[28:29], v16 offset:24576
  ds_read_b64_tr_b16 v[30:31], v16 offset:25600
  v_and_b32 v241, s45, v36
  v_lshlrev_b32 v240, 16, v36
  v_fmac_f32 v57, v241, v241
  v_fmac_f32 v56, v240, v240
  s_waitcnt lgkmcnt(4)
  v_mfma_f32_32x32x16_bf16 v[80:95], v[36:39], v[48:51], v[80:95]
  ds_read_b64_tr_b16 v[32:33], v17 offset:24576
  ds_read_b64_tr_b16 v[34:35], v17 offset:25600
  v_and_b32 v243, s45, v37
  v_lshlrev_b32 v242, 16, v37
  v_fmac_f32 v57, v243, v243
  v_fmac_f32 v56, v242, v242
  v_mfma_f32_16x16x32_bf16 v[52:55], v[244:247], v[36:39], v[52:55]
  s_waitcnt lgkmcnt(5)
  v_mfma_f32_32x32x16_bf16 v[96:111], v[40:43], v[44:47], v[96:111]
  ds_read_b128 v[24:27], v14 offset:16384
  v_and_b32 v241, s45, v38
  v_lshlrev_b32 v240, 16, v38
  v_fmac_f32 v57, v241, v241
  v_fmac_f32 v56, v240, v240
  v_mfma_f32_32x32x16_bf16 v[112:127], v[40:43], v[48:51], v[112:127]
  v_and_b32 v243, s45, v39
  v_lshlrev_b32 v242, 16, v39
  v_fmac_f32 v57, v243, v243
  v_fmac_f32 v56, v242, v242
  v_mfma_f32_16x16x32_bf16 v[60:63], v[244:247], v[44:47], v[60:63]
  s_waitcnt lgkmcnt(3)
  v_mfma_f32_32x32x16_bf16 v[64:79], v[20:23], v[28:31], v[64:79]
  ds_read_b128 v[36:39], v11 offset:16384
  ds_read_b64_tr_b16 v[44:45], v16 offset:28672
  ds_read_b64_tr_b16 v[46:47], v16 offset:29696
  v_and_b32 v241, s45, v20
  v_lshlrev_b32 v240, 16, v20
  v_fmac_f32 v57, v241, v241
  v_fmac_f32 v56, v240, v240
  s_waitcnt lgkmcnt(4)
  v_mfma_f32_32x32x16_bf16 v[80:95], v[20:23], v[32:35], v[80:95]
  ds_read_b64_tr_b16 v[48:49], v17 offset:28672
  ds_read_b64_tr_b16 v[50:51], v17 offset:29696
  v_and_b32 v243, s45, v21
  v_lshlrev_b32 v242, 16, v21
  v_fmac_f32 v57, v243, v243
  v_fmac_f32 v56, v242, v242
  v_mfma_f32_16x16x32_bf16 v[52:55], v[244:247], v[20:23], v[52:55]
  s_waitcnt lgkmcnt(5)
  v_mfma_f32_32x32x16_bf16 v[96:111], v[24:27], v[28:31], v[96:111]
  ds_read_b128 v[40:43], v15 offset:16384
  v_and_b32 v241, s45, v22
  v_lshlrev_b32 v240, 16, v22
  v_fmac_f32 v57, v241, v241
  v_fmac_f32 v56, v240, v240
  v_mfma_f32_32x32x16_bf16 v[112:127], v[24:27], v[32:35], v[112:127]
  v_and_b32 v243, s45, v23
  v_lshlrev_b32 v242, 16, v23
  v_fmac_f32 v57, v243, v243
  v_fmac_f32 v56, v242, v242
  v_mfma_f32_16x16x32_bf16 v[60:63], v[244:247], v[28:31], v[60:63]
  s_waitcnt lgkmcnt(0)
  s_barrier
  v_mfma_f32_32x32x16_bf16 v[64:79], v[36:39], v[44:47], v[64:79]
  ds_read_b128 v[20:23], v8 offset:32768
  ds_read_b64_tr_b16 v[28:29], v16 offset:32768
  ds_read_b64_tr_b16 v[30:31], v16 offset:33792
  v_and_b32 v241, s45, v36
  v_lshlrev_b32 v240, 16, v36
  v_fmac_f32 v57, v241, v241
  v_fmac_f32 v56, v240, v240
  v_mfma_f32_32x32x16_bf16 v[80:95], v[36:39], v[48:51], v[80:95]
  ds_read_b64_tr_b16 v[32:33], v17 offset:32768
  ds_read_b64_tr_b16 v[34:35], v17 offset:33792
  v_and_b32 v243, s45, v37
  v_lshlrev_b32 v242, 16, v37
  v_fmac_f32 v57, v243, v243
  v_fmac_f32 v56, v242, v242
  v_mfma_f32_16x16x32_bf16 v[52:55], v[244:247], v[36:39], v[52:55]
  v_mfma_f32_32x32x16_bf16 v[96:111], v[40:43], v[44:47], v[96:111]
  ds_read_b128 v[24:27], v12 offset:32768
  v_and_b32 v241, s45, v38
  v_lshlrev_b32 v240, 16, v38
  v_fmac_f32 v57, v241, v241
  v_fmac_f32 v56, v240, v240
  v_mfma_f32_32x32x16_bf16 v[112:127], v[40:43], v[48:51], v[112:127]
  v_and_b32 v243, s45, v39
  v_lshlrev_b32 v242, 16, v39
  v_fmac_f32 v57, v243, v243
  v_fmac_f32 v56, v242, v242
  v_mfma_f32_16x16x32_bf16 v[60:63], v[244:247], v[44:47], v[60:63]
  s_waitcnt lgkmcnt(3)
  v_mfma_f32_32x32x16_bf16 v[64:79], v[20:23], v[28:31], v[64:79]
  ds_read_b128 v[36:39], v9 offset:32768
  ds_read_b64_tr_b16 v[44:45], v16 offset:36864
  ds_read_b64_tr_b16 v[46:47], v16 offset:37888
  v_and_b32 v241, s45, v20
  v_lshlrev_b32 v240, 16, v20
  v_fmac_f32 v57, v241, v241
  v_fmac_f32 v56, v240, v240
  s_waitcnt lgkmcnt(4)
  v_mfma_f32_32x32x16_bf16 v[80:95], v[20:23], v[32:35], v[80:95]
  ds_read_b64_tr_b16 v[48:49], v17 offset:36864
  ds_read_b64_tr_b16 v[50:51], v17 offset:37888
  v_and_b32 v243, s45, v21
  v_lshlrev_b32 v242, 16, v21
  v_fmac_f32 v57, v243, v243
  v_fmac_f32 v56, v242, v242
  v_mfma_f32_16x16x32_bf16 v[52:55], v[244:247], v[20:23], v[52:55]
  s_waitcnt lgkmcnt(5)
  v_mfma_f32_32x32x16_bf16 v[96:111], v[24:27], v[28:31], v[96:111]
  ds_read_b128 v[40:43], v13 offset:32768
  v_and_b32 v241, s45, v22
  v_lshlrev_b32 v240, 16, v22
  v_fmac_f32 v57, v241, v241
  v_fmac_f32 v56, v240, v240
  v_mfma_f32_32x32x16_bf16 v[112:127], v[24:27], v[32:35], v[112:127]
  v_and_b32 v243, s45, v23
  v_lshlrev_b32 v242, 16, v23
  v_fmac_f32 v57, v243, v243
  v_fmac_f32 v56, v242, v242
  v_mfma_f32_16x16x32_bf16 v[60:63], v[244:247], v[28:31], v[60:63]
  s_waitcnt lgkmcnt(3)
  v_mfma_f32_32x32x16_bf16 v[64:79], v[36:39], v[44:47], v[64:79]
  ds_read_b128 v[20:23], v10 offset:32768
  ds_read_b64_tr_b16 v[28:29], v16 offset:40960
  ds_read_b64_tr_b16 v[30:31], v16 offset:41984
  v_and_b32 v241, s45, v36
  v_lshlrev_b32 v240, 16, v36
  v_fmac_f32 v57, v241, v241
  v_fmac_f32 v56, v240, v240
  s_waitcnt lgkmcnt(4)
  v_mfma_f32_32x32x16_bf16 v[80:95], v[36:39], v[48:51], v[80:95]
  ds_read_b64_tr_b16 v[32:33], v17 offset:40960
  ds_read_b64_tr_b16 v[34:35], v17 offset:41984
  v_and_b32 v243, s45, v37
  v_lshlrev_b32 v242, 16, v37
  v_fmac_f32 v57, v243, v243
  v_fmac_f32 v56, v242, v242
  v_mfma_f32_16x16x32_bf16 v[52:55], v[244:247], v[36:39], v[52:55]
  s_waitcnt lgkmcnt(5)
  v_mfma_f32_32x32x16_bf16 v[96:111], v[40:43], v[44:47], v[96:111]
  ds_read_b128 v[24:27], v14 offset:32768
  v_and_b32 v241, s45, v38
  v_lshlrev_b32 v240, 16, v38
  v_fmac_f32 v57, v241, v241
  v_fmac_f32 v56, v240, v240
  v_mfma_f32_32x32x16_bf16 v[112:127], v[40:43], v[48:51], v[112:127]
  v_and_b32 v243, s45, v39
  v_lshlrev_b32 v242, 16, v39
  v_fmac_f32 v57, v243, v243
  v_fmac_f32 v56, v242, v242
  v_mfma_f32_16x16x32_bf16 v[60:63], v[244:247], v[44:47], v[60:63]
  s_waitcnt lgkmcnt(3)
  v_mfma_f32_32x32x16_bf16 v[64:79], v[20:23], v[28:31], v[64:79]
  ds_read_b128 v[36:39], v11 offset:32768
  ds_read_b64_tr_b16 v[44:45], v16 offset:45056
  ds_read_b64_tr_b16 v[46:47], v16 offset:46080
  v_and_b32 v241, s45, v20
  v_lshlrev_b32 v240, 16, v20
  v_fmac_f32 v57, v241, v241
  v_fmac_f32 v56, v240, v240
  s_waitcnt lgkmcnt(4)
  v_mfma_f32_32x32x16_bf16 v[80:95], v[20:23], v[32:35], v[80:95]
  ds_read_b64_tr_b16 v[48:49], v17 offset:45056
  ds_read_b64_tr_b16 v[50:51], v17 offset:46080
  v_and_b32 v243, s45, v21
  v_lshlrev_b32 v242, 16, v21
  v_fmac_f32 v57, v243, v243
  v_fmac_f32 v56, v242, v242
  v_mfma_f32_16x16x32_bf16 v[52:55], v[244:247], v[20:23], v[52:55]
  s_waitcnt lgkmcnt(5)
  v_mfma_f32_32x32x16_bf16 v[96:111], v[24:27], v[28:31], v[96:111]
  ds_read_b128 v[40:43], v15 offset:32768
  v_and_b32 v241, s45, v22
  v_lshlrev_b32 v240, 16, v22
  v_fmac_f32 v57, v241, v241
  v_fmac_f32 v56, v240, v240
  v_mfma_f32_32x32x16_bf16 v[112:127], v[24:27], v[32:35], v[112:127]
  v_and_b32 v243, s45, v23
  v_lshlrev_b32 v242, 16, v23
  v_fmac_f32 v57, v243, v243
  v_fmac_f32 v56, v242, v242
  v_mfma_f32_16x16x32_bf16 v[60:63], v[244:247], v[28:31], v[60:63]
  s_waitcnt lgkmcnt(3)
  v_mfma_f32_32x32x16_bf16 v[64:79], v[36:39], v[44:47], v[64:79]
  v_and_b32 v241, s45, v36
  v_lshlrev_b32 v240, 16, v36
  v_fmac_f32 v57, v241, v241
  v_fmac_f32 v56, v240, v240
  s_waitcnt lgkmcnt(1)
  v_mfma_f32_32x32x16_bf16 v[80:95], v[36:39], v[48:51], v[80:95]
  v_and_b32 v243, s45, v37
  v_lshlrev_b32 v242, 16, v37
  v_fmac_f32 v57, v243, v243
  v_fmac_f32 v56, v242, v242
  v_mfma_f32_16x16x32_bf16 v[52:55], v[244:247], v[36:39], v[52:55]
  s_waitcnt lgkmcnt(0)
  v_mfma_f32_32x32x16_bf16 v[96:111], v[40:43], v[44:47], v[96:111]
  v_and_b32 v241, s45, v38
  v_lshlrev_b32 v240, 16, v38
  v_fmac_f32 v57, v241, v241
  v_fmac_f32 v56, v240, v240
  v_mfma_f32_32x32x16_bf16 v[112:127], v[40:43], v[48:51], v[112:127]
  v_and_b32 v243, s45, v39
  v_lshlrev_b32 v242, 16, v39
  v_fmac_f32 v57, v243, v243
  v_fmac_f32 v56, v242, v242
  v_mfma_f32_16x16x32_bf16 v[60:63], v[244:247], v[44:47], v[60:63]
parallel_sum__softmax_full_mha__mixer_s_mlp__prompt_kernel_ep:
  s_nop 3
  v_add_f32 v56, v56, v57
  v_mov_b32 v21, v56
  s_nop 1
  v_permlane32_swap_b32 v21, v56
  s_nop 7
  s_nop 3
  v_add_f32 v21, v21, v56
  v_mov_b32 v20, v52
  v_mov_b32 v22, v60
  v_mul_f32 v20, 0x3b124925, v20
  v_mul_f32 v21, 0x3b124925, v21
  v_fma_f32 v21, -v20, v20, v21
  v_max_f32 v21, 0, v21
  v_add_f32 v23, 0x3727c5ac, v21
  v_rsq_f32 v23, v23
  s_nop 0
  v_mul_f32 v24, v23, v23
  v_mov_b32 v25, 0x3727c5ac
  v_fma_f32 v24, v21, v24, v25
  v_rsq_f32 v24, v24
  s_nop 0
  s_cmp_eq_u32 s26, 3
  s_cselect_b64 vcc, -1, 0
  v_mov_b32 v25, 1.0
  v_cndmask_b32 v24, v25, v24, vcc
  s_cmp_eq_u32 s26, 0
  s_cselect_b32 s36, 0x3e8b97f6, 1.0
  v_mul_f32 v24, s36, v24
  v_mul_f32 v24, v24, v23
  v_mul_f32 v25, v24, v20
  v_sub_f32 v25, 0, v25
  v_and_b32 v5, 31, v1
  s_lshl_b32 s36, s40, 7
  v_lshl_add_u32 v26, v5, 2, s36
  v_add_u32 v26, 160768, v26
  ds_write_b32 v26, v24
  ds_write_b32 v26, v25 offset:512
  s_lshl_b32 s36, s42, 7
  v_lshl_add_u32 v27, v5, 2, s36
  v_add_u32 v27, 160768, v27
  ds_write_b32 v27, v22 offset:1024
  s_cmp_lg_u32 s25, 12
  s_cbranch_scc1 parallel_sum__softmax_full_mha__mixer_s_mlp__prompt_kernel_nostats
  s_lshl_b32 s36, s24, 7
  s_lshl_b32 s37, s40, 5
  s_add_u32 s36, s36, s37
  v_add_u32 v28, s36, v5
  v_lshlrev_b32 v28, 3, v28
  v_mov_b32 v30, v20
  v_mov_b32 v31, v23
  s_mov_b32 s36, 65536
  buffer_store_dwordx2 v[30:31], v28, s[20:23], s36 offen sc1
parallel_sum__softmax_full_mha__mixer_s_mlp__prompt_kernel_nostats:
  s_waitcnt lgkmcnt(0)
  s_barrier
  v_lshlrev_b32 v2, 4, v1
  v_lshrrev_b32 v6, 5, v1
  v_and_b32 v5, 31, v1
  s_cmp_eq_u32 s26, 2
  s_cbranch_scc1 parallel_sum__softmax_full_mha__mixer_s_mlp__prompt_kernel_epv
  s_lshl_b32 s36, s40, 7
  v_lshl_add_u32 v7, v5, 2, s36
  v_add_u32 v7, 160768, v7
  ds_read_b32 v20, v7
  ds_read_b32 v24, v7 offset:512
  s_lshl_b32 s36, s41, 7
  v_lshl_add_u32 v7, v5, 2, s36
  v_add_u32 v7, 160768, v7
  ds_read_b32 v22, v7
  ds_read_b32 v26, v7 offset:512
  s_lshl_b32 s36, s42, 7
  v_lshl_add_u32 v7, v6, 4, s36
  v_add_u32 v7, 160768, v7
  ds_read_b128 v[128:131], v7 offset:1024
  ds_read_b128 v[132:135], v7 offset:1056
  ds_read_b128 v[136:139], v7 offset:1088
  ds_read_b128 v[140:143], v7 offset:1120
  s_lshl_b32 s36, s43, 7
  v_lshl_add_u32 v7, v6, 4, s36
  v_add_u32 v7, 160768, v7
  ds_read_b128 v[144:147], v7 offset:1024
  ds_read_b128 v[148:151], v7 offset:1056
  ds_read_b128 v[152:155], v7 offset:1088
  ds_read_b128 v[156:159], v7 offset:1120
  s_waitcnt lgkmcnt(0)
  s_cmp_eq_u32 s26, 3
  s_cbranch_scc1 parallel_sum__softmax_full_mha__mixer_s_mlp__prompt_kernel_epw
  s_cmp_eq_u32 s26, 0
  s_mov_b32 s45, 3145728
  s_cselect_b32 s45, 1048576, s45
  s_cselect_b32 s46, 0, 0x3f803f80
  s_cselect_b32 s47, 0, 0x3f80
  v_pk_mul_f32 v[160:161], v[128:129], v[24:25] op_sel_hi:[1,0]
  v_pk_mul_f32 v[162:163], v[130:131], v[24:25] op_sel_hi:[1,0]
  v_pk_mul_f32 v[164:165], v[132:133], v[24:25] op_sel_hi:[1,0]
  v_pk_mul_f32 v[166:167], v[134:135], v[24:25] op_sel_hi:[1,0]
  v_pk_mul_f32 v[168:169], v[136:137], v[24:25] op_sel_hi:[1,0]
  v_pk_mul_f32 v[170:171], v[138:139], v[24:25] op_sel_hi:[1,0]
  v_pk_mul_f32 v[172:173], v[140:141], v[24:25] op_sel_hi:[1,0]
  v_pk_mul_f32 v[174:175], v[142:143], v[24:25] op_sel_hi:[1,0]
  v_pk_fma_f32 v[64:65], v[64:65], v[20:21], v[160:161] op_sel_hi:[1,0,1]
  v_pk_fma_f32 v[66:67], v[66:67], v[20:21], v[162:163] op_sel_hi:[1,0,1]
  v_pk_fma_f32 v[68:69], v[68:69], v[20:21], v[164:165] op_sel_hi:[1,0,1]
  v_pk_fma_f32 v[70:71], v[70:71], v[20:21], v[166:167] op_sel_hi:[1,0,1]
  v_pk_fma_f32 v[72:73], v[72:73], v[20:21], v[168:169] op_sel_hi:[1,0,1]
  v_pk_fma_f32 v[74:75], v[74:75], v[20:21], v[170:171] op_sel_hi:[1,0,1]
  v_pk_fma_f32 v[76:77], v[76:77], v[20:21], v[172:173] op_sel_hi:[1,0,1]
  v_pk_fma_f32 v[78:79], v[78:79], v[20:21], v[174:175] op_sel_hi:[1,0,1]
  v_cvt_pk_bf16_f32 v176, v64, v65
  v_cvt_pk_bf16_f32 v177, v66, v67
  v_cvt_pk_bf16_f32 v178, v68, v69
  v_cvt_pk_bf16_f32 v179, v70, v71
  v_cvt_pk_bf16_f32 v180, v72, v73
  v_cvt_pk_bf16_f32 v181, v74, v75
  v_cvt_pk_bf16_f32 v182, v76, v77
  v_cvt_pk_bf16_f32 v183, v78, v79
  s_mov_b32 exec_lo, 0
  v_mov_b32 v182, s46
  v_mov_b32 v183, s47
  s_mov_b32 exec_lo, -1
  s_and_b32 s36, s25, 3
  s_lshl_b32 s36, s36, 2
  s_add_u32 s36, s36, s42
  s_lshl_b32 s36, s36, 17
  s_lshl_b32 s37, s24, 2
  s_add_u32 s37, s37, s40
  s_lshl_b32 s37, s37, 11
  s_add_u32 s36, s36, s37
  s_add_u32 s36, s36, s45
  buffer_store_dwordx4 v[176:179], v2, s[20:23], s36 offen sc1
  buffer_store_dwordx4 v[180:183], v2, s[20:23], s36 offen offset:1024 sc1
  v_pk_mul_f32 v[160:161], v[144:145], v[24:25] op_sel_hi:[1,0]
  v_pk_mul_f32 v[162:163], v[146:147], v[24:25] op_sel_hi:[1,0]
  v_pk_mul_f32 v[164:165], v[148:149], v[24:25] op_sel_hi:[1,0]
  v_pk_mul_f32 v[166:167], v[150:151], v[24:25] op_sel_hi:[1,0]
  v_pk_mul_f32 v[168:169], v[152:153], v[24:25] op_sel_hi:[1,0]
  v_pk_mul_f32 v[170:171], v[154:155], v[24:25] op_sel_hi:[1,0]
  v_pk_mul_f32 v[172:173], v[156:157], v[24:25] op_sel_hi:[1,0]
  v_pk_mul_f32 v[174:175], v[158:159], v[24:25] op_sel_hi:[1,0]
  v_pk_fma_f32 v[80:81], v[80:81], v[20:21], v[160:161] op_sel_hi:[1,0,1]
  v_pk_fma_f32 v[82:83], v[82:83], v[20:21], v[162:163] op_sel_hi:[1,0,1]
  v_pk_fma_f32 v[84:85], v[84:85], v[20:21], v[164:165] op_sel_hi:[1,0,1]
  v_pk_fma_f32 v[86:87], v[86:87], v[20:21], v[166:167] op_sel_hi:[1,0,1]
  v_pk_fma_f32 v[88:89], v[88:89], v[20:21], v[168:169] op_sel_hi:[1,0,1]
  v_pk_fma_f32 v[90:91], v[90:91], v[20:21], v[170:171] op_sel_hi:[1,0,1]
  v_pk_fma_f32 v[92:93], v[92:93], v[20:21], v[172:173] op_sel_hi:[1,0,1]
  v_pk_fma_f32 v[94:95], v[94:95], v[20:21], v[174:175] op_sel_hi:[1,0,1]
  v_cvt_pk_bf16_f32 v184, v80, v81
  v_cvt_pk_bf16_f32 v185, v82, v83
  v_cvt_pk_bf16_f32 v186, v84, v85
  v_cvt_pk_bf16_f32 v187, v86, v87
  v_cvt_pk_bf16_f32 v188, v88, v89
  v_cvt_pk_bf16_f32 v189, v90, v91
  v_cvt_pk_bf16_f32 v190, v92, v93
  v_cvt_pk_bf16_f32 v191, v94, v95
  s_mov_b32 exec_lo, 0
  v_mov_b32 v190, s46
  v_mov_b32 v191, s47
  s_mov_b32 exec_lo, -1
  s_and_b32 s36, s25, 3
  s_lshl_b32 s36, s36, 2
  s_add_u32 s36, s36, s43
  s_lshl_b32 s36, s36, 17
  s_lshl_b32 s37, s24, 2
  s_add_u32 s37, s37, s40
  s_lshl_b32 s37, s37, 11
  s_add_u32 s36, s36, s37
  s_add_u32 s36, s36, s45
  buffer_store_dwordx4 v[184:187], v2, s[20:23], s36 offen sc1
  buffer_store_dwordx4 v[188:191], v2, s[20:23], s36 offen offset:1024 sc1
  v_pk_mul_f32 v[160:161], v[128:129], v[26:27] op_sel_hi:[1,0]
  v_pk_mul_f32 v[162:163], v[130:131], v[26:27] op_sel_hi:[1,0]
  v_pk_mul_f32 v[164:165], v[132:133], v[26:27] op_sel_hi:[1,0]
  v_pk_mul_f32 v[166:167], v[134:135], v[26:27] op_sel_hi:[1,0]
  v_pk_mul_f32 v[168:169], v[136:137], v[26:27] op_sel_hi:[1,0]
  v_pk_mul_f32 v[170:171], v[138:139], v[26:27] op_sel_hi:[1,0]
  v_pk_mul_f32 v[172:173], v[140:141], v[26:27] op_sel_hi:[1,0]
  v_pk_mul_f32 v[174:175], v[142:143], v[26:27] op_sel_hi:[1,0]
  v_pk_fma_f32 v[96:97], v[96:97], v[22:23], v[160:161] op_sel_hi:[1,0,1]
  v_pk_fma_f32 v[98:99], v[98:99], v[22:23], v[162:163] op_sel_hi:[1,0,1]
  v_pk_fma_f32 v[100:101], v[100:101], v[22:23], v[164:165] op_sel_hi:[1,0,1]
  v_pk_fma_f32 v[102:103], v[102:103], v[22:23], v[166:167] op_sel_hi:[1,0,1]
  v_pk_fma_f32 v[104:105], v[104:105], v[22:23], v[168:169] op_sel_hi:[1,0,1]
  v_pk_fma_f32 v[106:107], v[106:107], v[22:23], v[170:171] op_sel_hi:[1,0,1]
  v_pk_fma_f32 v[108:109], v[108:109], v[22:23], v[172:173] op_sel_hi:[1,0,1]
  v_pk_fma_f32 v[110:111], v[110:111], v[22:23], v[174:175] op_sel_hi:[1,0,1]
  v_cvt_pk_bf16_f32 v176, v96, v97
  v_cvt_pk_bf16_f32 v177, v98, v99
  v_cvt_pk_bf16_f32 v178, v100, v101
  v_cvt_pk_bf16_f32 v179, v102, v103
  v_cvt_pk_bf16_f32 v180, v104, v105
  v_cvt_pk_bf16_f32 v181, v106, v107
  v_cvt_pk_bf16_f32 v182, v108, v109
  v_cvt_pk_bf16_f32 v183, v110, v111
  s_mov_b32 exec_lo, 0
  v_mov_b32 v182, s46
  v_mov_b32 v183, s47
  s_mov_b32 exec_lo, -1
  s_and_b32 s36, s25, 3
  s_lshl_b32 s36, s36, 2
  s_add_u32 s36, s36, s42
  s_lshl_b32 s36, s36, 17
  s_lshl_b32 s37, s24, 2
  s_add_u32 s37, s37, s41
  s_lshl_b32 s37, s37, 11
  s_add_u32 s36, s36, s37
  s_add_u32 s36, s36, s45
  buffer_store_dwordx4 v[176:179], v2, s[20:23], s36 offen sc1
  buffer_store_dwordx4 v[180:183], v2, s[20:23], s36 offen offset:1024 sc1
  v_pk_mul_f32 v[160:161], v[144:145], v[26:27] op_sel_hi:[1,0]
  v_pk_mul_f32 v[162:163], v[146:147], v[26:27] op_sel_hi:[1,0]
  v_pk_mul_f32 v[164:165], v[148:149], v[26:27] op_sel_hi:[1,0]
  v_pk_mul_f32 v[166:167], v[150:151], v[26:27] op_sel_hi:[1,0]
  v_pk_mul_f32 v[168:169], v[152:153], v[26:27] op_sel_hi:[1,0]
  v_pk_mul_f32 v[170:171], v[154:155], v[26:27] op_sel_hi:[1,0]
  v_pk_mul_f32 v[172:173], v[156:157], v[26:27] op_sel_hi:[1,0]
  v_pk_mul_f32 v[174:175], v[158:159], v[26:27] op_sel_hi:[1,0]
  v_pk_fma_f32 v[112:113], v[112:113], v[22:23], v[160:161] op_sel_hi:[1,0,1]
  v_pk_fma_f32 v[114:115], v[114:115], v[22:23], v[162:163] op_sel_hi:[1,0,1]
  v_pk_fma_f32 v[116:117], v[116:117], v[22:23], v[164:165] op_sel_hi:[1,0,1]
  v_pk_fma_f32 v[118:119], v[118:119], v[22:23], v[166:167] op_sel_hi:[1,0,1]
  v_pk_fma_f32 v[120:121], v[120:121], v[22:23], v[168:169] op_sel_hi:[1,0,1]
  v_pk_fma_f32 v[122:123], v[122:123], v[22:23], v[170:171] op_sel_hi:[1,0,1]
  v_pk_fma_f32 v[124:125], v[124:125], v[22:23], v[172:173] op_sel_hi:[1,0,1]
  v_pk_fma_f32 v[126:127], v[126:127], v[22:23], v[174:175] op_sel_hi:[1,0,1]
  v_cvt_pk_bf16_f32 v184, v112, v113
  v_cvt_pk_bf16_f32 v185, v114, v115
  v_cvt_pk_bf16_f32 v186, v116, v117
  v_cvt_pk_bf16_f32 v187, v118, v119
  v_cvt_pk_bf16_f32 v188, v120, v121
  v_cvt_pk_bf16_f32 v189, v122, v123
  v_cvt_pk_bf16_f32 v190, v124, v125
  v_cvt_pk_bf16_f32 v191, v126, v127
  s_mov_b32 exec_lo, 0
  v_mov_b32 v190, s46
  v_mov_b32 v191, s47
  s_mov_b32 exec_lo, -1
  s_and_b32 s36, s25, 3
  s_lshl_b32 s36, s36, 2
  s_add_u32 s36, s36, s43
  s_lshl_b32 s36, s36, 17
  s_lshl_b32 s37, s24, 2
  s_add_u32 s37, s37, s41
  s_lshl_b32 s37, s37, 11
  s_add_u32 s36, s36, s37
  s_add_u32 s36, s36, s45
  buffer_store_dwordx4 v[184:187], v2, s[20:23], s36 offen sc1
  buffer_store_dwordx4 v[188:191], v2, s[20:23], s36 offen offset:1024 sc1
  s_branch parallel_sum__softmax_full_mha__mixer_s_mlp__prompt_kernel_fin
parallel_sum__softmax_full_mha__mixer_s_mlp__prompt_kernel_epw:
  v_mov_b32 v192, 0xc0135761
  v_mov_b32 v193, 0xc0135761
  v_mov_b32 v194, 0xbdd2d3e8
  v_mov_b32 v195, 0xbdd2d3e8
  v_mov_b32 v196, 1.0
  v_mov_b32 v197, 1.0
  s_and_b32 s45, s25, 3
  s_lshr_b32 s46, s45, 1
  s_add_u32 s46, s46, 1
  s_sub_u32 s47, 0, s46
  s_bitcmp1_b32 s45, 0
  s_cselect_b32 s46, s47, s46
  s_lshl_b32 s36, s24, 7
  s_lshl_b32 s37, s40, 5
  s_add_u32 s36, s36, s37
  s_add_u32 s36, s36, s46
  v_add_u32 v7, s36, v5
  v_cmp_gt_u32 vcc, 2048, v7
  v_and_b32 v7, 2047, v7
  v_lshrrev_b32 v8, 5, v7
  s_movk_i32 s36, 28672
  v_mul_lo_u32 v8, v8, s36
  v_and_b32 v7, 31, v7
  v_lshl_add_u32 v7, v6, 5, v7
  v_lshl_add_u32 v10, v7, 4, v8
  v_cndmask_b32 v12, 0, -1, vcc
  s_lshl_b32 s36, s24, 7
  s_lshl_b32 s37, s41, 5
  s_add_u32 s36, s36, s37
  s_add_u32 s36, s36, s46
  v_add_u32 v7, s36, v5
  v_cmp_gt_u32 vcc, 2048, v7
  v_and_b32 v7, 2047, v7
  v_lshrrev_b32 v8, 5, v7
  s_movk_i32 s36, 28672
  v_mul_lo_u32 v8, v8, s36
  v_and_b32 v7, 31, v7
  v_lshl_add_u32 v7, v6, 5, v7
  v_lshl_add_u32 v11, v7, 4, v8
  v_cndmask_b32 v13, 0, -1, vcc
  v_pk_mul_f32 v[160:161], v[128:129], v[24:25] op_sel_hi:[1,0]
  v_pk_mul_f32 v[162:163], v[130:131], v[24:25] op_sel_hi:[1,0]
  v_pk_mul_f32 v[164:165], v[132:133], v[24:25] op_sel_hi:[1,0]
  v_pk_mul_f32 v[166:167], v[134:135], v[24:25] op_sel_hi:[1,0]
  v_pk_mul_f32 v[168:169], v[136:137], v[24:25] op_sel_hi:[1,0]
  v_pk_mul_f32 v[170:171], v[138:139], v[24:25] op_sel_hi:[1,0]
  v_pk_mul_f32 v[172:173], v[140:141], v[24:25] op_sel_hi:[1,0]
  v_pk_mul_f32 v[174:175], v[142:143], v[24:25] op_sel_hi:[1,0]
  v_pk_fma_f32 v[64:65], v[64:65], v[20:21], v[160:161] op_sel_hi:[1,0,1]
  v_pk_fma_f32 v[66:67], v[66:67], v[20:21], v[162:163] op_sel_hi:[1,0,1]
  v_pk_fma_f32 v[68:69], v[68:69], v[20:21], v[164:165] op_sel_hi:[1,0,1]
  v_pk_fma_f32 v[70:71], v[70:71], v[20:21], v[166:167] op_sel_hi:[1,0,1]
  v_pk_fma_f32 v[72:73], v[72:73], v[20:21], v[168:169] op_sel_hi:[1,0,1]
  v_pk_fma_f32 v[74:75], v[74:75], v[20:21], v[170:171] op_sel_hi:[1,0,1]
  v_pk_fma_f32 v[76:77], v[76:77], v[20:21], v[172:173] op_sel_hi:[1,0,1]
  v_pk_fma_f32 v[78:79], v[78:79], v[20:21], v[174:175] op_sel_hi:[1,0,1]
  v_pk_mul_f32 v[200:201], v[64:65], v[64:65]
  v_pk_mul_f32 v[202:203], v[66:67], v[66:67]
  v_pk_mul_f32 v[204:205], v[68:69], v[68:69]
  v_pk_mul_f32 v[206:207], v[70:71], v[70:71]
  v_pk_mul_f32 v[208:209], v[72:73], v[72:73]
  v_pk_mul_f32 v[210:211], v[74:75], v[74:75]
  v_pk_mul_f32 v[212:213], v[76:77], v[76:77]
  v_pk_mul_f32 v[214:215], v[78:79], v[78:79]
  v_pk_fma_f32 v[200:201], v[200:201], v[194:195], v[192:193]
  v_pk_fma_f32 v[202:203], v[202:203], v[194:195], v[192:193]
  v_pk_fma_f32 v[204:205], v[204:205], v[194:195], v[192:193]
  v_pk_fma_f32 v[206:207], v[206:207], v[194:195], v[192:193]
  v_pk_fma_f32 v[208:209], v[208:209], v[194:195], v[192:193]
  v_pk_fma_f32 v[210:211], v[210:211], v[194:195], v[192:193]
  v_pk_fma_f32 v[212:213], v[212:213], v[194:195], v[192:193]
  v_pk_fma_f32 v[214:215], v[214:215], v[194:195], v[192:193]
  v_pk_mul_f32 v[200:201], v[200:201], v[64:65]
  v_pk_mul_f32 v[202:203], v[202:203], v[66:67]
  v_pk_mul_f32 v[204:205], v[204:205], v[68:69]
  v_pk_mul_f32 v[206:207], v[206:207], v[70:71]
  v_pk_mul_f32 v[208:209], v[208:209], v[72:73]
  v_pk_mul_f32 v[210:211], v[210:211], v[74:75]
  v_pk_mul_f32 v[212:213], v[212:213], v[76:77]
  v_pk_mul_f32 v[214:215], v[214:215], v[78:79]
  v_exp_f32 v200, v200
  v_exp_f32 v201, v201
  v_exp_f32 v202, v202
  v_exp_f32 v203, v203
  v_exp_f32 v204, v204
  v_exp_f32 v205, v205
  v_exp_f32 v206, v206
  v_exp_f32 v207, v207
  v_exp_f32 v208, v208
  v_exp_f32 v209, v209
  v_exp_f32 v210, v210
  v_exp_f32 v211, v211
  v_exp_f32 v212, v212
  v_exp_f32 v213, v213
  v_exp_f32 v214, v214
  v_exp_f32 v215, v215
  v_pk_add_f32 v[200:201], v[200:201], v[196:197]
  v_pk_add_f32 v[202:203], v[202:203], v[196:197]
  v_pk_add_f32 v[204:205], v[204:205], v[196:197]
  v_pk_add_f32 v[206:207], v[206:207], v[196:197]
  v_pk_add_f32 v[208:209], v[208:209], v[196:197]
  v_pk_add_f32 v[210:211], v[210:211], v[196:197]
  v_pk_add_f32 v[212:213], v[212:213], v[196:197]
  v_pk_add_f32 v[214:215], v[214:215], v[196:197]
  v_rcp_f32 v200, v200
  v_rcp_f32 v201, v201
  v_rcp_f32 v202, v202
  v_rcp_f32 v203, v203
  v_rcp_f32 v204, v204
  v_rcp_f32 v205, v205
  v_rcp_f32 v206, v206
  v_rcp_f32 v207, v207
  v_rcp_f32 v208, v208
  v_rcp_f32 v209, v209
  v_rcp_f32 v210, v210
  v_rcp_f32 v211, v211
  v_rcp_f32 v212, v212
  v_rcp_f32 v213, v213
  v_rcp_f32 v214, v214
  v_rcp_f32 v215, v215
  v_pk_mul_f32 v[64:65], v[64:65], v[200:201]
  v_pk_mul_f32 v[66:67], v[66:67], v[202:203]
  v_pk_mul_f32 v[68:69], v[68:69], v[204:205]
  v_pk_mul_f32 v[70:71], v[70:71], v[206:207]
  v_pk_mul_f32 v[72:73], v[72:73], v[208:209]
  v_pk_mul_f32 v[74:75], v[74:75], v[210:211]
  v_pk_mul_f32 v[76:77], v[76:77], v[212:213]
  v_pk_mul_f32 v[78:79], v[78:79], v[214:215]
  v_cvt_pk_bf16_f32 v176, v64, v65
  v_cvt_pk_bf16_f32 v177, v66, v67
  v_cvt_pk_bf16_f32 v178, v68, v69
  v_cvt_pk_bf16_f32 v179, v70, v71
  v_cvt_pk_bf16_f32 v180, v72, v73
  v_cvt_pk_bf16_f32 v181, v74, v75
  v_cvt_pk_bf16_f32 v182, v76, v77
  v_cvt_pk_bf16_f32 v183, v78, v79
  v_and_b32 v176, v176, v12
  v_and_b32 v177, v177, v12
  v_and_b32 v178, v178, v12
  v_and_b32 v179, v179, v12
  v_and_b32 v180, v180, v12
  v_and_b32 v181, v181, v12
  v_and_b32 v182, v182, v12
  v_and_b32 v183, v183, v12
  s_mul_i32 s36, s45, 7
  s_lshl_b32 s37, s42, 1
  s_add_u32 s36, s36, s37
  s_lshl_b32 s36, s36, 10
  s_add_u32 s36, s36, 7340032
  buffer_store_dwordx4 v[176:179], v10, s[20:23], s36 offen sc1
  s_cmp_eq_u32 s42, 3
  s_cbranch_scc1 k1skip_44
  buffer_store_dwordx4 v[180:183], v10, s[20:23], s36 offen offset:1024 sc1
k1skip_44:
  v_pk_mul_f32 v[160:161], v[144:145], v[24:25] op_sel_hi:[1,0]
  v_pk_mul_f32 v[162:163], v[146:147], v[24:25] op_sel_hi:[1,0]
  v_pk_mul_f32 v[164:165], v[148:149], v[24:25] op_sel_hi:[1,0]
  v_pk_mul_f32 v[166:167], v[150:151], v[24:25] op_sel_hi:[1,0]
  v_pk_mul_f32 v[168:169], v[152:153], v[24:25] op_sel_hi:[1,0]
  v_pk_mul_f32 v[170:171], v[154:155], v[24:25] op_sel_hi:[1,0]
  v_pk_mul_f32 v[172:173], v[156:157], v[24:25] op_sel_hi:[1,0]
  v_pk_mul_f32 v[174:175], v[158:159], v[24:25] op_sel_hi:[1,0]
  v_pk_fma_f32 v[80:81], v[80:81], v[20:21], v[160:161] op_sel_hi:[1,0,1]
  v_pk_fma_f32 v[82:83], v[82:83], v[20:21], v[162:163] op_sel_hi:[1,0,1]
  v_pk_fma_f32 v[84:85], v[84:85], v[20:21], v[164:165] op_sel_hi:[1,0,1]
  v_pk_fma_f32 v[86:87], v[86:87], v[20:21], v[166:167] op_sel_hi:[1,0,1]
  v_pk_fma_f32 v[88:89], v[88:89], v[20:21], v[168:169] op_sel_hi:[1,0,1]
  v_pk_fma_f32 v[90:91], v[90:91], v[20:21], v[170:171] op_sel_hi:[1,0,1]
  v_pk_fma_f32 v[92:93], v[92:93], v[20:21], v[172:173] op_sel_hi:[1,0,1]
  v_pk_fma_f32 v[94:95], v[94:95], v[20:21], v[174:175] op_sel_hi:[1,0,1]
  v_pk_mul_f32 v[200:201], v[80:81], v[80:81]
  v_pk_mul_f32 v[202:203], v[82:83], v[82:83]
  v_pk_mul_f32 v[204:205], v[84:85], v[84:85]
  v_pk_mul_f32 v[206:207], v[86:87], v[86:87]
  v_pk_mul_f32 v[208:209], v[88:89], v[88:89]
  v_pk_mul_f32 v[210:211], v[90:91], v[90:91]
  v_pk_mul_f32 v[212:213], v[92:93], v[92:93]
  v_pk_mul_f32 v[214:215], v[94:95], v[94:95]
  v_pk_fma_f32 v[200:201], v[200:201], v[194:195], v[192:193]
  v_pk_fma_f32 v[202:203], v[202:203], v[194:195], v[192:193]
  v_pk_fma_f32 v[204:205], v[204:205], v[194:195], v[192:193]
  v_pk_fma_f32 v[206:207], v[206:207], v[194:195], v[192:193]
  v_pk_fma_f32 v[208:209], v[208:209], v[194:195], v[192:193]
  v_pk_fma_f32 v[210:211], v[210:211], v[194:195], v[192:193]
  v_pk_fma_f32 v[212:213], v[212:213], v[194:195], v[192:193]
  v_pk_fma_f32 v[214:215], v[214:215], v[194:195], v[192:193]
  v_pk_mul_f32 v[200:201], v[200:201], v[80:81]
  v_pk_mul_f32 v[202:203], v[202:203], v[82:83]
  v_pk_mul_f32 v[204:205], v[204:205], v[84:85]
  v_pk_mul_f32 v[206:207], v[206:207], v[86:87]
  v_pk_mul_f32 v[208:209], v[208:209], v[88:89]
  v_pk_mul_f32 v[210:211], v[210:211], v[90:91]
  v_pk_mul_f32 v[212:213], v[212:213], v[92:93]
  v_pk_mul_f32 v[214:215], v[214:215], v[94:95]
  v_exp_f32 v200, v200
  v_exp_f32 v201, v201
  v_exp_f32 v202, v202
  v_exp_f32 v203, v203
  v_exp_f32 v204, v204
  v_exp_f32 v205, v205
  v_exp_f32 v206, v206
  v_exp_f32 v207, v207
  v_exp_f32 v208, v208
  v_exp_f32 v209, v209
  v_exp_f32 v210, v210
  v_exp_f32 v211, v211
  v_exp_f32 v212, v212
  v_exp_f32 v213, v213
  v_exp_f32 v214, v214
  v_exp_f32 v215, v215
  v_pk_add_f32 v[200:201], v[200:201], v[196:197]
  v_pk_add_f32 v[202:203], v[202:203], v[196:197]
  v_pk_add_f32 v[204:205], v[204:205], v[196:197]
  v_pk_add_f32 v[206:207], v[206:207], v[196:197]
  v_pk_add_f32 v[208:209], v[208:209], v[196:197]
  v_pk_add_f32 v[210:211], v[210:211], v[196:197]
  v_pk_add_f32 v[212:213], v[212:213], v[196:197]
  v_pk_add_f32 v[214:215], v[214:215], v[196:197]
  v_rcp_f32 v200, v200
  v_rcp_f32 v201, v201
  v_rcp_f32 v202, v202
  v_rcp_f32 v203, v203
  v_rcp_f32 v204, v204
  v_rcp_f32 v205, v205
  v_rcp_f32 v206, v206
  v_rcp_f32 v207, v207
  v_rcp_f32 v208, v208
  v_rcp_f32 v209, v209
  v_rcp_f32 v210, v210
  v_rcp_f32 v211, v211
  v_rcp_f32 v212, v212
  v_rcp_f32 v213, v213
  v_rcp_f32 v214, v214
  v_rcp_f32 v215, v215
  v_pk_mul_f32 v[80:81], v[80:81], v[200:201]
  v_pk_mul_f32 v[82:83], v[82:83], v[202:203]
  v_pk_mul_f32 v[84:85], v[84:85], v[204:205]
  v_pk_mul_f32 v[86:87], v[86:87], v[206:207]
  v_pk_mul_f32 v[88:89], v[88:89], v[208:209]
  v_pk_mul_f32 v[90:91], v[90:91], v[210:211]
  v_pk_mul_f32 v[92:93], v[92:93], v[212:213]
  v_pk_mul_f32 v[94:95], v[94:95], v[214:215]
  v_cvt_pk_bf16_f32 v184, v80, v81
  v_cvt_pk_bf16_f32 v185, v82, v83
  v_cvt_pk_bf16_f32 v186, v84, v85
  v_cvt_pk_bf16_f32 v187, v86, v87
  v_cvt_pk_bf16_f32 v188, v88, v89
  v_cvt_pk_bf16_f32 v189, v90, v91
  v_cvt_pk_bf16_f32 v190, v92, v93
  v_cvt_pk_bf16_f32 v191, v94, v95
  v_and_b32 v184, v184, v12
  v_and_b32 v185, v185, v12
  v_and_b32 v186, v186, v12
  v_and_b32 v187, v187, v12
  v_and_b32 v188, v188, v12
  v_and_b32 v189, v189, v12
  v_and_b32 v190, v190, v12
  v_and_b32 v191, v191, v12
  s_mul_i32 s36, s45, 7
  s_lshl_b32 s37, s43, 1
  s_add_u32 s36, s36, s37
  s_lshl_b32 s36, s36, 10
  s_add_u32 s36, s36, 7340032
  buffer_store_dwordx4 v[184:187], v10, s[20:23], s36 offen sc1
  s_cmp_eq_u32 s43, 3
  s_cbranch_scc1 k1skip_45
  buffer_store_dwordx4 v[188:191], v10, s[20:23], s36 offen offset:1024 sc1
k1skip_45:
  v_pk_mul_f32 v[160:161], v[128:129], v[26:27] op_sel_hi:[1,0]
  v_pk_mul_f32 v[162:163], v[130:131], v[26:27] op_sel_hi:[1,0]
  v_pk_mul_f32 v[164:165], v[132:133], v[26:27] op_sel_hi:[1,0]
  v_pk_mul_f32 v[166:167], v[134:135], v[26:27] op_sel_hi:[1,0]
  v_pk_mul_f32 v[168:169], v[136:137], v[26:27] op_sel_hi:[1,0]
  v_pk_mul_f32 v[170:171], v[138:139], v[26:27] op_sel_hi:[1,0]
  v_pk_mul_f32 v[172:173], v[140:141], v[26:27] op_sel_hi:[1,0]
  v_pk_mul_f32 v[174:175], v[142:143], v[26:27] op_sel_hi:[1,0]
  v_pk_fma_f32 v[96:97], v[96:97], v[22:23], v[160:161] op_sel_hi:[1,0,1]
  v_pk_fma_f32 v[98:99], v[98:99], v[22:23], v[162:163] op_sel_hi:[1,0,1]
  v_pk_fma_f32 v[100:101], v[100:101], v[22:23], v[164:165] op_sel_hi:[1,0,1]
  v_pk_fma_f32 v[102:103], v[102:103], v[22:23], v[166:167] op_sel_hi:[1,0,1]
  v_pk_fma_f32 v[104:105], v[104:105], v[22:23], v[168:169] op_sel_hi:[1,0,1]
  v_pk_fma_f32 v[106:107], v[106:107], v[22:23], v[170:171] op_sel_hi:[1,0,1]
  v_pk_fma_f32 v[108:109], v[108:109], v[22:23], v[172:173] op_sel_hi:[1,0,1]
  v_pk_fma_f32 v[110:111], v[110:111], v[22:23], v[174:175] op_sel_hi:[1,0,1]
  v_pk_mul_f32 v[200:201], v[96:97], v[96:97]
  v_pk_mul_f32 v[202:203], v[98:99], v[98:99]
  v_pk_mul_f32 v[204:205], v[100:101], v[100:101]
  v_pk_mul_f32 v[206:207], v[102:103], v[102:103]
  v_pk_mul_f32 v[208:209], v[104:105], v[104:105]
  v_pk_mul_f32 v[210:211], v[106:107], v[106:107]
  v_pk_mul_f32 v[212:213], v[108:109], v[108:109]
  v_pk_mul_f32 v[214:215], v[110:111], v[110:111]
  v_pk_fma_f32 v[200:201], v[200:201], v[194:195], v[192:193]
  v_pk_fma_f32 v[202:203], v[202:203], v[194:195], v[192:193]
  v_pk_fma_f32 v[204:205], v[204:205], v[194:195], v[192:193]
  v_pk_fma_f32 v[206:207], v[206:207], v[194:195], v[192:193]
  v_pk_fma_f32 v[208:209], v[208:209], v[194:195], v[192:193]
  v_pk_fma_f32 v[210:211], v[210:211], v[194:195], v[192:193]
  v_pk_fma_f32 v[212:213], v[212:213], v[194:195], v[192:193]
  v_pk_fma_f32 v[214:215], v[214:215], v[194:195], v[192:193]
  v_pk_mul_f32 v[200:201], v[200:201], v[96:97]
  v_pk_mul_f32 v[202:203], v[202:203], v[98:99]
  v_pk_mul_f32 v[204:205], v[204:205], v[100:101]
  v_pk_mul_f32 v[206:207], v[206:207], v[102:103]
  v_pk_mul_f32 v[208:209], v[208:209], v[104:105]
  v_pk_mul_f32 v[210:211], v[210:211], v[106:107]
  v_pk_mul_f32 v[212:213], v[212:213], v[108:109]
  v_pk_mul_f32 v[214:215], v[214:215], v[110:111]
  v_exp_f32 v200, v200
  v_exp_f32 v201, v201
  v_exp_f32 v202, v202
  v_exp_f32 v203, v203
  v_exp_f32 v204, v204
  v_exp_f32 v205, v205
  v_exp_f32 v206, v206
  v_exp_f32 v207, v207
  v_exp_f32 v208, v208
  v_exp_f32 v209, v209
  v_exp_f32 v210, v210
  v_exp_f32 v211, v211
  v_exp_f32 v212, v212
  v_exp_f32 v213, v213
  v_exp_f32 v214, v214
  v_exp_f32 v215, v215
  v_pk_add_f32 v[200:201], v[200:201], v[196:197]
  v_pk_add_f32 v[202:203], v[202:203], v[196:197]
  v_pk_add_f32 v[204:205], v[204:205], v[196:197]
  v_pk_add_f32 v[206:207], v[206:207], v[196:197]
  v_pk_add_f32 v[208:209], v[208:209], v[196:197]
  v_pk_add_f32 v[210:211], v[210:211], v[196:197]
  v_pk_add_f32 v[212:213], v[212:213], v[196:197]
  v_pk_add_f32 v[214:215], v[214:215], v[196:197]
  v_rcp_f32 v200, v200
  v_rcp_f32 v201, v201
  v_rcp_f32 v202, v202
  v_rcp_f32 v203, v203
  v_rcp_f32 v204, v204
  v_rcp_f32 v205, v205
  v_rcp_f32 v206, v206
  v_rcp_f32 v207, v207
  v_rcp_f32 v208, v208
  v_rcp_f32 v209, v209
  v_rcp_f32 v210, v210
  v_rcp_f32 v211, v211
  v_rcp_f32 v212, v212
  v_rcp_f32 v213, v213
  v_rcp_f32 v214, v214
  v_rcp_f32 v215, v215
  v_pk_mul_f32 v[96:97], v[96:97], v[200:201]
  v_pk_mul_f32 v[98:99], v[98:99], v[202:203]
  v_pk_mul_f32 v[100:101], v[100:101], v[204:205]
  v_pk_mul_f32 v[102:103], v[102:103], v[206:207]
  v_pk_mul_f32 v[104:105], v[104:105], v[208:209]
  v_pk_mul_f32 v[106:107], v[106:107], v[210:211]
  v_pk_mul_f32 v[108:109], v[108:109], v[212:213]
  v_pk_mul_f32 v[110:111], v[110:111], v[214:215]
  v_cvt_pk_bf16_f32 v176, v96, v97
  v_cvt_pk_bf16_f32 v177, v98, v99
  v_cvt_pk_bf16_f32 v178, v100, v101
  v_cvt_pk_bf16_f32 v179, v102, v103
  v_cvt_pk_bf16_f32 v180, v104, v105
  v_cvt_pk_bf16_f32 v181, v106, v107
  v_cvt_pk_bf16_f32 v182, v108, v109
  v_cvt_pk_bf16_f32 v183, v110, v111
  v_and_b32 v176, v176, v13
  v_and_b32 v177, v177, v13
  v_and_b32 v178, v178, v13
  v_and_b32 v179, v179, v13
  v_and_b32 v180, v180, v13
  v_and_b32 v181, v181, v13
  v_and_b32 v182, v182, v13
  v_and_b32 v183, v183, v13
  s_mul_i32 s36, s45, 7
  s_lshl_b32 s37, s42, 1
  s_add_u32 s36, s36, s37
  s_lshl_b32 s36, s36, 10
  s_add_u32 s36, s36, 7340032
  buffer_store_dwordx4 v[176:179], v11, s[20:23], s36 offen sc1
  s_cmp_eq_u32 s42, 3
  s_cbranch_scc1 k1skip_46
  buffer_store_dwordx4 v[180:183], v11, s[20:23], s36 offen offset:1024 sc1
k1skip_46:
  v_pk_mul_f32 v[160:161], v[144:145], v[26:27] op_sel_hi:[1,0]
  v_pk_mul_f32 v[162:163], v[146:147], v[26:27] op_sel_hi:[1,0]
  v_pk_mul_f32 v[164:165], v[148:149], v[26:27] op_sel_hi:[1,0]
  v_pk_mul_f32 v[166:167], v[150:151], v[26:27] op_sel_hi:[1,0]
  v_pk_mul_f32 v[168:169], v[152:153], v[26:27] op_sel_hi:[1,0]
  v_pk_mul_f32 v[170:171], v[154:155], v[26:27] op_sel_hi:[1,0]
  v_pk_mul_f32 v[172:173], v[156:157], v[26:27] op_sel_hi:[1,0]
  v_pk_mul_f32 v[174:175], v[158:159], v[26:27] op_sel_hi:[1,0]
  v_pk_fma_f32 v[112:113], v[112:113], v[22:23], v[160:161] op_sel_hi:[1,0,1]
  v_pk_fma_f32 v[114:115], v[114:115], v[22:23], v[162:163] op_sel_hi:[1,0,1]
  v_pk_fma_f32 v[116:117], v[116:117], v[22:23], v[164:165] op_sel_hi:[1,0,1]
  v_pk_fma_f32 v[118:119], v[118:119], v[22:23], v[166:167] op_sel_hi:[1,0,1]
  v_pk_fma_f32 v[120:121], v[120:121], v[22:23], v[168:169] op_sel_hi:[1,0,1]
  v_pk_fma_f32 v[122:123], v[122:123], v[22:23], v[170:171] op_sel_hi:[1,0,1]
  v_pk_fma_f32 v[124:125], v[124:125], v[22:23], v[172:173] op_sel_hi:[1,0,1]
  v_pk_fma_f32 v[126:127], v[126:127], v[22:23], v[174:175] op_sel_hi:[1,0,1]
  v_pk_mul_f32 v[200:201], v[112:113], v[112:113]
  v_pk_mul_f32 v[202:203], v[114:115], v[114:115]
  v_pk_mul_f32 v[204:205], v[116:117], v[116:117]
  v_pk_mul_f32 v[206:207], v[118:119], v[118:119]
  v_pk_mul_f32 v[208:209], v[120:121], v[120:121]
  v_pk_mul_f32 v[210:211], v[122:123], v[122:123]
  v_pk_mul_f32 v[212:213], v[124:125], v[124:125]
  v_pk_mul_f32 v[214:215], v[126:127], v[126:127]
  v_pk_fma_f32 v[200:201], v[200:201], v[194:195], v[192:193]
  v_pk_fma_f32 v[202:203], v[202:203], v[194:195], v[192:193]
  v_pk_fma_f32 v[204:205], v[204:205], v[194:195], v[192:193]
  v_pk_fma_f32 v[206:207], v[206:207], v[194:195], v[192:193]
  v_pk_fma_f32 v[208:209], v[208:209], v[194:195], v[192:193]
  v_pk_fma_f32 v[210:211], v[210:211], v[194:195], v[192:193]
  v_pk_fma_f32 v[212:213], v[212:213], v[194:195], v[192:193]
  v_pk_fma_f32 v[214:215], v[214:215], v[194:195], v[192:193]
  v_pk_mul_f32 v[200:201], v[200:201], v[112:113]
  v_pk_mul_f32 v[202:203], v[202:203], v[114:115]
  v_pk_mul_f32 v[204:205], v[204:205], v[116:117]
  v_pk_mul_f32 v[206:207], v[206:207], v[118:119]
  v_pk_mul_f32 v[208:209], v[208:209], v[120:121]
  v_pk_mul_f32 v[210:211], v[210:211], v[122:123]
  v_pk_mul_f32 v[212:213], v[212:213], v[124:125]
  v_pk_mul_f32 v[214:215], v[214:215], v[126:127]
  v_exp_f32 v200, v200
  v_exp_f32 v201, v201
  v_exp_f32 v202, v202
  v_exp_f32 v203, v203
  v_exp_f32 v204, v204
  v_exp_f32 v205, v205
  v_exp_f32 v206, v206
  v_exp_f32 v207, v207
  v_exp_f32 v208, v208
  v_exp_f32 v209, v209
  v_exp_f32 v210, v210
  v_exp_f32 v211, v211
  v_exp_f32 v212, v212
  v_exp_f32 v213, v213
  v_exp_f32 v214, v214
  v_exp_f32 v215, v215
  v_pk_add_f32 v[200:201], v[200:201], v[196:197]
  v_pk_add_f32 v[202:203], v[202:203], v[196:197]
  v_pk_add_f32 v[204:205], v[204:205], v[196:197]
  v_pk_add_f32 v[206:207], v[206:207], v[196:197]
  v_pk_add_f32 v[208:209], v[208:209], v[196:197]
  v_pk_add_f32 v[210:211], v[210:211], v[196:197]
  v_pk_add_f32 v[212:213], v[212:213], v[196:197]
  v_pk_add_f32 v[214:215], v[214:215], v[196:197]
  v_rcp_f32 v200, v200
  v_rcp_f32 v201, v201
  v_rcp_f32 v202, v202
  v_rcp_f32 v203, v203
  v_rcp_f32 v204, v204
  v_rcp_f32 v205, v205
  v_rcp_f32 v206, v206
  v_rcp_f32 v207, v207
  v_rcp_f32 v208, v208
  v_rcp_f32 v209, v209
  v_rcp_f32 v210, v210
  v_rcp_f32 v211, v211
  v_rcp_f32 v212, v212
  v_rcp_f32 v213, v213
  v_rcp_f32 v214, v214
  v_rcp_f32 v215, v215
  v_pk_mul_f32 v[112:113], v[112:113], v[200:201]
  v_pk_mul_f32 v[114:115], v[114:115], v[202:203]
  v_pk_mul_f32 v[116:117], v[116:117], v[204:205]
  v_pk_mul_f32 v[118:119], v[118:119], v[206:207]
  v_pk_mul_f32 v[120:121], v[120:121], v[208:209]
  v_pk_mul_f32 v[122:123], v[122:123], v[210:211]
  v_pk_mul_f32 v[124:125], v[124:125], v[212:213]
  v_pk_mul_f32 v[126:127], v[126:127], v[214:215]
  v_cvt_pk_bf16_f32 v184, v112, v113
  v_cvt_pk_bf16_f32 v185, v114, v115
  v_cvt_pk_bf16_f32 v186, v116, v117
  v_cvt_pk_bf16_f32 v187, v118, v119
  v_cvt_pk_bf16_f32 v188, v120, v121
  v_cvt_pk_bf16_f32 v189, v122, v123
  v_cvt_pk_bf16_f32 v190, v124, v125
  v_cvt_pk_bf16_f32 v191, v126, v127
  v_and_b32 v184, v184, v13
  v_and_b32 v185, v185, v13
  v_and_b32 v186, v186, v13
  v_and_b32 v187, v187, v13
  v_and_b32 v188, v188, v13
  v_and_b32 v189, v189, v13
  v_and_b32 v190, v190, v13
  v_and_b32 v191, v191, v13
  s_mul_i32 s36, s45, 7
  s_lshl_b32 s37, s43, 1
  s_add_u32 s36, s36, s37
  s_lshl_b32 s36, s36, 10
  s_add_u32 s36, s36, 7340032
  buffer_store_dwordx4 v[184:187], v11, s[20:23], s36 offen sc1
  s_cmp_eq_u32 s43, 3
  s_cbranch_scc1 k1skip_47
  buffer_store_dwordx4 v[188:191], v11, s[20:23], s36 offen offset:1024 sc1
k1skip_47:
  s_branch parallel_sum__softmax_full_mha__mixer_s_mlp__prompt_kernel_fin
parallel_sum__softmax_full_mha__mixer_s_mlp__prompt_kernel_epv:
  s_lshl_b32 s36, s42, 7
  v_lshl_add_u32 v7, v5, 2, s36
  v_add_u32 v7, 160768, v7
  ds_read_b32 v20, v7 offset:1024
  s_lshl_b32 s36, s43, 7
  v_lshl_add_u32 v7, v5, 2, s36
  v_add_u32 v7, 160768, v7
  ds_read_b32 v22, v7 offset:1024
  s_lshl_b32 s36, s40, 7
  v_lshl_add_u32 v7, v6, 4, s36
  v_add_u32 v7, 160768, v7
  ds_read_b128 v[128:131], v7 offset:0
  ds_read_b128 v[144:147], v7 offset:512
  ds_read_b128 v[132:135], v7 offset:32
  ds_read_b128 v[148:151], v7 offset:544
  ds_read_b128 v[136:139], v7 offset:64
  ds_read_b128 v[152:155], v7 offset:576
  ds_read_b128 v[140:143], v7 offset:96
  ds_read_b128 v[156:159], v7 offset:608
  s_lshl_b32 s36, s41, 7
  v_lshl_add_u32 v7, v6, 4, s36
  v_add_u32 v7, 160768, v7
  ds_read_b128 v[160:163], v7 offset:0
  ds_read_b128 v[176:179], v7 offset:512
  ds_read_b128 v[164:167], v7 offset:32
  ds_read_b128 v[180:183], v7 offset:544
  ds_read_b128 v[168:171], v7 offset:64
  ds_read_b128 v[184:187], v7 offset:576
  ds_read_b128 v[172:175], v7 offset:96
  ds_read_b128 v[188:191], v7 offset:608
  s_waitcnt lgkmcnt(0)
  v_cmp_eq_u32 vcc, 28, v5
  v_pk_mul_f32 v[192:193], v[144:145], v[20:21] op_sel_hi:[1,0]
  v_pk_mul_f32 v[194:195], v[146:147], v[20:21] op_sel_hi:[1,0]
  v_pk_mul_f32 v[196:197], v[148:149], v[20:21] op_sel_hi:[1,0]
  v_pk_mul_f32 v[198:199], v[150:151], v[20:21] op_sel_hi:[1,0]
  v_pk_mul_f32 v[200:201], v[152:153], v[20:21] op_sel_hi:[1,0]
  v_pk_mul_f32 v[202:203], v[154:155], v[20:21] op_sel_hi:[1,0]
  v_pk_mul_f32 v[204:205], v[156:157], v[20:21] op_sel_hi:[1,0]
  v_pk_mul_f32 v[206:207], v[158:159], v[20:21] op_sel_hi:[1,0]
  v_pk_fma_f32 v[64:65], v[64:65], v[128:129], v[192:193]
  v_pk_fma_f32 v[66:67], v[66:67], v[130:131], v[194:195]
  v_pk_fma_f32 v[68:69], v[68:69], v[132:133], v[196:197]
  v_pk_fma_f32 v[70:71], v[70:71], v[134:135], v[198:199]
  v_pk_fma_f32 v[72:73], v[72:73], v[136:137], v[200:201]
  v_pk_fma_f32 v[74:75], v[74:75], v[138:139], v[202:203]
  v_pk_fma_f32 v[76:77], v[76:77], v[140:141], v[204:205]
  v_pk_fma_f32 v[78:79], v[78:79], v[142:143], v[206:207]
  v_cvt_pk_bf16_f32 v208, v64, v65
  v_cvt_pk_bf16_f32 v209, v66, v67
  v_cvt_pk_bf16_f32 v210, v68, v69
  v_cvt_pk_bf16_f32 v211, v70, v71
  v_cvt_pk_bf16_f32 v212, v72, v73
  v_cvt_pk_bf16_f32 v213, v74, v75
  v_cvt_pk_bf16_f32 v214, v76, v77
  v_cvt_pk_bf16_f32 v215, v78, v79
  s_and_saveexec_b64 s[48:49], vcc
  v_mov_b32 v208, s44
  v_mov_b32 v209, s44
  v_mov_b32 v210, s44
  v_mov_b32 v211, s44
  v_mov_b32 v212, s44
  v_mov_b32 v213, s44
  v_mov_b32 v214, s44
  v_mov_b32 v215, s44
  s_mov_b64 exec, s[48:49]
  s_and_b32 s36, s25, 3
  s_lshl_b32 s36, s36, 2
  s_add_u32 s36, s36, s42
  s_lshl_b32 s36, s36, 17
  s_lshl_b32 s37, s24, 2
  s_add_u32 s37, s37, s40
  s_lshl_b32 s37, s37, 11
  s_add_u32 s36, s36, s37
  s_add_u32 s36, s36, 5242880
  buffer_store_dwordx4 v[208:211], v2, s[20:23], s36 offen sc1
  buffer_store_dwordx4 v[212:215], v2, s[20:23], s36 offen offset:1024 sc1
  v_pk_mul_f32 v[192:193], v[144:145], v[22:23] op_sel_hi:[1,0]
  v_pk_mul_f32 v[194:195], v[146:147], v[22:23] op_sel_hi:[1,0]
  v_pk_mul_f32 v[196:197], v[148:149], v[22:23] op_sel_hi:[1,0]
  v_pk_mul_f32 v[198:199], v[150:151], v[22:23] op_sel_hi:[1,0]
  v_pk_mul_f32 v[200:201], v[152:153], v[22:23] op_sel_hi:[1,0]
  v_pk_mul_f32 v[202:203], v[154:155], v[22:23] op_sel_hi:[1,0]
  v_pk_mul_f32 v[204:205], v[156:157], v[22:23] op_sel_hi:[1,0]
  v_pk_mul_f32 v[206:207], v[158:159], v[22:23] op_sel_hi:[1,0]
  v_pk_fma_f32 v[80:81], v[80:81], v[128:129], v[192:193]
  v_pk_fma_f32 v[82:83], v[82:83], v[130:131], v[194:195]
  v_pk_fma_f32 v[84:85], v[84:85], v[132:133], v[196:197]
  v_pk_fma_f32 v[86:87], v[86:87], v[134:135], v[198:199]
  v_pk_fma_f32 v[88:89], v[88:89], v[136:137], v[200:201]
  v_pk_fma_f32 v[90:91], v[90:91], v[138:139], v[202:203]
  v_pk_fma_f32 v[92:93], v[92:93], v[140:141], v[204:205]
  v_pk_fma_f32 v[94:95], v[94:95], v[142:143], v[206:207]
  v_cvt_pk_bf16_f32 v216, v80, v81
  v_cvt_pk_bf16_f32 v217, v82, v83
  v_cvt_pk_bf16_f32 v218, v84, v85
  v_cvt_pk_bf16_f32 v219, v86, v87
  v_cvt_pk_bf16_f32 v220, v88, v89
  v_cvt_pk_bf16_f32 v221, v90, v91
  v_cvt_pk_bf16_f32 v222, v92, v93
  v_cvt_pk_bf16_f32 v223, v94, v95
  s_and_saveexec_b64 s[48:49], vcc
  v_mov_b32 v216, s44
  v_mov_b32 v217, s44
  v_mov_b32 v218, s44
  v_mov_b32 v219, s44
  v_mov_b32 v220, s44
  v_mov_b32 v221, s44
  v_mov_b32 v222, s44
  v_mov_b32 v223, s44
  s_mov_b64 exec, s[48:49]
  s_and_b32 s36, s25, 3
  s_lshl_b32 s36, s36, 2
  s_add_u32 s36, s36, s43
  s_lshl_b32 s36, s36, 17
  s_lshl_b32 s37, s24, 2
  s_add_u32 s37, s37, s40
  s_lshl_b32 s37, s37, 11
  s_add_u32 s36, s36, s37
  s_add_u32 s36, s36, 5242880
  buffer_store_dwordx4 v[216:219], v2, s[20:23], s36 offen sc1
  buffer_store_dwordx4 v[220:223], v2, s[20:23], s36 offen offset:1024 sc1
  v_pk_mul_f32 v[192:193], v[176:177], v[20:21] op_sel_hi:[1,0]
  v_pk_mul_f32 v[194:195], v[178:179], v[20:21] op_sel_hi:[1,0]
  v_pk_mul_f32 v[196:197], v[180:181], v[20:21] op_sel_hi:[1,0]
  v_pk_mul_f32 v[198:199], v[182:183], v[20:21] op_sel_hi:[1,0]
  v_pk_mul_f32 v[200:201], v[184:185], v[20:21] op_sel_hi:[1,0]
  v_pk_mul_f32 v[202:203], v[186:187], v[20:21] op_sel_hi:[1,0]
  v_pk_mul_f32 v[204:205], v[188:189], v[20:21] op_sel_hi:[1,0]
  v_pk_mul_f32 v[206:207], v[190:191], v[20:21] op_sel_hi:[1,0]
  v_pk_fma_f32 v[96:97], v[96:97], v[160:161], v[192:193]
  v_pk_fma_f32 v[98:99], v[98:99], v[162:163], v[194:195]
  v_pk_fma_f32 v[100:101], v[100:101], v[164:165], v[196:197]
  v_pk_fma_f32 v[102:103], v[102:103], v[166:167], v[198:199]
  v_pk_fma_f32 v[104:105], v[104:105], v[168:169], v[200:201]
  v_pk_fma_f32 v[106:107], v[106:107], v[170:171], v[202:203]
  v_pk_fma_f32 v[108:109], v[108:109], v[172:173], v[204:205]
  v_pk_fma_f32 v[110:111], v[110:111], v[174:175], v[206:207]
  v_cvt_pk_bf16_f32 v208, v96, v97
  v_cvt_pk_bf16_f32 v209, v98, v99
  v_cvt_pk_bf16_f32 v210, v100, v101
  v_cvt_pk_bf16_f32 v211, v102, v103
  v_cvt_pk_bf16_f32 v212, v104, v105
  v_cvt_pk_bf16_f32 v213, v106, v107
  v_cvt_pk_bf16_f32 v214, v108, v109
  v_cvt_pk_bf16_f32 v215, v110, v111
  s_and_saveexec_b64 s[48:49], vcc
  v_mov_b32 v208, s44
  v_mov_b32 v209, s44
  v_mov_b32 v210, s44
  v_mov_b32 v211, s44
  v_mov_b32 v212, s44
  v_mov_b32 v213, s44
  v_mov_b32 v214, s44
  v_mov_b32 v215, s44
  s_mov_b64 exec, s[48:49]
  s_and_b32 s36, s25, 3
  s_lshl_b32 s36, s36, 2
  s_add_u32 s36, s36, s42
  s_lshl_b32 s36, s36, 17
  s_lshl_b32 s37, s24, 2
  s_add_u32 s37, s37, s41
  s_lshl_b32 s37, s37, 11
  s_add_u32 s36, s36, s37
  s_add_u32 s36, s36, 5242880
  buffer_store_dwordx4 v[208:211], v2, s[20:23], s36 offen sc1
  buffer_store_dwordx4 v[212:215], v2, s[20:23], s36 offen offset:1024 sc1
  v_pk_mul_f32 v[192:193], v[176:177], v[22:23] op_sel_hi:[1,0]
  v_pk_mul_f32 v[194:195], v[178:179], v[22:23] op_sel_hi:[1,0]
  v_pk_mul_f32 v[196:197], v[180:181], v[22:23] op_sel_hi:[1,0]
  v_pk_mul_f32 v[198:199], v[182:183], v[22:23] op_sel_hi:[1,0]
  v_pk_mul_f32 v[200:201], v[184:185], v[22:23] op_sel_hi:[1,0]
  v_pk_mul_f32 v[202:203], v[186:187], v[22:23] op_sel_hi:[1,0]
  v_pk_mul_f32 v[204:205], v[188:189], v[22:23] op_sel_hi:[1,0]
  v_pk_mul_f32 v[206:207], v[190:191], v[22:23] op_sel_hi:[1,0]
  v_pk_fma_f32 v[112:113], v[112:113], v[160:161], v[192:193]
  v_pk_fma_f32 v[114:115], v[114:115], v[162:163], v[194:195]
  v_pk_fma_f32 v[116:117], v[116:117], v[164:165], v[196:197]
  v_pk_fma_f32 v[118:119], v[118:119], v[166:167], v[198:199]
  v_pk_fma_f32 v[120:121], v[120:121], v[168:169], v[200:201]
  v_pk_fma_f32 v[122:123], v[122:123], v[170:171], v[202:203]
  v_pk_fma_f32 v[124:125], v[124:125], v[172:173], v[204:205]
  v_pk_fma_f32 v[126:127], v[126:127], v[174:175], v[206:207]
  v_cvt_pk_bf16_f32 v216, v112, v113
  v_cvt_pk_bf16_f32 v217, v114, v115
  v_cvt_pk_bf16_f32 v218, v116, v117
  v_cvt_pk_bf16_f32 v219, v118, v119
  v_cvt_pk_bf16_f32 v220, v120, v121
  v_cvt_pk_bf16_f32 v221, v122, v123
  v_cvt_pk_bf16_f32 v222, v124, v125
  v_cvt_pk_bf16_f32 v223, v126, v127
  s_and_saveexec_b64 s[48:49], vcc
  v_mov_b32 v216, s44
  v_mov_b32 v217, s44
  v_mov_b32 v218, s44
  v_mov_b32 v219, s44
  v_mov_b32 v220, s44
  v_mov_b32 v221, s44
  v_mov_b32 v222, s44
  v_mov_b32 v223, s44
  s_mov_b64 exec, s[48:49]
  s_and_b32 s36, s25, 3
  s_lshl_b32 s36, s36, 2
  s_add_u32 s36, s36, s43
  s_lshl_b32 s36, s36, 17
  s_lshl_b32 s37, s24, 2
  s_add_u32 s37, s37, s41
  s_lshl_b32 s37, s37, 11
  s_add_u32 s36, s36, s37
  s_add_u32 s36, s36, 5242880
  buffer_store_dwordx4 v[216:219], v2, s[20:23], s36 offen sc1
  buffer_store_dwordx4 v[220:223], v2, s[20:23], s36 offen offset:1024 sc1
parallel_sum__softmax_full_mha__mixer_s_mlp__prompt_kernel_fin:
  s_and_b32 s45, s25, 3
  s_cmp_eq_u32 s26, 0
  s_cbranch_scc1 parallel_sum__softmax_full_mha__mixer_s_mlp__prompt_kernel_fq
  s_cmp_eq_u32 s26, 3
  s_cbranch_scc1 parallel_sum__softmax_full_mha__mixer_s_mlp__prompt_kernel_fh
  s_lshl_b32 s46, s45, 4
  s_lshl_b32 s47, s31, 3
  s_add_u32 s46, s46, s47
  s_lshr_b32 s47, s24, 2
  s_add_u32 s46, s46, s47
  s_lshl_b32 s46, s46, 7
  s_sub_u32 s47, s26, 1
  s_lshl_b32 s47, s47, 3
  s_and_b32 s48, s24, 3
  s_lshl_b32 s48, s48, 1
  s_add_u32 s47, s47, s48
  s_add_u32 s47, s47, s30
  s_lshl_b32 s47, s47, 2
  s_add_u32 s46, s46, s47
  s_add_u32 s46, s46, 917504
  v_lshlrev_b32 v5, 9, v1
  v_add_u32 v5, s46, v5
  s_mov_b32 s48, 3
  s_branch parallel_sum__softmax_full_mha__mixer_s_mlp__prompt_kernel_fl
parallel_sum__softmax_full_mha__mixer_s_mlp__prompt_kernel_fq:
  s_lshl_b32 s46, s45, 3
  s_lshl_b32 s47, s31, 2
  s_add_u32 s46, s46, s47
  s_lshr_b32 s47, s24, 3
  s_add_u32 s46, s46, s47
  s_lshl_b32 s46, s46, 7
  s_and_b32 s47, s24, 7
  s_lshl_b32 s47, s47, 1
  s_add_u32 s47, s47, s30
  s_lshl_b32 s47, s47, 2
  s_add_u32 s46, s46, s47
  s_add_u32 s46, s46, 925696
  v_lshlrev_b32 v5, 8, v1
  v_add_u32 v5, s46, v5
  s_mov_b32 s48, 3
  s_branch parallel_sum__softmax_full_mha__mixer_s_mlp__prompt_kernel_fl
parallel_sum__softmax_full_mha__mixer_s_mlp__prompt_kernel_fh:
  s_lshl_b32 s46, s24, 2
  s_lshl_b32 s47, s30, 1
  s_add_u32 s46, s46, s47
  s_bitcmp1_b32 s45, 0
  s_cselect_b32 s47, 63, 1
  v_and_b32 v5, 1, v1
  v_add_u32 v5, s46, v5
  v_bfe_u32 v6, v1, 1, 1
  v_mul_lo_u32 v7, v6, s47
  v_add_u32 v5, v5, v7
  v_and_b32 v5, 63, v5
  v_lshlrev_b32 v5, 7, v5
  v_lshl_add_u32 v5, v6, 3, v5
  s_lshl_b32 s46, s45, 2
  s_add_u32 s46, s46, s31
  s_lshl_b32 s46, s46, 2
  s_add_u32 s46, s46, 929792
  v_add_u32 v5, s46, v5
  s_mov_b32 s48, 15
parallel_sum__softmax_full_mha__mixer_s_mlp__prompt_kernel_fl:
  v_mov_b32 v6, s3
  s_waitcnt vmcnt(0)
  v_mov_b32 v8, 159764
  v_mov_b32 v9, 1
  s_waitcnt lgkmcnt(0)
  s_mov_b32 exec_lo, 1
  s_mov_b32 exec_hi, 0
  ds_add_u32 v8, v9
  s_mov_b32 exec_lo, -1
  s_mov_b32 exec_hi, -1
  s_mov_b32 exec_lo, s48
  s_mov_b32 exec_hi, 0
  buffer_store_dword v6, v5, s[20:23], 0 offen sc1
  s_mov_b32 exec_lo, -1
  s_mov_b32 exec_hi, -1
  s_load_dwordx2 s[4:5], s[0:1], 0
  s_load_dwordx2 s[6:7], s[0:1], 16
  s_load_dwordx4 s[12:15], s[0:1], 40
  s_load_dwordx4 s[16:19], s[0:1], 56
  s_load_dwordx2 s[20:21], s[0:1], 80
  v_and_b32 v2, 63, v0
  v_lshrrev_b32 v5, 6, v0
  v_lshlrev_b32 v1, 4, v2
  v_readfirstlane_b32 s36, v5
  s_mov_b32 s33, 0
  s_waitcnt lgkmcnt(0)
  s_mov_b32 s8, s20
  s_and_b32 s9, s21, 0xffff
  s_mov_b32 s10, 22020096
  s_mov_b32 s11, 0x20000
  s_mov_b32 s40, s4
  s_and_b32 s41, s5, 0xffff
  s_mov_b32 s42, 1835008
  s_mov_b32 s43, 0x20000
  s_mov_b32 s56, s6
  s_and_b32 s57, s7, 0xffff
  s_mov_b32 s58, 401408
  s_mov_b32 s59, 0x20000
  s_mov_b32 s44, s12
  s_and_b32 s45, s13, 0xffff
  s_mov_b32 s46, 401408
  s_mov_b32 s47, 0x20000
  s_mov_b32 s48, s14
  s_and_b32 s49, s15, 0xffff
  s_mov_b32 s50, 1605632
  s_mov_b32 s51, 0x20000
  s_mov_b32 s52, s16
  s_and_b32 s53, s17, 0xffff
  s_mov_b32 s54, 1605632
  s_mov_b32 s55, 0x20000
  s_mov_b32 s60, s18
  s_and_b32 s61, s19, 0xffff
  s_mov_b32 s62, 1835008
  s_mov_b32 s63, 0x20000
  s_and_b32 s32, s36, 3
  s_and_b32 s12, s2, 7
  s_lshl_b32 s12, s12, 1
  s_bfe_u32 s13, s2, 0x10003
  s_add_u32 s12, s12, s13
  s_lshr_b32 s13, s2, 4
  s_lshl_b32 s14, s12, 17
  s_lshl_b32 s15, s32, 15
  s_add_u32 s15, s15, s14
  s_add_u32 s15, s15, 3145728
  s_mov_b32 s20, 0
  s_mov_b32 s21, 0
  s_lshl_b32 s22, s12, 2
  s_add_u32 s22, s22, s32
  s_lshl_b32 s22, s22, 7
  s_add_u32 s22, s22, 917504
  v_lshlrev_b32 v3, 2, v2
  v_add_u32 v3, s22, v3
  s_lshl_b32 s22, s12, 1
  s_lshr_b32 s23, s13, 3
  s_add_u32 s22, s22, s23
  s_lshl_b32 s22, s22, 7
  s_and_b32 s23, s13, 7
  s_lshl_b32 s23, s23, 3
  s_add_u32 s22, s22, s23
  s_add_u32 s22, s22, 925696
  v_and_b32 v4, 1, v2
  v_lshlrev_b32 v4, 2, v4
  v_add_u32 v4, s22, v4
  v_cmp_gt_u32 vcc, 16, v2
  s_nop 0
  v_cndmask_b32 v3, v4, v3, vcc
  s_mov_b32 s24, 0x3ffff
  s_mov_b32 s25, 0
  s_mov_b32 s22, 0
poll_48:
  buffer_load_dword v4, v3, s[8:11], 0 offen sc1
  s_add_u32 s22, s22, 1
  s_waitcnt vmcnt(0)
  v_cmp_ne_u32 vcc, s3, v4
  s_cmp_gt_u32 s22, 1048576
  s_cbranch_scc1 pollx_49
  s_and_b64 vcc, vcc, s[24:25]
  s_cbranch_scc0 pollx_49
  s_nop 15
  s_nop 15
  s_nop 15
  s_nop 15
  s_nop 15
  s_nop 15
  s_nop 15
  s_nop 15
  s_nop 15
  s_nop 15
  s_nop 15
  s_nop 15
  s_nop 15
  s_nop 15
  s_nop 15
  s_nop 15
  s_nop 15
  s_nop 15
  s_nop 15
  s_nop 15
  s_nop 15
  s_nop 15
  s_nop 15
  s_nop 15
  s_nop 15
  s_nop 15
  s_nop 15
  s_nop 15
  s_nop 15
  s_nop 15
  s_nop 15
  s_nop 15
  s_branch poll_48
pollx_49:
  s_add_u32 s18, s15, 2097152
  s_lshl_b32 s16, s13, 11
  s_or_b32 s17, s16, s18
  s_or_b32 s16, s16, s15
  s_setprio 3
  s_xor_b32 s22, s32, 0
  s_lshl_b32 s23, s13, 2
  s_add_u32 s22, s22, s23
  s_lshl_b32 s22, s22, 11
  s_add_u32 s22, s22, s14
  s_add_u32 s22, s22, 1048576
  buffer_load_dwordx4 v[16:19], v1, s[8:11], s22 offen offset:0 sc1
  buffer_load_dwordx4 v[20:23], v1, s[8:11], s22 offen offset:1024 sc1
  buffer_load_dwordx4 v[48:51], v1, s[8:11], s16 offen offset:0 sc1
  buffer_load_dwordx4 v[52:55], v1, s[8:11], s16 offen offset:1024 sc1
  s_add_u32 s16, s16, 2048
  s_and_b32 s16, s16, 0x7fff
  s_or_b32 s16, s16, s15
  s_xor_b32 s22, s32, 1
  s_lshl_b32 s23, s13, 2
  s_add_u32 s22, s22, s23
  s_lshl_b32 s22, s22, 11
  s_add_u32 s22, s22, s14
  s_add_u32 s22, s22, 1048576
  buffer_load_dwordx4 v[24:27], v1, s[8:11], s22 offen offset:0 sc1
  buffer_load_dwordx4 v[28:31], v1, s[8:11], s22 offen offset:1024 sc1
  s_xor_b32 s22, s32, 2
  s_lshl_b32 s23, s13, 2
  s_add_u32 s22, s22, s23
  s_lshl_b32 s22, s22, 11
  s_add_u32 s22, s22, s14
  s_add_u32 s22, s22, 1048576
  buffer_load_dwordx4 v[32:35], v1, s[8:11], s22 offen offset:0 sc1
  buffer_load_dwordx4 v[36:39], v1, s[8:11], s22 offen offset:1024 sc1
  s_xor_b32 s22, s32, 3
  s_lshl_b32 s23, s13, 2
  s_add_u32 s22, s22, s23
  s_lshl_b32 s22, s22, 11
  s_add_u32 s22, s22, s14
  s_add_u32 s22, s22, 1048576
  buffer_load_dwordx4 v[40:43], v1, s[8:11], s22 offen offset:0 sc1
  buffer_load_dwordx4 v[44:47], v1, s[8:11], s22 offen offset:1024 sc1
  buffer_load_dwordx4 v[96:99], v1, s[8:11], s17 offen offset:0 sc1
  buffer_load_dwordx4 v[100:103], v1, s[8:11], s17 offen offset:1024 sc1
  s_add_u32 s17, s17, 2048
  s_and_b32 s17, s17, 0x7fff
  s_or_b32 s17, s17, s18
  buffer_load_dwordx4 v[56:59], v1, s[8:11], s16 offen offset:0 sc1
  buffer_load_dwordx4 v[60:63], v1, s[8:11], s16 offen offset:1024 sc1
  s_add_u32 s16, s16, 2048
  s_and_b32 s16, s16, 0x7fff
  s_or_b32 s16, s16, s15
  buffer_load_dwordx4 v[104:107], v1, s[8:11], s17 offen offset:0 sc1
  buffer_load_dwordx4 v[108:111], v1, s[8:11], s17 offen offset:1024 sc1
  s_add_u32 s17, s17, 2048
  s_and_b32 s17, s17, 0x7fff
  s_or_b32 s17, s17, s18
  s_setprio 0
  v_mov_b32 v192, 0
  v_mov_b32 v193, 0
  v_mov_b32 v194, 0
  v_mov_b32 v195, 0
  v_mov_b32 v196, 0
  v_mov_b32 v197, 0
  v_mov_b32 v198, 0
  v_mov_b32 v199, 0
  v_mov_b32 v200, 0
  v_mov_b32 v201, 0
  v_mov_b32 v202, 0
  v_mov_b32 v203, 0
  v_mov_b32 v204, 0
  v_mov_b32 v205, 0
  v_mov_b32 v206, 0
  v_mov_b32 v207, 0
  v_mov_b32 v208, 0
  v_mov_b32 v209, 0
  v_mov_b32 v210, 0
  v_mov_b32 v211, 0
  v_mov_b32 v212, 0
  v_mov_b32 v213, 0
  v_mov_b32 v214, 0
  v_mov_b32 v215, 0
  v_mov_b32 v216, 0
  v_mov_b32 v217, 0
  v_mov_b32 v218, 0
  v_mov_b32 v219, 0
  v_mov_b32 v220, 0
  v_mov_b32 v221, 0
  v_mov_b32 v222, 0
  v_mov_b32 v223, 0
  v_mov_b32 v224, 0
  v_mov_b32 v225, 0
  v_mov_b32 v226, 0
  v_mov_b32 v227, 0
  v_mov_b32 v228, 0
  v_mov_b32 v229, 0
  v_mov_b32 v230, 0
  v_mov_b32 v231, 0
  v_mov_b32 v232, 0
  v_mov_b32 v233, 0
  v_mov_b32 v234, 0
  v_mov_b32 v235, 0
  v_mov_b32 v236, 0
  v_mov_b32 v237, 0
  v_mov_b32 v238, 0
  v_mov_b32 v239, 0
  v_mov_b32 v240, 0
  v_mov_b32 v241, 0
  v_mov_b32 v242, 0
  v_mov_b32 v243, 0
  v_mov_b32 v244, 0
  v_mov_b32 v245, 0
  v_mov_b32 v246, 0
  v_mov_b32 v247, 0
  v_mov_b32 v248, 0
  v_mov_b32 v249, 0
  v_mov_b32 v250, 0
  v_mov_b32 v251, 0
  v_mov_b32 v252, 0
  v_mov_b32 v253, 0
  v_mov_b32 v254, 0
  v_mov_b32 v255, 0
  s_waitcnt vmcnt(6)
  v_mfma_f32_32x32x16_bf16 v[144:159], v[48:51], v[16:19], 0
  v_mfma_f32_32x32x16_bf16 v[144:159], v[52:55], v[20:23], v[144:159]
  s_nop 7
  s_nop 3
  v_mfma_f32_32x32x16_bf16 v[160:175], v[48:51], v[24:27], 0
  s_setprio 3
  buffer_load_dwordx4 v[64:67], v1, s[8:11], s16 offen offset:0 sc1
  buffer_load_dwordx4 v[68:71], v1, s[8:11], s16 offen offset:1024 sc1
  s_setprio 0
  s_add_u32 s16, s16, 2048
  s_and_b32 s16, s16, 0x7fff
  s_or_b32 s16, s16, s15
  v_exp_f32 v144, v144
  v_exp_f32 v145, v145
  v_exp_f32 v146, v146
  v_exp_f32 v147, v147
  v_exp_f32 v148, v148
  v_exp_f32 v149, v149
  v_exp_f32 v150, v150
  v_exp_f32 v151, v151
  v_cvt_pk_bf16_f32 v176, v144, v145
  v_cvt_pk_bf16_f32 v177, v146, v147
  v_mfma_f32_32x32x16_bf16 v[160:175], v[52:55], v[28:31], v[160:175]
  v_exp_f32 v152, v152
  v_exp_f32 v153, v153
  v_exp_f32 v154, v154
  v_exp_f32 v155, v155
  v_cvt_pk_bf16_f32 v178, v148, v149
  v_cvt_pk_bf16_f32 v179, v150, v151
  v_exp_f32 v156, v156
  v_exp_f32 v157, v157
  v_exp_f32 v158, v158
  v_exp_f32 v159, v159
  v_cvt_pk_bf16_f32 v180, v152, v153
  v_cvt_pk_bf16_f32 v181, v154, v155
  v_cvt_pk_bf16_f32 v182, v156, v157
  v_cvt_pk_bf16_f32 v183, v158, v159
  v_mfma_f32_32x32x16_bf16 v[144:159], v[48:51], v[32:35], 0
  v_exp_f32 v160, v160
  v_exp_f32 v161, v161
  v_exp_f32 v162, v162
  v_exp_f32 v163, v163
  s_waitcnt vmcnt(6)
  v_mfma_f32_32x32x16_bf16 v[192:207], v[96:99], v[176:179], v[192:207]
  s_setprio 3
  buffer_load_dwordx4 v[112:115], v1, s[8:11], s17 offen offset:0 sc1
  buffer_load_dwordx4 v[116:119], v1, s[8:11], s17 offen offset:1024 sc1
  s_setprio 0
  s_add_u32 s17, s17, 2048
  s_and_b32 s17, s17, 0x7fff
  s_or_b32 s17, s17, s18
  v_exp_f32 v164, v164
  v_exp_f32 v165, v165
  v_exp_f32 v166, v166
  v_exp_f32 v167, v167
  v_cvt_pk_bf16_f32 v184, v160, v161
  v_cvt_pk_bf16_f32 v185, v162, v163
  v_mfma_f32_32x32x16_bf16 v[144:159], v[52:55], v[36:39], v[144:159]
  v_exp_f32 v168, v168
  v_exp_f32 v169, v169
  v_exp_f32 v170, v170
  v_exp_f32 v171, v171
  v_cvt_pk_bf16_f32 v186, v164, v165
  v_cvt_pk_bf16_f32 v187, v166, v167
  v_mfma_f32_32x32x16_bf16 v[192:207], v[100:103], v[180:183], v[192:207]
  v_exp_f32 v172, v172
  v_exp_f32 v173, v173
  v_exp_f32 v174, v174
  v_exp_f32 v175, v175
  v_cvt_pk_bf16_f32 v188, v168, v169
  v_cvt_pk_bf16_f32 v189, v170, v171
  v_cvt_pk_bf16_f32 v190, v172, v173
  v_cvt_pk_bf16_f32 v191, v174, v175
  v_mfma_f32_32x32x16_bf16 v[160:175], v[48:51], v[40:43], 0
  v_exp_f32 v144, v144
  v_exp_f32 v145, v145
  v_exp_f32 v146, v146
  v_exp_f32 v147, v147
  v_mfma_f32_32x32x16_bf16 v[208:223], v[96:99], v[184:187], v[208:223]
  v_exp_f32 v148, v148
  v_exp_f32 v149, v149
  v_exp_f32 v150, v150
  v_exp_f32 v151, v151
  v_cvt_pk_bf16_f32 v176, v144, v145
  v_cvt_pk_bf16_f32 v177, v146, v147
  v_mfma_f32_32x32x16_bf16 v[160:175], v[52:55], v[44:47], v[160:175]
  v_mov_b32 v4, -1
  v_mov_b32 v5, -1
  v_mov_b32 v6, -1
  v_mov_b32 v7, -1
  s_lshl_b32 s26, s13, 2
  s_add_u32 s26, s26, s32
  s_lshl_b32 s27, s26, 15
  s_lshl_b32 s24, s12, 11
  s_add_u32 s27, s27, s24
  s_add_u32 s27, s27, 11534336
  buffer_store_dwordx4 v[4:7], v1, s[8:11], s27 offen offset:0 sc1
  buffer_store_dwordx4 v[4:7], v1, s[8:11], s27 offen offset:1024 sc1
  s_and_b32 s24, s26, 1
  s_lshl_b32 s24, s24, 2
  s_and_b32 s25, s12, 3
  s_add_u32 s24, s24, s25
  s_lshl_b32 s24, s24, 2
  s_lshr_b32 s26, s26, 1
  s_lshl_b32 s26, s26, 12
  s_lshr_b32 s25, s12, 2
  s_lshl_b32 s25, s25, 7
  s_add_u32 s26, s26, s24
  s_add_u32 s26, s26, s25
  s_add_u32 s26, s26, 786432
  v_exp_f32 v152, v152
  v_exp_f32 v153, v153
  v_exp_f32 v154, v154
  v_exp_f32 v155, v155
  v_cvt_pk_bf16_f32 v178, v148, v149
  v_cvt_pk_bf16_f32 v179, v150, v151
  v_mfma_f32_32x32x16_bf16 v[208:223], v[100:103], v[188:191], v[208:223]
  v_exp_f32 v156, v156
  v_exp_f32 v157, v157
  v_exp_f32 v158, v158
  v_exp_f32 v159, v159
  v_cvt_pk_bf16_f32 v180, v152, v153
  v_cvt_pk_bf16_f32 v181, v154, v155
  v_cvt_pk_bf16_f32 v182, v156, v157
  v_cvt_pk_bf16_f32 v183, v158, v159
  s_waitcnt vmcnt(8)
  v_mfma_f32_32x32x16_bf16 v[144:159], v[56:59], v[16:19], 0
  v_exp_f32 v160, v160
  v_exp_f32 v161, v161
  v_exp_f32 v162, v162
  v_exp_f32 v163, v163
  v_mfma_f32_32x32x16_bf16 v[224:239], v[96:99], v[176:179], v[224:239]
  v_exp_f32 v164, v164
  v_exp_f32 v165, v165
  v_exp_f32 v166, v166
  v_exp_f32 v167, v167
  v_cvt_pk_bf16_f32 v184, v160, v161
  v_cvt_pk_bf16_f32 v185, v162, v163
  v_mfma_f32_32x32x16_bf16 v[144:159], v[60:63], v[20:23], v[144:159]
  v_exp_f32 v168, v168
  v_exp_f32 v169, v169
  v_exp_f32 v170, v170
  v_exp_f32 v171, v171
  v_cvt_pk_bf16_f32 v186, v164, v165
  v_cvt_pk_bf16_f32 v187, v166, v167
  v_mfma_f32_32x32x16_bf16 v[224:239], v[100:103], v[180:183], v[224:239]
  v_exp_f32 v172, v172
  v_exp_f32 v173, v173
  v_exp_f32 v174, v174
  v_exp_f32 v175, v175
  v_cvt_pk_bf16_f32 v188, v168, v169
  v_cvt_pk_bf16_f32 v189, v170, v171
  v_cvt_pk_bf16_f32 v190, v172, v173
  v_cvt_pk_bf16_f32 v191, v174, v175
  v_mfma_f32_32x32x16_bf16 v[160:175], v[56:59], v[24:27], 0
  s_setprio 3
  buffer_load_dwordx4 v[72:75], v1, s[8:11], s16 offen offset:0 sc1
  buffer_load_dwordx4 v[76:79], v1, s[8:11], s16 offen offset:1024 sc1
  s_setprio 0
  s_add_u32 s16, s16, 2048
  s_and_b32 s16, s16, 0x7fff
  s_or_b32 s16, s16, s15
  v_exp_f32 v144, v144
  v_exp_f32 v145, v145
  v_exp_f32 v146, v146
  v_exp_f32 v147, v147
  v_mfma_f32_32x32x16_bf16 v[240:255], v[96:99], v[184:187], v[240:255]
  v_exp_f32 v148, v148
  v_exp_f32 v149, v149
  v_exp_f32 v150, v150
  v_exp_f32 v151, v151
  v_cvt_pk_bf16_f32 v176, v144, v145
  v_cvt_pk_bf16_f32 v177, v146, v147
  v_mfma_f32_32x32x16_bf16 v[160:175], v[60:63], v[28:31], v[160:175]
  v_exp_f32 v152, v152
  v_exp_f32 v153, v153
  v_exp_f32 v154, v154
  v_exp_f32 v155, v155
  v_cvt_pk_bf16_f32 v178, v148, v149
  v_cvt_pk_bf16_f32 v179, v150, v151
  v_mfma_f32_32x32x16_bf16 v[240:255], v[100:103], v[188:191], v[240:255]
  v_exp_f32 v156, v156
  v_exp_f32 v157, v157
  v_exp_f32 v158, v158
  v_exp_f32 v159, v159
  v_cvt_pk_bf16_f32 v180, v152, v153
  v_cvt_pk_bf16_f32 v181, v154, v155
  v_cvt_pk_bf16_f32 v182, v156, v157
  v_cvt_pk_bf16_f32 v183, v158, v159
  v_mfma_f32_32x32x16_bf16 v[144:159], v[56:59], v[32:35], 0
  v_exp_f32 v160, v160
  v_exp_f32 v161, v161
  v_exp_f32 v162, v162
  v_exp_f32 v163, v163
  s_waitcnt vmcnt(8)
  v_mfma_f32_32x32x16_bf16 v[192:207], v[104:107], v[176:179], v[192:207]
  s_setprio 3
  buffer_load_dwordx4 v[120:123], v1, s[8:11], s17 offen offset:0 sc1
  buffer_load_dwordx4 v[124:127], v1, s[8:11], s17 offen offset:1024 sc1
  s_setprio 0
  s_add_u32 s17, s17, 2048
  s_and_b32 s17, s17, 0x7fff
  s_or_b32 s17, s17, s18
  v_exp_f32 v164, v164
  v_exp_f32 v165, v165
  v_exp_f32 v166, v166
  v_exp_f32 v167, v167
  v_cvt_pk_bf16_f32 v184, v160, v161
  v_cvt_pk_bf16_f32 v185, v162, v163
  v_mfma_f32_32x32x16_bf16 v[144:159], v[60:63], v[36:39], v[144:159]
  v_exp_f32 v168, v168
  v_exp_f32 v169, v169
  v_exp_f32 v170, v170
  v_exp_f32 v171, v171
  v_cvt_pk_bf16_f32 v186, v164, v165
  v_cvt_pk_bf16_f32 v187, v166, v167
  v_mfma_f32_32x32x16_bf16 v[192:207], v[108:111], v[180:183], v[192:207]
  v_exp_f32 v172, v172
  v_exp_f32 v173, v173
  v_exp_f32 v174, v174
  v_exp_f32 v175, v175
  v_cvt_pk_bf16_f32 v188, v168, v169
  v_cvt_pk_bf16_f32 v189, v170, v171
  v_cvt_pk_bf16_f32 v190, v172, v173
  v_cvt_pk_bf16_f32 v191, v174, v175
  v_mfma_f32_32x32x16_bf16 v[160:175], v[56:59], v[40:43], 0
  v_exp_f32 v144, v144
  v_exp_f32 v145, v145
  v_exp_f32 v146, v146
  v_exp_f32 v147, v147
  v_mfma_f32_32x32x16_bf16 v[208:223], v[104:107], v[184:187], v[208:223]
  v_exp_f32 v148, v148
  v_exp_f32 v149, v149
  v_exp_f32 v150, v150
  v_exp_f32 v151, v151
  v_cvt_pk_bf16_f32 v176, v144, v145
  v_cvt_pk_bf16_f32 v177, v146, v147
  v_mfma_f32_32x32x16_bf16 v[160:175], v[60:63], v[44:47], v[160:175]
  v_exp_f32 v152, v152
  v_exp_f32 v153, v153
  v_exp_f32 v154, v154
  v_exp_f32 v155, v155
  v_cvt_pk_bf16_f32 v178, v148, v149
  v_cvt_pk_bf16_f32 v179, v150, v151
  v_mfma_f32_32x32x16_bf16 v[208:223], v[108:111], v[188:191], v[208:223]
  v_exp_f32 v156, v156
  v_exp_f32 v157, v157
  v_exp_f32 v158, v158
  v_exp_f32 v159, v159
  v_cvt_pk_bf16_f32 v180, v152, v153
  v_cvt_pk_bf16_f32 v181, v154, v155
  v_cvt_pk_bf16_f32 v182, v156, v157
  v_cvt_pk_bf16_f32 v183, v158, v159
  s_waitcnt vmcnt(8)
  v_mfma_f32_32x32x16_bf16 v[144:159], v[64:67], v[16:19], 0
  v_exp_f32 v160, v160
  v_exp_f32 v161, v161
  v_exp_f32 v162, v162
  v_exp_f32 v163, v163
  v_mfma_f32_32x32x16_bf16 v[224:239], v[104:107], v[176:179], v[224:239]
  v_exp_f32 v164, v164
  v_exp_f32 v165, v165
  v_exp_f32 v166, v166
  v_exp_f32 v167, v167
  v_cvt_pk_bf16_f32 v184, v160, v161
  v_cvt_pk_bf16_f32 v185, v162, v163
  v_mfma_f32_32x32x16_bf16 v[144:159], v[68:71], v[20:23], v[144:159]
  v_exp_f32 v168, v168
  v_exp_f32 v169, v169
  v_exp_f32 v170, v170
  v_exp_f32 v171, v171
  v_cvt_pk_bf16_f32 v186, v164, v165
  v_cvt_pk_bf16_f32 v187, v166, v167
  v_mfma_f32_32x32x16_bf16 v[224:239], v[108:111], v[180:183], v[224:239]
  v_exp_f32 v172, v172
  v_exp_f32 v173, v173
  v_exp_f32 v174, v174
  v_exp_f32 v175, v175
  v_cvt_pk_bf16_f32 v188, v168, v169
  v_cvt_pk_bf16_f32 v189, v170, v171
  v_cvt_pk_bf16_f32 v190, v172, v173
  v_cvt_pk_bf16_f32 v191, v174, v175
  v_mfma_f32_32x32x16_bf16 v[160:175], v[64:67], v[24:27], 0
  s_setprio 3
  buffer_load_dwordx4 v[80:83], v1, s[8:11], s16 offen offset:0 sc1
  buffer_load_dwordx4 v[84:87], v1, s[8:11], s16 offen offset:1024 sc1
  s_setprio 0
  s_add_u32 s16, s16, 2048
  s_and_b32 s16, s16, 0x7fff
  s_or_b32 s16, s16, s15
  v_exp_f32 v144, v144
  v_exp_f32 v145, v145
  v_exp_f32 v146, v146
  v_exp_f32 v147, v147
  v_mfma_f32_32x32x16_bf16 v[240:255], v[104:107], v[184:187], v[240:255]
  v_exp_f32 v148, v148
  v_exp_f32 v149, v149
  v_exp_f32 v150, v150
  v_exp_f32 v151, v151
  v_cvt_pk_bf16_f32 v176, v144, v145
  v_cvt_pk_bf16_f32 v177, v146, v147
  v_mfma_f32_32x32x16_bf16 v[160:175], v[68:71], v[28:31], v[160:175]
  v_exp_f32 v152, v152
  v_exp_f32 v153, v153
  v_exp_f32 v154, v154
  v_exp_f32 v155, v155
  v_cvt_pk_bf16_f32 v178, v148, v149
  v_cvt_pk_bf16_f32 v179, v150, v151
  v_mfma_f32_32x32x16_bf16 v[240:255], v[108:111], v[188:191], v[240:255]
  v_exp_f32 v156, v156
  v_exp_f32 v157, v157
  v_exp_f32 v158, v158
  v_exp_f32 v159, v159
  v_cvt_pk_bf16_f32 v180, v152, v153
  v_cvt_pk_bf16_f32 v181, v154, v155
  v_cvt_pk_bf16_f32 v182, v156, v157
  v_cvt_pk_bf16_f32 v183, v158, v159
  v_mfma_f32_32x32x16_bf16 v[144:159], v[64:67], v[32:35], 0
  v_exp_f32 v160, v160
  v_exp_f32 v161, v161
  v_exp_f32 v162, v162
  v_exp_f32 v163, v163
  s_waitcnt vmcnt(8)
  v_mfma_f32_32x32x16_bf16 v[192:207], v[112:115], v[176:179], v[192:207]
  s_setprio 3
  buffer_load_dwordx4 v[128:131], v1, s[8:11], s17 offen offset:0 sc1
  buffer_load_dwordx4 v[132:135], v1, s[8:11], s17 offen offset:1024 sc1
  s_setprio 0
  s_add_u32 s17, s17, 2048
  s_and_b32 s17, s17, 0x7fff
  s_or_b32 s17, s17, s18
  v_exp_f32 v164, v164
  v_exp_f32 v165, v165
  v_exp_f32 v166, v166
  v_exp_f32 v167, v167
  v_cvt_pk_bf16_f32 v184, v160, v161
  v_cvt_pk_bf16_f32 v185, v162, v163
  v_mfma_f32_32x32x16_bf16 v[144:159], v[68:71], v[36:39], v[144:159]
  v_exp_f32 v168, v168
  v_exp_f32 v169, v169
  v_exp_f32 v170, v170
  v_exp_f32 v171, v171
  v_cvt_pk_bf16_f32 v186, v164, v165
  v_cvt_pk_bf16_f32 v187, v166, v167
  v_mfma_f32_32x32x16_bf16 v[192:207], v[116:119], v[180:183], v[192:207]
  v_exp_f32 v172, v172
  v_exp_f32 v173, v173
  v_exp_f32 v174, v174
  v_exp_f32 v175, v175
  v_cvt_pk_bf16_f32 v188, v168, v169
  v_cvt_pk_bf16_f32 v189, v170, v171
  v_cvt_pk_bf16_f32 v190, v172, v173
  v_cvt_pk_bf16_f32 v191, v174, v175
  v_mfma_f32_32x32x16_bf16 v[160:175], v[64:67], v[40:43], 0
  v_exp_f32 v144, v144
  v_exp_f32 v145, v145
  v_exp_f32 v146, v146
  v_exp_f32 v147, v147
  v_mfma_f32_32x32x16_bf16 v[208:223], v[112:115], v[184:187], v[208:223]
  v_exp_f32 v148, v148
  v_exp_f32 v149, v149
  v_exp_f32 v150, v150
  v_exp_f32 v151, v151
  v_cvt_pk_bf16_f32 v176, v144, v145
  v_cvt_pk_bf16_f32 v177, v146, v147
  v_mfma_f32_32x32x16_bf16 v[160:175], v[68:71], v[44:47], v[160:175]
  v_exp_f32 v152, v152
  v_exp_f32 v153, v153
  v_exp_f32 v154, v154
  v_exp_f32 v155, v155
  v_cvt_pk_bf16_f32 v178, v148, v149
  v_cvt_pk_bf16_f32 v179, v150, v151
  v_mfma_f32_32x32x16_bf16 v[208:223], v[116:119], v[188:191], v[208:223]
  v_exp_f32 v156, v156
  v_exp_f32 v157, v157
  v_exp_f32 v158, v158
  v_exp_f32 v159, v159
  v_cvt_pk_bf16_f32 v180, v152, v153
  v_cvt_pk_bf16_f32 v181, v154, v155
  v_cvt_pk_bf16_f32 v182, v156, v157
  v_cvt_pk_bf16_f32 v183, v158, v159
  s_waitcnt vmcnt(6)
  v_mfma_f32_32x32x16_bf16 v[144:159], v[72:75], v[16:19], 0
  v_exp_f32 v160, v160
  v_exp_f32 v161, v161
  v_exp_f32 v162, v162
  v_exp_f32 v163, v163
  v_mfma_f32_32x32x16_bf16 v[224:239], v[112:115], v[176:179], v[224:239]
  v_exp_f32 v164, v164
  v_exp_f32 v165, v165
  v_exp_f32 v166, v166
  v_exp_f32 v167, v167
  v_cvt_pk_bf16_f32 v184, v160, v161
  v_cvt_pk_bf16_f32 v185, v162, v163
  v_mfma_f32_32x32x16_bf16 v[144:159], v[76:79], v[20:23], v[144:159]
  v_exp_f32 v168, v168
  v_exp_f32 v169, v169
  v_exp_f32 v170, v170
  v_exp_f32 v171, v171
  v_cvt_pk_bf16_f32 v186, v164, v165
  v_cvt_pk_bf16_f32 v187, v166, v167
  v_mfma_f32_32x32x16_bf16 v[224:239], v[116:119], v[180:183], v[224:239]
  v_exp_f32 v172, v172
  v_exp_f32 v173, v173
  v_exp_f32 v174, v174
  v_exp_f32 v175, v175
  v_cvt_pk_bf16_f32 v188, v168, v169
  v_cvt_pk_bf16_f32 v189, v170, v171
  v_cvt_pk_bf16_f32 v190, v172, v173
  v_cvt_pk_bf16_f32 v191, v174, v175
  v_mfma_f32_32x32x16_bf16 v[160:175], v[72:75], v[24:27], 0
  s_setprio 3
  buffer_load_dwordx4 v[88:91], v1, s[8:11], s16 offen offset:0 sc1
  buffer_load_dwordx4 v[92:95], v1, s[8:11], s16 offen offset:1024 sc1
  s_setprio 0
  s_add_u32 s16, s16, 2048
  s_and_b32 s16, s16, 0x7fff
  s_or_b32 s16, s16, s15
  v_exp_f32 v144, v144
  v_exp_f32 v145, v145
  v_exp_f32 v146, v146
  v_exp_f32 v147, v147
  v_mfma_f32_32x32x16_bf16 v[240:255], v[112:115], v[184:187], v[240:255]
  v_exp_f32 v148, v148
  v_exp_f32 v149, v149
  v_exp_f32 v150, v150
  v_exp_f32 v151, v151
  v_cvt_pk_bf16_f32 v176, v144, v145
  v_cvt_pk_bf16_f32 v177, v146, v147
  v_mfma_f32_32x32x16_bf16 v[160:175], v[76:79], v[28:31], v[160:175]
  v_lshlrev_b32 v8, 9, v2
  v_mov_b32 v9, s3
  s_mov_b32 exec_lo, 127
  s_mov_b32 exec_hi, 0
  buffer_store_dword v9, v8, s[8:11], s26 offen sc1
  s_mov_b32 exec_lo, -1
  s_mov_b32 exec_hi, -1
  v_exp_f32 v152, v152
  v_exp_f32 v153, v153
  v_exp_f32 v154, v154
  v_exp_f32 v155, v155
  v_cvt_pk_bf16_f32 v178, v148, v149
  v_cvt_pk_bf16_f32 v179, v150, v151
  v_mfma_f32_32x32x16_bf16 v[240:255], v[116:119], v[188:191], v[240:255]
  v_exp_f32 v156, v156
  v_exp_f32 v157, v157
  v_exp_f32 v158, v158
  v_exp_f32 v159, v159
  v_cvt_pk_bf16_f32 v180, v152, v153
  v_cvt_pk_bf16_f32 v181, v154, v155
  v_cvt_pk_bf16_f32 v182, v156, v157
  v_cvt_pk_bf16_f32 v183, v158, v159
  v_mfma_f32_32x32x16_bf16 v[144:159], v[72:75], v[32:35], 0
  v_exp_f32 v160, v160
  v_exp_f32 v161, v161
  v_exp_f32 v162, v162
  v_exp_f32 v163, v163
  s_waitcnt vmcnt(7)
  v_mfma_f32_32x32x16_bf16 v[192:207], v[120:123], v[176:179], v[192:207]
  s_setprio 3
  buffer_load_dwordx4 v[136:139], v1, s[8:11], s17 offen offset:0 sc1
  buffer_load_dwordx4 v[140:143], v1, s[8:11], s17 offen offset:1024 sc1
  s_setprio 0
  s_add_u32 s17, s17, 2048
  s_and_b32 s17, s17, 0x7fff
  s_or_b32 s17, s17, s18
  v_exp_f32 v164, v164
  v_exp_f32 v165, v165
  v_exp_f32 v166, v166
  v_exp_f32 v167, v167
  v_cvt_pk_bf16_f32 v184, v160, v161
  v_cvt_pk_bf16_f32 v185, v162, v163
  v_mfma_f32_32x32x16_bf16 v[144:159], v[76:79], v[36:39], v[144:159]
  v_exp_f32 v168, v168
  v_exp_f32 v169, v169
  v_exp_f32 v170, v170
  v_exp_f32 v171, v171
  v_cvt_pk_bf16_f32 v186, v164, v165
  v_cvt_pk_bf16_f32 v187, v166, v167
  v_mfma_f32_32x32x16_bf16 v[192:207], v[124:127], v[180:183], v[192:207]
  v_exp_f32 v172, v172
  v_exp_f32 v173, v173
  v_exp_f32 v174, v174
  v_exp_f32 v175, v175
  v_cvt_pk_bf16_f32 v188, v168, v169
  v_cvt_pk_bf16_f32 v189, v170, v171
  v_cvt_pk_bf16_f32 v190, v172, v173
  v_cvt_pk_bf16_f32 v191, v174, v175
  v_mfma_f32_32x32x16_bf16 v[160:175], v[72:75], v[40:43], 0
  v_exp_f32 v144, v144
  v_exp_f32 v145, v145
  v_exp_f32 v146, v146
  v_exp_f32 v147, v147
  v_mfma_f32_32x32x16_bf16 v[208:223], v[120:123], v[184:187], v[208:223]
  v_exp_f32 v148, v148
  v_exp_f32 v149, v149
  v_exp_f32 v150, v150
  v_exp_f32 v151, v151
  v_cvt_pk_bf16_f32 v176, v144, v145
  v_cvt_pk_bf16_f32 v177, v146, v147
  v_mfma_f32_32x32x16_bf16 v[160:175], v[76:79], v[44:47], v[160:175]
  v_exp_f32 v152, v152
  v_exp_f32 v153, v153
  v_exp_f32 v154, v154
  v_exp_f32 v155, v155
  v_cvt_pk_bf16_f32 v178, v148, v149
  v_cvt_pk_bf16_f32 v179, v150, v151
  v_mfma_f32_32x32x16_bf16 v[208:223], v[124:127], v[188:191], v[208:223]
  v_exp_f32 v156, v156
  v_exp_f32 v157, v157
  v_exp_f32 v158, v158
  v_exp_f32 v159, v159
  v_cvt_pk_bf16_f32 v180, v152, v153
  v_cvt_pk_bf16_f32 v181, v154, v155
  v_cvt_pk_bf16_f32 v182, v156, v157
  v_cvt_pk_bf16_f32 v183, v158, v159
  s_waitcnt vmcnt(7)
  v_mfma_f32_32x32x16_bf16 v[144:159], v[80:83], v[16:19], 0
  v_exp_f32 v160, v160
  v_exp_f32 v161, v161
  v_exp_f32 v162, v162
  v_exp_f32 v163, v163
  v_mfma_f32_32x32x16_bf16 v[224:239], v[120:123], v[176:179], v[224:239]
  v_exp_f32 v164, v164
  v_exp_f32 v165, v165
  v_exp_f32 v166, v166
  v_exp_f32 v167, v167
  v_cvt_pk_bf16_f32 v184, v160, v161
  v_cvt_pk_bf16_f32 v185, v162, v163
  v_mfma_f32_32x32x16_bf16 v[144:159], v[84:87], v[20:23], v[144:159]
  v_exp_f32 v168, v168
  v_exp_f32 v169, v169
  v_exp_f32 v170, v170
  v_exp_f32 v171, v171
  v_cvt_pk_bf16_f32 v186, v164, v165
  v_cvt_pk_bf16_f32 v187, v166, v167
  v_mfma_f32_32x32x16_bf16 v[224:239], v[124:127], v[180:183], v[224:239]
  v_exp_f32 v172, v172
  v_exp_f32 v173, v173
  v_exp_f32 v174, v174
  v_exp_f32 v175, v175
  v_cvt_pk_bf16_f32 v188, v168, v169
  v_cvt_pk_bf16_f32 v189, v170, v171
  v_cvt_pk_bf16_f32 v190, v172, v173
  v_cvt_pk_bf16_f32 v191, v174, v175
  v_mfma_f32_32x32x16_bf16 v[160:175], v[80:83], v[24:27], 0
  s_setprio 3
  buffer_load_dwordx4 v[48:51], v1, s[8:11], s16 offen offset:0 sc1
  buffer_load_dwordx4 v[52:55], v1, s[8:11], s16 offen offset:1024 sc1
  s_setprio 0
  s_add_u32 s16, s16, 2048
  s_and_b32 s16, s16, 0x7fff
  s_or_b32 s16, s16, s15
  v_exp_f32 v144, v144
  v_exp_f32 v145, v145
  v_exp_f32 v146, v146
  v_exp_f32 v147, v147
  v_mfma_f32_32x32x16_bf16 v[240:255], v[120:123], v[184:187], v[240:255]
  v_exp_f32 v148, v148
  v_exp_f32 v149, v149
  v_exp_f32 v150, v150
  v_exp_f32 v151, v151
  v_cvt_pk_bf16_f32 v176, v144, v145
  v_cvt_pk_bf16_f32 v177, v146, v147
  v_mfma_f32_32x32x16_bf16 v[160:175], v[84:87], v[28:31], v[160:175]
  v_exp_f32 v152, v152
  v_exp_f32 v153, v153
  v_exp_f32 v154, v154
  v_exp_f32 v155, v155
  v_cvt_pk_bf16_f32 v178, v148, v149
  v_cvt_pk_bf16_f32 v179, v150, v151
  v_mfma_f32_32x32x16_bf16 v[240:255], v[124:127], v[188:191], v[240:255]
  v_exp_f32 v156, v156
  v_exp_f32 v157, v157
  v_exp_f32 v158, v158
  v_exp_f32 v159, v159
  v_cvt_pk_bf16_f32 v180, v152, v153
  v_cvt_pk_bf16_f32 v181, v154, v155
  v_cvt_pk_bf16_f32 v182, v156, v157
  v_cvt_pk_bf16_f32 v183, v158, v159
  v_mfma_f32_32x32x16_bf16 v[144:159], v[80:83], v[32:35], 0
  v_exp_f32 v160, v160
  v_exp_f32 v161, v161
  v_exp_f32 v162, v162
  v_exp_f32 v163, v163
  s_waitcnt vmcnt(7)
  v_mfma_f32_32x32x16_bf16 v[192:207], v[128:131], v[176:179], v[192:207]
  s_setprio 3
  buffer_load_dwordx4 v[96:99], v1, s[8:11], s17 offen offset:0 sc1
  buffer_load_dwordx4 v[100:103], v1, s[8:11], s17 offen offset:1024 sc1
  s_setprio 0
  s_add_u32 s17, s17, 2048
  s_and_b32 s17, s17, 0x7fff
  s_or_b32 s17, s17, s18
  v_exp_f32 v164, v164
  v_exp_f32 v165, v165
  v_exp_f32 v166, v166
  v_exp_f32 v167, v167
  v_cvt_pk_bf16_f32 v184, v160, v161
  v_cvt_pk_bf16_f32 v185, v162, v163
  v_mfma_f32_32x32x16_bf16 v[144:159], v[84:87], v[36:39], v[144:159]
  v_exp_f32 v168, v168
  v_exp_f32 v169, v169
  v_exp_f32 v170, v170
  v_exp_f32 v171, v171
  v_cvt_pk_bf16_f32 v186, v164, v165
  v_cvt_pk_bf16_f32 v187, v166, v167
  v_mfma_f32_32x32x16_bf16 v[192:207], v[132:135], v[180:183], v[192:207]
  v_exp_f32 v172, v172
  v_exp_f32 v173, v173
  v_exp_f32 v174, v174
  v_exp_f32 v175, v175
  v_cvt_pk_bf16_f32 v188, v168, v169
  v_cvt_pk_bf16_f32 v189, v170, v171
  v_cvt_pk_bf16_f32 v190, v172, v173
  v_cvt_pk_bf16_f32 v191, v174, v175
  v_mfma_f32_32x32x16_bf16 v[160:175], v[80:83], v[40:43], 0
  v_exp_f32 v144, v144
  v_exp_f32 v145, v145
  v_exp_f32 v146, v146
  v_exp_f32 v147, v147
  v_mfma_f32_32x32x16_bf16 v[208:223], v[128:131], v[184:187], v[208:223]
  v_exp_f32 v148, v148
  v_exp_f32 v149, v149
  v_exp_f32 v150, v150
  v_exp_f32 v151, v151
  v_cvt_pk_bf16_f32 v176, v144, v145
  v_cvt_pk_bf16_f32 v177, v146, v147
  v_mfma_f32_32x32x16_bf16 v[160:175], v[84:87], v[44:47], v[160:175]
  v_exp_f32 v152, v152
  v_exp_f32 v153, v153
  v_exp_f32 v154, v154
  v_exp_f32 v155, v155
  v_cvt_pk_bf16_f32 v178, v148, v149
  v_cvt_pk_bf16_f32 v179, v150, v151
  v_mfma_f32_32x32x16_bf16 v[208:223], v[132:135], v[188:191], v[208:223]
  v_exp_f32 v156, v156
  v_exp_f32 v157, v157
  v_exp_f32 v158, v158
  v_exp_f32 v159, v159
  v_cvt_pk_bf16_f32 v180, v152, v153
  v_cvt_pk_bf16_f32 v181, v154, v155
  v_cvt_pk_bf16_f32 v182, v156, v157
  v_cvt_pk_bf16_f32 v183, v158, v159
  s_waitcnt vmcnt(7)
  v_mfma_f32_32x32x16_bf16 v[144:159], v[88:91], v[16:19], 0
  v_exp_f32 v160, v160
  v_exp_f32 v161, v161
  v_exp_f32 v162, v162
  v_exp_f32 v163, v163
  v_mfma_f32_32x32x16_bf16 v[224:239], v[128:131], v[176:179], v[224:239]
  v_exp_f32 v164, v164
  v_exp_f32 v165, v165
  v_exp_f32 v166, v166
  v_exp_f32 v167, v167
  v_cvt_pk_bf16_f32 v184, v160, v161
  v_cvt_pk_bf16_f32 v185, v162, v163
  v_mfma_f32_32x32x16_bf16 v[144:159], v[92:95], v[20:23], v[144:159]
  v_exp_f32 v168, v168
  v_exp_f32 v169, v169
  v_exp_f32 v170, v170
  v_exp_f32 v171, v171
  v_cvt_pk_bf16_f32 v186, v164, v165
  v_cvt_pk_bf16_f32 v187, v166, v167
  v_mfma_f32_32x32x16_bf16 v[224:239], v[132:135], v[180:183], v[224:239]
  v_exp_f32 v172, v172
  v_exp_f32 v173, v173
  v_exp_f32 v174, v174
  v_exp_f32 v175, v175
  v_cvt_pk_bf16_f32 v188, v168, v169
  v_cvt_pk_bf16_f32 v189, v170, v171
  v_cvt_pk_bf16_f32 v190, v172, v173
  v_cvt_pk_bf16_f32 v191, v174, v175
  v_mfma_f32_32x32x16_bf16 v[160:175], v[88:91], v[24:27], 0
  s_setprio 3
  buffer_load_dwordx4 v[56:59], v1, s[8:11], s16 offen offset:0 sc1
  buffer_load_dwordx4 v[60:63], v1, s[8:11], s16 offen offset:1024 sc1
  s_setprio 0
  s_add_u32 s16, s16, 2048
  s_and_b32 s16, s16, 0x7fff
  s_or_b32 s16, s16, s15
  v_exp_f32 v144, v144
  v_exp_f32 v145, v145
  v_exp_f32 v146, v146
  v_exp_f32 v147, v147
  v_mfma_f32_32x32x16_bf16 v[240:255], v[128:131], v[184:187], v[240:255]
  v_exp_f32 v148, v148
  v_exp_f32 v149, v149
  v_exp_f32 v150, v150
  v_exp_f32 v151, v151
  v_cvt_pk_bf16_f32 v176, v144, v145
  v_cvt_pk_bf16_f32 v177, v146, v147
  v_mfma_f32_32x32x16_bf16 v[160:175], v[92:95], v[28:31], v[160:175]
  v_exp_f32 v152, v152
  v_exp_f32 v153, v153
  v_exp_f32 v154, v154
  v_exp_f32 v155, v155
  v_cvt_pk_bf16_f32 v178, v148, v149
  v_cvt_pk_bf16_f32 v179, v150, v151
  v_mfma_f32_32x32x16_bf16 v[240:255], v[132:135], v[188:191], v[240:255]
  v_exp_f32 v156, v156
  v_exp_f32 v157, v157
  v_exp_f32 v158, v158
  v_exp_f32 v159, v159
  v_cvt_pk_bf16_f32 v180, v152, v153
  v_cvt_pk_bf16_f32 v181, v154, v155
  v_cvt_pk_bf16_f32 v182, v156, v157
  v_cvt_pk_bf16_f32 v183, v158, v159
  v_mfma_f32_32x32x16_bf16 v[144:159], v[88:91], v[32:35], 0
  v_exp_f32 v160, v160
  v_exp_f32 v161, v161
  v_exp_f32 v162, v162
  v_exp_f32 v163, v163
  s_waitcnt vmcnt(6)
  v_mfma_f32_32x32x16_bf16 v[192:207], v[136:139], v[176:179], v[192:207]
  s_setprio 3
  buffer_load_dwordx4 v[104:107], v1, s[8:11], s17 offen offset:0 sc1
  buffer_load_dwordx4 v[108:111], v1, s[8:11], s17 offen offset:1024 sc1
  s_setprio 0
  s_add_u32 s17, s17, 2048
  s_and_b32 s17, s17, 0x7fff
  s_or_b32 s17, s17, s18
  v_exp_f32 v164, v164
  v_exp_f32 v165, v165
  v_exp_f32 v166, v166
  v_exp_f32 v167, v167
  v_cvt_pk_bf16_f32 v184, v160, v161
  v_cvt_pk_bf16_f32 v185, v162, v163
  v_mfma_f32_32x32x16_bf16 v[144:159], v[92:95], v[36:39], v[144:159]
  v_exp_f32 v168, v168
  v_exp_f32 v169, v169
  v_exp_f32 v170, v170
  v_exp_f32 v171, v171
  v_cvt_pk_bf16_f32 v186, v164, v165
  v_cvt_pk_bf16_f32 v187, v166, v167
  v_mfma_f32_32x32x16_bf16 v[192:207], v[140:143], v[180:183], v[192:207]
  v_exp_f32 v172, v172
  v_exp_f32 v173, v173
  v_exp_f32 v174, v174
  v_exp_f32 v175, v175
  v_cvt_pk_bf16_f32 v188, v168, v169
  v_cvt_pk_bf16_f32 v189, v170, v171
  v_cvt_pk_bf16_f32 v190, v172, v173
  v_cvt_pk_bf16_f32 v191, v174, v175
  v_mfma_f32_32x32x16_bf16 v[160:175], v[88:91], v[40:43], 0
  v_exp_f32 v144, v144
  v_exp_f32 v145, v145
  v_exp_f32 v146, v146
  v_exp_f32 v147, v147
  v_mfma_f32_32x32x16_bf16 v[208:223], v[136:139], v[184:187], v[208:223]
  v_exp_f32 v148, v148
  v_exp_f32 v149, v149
  v_exp_f32 v150, v150
  v_exp_f32 v151, v151
  v_cvt_pk_bf16_f32 v176, v144, v145
  v_cvt_pk_bf16_f32 v177, v146, v147
  v_mfma_f32_32x32x16_bf16 v[160:175], v[92:95], v[44:47], v[160:175]
  v_exp_f32 v152, v152
  v_exp_f32 v153, v153
  v_exp_f32 v154, v154
  v_exp_f32 v155, v155
  v_cvt_pk_bf16_f32 v178, v148, v149
  v_cvt_pk_bf16_f32 v179, v150, v151
  v_mfma_f32_32x32x16_bf16 v[208:223], v[140:143], v[188:191], v[208:223]
  v_exp_f32 v156, v156
  v_exp_f32 v157, v157
  v_exp_f32 v158, v158
  v_exp_f32 v159, v159
  v_cvt_pk_bf16_f32 v180, v152, v153
  v_cvt_pk_bf16_f32 v181, v154, v155
  v_cvt_pk_bf16_f32 v182, v156, v157
  v_cvt_pk_bf16_f32 v183, v158, v159
  s_waitcnt vmcnt(6)
  v_mfma_f32_32x32x16_bf16 v[144:159], v[48:51], v[16:19], 0
  v_exp_f32 v160, v160
  v_exp_f32 v161, v161
  v_exp_f32 v162, v162
  v_exp_f32 v163, v163
  v_mfma_f32_32x32x16_bf16 v[224:239], v[136:139], v[176:179], v[224:239]
  v_exp_f32 v164, v164
  v_exp_f32 v165, v165
  v_exp_f32 v166, v166
  v_exp_f32 v167, v167
  v_cvt_pk_bf16_f32 v184, v160, v161
  v_cvt_pk_bf16_f32 v185, v162, v163
  v_mfma_f32_32x32x16_bf16 v[144:159], v[52:55], v[20:23], v[144:159]
  v_exp_f32 v168, v168
  v_exp_f32 v169, v169
  v_exp_f32 v170, v170
  v_exp_f32 v171, v171
  v_cvt_pk_bf16_f32 v186, v164, v165
  v_cvt_pk_bf16_f32 v187, v166, v167
  v_mfma_f32_32x32x16_bf16 v[224:239], v[140:143], v[180:183], v[224:239]
  v_exp_f32 v172, v172
  v_exp_f32 v173, v173
  v_exp_f32 v174, v174
  v_exp_f32 v175, v175
  v_cvt_pk_bf16_f32 v188, v168, v169
  v_cvt_pk_bf16_f32 v189, v170, v171
  v_cvt_pk_bf16_f32 v190, v172, v173
  v_cvt_pk_bf16_f32 v191, v174, v175
  v_mfma_f32_32x32x16_bf16 v[160:175], v[48:51], v[24:27], 0
  s_setprio 3
  buffer_load_dwordx4 v[64:67], v1, s[8:11], s16 offen offset:0 sc1
  buffer_load_dwordx4 v[68:71], v1, s[8:11], s16 offen offset:1024 sc1
  s_setprio 0
  s_add_u32 s16, s16, 2048
  s_and_b32 s16, s16, 0x7fff
  s_or_b32 s16, s16, s15
  v_exp_f32 v144, v144
  v_exp_f32 v145, v145
  v_exp_f32 v146, v146
  v_exp_f32 v147, v147
  v_mfma_f32_32x32x16_bf16 v[240:255], v[136:139], v[184:187], v[240:255]
  v_exp_f32 v148, v148
  v_exp_f32 v149, v149
  v_exp_f32 v150, v150
  v_exp_f32 v151, v151
  v_cvt_pk_bf16_f32 v176, v144, v145
  v_cvt_pk_bf16_f32 v177, v146, v147
  v_mfma_f32_32x32x16_bf16 v[160:175], v[52:55], v[28:31], v[160:175]
  v_exp_f32 v152, v152
  v_exp_f32 v153, v153
  v_exp_f32 v154, v154
  v_exp_f32 v155, v155
  v_cvt_pk_bf16_f32 v178, v148, v149
  v_cvt_pk_bf16_f32 v179, v150, v151
  v_mfma_f32_32x32x16_bf16 v[240:255], v[140:143], v[188:191], v[240:255]
  v_exp_f32 v156, v156
  v_exp_f32 v157, v157
  v_exp_f32 v158, v158
  v_exp_f32 v159, v159
  v_cvt_pk_bf16_f32 v180, v152, v153
  v_cvt_pk_bf16_f32 v181, v154, v155
  v_cvt_pk_bf16_f32 v182, v156, v157
  v_cvt_pk_bf16_f32 v183, v158, v159
  v_mfma_f32_32x32x16_bf16 v[144:159], v[48:51], v[32:35], 0
  v_exp_f32 v160, v160
  v_exp_f32 v161, v161
  v_exp_f32 v162, v162
  v_exp_f32 v163, v163
  s_waitcnt vmcnt(6)
  v_mfma_f32_32x32x16_bf16 v[192:207], v[96:99], v[176:179], v[192:207]
  s_setprio 3
  buffer_load_dwordx4 v[112:115], v1, s[8:11], s17 offen offset:0 sc1
  buffer_load_dwordx4 v[116:119], v1, s[8:11], s17 offen offset:1024 sc1
  s_setprio 0
  s_add_u32 s17, s17, 2048
  s_and_b32 s17, s17, 0x7fff
  s_or_b32 s17, s17, s18
  v_exp_f32 v164, v164
  v_exp_f32 v165, v165
  v_exp_f32 v166, v166
  v_exp_f32 v167, v167
  v_cvt_pk_bf16_f32 v184, v160, v161
  v_cvt_pk_bf16_f32 v185, v162, v163
  v_mfma_f32_32x32x16_bf16 v[144:159], v[52:55], v[36:39], v[144:159]
  v_exp_f32 v168, v168
  v_exp_f32 v169, v169
  v_exp_f32 v170, v170
  v_exp_f32 v171, v171
  v_cvt_pk_bf16_f32 v186, v164, v165
  v_cvt_pk_bf16_f32 v187, v166, v167
  v_mfma_f32_32x32x16_bf16 v[192:207], v[100:103], v[180:183], v[192:207]
  v_exp_f32 v172, v172
  v_exp_f32 v173, v173
  v_exp_f32 v174, v174
  v_exp_f32 v175, v175
  v_cvt_pk_bf16_f32 v188, v168, v169
  v_cvt_pk_bf16_f32 v189, v170, v171
  v_cvt_pk_bf16_f32 v190, v172, v173
  v_cvt_pk_bf16_f32 v191, v174, v175
  v_mfma_f32_32x32x16_bf16 v[160:175], v[48:51], v[40:43], 0
  v_exp_f32 v144, v144
  v_exp_f32 v145, v145
  v_exp_f32 v146, v146
  v_exp_f32 v147, v147
  v_mfma_f32_32x32x16_bf16 v[208:223], v[96:99], v[184:187], v[208:223]
  v_exp_f32 v148, v148
  v_exp_f32 v149, v149
  v_exp_f32 v150, v150
  v_exp_f32 v151, v151
  v_cvt_pk_bf16_f32 v176, v144, v145
  v_cvt_pk_bf16_f32 v177, v146, v147
  v_mfma_f32_32x32x16_bf16 v[160:175], v[52:55], v[44:47], v[160:175]
  v_exp_f32 v152, v152
  v_exp_f32 v153, v153
  v_exp_f32 v154, v154
  v_exp_f32 v155, v155
  v_cvt_pk_bf16_f32 v178, v148, v149
  v_cvt_pk_bf16_f32 v179, v150, v151
  v_mfma_f32_32x32x16_bf16 v[208:223], v[100:103], v[188:191], v[208:223]
  v_exp_f32 v156, v156
  v_exp_f32 v157, v157
  v_exp_f32 v158, v158
  v_exp_f32 v159, v159
  v_cvt_pk_bf16_f32 v180, v152, v153
  v_cvt_pk_bf16_f32 v181, v154, v155
  v_cvt_pk_bf16_f32 v182, v156, v157
  v_cvt_pk_bf16_f32 v183, v158, v159
  s_waitcnt vmcnt(6)
  v_mfma_f32_32x32x16_bf16 v[144:159], v[56:59], v[16:19], 0
  v_exp_f32 v160, v160
  v_exp_f32 v161, v161
  v_exp_f32 v162, v162
  v_exp_f32 v163, v163
  v_mfma_f32_32x32x16_bf16 v[224:239], v[96:99], v[176:179], v[224:239]
  v_exp_f32 v164, v164
  v_exp_f32 v165, v165
  v_exp_f32 v166, v166
  v_exp_f32 v167, v167
  v_cvt_pk_bf16_f32 v184, v160, v161
  v_cvt_pk_bf16_f32 v185, v162, v163
  v_mfma_f32_32x32x16_bf16 v[144:159], v[60:63], v[20:23], v[144:159]
  v_exp_f32 v168, v168
  v_exp_f32 v169, v169
  v_exp_f32 v170, v170
  v_exp_f32 v171, v171
  v_cvt_pk_bf16_f32 v186, v164, v165
  v_cvt_pk_bf16_f32 v187, v166, v167
  v_mfma_f32_32x32x16_bf16 v[224:239], v[100:103], v[180:183], v[224:239]
  v_exp_f32 v172, v172
  v_exp_f32 v173, v173
  v_exp_f32 v174, v174
  v_exp_f32 v175, v175
  v_cvt_pk_bf16_f32 v188, v168, v169
  v_cvt_pk_bf16_f32 v189, v170, v171
  v_cvt_pk_bf16_f32 v190, v172, v173
  v_cvt_pk_bf16_f32 v191, v174, v175
  v_mfma_f32_32x32x16_bf16 v[160:175], v[56:59], v[24:27], 0
  s_setprio 3
  buffer_load_dwordx4 v[72:75], v1, s[8:11], s16 offen offset:0 sc1
  buffer_load_dwordx4 v[76:79], v1, s[8:11], s16 offen offset:1024 sc1
  s_setprio 0
  s_add_u32 s16, s16, 2048
  s_and_b32 s16, s16, 0x7fff
  s_or_b32 s16, s16, s15
  v_exp_f32 v144, v144
  v_exp_f32 v145, v145
  v_exp_f32 v146, v146
  v_exp_f32 v147, v147
  v_mfma_f32_32x32x16_bf16 v[240:255], v[96:99], v[184:187], v[240:255]
  v_exp_f32 v148, v148
  v_exp_f32 v149, v149
  v_exp_f32 v150, v150
  v_exp_f32 v151, v151
  v_cvt_pk_bf16_f32 v176, v144, v145
  v_cvt_pk_bf16_f32 v177, v146, v147
  v_mfma_f32_32x32x16_bf16 v[160:175], v[60:63], v[28:31], v[160:175]
  v_exp_f32 v152, v152
  v_exp_f32 v153, v153
  v_exp_f32 v154, v154
  v_exp_f32 v155, v155
  v_cvt_pk_bf16_f32 v178, v148, v149
  v_cvt_pk_bf16_f32 v179, v150, v151
  v_mfma_f32_32x32x16_bf16 v[240:255], v[100:103], v[188:191], v[240:255]
  v_exp_f32 v156, v156
  v_exp_f32 v157, v157
  v_exp_f32 v158, v158
  v_exp_f32 v159, v159
  v_cvt_pk_bf16_f32 v180, v152, v153
  v_cvt_pk_bf16_f32 v181, v154, v155
  v_cvt_pk_bf16_f32 v182, v156, v157
  v_cvt_pk_bf16_f32 v183, v158, v159
  v_mfma_f32_32x32x16_bf16 v[144:159], v[56:59], v[32:35], 0
  v_exp_f32 v160, v160
  v_exp_f32 v161, v161
  v_exp_f32 v162, v162
  v_exp_f32 v163, v163
  s_waitcnt vmcnt(6)
  v_mfma_f32_32x32x16_bf16 v[192:207], v[104:107], v[176:179], v[192:207]
  s_setprio 3
  buffer_load_dwordx4 v[120:123], v1, s[8:11], s17 offen offset:0 sc1
  buffer_load_dwordx4 v[124:127], v1, s[8:11], s17 offen offset:1024 sc1
  s_setprio 0
  s_add_u32 s17, s17, 2048
  s_and_b32 s17, s17, 0x7fff
  s_or_b32 s17, s17, s18
  v_exp_f32 v164, v164
  v_exp_f32 v165, v165
  v_exp_f32 v166, v166
  v_exp_f32 v167, v167
  v_cvt_pk_bf16_f32 v184, v160, v161
  v_cvt_pk_bf16_f32 v185, v162, v163
  v_mfma_f32_32x32x16_bf16 v[144:159], v[60:63], v[36:39], v[144:159]
  v_exp_f32 v168, v168
  v_exp_f32 v169, v169
  v_exp_f32 v170, v170
  v_exp_f32 v171, v171
  v_cvt_pk_bf16_f32 v186, v164, v165
  v_cvt_pk_bf16_f32 v187, v166, v167
  v_mfma_f32_32x32x16_bf16 v[192:207], v[108:111], v[180:183], v[192:207]
  v_exp_f32 v172, v172
  v_exp_f32 v173, v173
  v_exp_f32 v174, v174
  v_exp_f32 v175, v175
  v_cvt_pk_bf16_f32 v188, v168, v169
  v_cvt_pk_bf16_f32 v189, v170, v171
  v_cvt_pk_bf16_f32 v190, v172, v173
  v_cvt_pk_bf16_f32 v191, v174, v175
  v_mfma_f32_32x32x16_bf16 v[160:175], v[56:59], v[40:43], 0
  v_exp_f32 v144, v144
  v_exp_f32 v145, v145
  v_exp_f32 v146, v146
  v_exp_f32 v147, v147
  v_mfma_f32_32x32x16_bf16 v[208:223], v[104:107], v[184:187], v[208:223]
  v_exp_f32 v148, v148
  v_exp_f32 v149, v149
  v_exp_f32 v150, v150
  v_exp_f32 v151, v151
  v_cvt_pk_bf16_f32 v176, v144, v145
  v_cvt_pk_bf16_f32 v177, v146, v147
  v_mfma_f32_32x32x16_bf16 v[160:175], v[60:63], v[44:47], v[160:175]
  v_exp_f32 v152, v152
  v_exp_f32 v153, v153
  v_exp_f32 v154, v154
  v_exp_f32 v155, v155
  v_cvt_pk_bf16_f32 v178, v148, v149
  v_cvt_pk_bf16_f32 v179, v150, v151
  v_mfma_f32_32x32x16_bf16 v[208:223], v[108:111], v[188:191], v[208:223]
  v_exp_f32 v156, v156
  v_exp_f32 v157, v157
  v_exp_f32 v158, v158
  v_exp_f32 v159, v159
  v_cvt_pk_bf16_f32 v180, v152, v153
  v_cvt_pk_bf16_f32 v181, v154, v155
  v_cvt_pk_bf16_f32 v182, v156, v157
  v_cvt_pk_bf16_f32 v183, v158, v159
  s_waitcnt vmcnt(6)
  v_mfma_f32_32x32x16_bf16 v[144:159], v[64:67], v[16:19], 0
  v_exp_f32 v160, v160
  v_exp_f32 v161, v161
  v_exp_f32 v162, v162
  v_exp_f32 v163, v163
  v_mfma_f32_32x32x16_bf16 v[224:239], v[104:107], v[176:179], v[224:239]
  v_exp_f32 v164, v164
  v_exp_f32 v165, v165
  v_exp_f32 v166, v166
  v_exp_f32 v167, v167
  v_cvt_pk_bf16_f32 v184, v160, v161
  v_cvt_pk_bf16_f32 v185, v162, v163
  v_mfma_f32_32x32x16_bf16 v[144:159], v[68:71], v[20:23], v[144:159]
  v_exp_f32 v168, v168
  v_exp_f32 v169, v169
  v_exp_f32 v170, v170
  v_exp_f32 v171, v171
  v_cvt_pk_bf16_f32 v186, v164, v165
  v_cvt_pk_bf16_f32 v187, v166, v167
  v_mfma_f32_32x32x16_bf16 v[224:239], v[108:111], v[180:183], v[224:239]
  v_exp_f32 v172, v172
  v_exp_f32 v173, v173
  v_exp_f32 v174, v174
  v_exp_f32 v175, v175
  v_cvt_pk_bf16_f32 v188, v168, v169
  v_cvt_pk_bf16_f32 v189, v170, v171
  v_cvt_pk_bf16_f32 v190, v172, v173
  v_cvt_pk_bf16_f32 v191, v174, v175
  v_mfma_f32_32x32x16_bf16 v[160:175], v[64:67], v[24:27], 0
  s_setprio 3
  buffer_load_dwordx4 v[80:83], v1, s[8:11], s16 offen offset:0 sc1
  buffer_load_dwordx4 v[84:87], v1, s[8:11], s16 offen offset:1024 sc1
  s_setprio 0
  s_add_u32 s16, s16, 2048
  s_and_b32 s16, s16, 0x7fff
  s_or_b32 s16, s16, s15
  v_exp_f32 v144, v144
  v_exp_f32 v145, v145
  v_exp_f32 v146, v146
  v_exp_f32 v147, v147
  v_mfma_f32_32x32x16_bf16 v[240:255], v[104:107], v[184:187], v[240:255]
  v_exp_f32 v148, v148
  v_exp_f32 v149, v149
  v_exp_f32 v150, v150
  v_exp_f32 v151, v151
  v_cvt_pk_bf16_f32 v176, v144, v145
  v_cvt_pk_bf16_f32 v177, v146, v147
  v_mfma_f32_32x32x16_bf16 v[160:175], v[68:71], v[28:31], v[160:175]
  v_exp_f32 v152, v152
  v_exp_f32 v153, v153
  v_exp_f32 v154, v154
  v_exp_f32 v155, v155
  v_cvt_pk_bf16_f32 v178, v148, v149
  v_cvt_pk_bf16_f32 v179, v150, v151
  v_mfma_f32_32x32x16_bf16 v[240:255], v[108:111], v[188:191], v[240:255]
  v_exp_f32 v156, v156
  v_exp_f32 v157, v157
  v_exp_f32 v158, v158
  v_exp_f32 v159, v159
  v_cvt_pk_bf16_f32 v180, v152, v153
  v_cvt_pk_bf16_f32 v181, v154, v155
  v_cvt_pk_bf16_f32 v182, v156, v157
  v_cvt_pk_bf16_f32 v183, v158, v159
  v_mfma_f32_32x32x16_bf16 v[144:159], v[64:67], v[32:35], 0
  v_exp_f32 v160, v160
  v_exp_f32 v161, v161
  v_exp_f32 v162, v162
  v_exp_f32 v163, v163
  s_waitcnt vmcnt(6)
  v_mfma_f32_32x32x16_bf16 v[192:207], v[112:115], v[176:179], v[192:207]
  s_setprio 3
  buffer_load_dwordx4 v[128:131], v1, s[8:11], s17 offen offset:0 sc1
  buffer_load_dwordx4 v[132:135], v1, s[8:11], s17 offen offset:1024 sc1
  s_setprio 0
  s_add_u32 s17, s17, 2048
  s_and_b32 s17, s17, 0x7fff
  s_or_b32 s17, s17, s18
  v_exp_f32 v164, v164
  v_exp_f32 v165, v165
  v_exp_f32 v166, v166
  v_exp_f32 v167, v167
  v_cvt_pk_bf16_f32 v184, v160, v161
  v_cvt_pk_bf16_f32 v185, v162, v163
  v_mfma_f32_32x32x16_bf16 v[144:159], v[68:71], v[36:39], v[144:159]
  v_exp_f32 v168, v168
  v_exp_f32 v169, v169
  v_exp_f32 v170, v170
  v_exp_f32 v171, v171
  v_cvt_pk_bf16_f32 v186, v164, v165
  v_cvt_pk_bf16_f32 v187, v166, v167
  v_mfma_f32_32x32x16_bf16 v[192:207], v[116:119], v[180:183], v[192:207]
  v_exp_f32 v172, v172
  v_exp_f32 v173, v173
  v_exp_f32 v174, v174
  v_exp_f32 v175, v175
  v_cvt_pk_bf16_f32 v188, v168, v169
  v_cvt_pk_bf16_f32 v189, v170, v171
  v_cvt_pk_bf16_f32 v190, v172, v173
  v_cvt_pk_bf16_f32 v191, v174, v175
  v_mfma_f32_32x32x16_bf16 v[160:175], v[64:67], v[40:43], 0
  v_exp_f32 v144, v144
  v_exp_f32 v145, v145
  v_exp_f32 v146, v146
  v_exp_f32 v147, v147
  v_mfma_f32_32x32x16_bf16 v[208:223], v[112:115], v[184:187], v[208:223]
  v_exp_f32 v148, v148
  v_exp_f32 v149, v149
  v_exp_f32 v150, v150
  v_exp_f32 v151, v151
  v_cvt_pk_bf16_f32 v176, v144, v145
  v_cvt_pk_bf16_f32 v177, v146, v147
  v_mfma_f32_32x32x16_bf16 v[160:175], v[68:71], v[44:47], v[160:175]
  v_exp_f32 v152, v152
  v_exp_f32 v153, v153
  v_exp_f32 v154, v154
  v_exp_f32 v155, v155
  v_cvt_pk_bf16_f32 v178, v148, v149
  v_cvt_pk_bf16_f32 v179, v150, v151
  v_mfma_f32_32x32x16_bf16 v[208:223], v[116:119], v[188:191], v[208:223]
  v_exp_f32 v156, v156
  v_exp_f32 v157, v157
  v_exp_f32 v158, v158
  v_exp_f32 v159, v159
  v_cvt_pk_bf16_f32 v180, v152, v153
  v_cvt_pk_bf16_f32 v181, v154, v155
  v_cvt_pk_bf16_f32 v182, v156, v157
  v_cvt_pk_bf16_f32 v183, v158, v159
  s_waitcnt vmcnt(6)
  v_mfma_f32_32x32x16_bf16 v[144:159], v[72:75], v[16:19], 0
  v_exp_f32 v160, v160
  v_exp_f32 v161, v161
  v_exp_f32 v162, v162
  v_exp_f32 v163, v163
  v_mfma_f32_32x32x16_bf16 v[224:239], v[112:115], v[176:179], v[224:239]
  v_exp_f32 v164, v164
  v_exp_f32 v165, v165
  v_exp_f32 v166, v166
  v_exp_f32 v167, v167
  v_cvt_pk_bf16_f32 v184, v160, v161
  v_cvt_pk_bf16_f32 v185, v162, v163
  v_mfma_f32_32x32x16_bf16 v[144:159], v[76:79], v[20:23], v[144:159]
  v_exp_f32 v168, v168
  v_exp_f32 v169, v169
  v_exp_f32 v170, v170
  v_exp_f32 v171, v171
  v_cvt_pk_bf16_f32 v186, v164, v165
  v_cvt_pk_bf16_f32 v187, v166, v167
  v_mfma_f32_32x32x16_bf16 v[224:239], v[116:119], v[180:183], v[224:239]
  v_exp_f32 v172, v172
  v_exp_f32 v173, v173
  v_exp_f32 v174, v174
  v_exp_f32 v175, v175
  v_cvt_pk_bf16_f32 v188, v168, v169
  v_cvt_pk_bf16_f32 v189, v170, v171
  v_cvt_pk_bf16_f32 v190, v172, v173
  v_cvt_pk_bf16_f32 v191, v174, v175
  v_mfma_f32_32x32x16_bf16 v[160:175], v[72:75], v[24:27], 0
  s_setprio 3
  buffer_load_dwordx4 v[88:91], v1, s[8:11], s16 offen offset:0 sc1
  buffer_load_dwordx4 v[92:95], v1, s[8:11], s16 offen offset:1024 sc1
  s_setprio 0
  s_add_u32 s16, s16, 2048
  s_and_b32 s16, s16, 0x7fff
  s_or_b32 s16, s16, s15
  v_exp_f32 v144, v144
  v_exp_f32 v145, v145
  v_exp_f32 v146, v146
  v_exp_f32 v147, v147
  v_mfma_f32_32x32x16_bf16 v[240:255], v[112:115], v[184:187], v[240:255]
  v_exp_f32 v148, v148
  v_exp_f32 v149, v149
  v_exp_f32 v150, v150
  v_exp_f32 v151, v151
  v_cvt_pk_bf16_f32 v176, v144, v145
  v_cvt_pk_bf16_f32 v177, v146, v147
  v_mfma_f32_32x32x16_bf16 v[160:175], v[76:79], v[28:31], v[160:175]
  v_exp_f32 v152, v152
  v_exp_f32 v153, v153
  v_exp_f32 v154, v154
  v_exp_f32 v155, v155
  v_cvt_pk_bf16_f32 v178, v148, v149
  v_cvt_pk_bf16_f32 v179, v150, v151
  v_mfma_f32_32x32x16_bf16 v[240:255], v[116:119], v[188:191], v[240:255]
  v_exp_f32 v156, v156
  v_exp_f32 v157, v157
  v_exp_f32 v158, v158
  v_exp_f32 v159, v159
  v_cvt_pk_bf16_f32 v180, v152, v153
  v_cvt_pk_bf16_f32 v181, v154, v155
  v_cvt_pk_bf16_f32 v182, v156, v157
  v_cvt_pk_bf16_f32 v183, v158, v159
  v_mfma_f32_32x32x16_bf16 v[144:159], v[72:75], v[32:35], 0
  v_exp_f32 v160, v160
  v_exp_f32 v161, v161
  v_exp_f32 v162, v162
  v_exp_f32 v163, v163
  s_waitcnt vmcnt(6)
  v_mfma_f32_32x32x16_bf16 v[192:207], v[120:123], v[176:179], v[192:207]
  s_setprio 3
  buffer_load_dwordx4 v[136:139], v1, s[8:11], s17 offen offset:0 sc1
  buffer_load_dwordx4 v[140:143], v1, s[8:11], s17 offen offset:1024 sc1
  s_setprio 0
  s_add_u32 s17, s17, 2048
  s_and_b32 s17, s17, 0x7fff
  s_or_b32 s17, s17, s18
  v_exp_f32 v164, v164
  v_exp_f32 v165, v165
  v_exp_f32 v166, v166
  v_exp_f32 v167, v167
  v_cvt_pk_bf16_f32 v184, v160, v161
  v_cvt_pk_bf16_f32 v185, v162, v163
  v_mfma_f32_32x32x16_bf16 v[144:159], v[76:79], v[36:39], v[144:159]
  v_exp_f32 v168, v168
  v_exp_f32 v169, v169
  v_exp_f32 v170, v170
  v_exp_f32 v171, v171
  v_cvt_pk_bf16_f32 v186, v164, v165
  v_cvt_pk_bf16_f32 v187, v166, v167
  v_mfma_f32_32x32x16_bf16 v[192:207], v[124:127], v[180:183], v[192:207]
  v_exp_f32 v172, v172
  v_exp_f32 v173, v173
  v_exp_f32 v174, v174
  v_exp_f32 v175, v175
  v_cvt_pk_bf16_f32 v188, v168, v169
  v_cvt_pk_bf16_f32 v189, v170, v171
  v_cvt_pk_bf16_f32 v190, v172, v173
  v_cvt_pk_bf16_f32 v191, v174, v175
  v_mfma_f32_32x32x16_bf16 v[160:175], v[72:75], v[40:43], 0
  v_exp_f32 v144, v144
  v_exp_f32 v145, v145
  v_exp_f32 v146, v146
  v_exp_f32 v147, v147
  v_mfma_f32_32x32x16_bf16 v[208:223], v[120:123], v[184:187], v[208:223]
  v_exp_f32 v148, v148
  v_exp_f32 v149, v149
  v_exp_f32 v150, v150
  v_exp_f32 v151, v151
  v_cvt_pk_bf16_f32 v176, v144, v145
  v_cvt_pk_bf16_f32 v177, v146, v147
  v_mfma_f32_32x32x16_bf16 v[160:175], v[76:79], v[44:47], v[160:175]
  v_exp_f32 v152, v152
  v_exp_f32 v153, v153
  v_exp_f32 v154, v154
  v_exp_f32 v155, v155
  v_cvt_pk_bf16_f32 v178, v148, v149
  v_cvt_pk_bf16_f32 v179, v150, v151
  v_mfma_f32_32x32x16_bf16 v[208:223], v[124:127], v[188:191], v[208:223]
  v_exp_f32 v156, v156
  v_exp_f32 v157, v157
  v_exp_f32 v158, v158
  v_exp_f32 v159, v159
  v_cvt_pk_bf16_f32 v180, v152, v153
  v_cvt_pk_bf16_f32 v181, v154, v155
  v_cvt_pk_bf16_f32 v182, v156, v157
  v_cvt_pk_bf16_f32 v183, v158, v159
  s_waitcnt vmcnt(6)
  v_mfma_f32_32x32x16_bf16 v[144:159], v[80:83], v[16:19], 0
  v_exp_f32 v160, v160
  v_exp_f32 v161, v161
  v_exp_f32 v162, v162
  v_exp_f32 v163, v163
  v_mfma_f32_32x32x16_bf16 v[224:239], v[120:123], v[176:179], v[224:239]
  v_exp_f32 v164, v164
  v_exp_f32 v165, v165
  v_exp_f32 v166, v166
  v_exp_f32 v167, v167
  v_cvt_pk_bf16_f32 v184, v160, v161
  v_cvt_pk_bf16_f32 v185, v162, v163
  v_mfma_f32_32x32x16_bf16 v[144:159], v[84:87], v[20:23], v[144:159]
  v_exp_f32 v168, v168
  v_exp_f32 v169, v169
  v_exp_f32 v170, v170
  v_exp_f32 v171, v171
  v_cvt_pk_bf16_f32 v186, v164, v165
  v_cvt_pk_bf16_f32 v187, v166, v167
  v_mfma_f32_32x32x16_bf16 v[224:239], v[124:127], v[180:183], v[224:239]
  v_exp_f32 v172, v172
  v_exp_f32 v173, v173
  v_exp_f32 v174, v174
  v_exp_f32 v175, v175
  v_cvt_pk_bf16_f32 v188, v168, v169
  v_cvt_pk_bf16_f32 v189, v170, v171
  v_cvt_pk_bf16_f32 v190, v172, v173
  v_cvt_pk_bf16_f32 v191, v174, v175
  v_mfma_f32_32x32x16_bf16 v[160:175], v[80:83], v[24:27], 0
  s_setprio 3
  buffer_load_dwordx4 v[48:51], v1, s[8:11], s16 offen offset:0 sc1
  buffer_load_dwordx4 v[52:55], v1, s[8:11], s16 offen offset:1024 sc1
  s_setprio 0
  s_add_u32 s16, s16, 2048
  s_and_b32 s16, s16, 0x7fff
  s_or_b32 s16, s16, s15
  v_exp_f32 v144, v144
  v_exp_f32 v145, v145
  v_exp_f32 v146, v146
  v_exp_f32 v147, v147
  v_mfma_f32_32x32x16_bf16 v[240:255], v[120:123], v[184:187], v[240:255]
  v_exp_f32 v148, v148
  v_exp_f32 v149, v149
  v_exp_f32 v150, v150
  v_exp_f32 v151, v151
  v_cvt_pk_bf16_f32 v176, v144, v145
  v_cvt_pk_bf16_f32 v177, v146, v147
  v_mfma_f32_32x32x16_bf16 v[160:175], v[84:87], v[28:31], v[160:175]
  v_exp_f32 v152, v152
  v_exp_f32 v153, v153
  v_exp_f32 v154, v154
  v_exp_f32 v155, v155
  v_cvt_pk_bf16_f32 v178, v148, v149
  v_cvt_pk_bf16_f32 v179, v150, v151
  v_mfma_f32_32x32x16_bf16 v[240:255], v[124:127], v[188:191], v[240:255]
  v_exp_f32 v156, v156
  v_exp_f32 v157, v157
  v_exp_f32 v158, v158
  v_exp_f32 v159, v159
  v_cvt_pk_bf16_f32 v180, v152, v153
  v_cvt_pk_bf16_f32 v181, v154, v155
  v_cvt_pk_bf16_f32 v182, v156, v157
  v_cvt_pk_bf16_f32 v183, v158, v159
  v_mfma_f32_32x32x16_bf16 v[144:159], v[80:83], v[32:35], 0
  v_exp_f32 v160, v160
  v_exp_f32 v161, v161
  v_exp_f32 v162, v162
  v_exp_f32 v163, v163
  s_waitcnt vmcnt(6)
  v_mfma_f32_32x32x16_bf16 v[192:207], v[128:131], v[176:179], v[192:207]
  s_setprio 3
  buffer_load_dwordx4 v[96:99], v1, s[8:11], s17 offen offset:0 sc1
  buffer_load_dwordx4 v[100:103], v1, s[8:11], s17 offen offset:1024 sc1
  s_setprio 0
  s_add_u32 s17, s17, 2048
  s_and_b32 s17, s17, 0x7fff
  s_or_b32 s17, s17, s18
  v_exp_f32 v164, v164
  v_exp_f32 v165, v165
  v_exp_f32 v166, v166
  v_exp_f32 v167, v167
  v_cvt_pk_bf16_f32 v184, v160, v161
  v_cvt_pk_bf16_f32 v185, v162, v163
  v_mfma_f32_32x32x16_bf16 v[144:159], v[84:87], v[36:39], v[144:159]
  v_exp_f32 v168, v168
  v_exp_f32 v169, v169
  v_exp_f32 v170, v170
  v_exp_f32 v171, v171
  v_cvt_pk_bf16_f32 v186, v164, v165
  v_cvt_pk_bf16_f32 v187, v166, v167
  v_mfma_f32_32x32x16_bf16 v[192:207], v[132:135], v[180:183], v[192:207]
  v_exp_f32 v172, v172
  v_exp_f32 v173, v173
  v_exp_f32 v174, v174
  v_exp_f32 v175, v175
  v_cvt_pk_bf16_f32 v188, v168, v169
  v_cvt_pk_bf16_f32 v189, v170, v171
  v_cvt_pk_bf16_f32 v190, v172, v173
  v_cvt_pk_bf16_f32 v191, v174, v175
  v_mfma_f32_32x32x16_bf16 v[160:175], v[80:83], v[40:43], 0
  v_exp_f32 v144, v144
  v_exp_f32 v145, v145
  v_exp_f32 v146, v146
  v_exp_f32 v147, v147
  v_mfma_f32_32x32x16_bf16 v[208:223], v[128:131], v[184:187], v[208:223]
  v_exp_f32 v148, v148
  v_exp_f32 v149, v149
  v_exp_f32 v150, v150
  v_exp_f32 v151, v151
  v_cvt_pk_bf16_f32 v176, v144, v145
  v_cvt_pk_bf16_f32 v177, v146, v147
  v_mfma_f32_32x32x16_bf16 v[160:175], v[84:87], v[44:47], v[160:175]
  v_exp_f32 v152, v152
  v_exp_f32 v153, v153
  v_exp_f32 v154, v154
  v_exp_f32 v155, v155
  v_cvt_pk_bf16_f32 v178, v148, v149
  v_cvt_pk_bf16_f32 v179, v150, v151
  v_mfma_f32_32x32x16_bf16 v[208:223], v[132:135], v[188:191], v[208:223]
  v_exp_f32 v156, v156
  v_exp_f32 v157, v157
  v_exp_f32 v158, v158
  v_exp_f32 v159, v159
  v_cvt_pk_bf16_f32 v180, v152, v153
  v_cvt_pk_bf16_f32 v181, v154, v155
  v_cvt_pk_bf16_f32 v182, v156, v157
  v_cvt_pk_bf16_f32 v183, v158, v159
  s_waitcnt vmcnt(6)
  v_mfma_f32_32x32x16_bf16 v[144:159], v[88:91], v[16:19], 0
  v_exp_f32 v160, v160
  v_exp_f32 v161, v161
  v_exp_f32 v162, v162
  v_exp_f32 v163, v163
  v_mfma_f32_32x32x16_bf16 v[224:239], v[128:131], v[176:179], v[224:239]
  v_exp_f32 v164, v164
  v_exp_f32 v165, v165
  v_exp_f32 v166, v166
  v_exp_f32 v167, v167
  v_cvt_pk_bf16_f32 v184, v160, v161
  v_cvt_pk_bf16_f32 v185, v162, v163
  v_mfma_f32_32x32x16_bf16 v[144:159], v[92:95], v[20:23], v[144:159]
  v_exp_f32 v168, v168
  v_exp_f32 v169, v169
  v_exp_f32 v170, v170
  v_exp_f32 v171, v171
  v_cvt_pk_bf16_f32 v186, v164, v165
  v_cvt_pk_bf16_f32 v187, v166, v167
  v_mfma_f32_32x32x16_bf16 v[224:239], v[132:135], v[180:183], v[224:239]
  v_exp_f32 v172, v172
  v_exp_f32 v173, v173
  v_exp_f32 v174, v174
  v_exp_f32 v175, v175
  v_cvt_pk_bf16_f32 v188, v168, v169
  v_cvt_pk_bf16_f32 v189, v170, v171
  v_cvt_pk_bf16_f32 v190, v172, v173
  v_cvt_pk_bf16_f32 v191, v174, v175
  v_mfma_f32_32x32x16_bf16 v[160:175], v[88:91], v[24:27], 0
  s_setprio 3
  buffer_load_dwordx4 v[56:59], v1, s[8:11], s16 offen offset:0 sc1
  buffer_load_dwordx4 v[60:63], v1, s[8:11], s16 offen offset:1024 sc1
  s_setprio 0
  s_add_u32 s16, s16, 2048
  s_and_b32 s16, s16, 0x7fff
  s_or_b32 s16, s16, s15
  v_exp_f32 v144, v144
  v_exp_f32 v145, v145
  v_exp_f32 v146, v146
  v_exp_f32 v147, v147
  v_mfma_f32_32x32x16_bf16 v[240:255], v[128:131], v[184:187], v[240:255]
  v_exp_f32 v148, v148
  v_exp_f32 v149, v149
  v_exp_f32 v150, v150
  v_exp_f32 v151, v151
  v_cvt_pk_bf16_f32 v176, v144, v145
  v_cvt_pk_bf16_f32 v177, v146, v147
  v_mfma_f32_32x32x16_bf16 v[160:175], v[92:95], v[28:31], v[160:175]
  v_exp_f32 v152, v152
  v_exp_f32 v153, v153
  v_exp_f32 v154, v154
  v_exp_f32 v155, v155
  v_cvt_pk_bf16_f32 v178, v148, v149
  v_cvt_pk_bf16_f32 v179, v150, v151
  v_mfma_f32_32x32x16_bf16 v[240:255], v[132:135], v[188:191], v[240:255]
  v_exp_f32 v156, v156
  v_exp_f32 v157, v157
  v_exp_f32 v158, v158
  v_exp_f32 v159, v159
  v_cvt_pk_bf16_f32 v180, v152, v153
  v_cvt_pk_bf16_f32 v181, v154, v155
  v_cvt_pk_bf16_f32 v182, v156, v157
  v_cvt_pk_bf16_f32 v183, v158, v159
  v_mfma_f32_32x32x16_bf16 v[144:159], v[88:91], v[32:35], 0
  v_exp_f32 v160, v160
  v_exp_f32 v161, v161
  v_exp_f32 v162, v162
  v_exp_f32 v163, v163
  s_waitcnt vmcnt(6)
  v_mfma_f32_32x32x16_bf16 v[192:207], v[136:139], v[176:179], v[192:207]
  s_setprio 3
  buffer_load_dwordx4 v[104:107], v1, s[8:11], s17 offen offset:0 sc1
  buffer_load_dwordx4 v[108:111], v1, s[8:11], s17 offen offset:1024 sc1
  s_setprio 0
  s_add_u32 s17, s17, 2048
  s_and_b32 s17, s17, 0x7fff
  s_or_b32 s17, s17, s18
  v_exp_f32 v164, v164
  v_exp_f32 v165, v165
  v_exp_f32 v166, v166
  v_exp_f32 v167, v167
  v_cvt_pk_bf16_f32 v184, v160, v161
  v_cvt_pk_bf16_f32 v185, v162, v163
  v_mfma_f32_32x32x16_bf16 v[144:159], v[92:95], v[36:39], v[144:159]
  v_exp_f32 v168, v168
  v_exp_f32 v169, v169
  v_exp_f32 v170, v170
  v_exp_f32 v171, v171
  v_cvt_pk_bf16_f32 v186, v164, v165
  v_cvt_pk_bf16_f32 v187, v166, v167
  v_mfma_f32_32x32x16_bf16 v[192:207], v[140:143], v[180:183], v[192:207]
  v_exp_f32 v172, v172
  v_exp_f32 v173, v173
  v_exp_f32 v174, v174
  v_exp_f32 v175, v175
  v_cvt_pk_bf16_f32 v188, v168, v169
  v_cvt_pk_bf16_f32 v189, v170, v171
  v_cvt_pk_bf16_f32 v190, v172, v173
  v_cvt_pk_bf16_f32 v191, v174, v175
  v_mfma_f32_32x32x16_bf16 v[160:175], v[88:91], v[40:43], 0
  v_exp_f32 v144, v144
  v_exp_f32 v145, v145
  v_exp_f32 v146, v146
  v_exp_f32 v147, v147
  v_mfma_f32_32x32x16_bf16 v[208:223], v[136:139], v[184:187], v[208:223]
  v_exp_f32 v148, v148
  v_exp_f32 v149, v149
  v_exp_f32 v150, v150
  v_exp_f32 v151, v151
  v_cvt_pk_bf16_f32 v176, v144, v145
  v_cvt_pk_bf16_f32 v177, v146, v147
  v_mfma_f32_32x32x16_bf16 v[160:175], v[92:95], v[44:47], v[160:175]
  v_exp_f32 v152, v152
  v_exp_f32 v153, v153
  v_exp_f32 v154, v154
  v_exp_f32 v155, v155
  v_cvt_pk_bf16_f32 v178, v148, v149
  v_cvt_pk_bf16_f32 v179, v150, v151
  v_mfma_f32_32x32x16_bf16 v[208:223], v[140:143], v[188:191], v[208:223]
  v_exp_f32 v156, v156
  v_exp_f32 v157, v157
  v_exp_f32 v158, v158
  v_exp_f32 v159, v159
  v_cvt_pk_bf16_f32 v180, v152, v153
  v_cvt_pk_bf16_f32 v181, v154, v155
  v_cvt_pk_bf16_f32 v182, v156, v157
  v_cvt_pk_bf16_f32 v183, v158, v159
  s_waitcnt vmcnt(6)
  v_mfma_f32_32x32x16_bf16 v[144:159], v[48:51], v[16:19], 0
  v_exp_f32 v160, v160
  v_exp_f32 v161, v161
  v_exp_f32 v162, v162
  v_exp_f32 v163, v163
  v_mfma_f32_32x32x16_bf16 v[224:239], v[136:139], v[176:179], v[224:239]
  v_exp_f32 v164, v164
  v_exp_f32 v165, v165
  v_exp_f32 v166, v166
  v_exp_f32 v167, v167
  v_cvt_pk_bf16_f32 v184, v160, v161
  v_cvt_pk_bf16_f32 v185, v162, v163
  v_mfma_f32_32x32x16_bf16 v[144:159], v[52:55], v[20:23], v[144:159]
  v_exp_f32 v168, v168
  v_exp_f32 v169, v169
  v_exp_f32 v170, v170
  v_exp_f32 v171, v171
  v_cvt_pk_bf16_f32 v186, v164, v165
  v_cvt_pk_bf16_f32 v187, v166, v167
  v_mfma_f32_32x32x16_bf16 v[224:239], v[140:143], v[180:183], v[224:239]
  v_exp_f32 v172, v172
  v_exp_f32 v173, v173
  v_exp_f32 v174, v174
  v_exp_f32 v175, v175
  v_cvt_pk_bf16_f32 v188, v168, v169
  v_cvt_pk_bf16_f32 v189, v170, v171
  v_cvt_pk_bf16_f32 v190, v172, v173
  v_cvt_pk_bf16_f32 v191, v174, v175
  v_mfma_f32_32x32x16_bf16 v[160:175], v[48:51], v[24:27], 0
  s_setprio 3
  buffer_load_dwordx4 v[64:67], v1, s[8:11], s16 offen offset:0 sc1
  buffer_load_dwordx4 v[68:71], v1, s[8:11], s16 offen offset:1024 sc1
  s_setprio 0
  s_add_u32 s16, s16, 2048
  s_and_b32 s16, s16, 0x7fff
  s_or_b32 s16, s16, s15
  v_exp_f32 v144, v144
  v_exp_f32 v145, v145
  v_exp_f32 v146, v146
  v_exp_f32 v147, v147
  v_mfma_f32_32x32x16_bf16 v[240:255], v[136:139], v[184:187], v[240:255]
  v_exp_f32 v148, v148
  v_exp_f32 v149, v149
  v_exp_f32 v150, v150
  v_exp_f32 v151, v151
  v_cvt_pk_bf16_f32 v176, v144, v145
  v_cvt_pk_bf16_f32 v177, v146, v147
  v_mfma_f32_32x32x16_bf16 v[160:175], v[52:55], v[28:31], v[160:175]
  v_exp_f32 v152, v152
  v_exp_f32 v153, v153
  v_exp_f32 v154, v154
  v_exp_f32 v155, v155
  v_cvt_pk_bf16_f32 v178, v148, v149
  v_cvt_pk_bf16_f32 v179, v150, v151
  v_mfma_f32_32x32x16_bf16 v[240:255], v[140:143], v[188:191], v[240:255]
  v_exp_f32 v156, v156
  v_exp_f32 v157, v157
  v_exp_f32 v158, v158
  v_exp_f32 v159, v159
  v_cvt_pk_bf16_f32 v180, v152, v153
  v_cvt_pk_bf16_f32 v181, v154, v155
  v_cvt_pk_bf16_f32 v182, v156, v157
  v_cvt_pk_bf16_f32 v183, v158, v159
  v_mfma_f32_32x32x16_bf16 v[144:159], v[48:51], v[32:35], 0
  v_exp_f32 v160, v160
  v_exp_f32 v161, v161
  v_exp_f32 v162, v162
  v_exp_f32 v163, v163
  s_waitcnt vmcnt(6)
  v_mfma_f32_32x32x16_bf16 v[192:207], v[96:99], v[176:179], v[192:207]
  s_setprio 3
  buffer_load_dwordx4 v[112:115], v1, s[8:11], s17 offen offset:0 sc1
  buffer_load_dwordx4 v[116:119], v1, s[8:11], s17 offen offset:1024 sc1
  s_setprio 0
  s_add_u32 s17, s17, 2048
  s_and_b32 s17, s17, 0x7fff
  s_or_b32 s17, s17, s18
  v_exp_f32 v164, v164
  v_exp_f32 v165, v165
  v_exp_f32 v166, v166
  v_exp_f32 v167, v167
  v_cvt_pk_bf16_f32 v184, v160, v161
  v_cvt_pk_bf16_f32 v185, v162, v163
  v_mfma_f32_32x32x16_bf16 v[144:159], v[52:55], v[36:39], v[144:159]
  v_exp_f32 v168, v168
  v_exp_f32 v169, v169
  v_exp_f32 v170, v170
  v_exp_f32 v171, v171
  v_cvt_pk_bf16_f32 v186, v164, v165
  v_cvt_pk_bf16_f32 v187, v166, v167
  v_mfma_f32_32x32x16_bf16 v[192:207], v[100:103], v[180:183], v[192:207]
  v_exp_f32 v172, v172
  v_exp_f32 v173, v173
  v_exp_f32 v174, v174
  v_exp_f32 v175, v175
  v_cvt_pk_bf16_f32 v188, v168, v169
  v_cvt_pk_bf16_f32 v189, v170, v171
  v_cvt_pk_bf16_f32 v190, v172, v173
  v_cvt_pk_bf16_f32 v191, v174, v175
  v_mfma_f32_32x32x16_bf16 v[160:175], v[48:51], v[40:43], 0
  v_exp_f32 v144, v144
  v_exp_f32 v145, v145
  v_exp_f32 v146, v146
  v_exp_f32 v147, v147
  v_mfma_f32_32x32x16_bf16 v[208:223], v[96:99], v[184:187], v[208:223]
  v_exp_f32 v148, v148
  v_exp_f32 v149, v149
  v_exp_f32 v150, v150
  v_exp_f32 v151, v151
  v_cvt_pk_bf16_f32 v176, v144, v145
  v_cvt_pk_bf16_f32 v177, v146, v147
  v_mfma_f32_32x32x16_bf16 v[160:175], v[52:55], v[44:47], v[160:175]
  v_exp_f32 v152, v152
  v_exp_f32 v153, v153
  v_exp_f32 v154, v154
  v_exp_f32 v155, v155
  v_cvt_pk_bf16_f32 v178, v148, v149
  v_cvt_pk_bf16_f32 v179, v150, v151
  v_mfma_f32_32x32x16_bf16 v[208:223], v[100:103], v[188:191], v[208:223]
  v_exp_f32 v156, v156
  v_exp_f32 v157, v157
  v_exp_f32 v158, v158
  v_exp_f32 v159, v159
  v_cvt_pk_bf16_f32 v180, v152, v153
  v_cvt_pk_bf16_f32 v181, v154, v155
  v_cvt_pk_bf16_f32 v182, v156, v157
  v_cvt_pk_bf16_f32 v183, v158, v159
  s_waitcnt vmcnt(6)
  v_mfma_f32_32x32x16_bf16 v[144:159], v[56:59], v[16:19], 0
  v_exp_f32 v160, v160
  v_exp_f32 v161, v161
  v_exp_f32 v162, v162
  v_exp_f32 v163, v163
  v_mfma_f32_32x32x16_bf16 v[224:239], v[96:99], v[176:179], v[224:239]
  v_exp_f32 v164, v164
  v_exp_f32 v165, v165
  v_exp_f32 v166, v166
  v_exp_f32 v167, v167
  v_cvt_pk_bf16_f32 v184, v160, v161
  v_cvt_pk_bf16_f32 v185, v162, v163
  v_mfma_f32_32x32x16_bf16 v[144:159], v[60:63], v[20:23], v[144:159]
  v_exp_f32 v168, v168
  v_exp_f32 v169, v169
  v_exp_f32 v170, v170
  v_exp_f32 v171, v171
  v_cvt_pk_bf16_f32 v186, v164, v165
  v_cvt_pk_bf16_f32 v187, v166, v167
  v_mfma_f32_32x32x16_bf16 v[224:239], v[100:103], v[180:183], v[224:239]
  v_exp_f32 v172, v172
  v_exp_f32 v173, v173
  v_exp_f32 v174, v174
  v_exp_f32 v175, v175
  v_cvt_pk_bf16_f32 v188, v168, v169
  v_cvt_pk_bf16_f32 v189, v170, v171
  v_cvt_pk_bf16_f32 v190, v172, v173
  v_cvt_pk_bf16_f32 v191, v174, v175
  v_mfma_f32_32x32x16_bf16 v[160:175], v[56:59], v[24:27], 0
  s_setprio 3
  buffer_load_dwordx4 v[72:75], v1, s[8:11], s16 offen offset:0 sc1
  buffer_load_dwordx4 v[76:79], v1, s[8:11], s16 offen offset:1024 sc1
  s_setprio 0
  s_add_u32 s16, s16, 2048
  s_and_b32 s16, s16, 0x7fff
  s_or_b32 s16, s16, s15
  v_exp_f32 v144, v144
  v_exp_f32 v145, v145
  v_exp_f32 v146, v146
  v_exp_f32 v147, v147
  v_mfma_f32_32x32x16_bf16 v[240:255], v[96:99], v[184:187], v[240:255]
  v_exp_f32 v148, v148
  v_exp_f32 v149, v149
  v_exp_f32 v150, v150
  v_exp_f32 v151, v151
  v_cvt_pk_bf16_f32 v176, v144, v145
  v_cvt_pk_bf16_f32 v177, v146, v147
  v_mfma_f32_32x32x16_bf16 v[160:175], v[60:63], v[28:31], v[160:175]
  v_exp_f32 v152, v152
  v_exp_f32 v153, v153
  v_exp_f32 v154, v154
  v_exp_f32 v155, v155
  v_cvt_pk_bf16_f32 v178, v148, v149
  v_cvt_pk_bf16_f32 v179, v150, v151
  v_mfma_f32_32x32x16_bf16 v[240:255], v[100:103], v[188:191], v[240:255]
  v_exp_f32 v156, v156
  v_exp_f32 v157, v157
  v_exp_f32 v158, v158
  v_exp_f32 v159, v159
  v_cvt_pk_bf16_f32 v180, v152, v153
  v_cvt_pk_bf16_f32 v181, v154, v155
  v_cvt_pk_bf16_f32 v182, v156, v157
  v_cvt_pk_bf16_f32 v183, v158, v159
  v_mfma_f32_32x32x16_bf16 v[144:159], v[56:59], v[32:35], 0
  v_exp_f32 v160, v160
  v_exp_f32 v161, v161
  v_exp_f32 v162, v162
  v_exp_f32 v163, v163
  s_waitcnt vmcnt(6)
  v_mfma_f32_32x32x16_bf16 v[192:207], v[104:107], v[176:179], v[192:207]
  s_setprio 3
  buffer_load_dwordx4 v[120:123], v1, s[8:11], s17 offen offset:0 sc1
  buffer_load_dwordx4 v[124:127], v1, s[8:11], s17 offen offset:1024 sc1
  s_setprio 0
  s_add_u32 s17, s17, 2048
  s_and_b32 s17, s17, 0x7fff
  s_or_b32 s17, s17, s18
  v_exp_f32 v164, v164
  v_exp_f32 v165, v165
  v_exp_f32 v166, v166
  v_exp_f32 v167, v167
  v_cvt_pk_bf16_f32 v184, v160, v161
  v_cvt_pk_bf16_f32 v185, v162, v163
  v_mfma_f32_32x32x16_bf16 v[144:159], v[60:63], v[36:39], v[144:159]
  v_exp_f32 v168, v168
  v_exp_f32 v169, v169
  v_exp_f32 v170, v170
  v_exp_f32 v171, v171
  v_cvt_pk_bf16_f32 v186, v164, v165
  v_cvt_pk_bf16_f32 v187, v166, v167
  v_mfma_f32_32x32x16_bf16 v[192:207], v[108:111], v[180:183], v[192:207]
  v_exp_f32 v172, v172
  v_exp_f32 v173, v173
  v_exp_f32 v174, v174
  v_exp_f32 v175, v175
  v_cvt_pk_bf16_f32 v188, v168, v169
  v_cvt_pk_bf16_f32 v189, v170, v171
  v_cvt_pk_bf16_f32 v190, v172, v173
  v_cvt_pk_bf16_f32 v191, v174, v175
  v_mfma_f32_32x32x16_bf16 v[160:175], v[56:59], v[40:43], 0
  v_exp_f32 v144, v144
  v_exp_f32 v145, v145
  v_exp_f32 v146, v146
  v_exp_f32 v147, v147
  v_mfma_f32_32x32x16_bf16 v[208:223], v[104:107], v[184:187], v[208:223]
  v_exp_f32 v148, v148
  v_exp_f32 v149, v149
  v_exp_f32 v150, v150
  v_exp_f32 v151, v151
  v_cvt_pk_bf16_f32 v176, v144, v145
  v_cvt_pk_bf16_f32 v177, v146, v147
  v_mfma_f32_32x32x16_bf16 v[160:175], v[60:63], v[44:47], v[160:175]
  v_exp_f32 v152, v152
  v_exp_f32 v153, v153
  v_exp_f32 v154, v154
  v_exp_f32 v155, v155
  v_cvt_pk_bf16_f32 v178, v148, v149
  v_cvt_pk_bf16_f32 v179, v150, v151
  v_mfma_f32_32x32x16_bf16 v[208:223], v[108:111], v[188:191], v[208:223]
  v_exp_f32 v156, v156
  v_exp_f32 v157, v157
  v_exp_f32 v158, v158
  v_exp_f32 v159, v159
  v_cvt_pk_bf16_f32 v180, v152, v153
  v_cvt_pk_bf16_f32 v181, v154, v155
  v_cvt_pk_bf16_f32 v182, v156, v157
  v_cvt_pk_bf16_f32 v183, v158, v159
  s_waitcnt vmcnt(6)
  v_mfma_f32_32x32x16_bf16 v[144:159], v[64:67], v[16:19], 0
  v_exp_f32 v160, v160
  v_exp_f32 v161, v161
  v_exp_f32 v162, v162
  v_exp_f32 v163, v163
  v_mfma_f32_32x32x16_bf16 v[224:239], v[104:107], v[176:179], v[224:239]
  v_exp_f32 v164, v164
  v_exp_f32 v165, v165
  v_exp_f32 v166, v166
  v_exp_f32 v167, v167
  v_cvt_pk_bf16_f32 v184, v160, v161
  v_cvt_pk_bf16_f32 v185, v162, v163
  v_mfma_f32_32x32x16_bf16 v[144:159], v[68:71], v[20:23], v[144:159]
  v_exp_f32 v168, v168
  v_exp_f32 v169, v169
  v_exp_f32 v170, v170
  v_exp_f32 v171, v171
  v_cvt_pk_bf16_f32 v186, v164, v165
  v_cvt_pk_bf16_f32 v187, v166, v167
  v_mfma_f32_32x32x16_bf16 v[224:239], v[108:111], v[180:183], v[224:239]
  v_exp_f32 v172, v172
  v_exp_f32 v173, v173
  v_exp_f32 v174, v174
  v_exp_f32 v175, v175
  v_cvt_pk_bf16_f32 v188, v168, v169
  v_cvt_pk_bf16_f32 v189, v170, v171
  v_cvt_pk_bf16_f32 v190, v172, v173
  v_cvt_pk_bf16_f32 v191, v174, v175
  v_mfma_f32_32x32x16_bf16 v[160:175], v[64:67], v[24:27], 0
  v_exp_f32 v144, v144
  v_exp_f32 v145, v145
  v_exp_f32 v146, v146
  v_exp_f32 v147, v147
  v_mfma_f32_32x32x16_bf16 v[240:255], v[104:107], v[184:187], v[240:255]
  v_exp_f32 v148, v148
  v_exp_f32 v149, v149
  v_exp_f32 v150, v150
  v_exp_f32 v151, v151
  v_cvt_pk_bf16_f32 v176, v144, v145
  v_cvt_pk_bf16_f32 v177, v146, v147
  v_mfma_f32_32x32x16_bf16 v[160:175], v[68:71], v[28:31], v[160:175]
  v_exp_f32 v152, v152
  v_exp_f32 v153, v153
  v_exp_f32 v154, v154
  v_exp_f32 v155, v155
  v_cvt_pk_bf16_f32 v178, v148, v149
  v_cvt_pk_bf16_f32 v179, v150, v151
  v_mfma_f32_32x32x16_bf16 v[240:255], v[108:111], v[188:191], v[240:255]
  v_exp_f32 v156, v156
  v_exp_f32 v157, v157
  v_exp_f32 v158, v158
  v_exp_f32 v159, v159
  v_cvt_pk_bf16_f32 v180, v152, v153
  v_cvt_pk_bf16_f32 v181, v154, v155
  v_cvt_pk_bf16_f32 v182, v156, v157
  v_cvt_pk_bf16_f32 v183, v158, v159
  v_mfma_f32_32x32x16_bf16 v[144:159], v[64:67], v[32:35], 0
  v_exp_f32 v160, v160
  v_exp_f32 v161, v161
  v_exp_f32 v162, v162
  v_exp_f32 v163, v163
  s_waitcnt vmcnt(4)
  v_mfma_f32_32x32x16_bf16 v[192:207], v[112:115], v[176:179], v[192:207]
  v_exp_f32 v164, v164
  v_exp_f32 v165, v165
  v_exp_f32 v166, v166
  v_exp_f32 v167, v167
  v_cvt_pk_bf16_f32 v184, v160, v161
  v_cvt_pk_bf16_f32 v185, v162, v163
  v_mfma_f32_32x32x16_bf16 v[144:159], v[68:71], v[36:39], v[144:159]
  v_exp_f32 v168, v168
  v_exp_f32 v169, v169
  v_exp_f32 v170, v170
  v_exp_f32 v171, v171
  v_cvt_pk_bf16_f32 v186, v164, v165
  v_cvt_pk_bf16_f32 v187, v166, v167
  v_mfma_f32_32x32x16_bf16 v[192:207], v[116:119], v[180:183], v[192:207]
  v_exp_f32 v172, v172
  v_exp_f32 v173, v173
  v_exp_f32 v174, v174
  v_exp_f32 v175, v175
  v_cvt_pk_bf16_f32 v188, v168, v169
  v_cvt_pk_bf16_f32 v189, v170, v171
  v_cvt_pk_bf16_f32 v190, v172, v173
  v_cvt_pk_bf16_f32 v191, v174, v175
  v_mfma_f32_32x32x16_bf16 v[160:175], v[64:67], v[40:43], 0
  v_exp_f32 v144, v144
  v_exp_f32 v145, v145
  v_exp_f32 v146, v146
  v_exp_f32 v147, v147
  v_mfma_f32_32x32x16_bf16 v[208:223], v[112:115], v[184:187], v[208:223]
  v_exp_f32 v148, v148
  v_exp_f32 v149, v149
  v_exp_f32 v150, v150
  v_exp_f32 v151, v151
  v_cvt_pk_bf16_f32 v176, v144, v145
  v_cvt_pk_bf16_f32 v177, v146, v147
  v_mfma_f32_32x32x16_bf16 v[160:175], v[68:71], v[44:47], v[160:175]
  v_exp_f32 v152, v152
  v_exp_f32 v153, v153
  v_exp_f32 v154, v154
  v_exp_f32 v155, v155
  v_cvt_pk_bf16_f32 v178, v148, v149
  v_cvt_pk_bf16_f32 v179, v150, v151
  v_mfma_f32_32x32x16_bf16 v[208:223], v[116:119], v[188:191], v[208:223]
  v_exp_f32 v156, v156
  v_exp_f32 v157, v157
  v_exp_f32 v158, v158
  v_exp_f32 v159, v159
  v_cvt_pk_bf16_f32 v180, v152, v153
  v_cvt_pk_bf16_f32 v181, v154, v155
  v_cvt_pk_bf16_f32 v182, v156, v157
  v_cvt_pk_bf16_f32 v183, v158, v159
  s_waitcnt vmcnt(2)
  v_mfma_f32_32x32x16_bf16 v[144:159], v[72:75], v[16:19], 0
  v_exp_f32 v160, v160
  v_exp_f32 v161, v161
  v_exp_f32 v162, v162
  v_exp_f32 v163, v163
  v_mfma_f32_32x32x16_bf16 v[224:239], v[112:115], v[176:179], v[224:239]
  v_exp_f32 v164, v164
  v_exp_f32 v165, v165
  v_exp_f32 v166, v166
  v_exp_f32 v167, v167
  v_cvt_pk_bf16_f32 v184, v160, v161
  v_cvt_pk_bf16_f32 v185, v162, v163
  v_mfma_f32_32x32x16_bf16 v[144:159], v[76:79], v[20:23], v[144:159]
  v_exp_f32 v168, v168
  v_exp_f32 v169, v169
  v_exp_f32 v170, v170
  v_exp_f32 v171, v171
  v_cvt_pk_bf16_f32 v186, v164, v165
  v_cvt_pk_bf16_f32 v187, v166, v167
  v_mfma_f32_32x32x16_bf16 v[224:239], v[116:119], v[180:183], v[224:239]
  v_exp_f32 v172, v172
  v_exp_f32 v173, v173
  v_exp_f32 v174, v174
  v_exp_f32 v175, v175
  v_cvt_pk_bf16_f32 v188, v168, v169
  v_cvt_pk_bf16_f32 v189, v170, v171
  v_cvt_pk_bf16_f32 v190, v172, v173
  v_cvt_pk_bf16_f32 v191, v174, v175
  v_mfma_f32_32x32x16_bf16 v[160:175], v[72:75], v[24:27], 0
  v_exp_f32 v144, v144
  v_exp_f32 v145, v145
  v_exp_f32 v146, v146
  v_exp_f32 v147, v147
  v_mfma_f32_32x32x16_bf16 v[240:255], v[112:115], v[184:187], v[240:255]
  v_exp_f32 v148, v148
  v_exp_f32 v149, v149
  v_exp_f32 v150, v150
  v_exp_f32 v151, v151
  v_cvt_pk_bf16_f32 v176, v144, v145
  v_cvt_pk_bf16_f32 v177, v146, v147
  v_mfma_f32_32x32x16_bf16 v[160:175], v[76:79], v[28:31], v[160:175]
  v_exp_f32 v152, v152
  v_exp_f32 v153, v153
  v_exp_f32 v154, v154
  v_exp_f32 v155, v155
  v_cvt_pk_bf16_f32 v178, v148, v149
  v_cvt_pk_bf16_f32 v179, v150, v151
  v_mfma_f32_32x32x16_bf16 v[240:255], v[116:119], v[188:191], v[240:255]
  v_exp_f32 v156, v156
  v_exp_f32 v157, v157
  v_exp_f32 v158, v158
  v_exp_f32 v159, v159
  v_cvt_pk_bf16_f32 v180, v152, v153
  v_cvt_pk_bf16_f32 v181, v154, v155
  v_cvt_pk_bf16_f32 v182, v156, v157
  v_cvt_pk_bf16_f32 v183, v158, v159
  v_mfma_f32_32x32x16_bf16 v[144:159], v[72:75], v[32:35], 0
  v_exp_f32 v160, v160
  v_exp_f32 v161, v161
  v_exp_f32 v162, v162
  v_exp_f32 v163, v163
  s_waitcnt vmcnt(0)
  v_mfma_f32_32x32x16_bf16 v[192:207], v[120:123], v[176:179], v[192:207]
  v_exp_f32 v164, v164
  v_exp_f32 v165, v165
  v_exp_f32 v166, v166
  v_exp_f32 v167, v167
  v_cvt_pk_bf16_f32 v184, v160, v161
  v_cvt_pk_bf16_f32 v185, v162, v163
  v_mfma_f32_32x32x16_bf16 v[144:159], v[76:79], v[36:39], v[144:159]
  v_exp_f32 v168, v168
  v_exp_f32 v169, v169
  v_exp_f32 v170, v170
  v_exp_f32 v171, v171
  v_cvt_pk_bf16_f32 v186, v164, v165
  v_cvt_pk_bf16_f32 v187, v166, v167
  v_mfma_f32_32x32x16_bf16 v[192:207], v[124:127], v[180:183], v[192:207]
  v_exp_f32 v172, v172
  v_exp_f32 v173, v173
  v_exp_f32 v174, v174
  v_exp_f32 v175, v175
  v_cvt_pk_bf16_f32 v188, v168, v169
  v_cvt_pk_bf16_f32 v189, v170, v171
  v_cvt_pk_bf16_f32 v190, v172, v173
  v_cvt_pk_bf16_f32 v191, v174, v175
  v_mfma_f32_32x32x16_bf16 v[160:175], v[72:75], v[40:43], 0
  v_exp_f32 v144, v144
  v_exp_f32 v145, v145
  v_exp_f32 v146, v146
  v_exp_f32 v147, v147
  v_mfma_f32_32x32x16_bf16 v[208:223], v[120:123], v[184:187], v[208:223]
  v_exp_f32 v148, v148
  v_exp_f32 v149, v149
  v_exp_f32 v150, v150
  v_exp_f32 v151, v151
  v_cvt_pk_bf16_f32 v176, v144, v145
  v_cvt_pk_bf16_f32 v177, v146, v147
  v_mfma_f32_32x32x16_bf16 v[160:175], v[76:79], v[44:47], v[160:175]
  v_exp_f32 v152, v152
  v_exp_f32 v153, v153
  v_exp_f32 v154, v154
  v_exp_f32 v155, v155
  v_cvt_pk_bf16_f32 v178, v148, v149
  v_cvt_pk_bf16_f32 v179, v150, v151
  v_mfma_f32_32x32x16_bf16 v[208:223], v[124:127], v[188:191], v[208:223]
  v_exp_f32 v156, v156
  v_exp_f32 v157, v157
  v_exp_f32 v158, v158
  v_exp_f32 v159, v159
  v_cvt_pk_bf16_f32 v180, v152, v153
  v_cvt_pk_bf16_f32 v181, v154, v155
  v_cvt_pk_bf16_f32 v182, v156, v157
  v_cvt_pk_bf16_f32 v183, v158, v159
  v_exp_f32 v160, v160
  v_exp_f32 v161, v161
  v_exp_f32 v162, v162
  v_exp_f32 v163, v163
  v_mfma_f32_32x32x16_bf16 v[224:239], v[120:123], v[176:179], v[224:239]
  v_exp_f32 v164, v164
  v_exp_f32 v165, v165
  v_exp_f32 v166, v166
  v_exp_f32 v167, v167
  v_cvt_pk_bf16_f32 v184, v160, v161
  v_cvt_pk_bf16_f32 v185, v162, v163
  v_exp_f32 v168, v168
  v_exp_f32 v169, v169
  v_exp_f32 v170, v170
  v_exp_f32 v171, v171
  v_cvt_pk_bf16_f32 v186, v164, v165
  v_cvt_pk_bf16_f32 v187, v166, v167
  v_mfma_f32_32x32x16_bf16 v[224:239], v[124:127], v[180:183], v[224:239]
  v_exp_f32 v172, v172
  v_exp_f32 v173, v173
  v_exp_f32 v174, v174
  v_exp_f32 v175, v175
  v_cvt_pk_bf16_f32 v188, v168, v169
  v_cvt_pk_bf16_f32 v189, v170, v171
  v_cvt_pk_bf16_f32 v190, v172, v173
  v_cvt_pk_bf16_f32 v191, v174, v175
  s_branch parallel_sum__softmax_full_mha__mixer_s_mlp__prompt_kernel_are
parallel_sum__softmax_full_mha__mixer_s_mlp__prompt_kernel_astart:
  s_add_u32 s18, s15, 2097152
  s_lshl_b32 s16, s13, 11
  s_or_b32 s17, s16, s18
  s_or_b32 s16, s16, s15
  buffer_load_dwordx4 v[48:51], v1, s[8:11], s16 offen offset:0 sc1
  buffer_load_dwordx4 v[52:55], v1, s[8:11], s16 offen offset:1024 sc1
  s_add_u32 s16, s16, 2048
  s_and_b32 s16, s16, 0x7fff
  s_or_b32 s16, s16, s15
  buffer_load_dwordx4 v[96:99], v1, s[8:11], s17 offen offset:0 sc1
  buffer_load_dwordx4 v[100:103], v1, s[8:11], s17 offen offset:1024 sc1
  s_add_u32 s17, s17, 2048
  s_and_b32 s17, s17, 0x7fff
  s_or_b32 s17, s17, s18
  buffer_load_dwordx4 v[56:59], v1, s[8:11], s16 offen offset:0 sc1
  buffer_load_dwordx4 v[60:63], v1, s[8:11], s16 offen offset:1024 sc1
  s_add_u32 s16, s16, 2048
  s_and_b32 s16, s16, 0x7fff
  s_or_b32 s16, s16, s15
  buffer_load_dwordx4 v[104:107], v1, s[8:11], s17 offen offset:0 sc1
  buffer_load_dwordx4 v[108:111], v1, s[8:11], s17 offen offset:1024 sc1
  s_add_u32 s17, s17, 2048
  s_and_b32 s17, s17, 0x7fff
  s_or_b32 s17, s17, s18
  s_setprio 0
  v_mov_b32 v192, 0
  v_mov_b32 v193, 0
  v_mov_b32 v194, 0
  v_mov_b32 v195, 0
  v_mov_b32 v196, 0
  v_mov_b32 v197, 0
  v_mov_b32 v198, 0
  v_mov_b32 v199, 0
  v_mov_b32 v200, 0
  v_mov_b32 v201, 0
  v_mov_b32 v202, 0
  v_mov_b32 v203, 0
  v_mov_b32 v204, 0
  v_mov_b32 v205, 0
  v_mov_b32 v206, 0
  v_mov_b32 v207, 0
  v_mov_b32 v208, 0
  v_mov_b32 v209, 0
  v_mov_b32 v210, 0
  v_mov_b32 v211, 0
  v_mov_b32 v212, 0
  v_mov_b32 v213, 0
  v_mov_b32 v214, 0
  v_mov_b32 v215, 0
  v_mov_b32 v216, 0
  v_mov_b32 v217, 0
  v_mov_b32 v218, 0
  v_mov_b32 v219, 0
  v_mov_b32 v220, 0
  v_mov_b32 v221, 0
  v_mov_b32 v222, 0
  v_mov_b32 v223, 0
  v_mov_b32 v224, 0
  v_mov_b32 v225, 0
  v_mov_b32 v226, 0
  v_mov_b32 v227, 0
  v_mov_b32 v228, 0
  v_mov_b32 v229, 0
  v_mov_b32 v230, 0
  v_mov_b32 v231, 0
  v_mov_b32 v232, 0
  v_mov_b32 v233, 0
  v_mov_b32 v234, 0
  v_mov_b32 v235, 0
  v_mov_b32 v236, 0
  v_mov_b32 v237, 0
  v_mov_b32 v238, 0
  v_mov_b32 v239, 0
  v_mov_b32 v240, 0
  v_mov_b32 v241, 0
  v_mov_b32 v242, 0
  v_mov_b32 v243, 0
  v_mov_b32 v244, 0
  v_mov_b32 v245, 0
  v_mov_b32 v246, 0
  v_mov_b32 v247, 0
  v_mov_b32 v248, 0
  v_mov_b32 v249, 0
  v_mov_b32 v250, 0
  v_mov_b32 v251, 0
  v_mov_b32 v252, 0
  v_mov_b32 v253, 0
  v_mov_b32 v254, 0
  v_mov_b32 v255, 0
  s_waitcnt vmcnt(6)
  v_mfma_f32_32x32x16_bf16 v[144:159], v[48:51], v[16:19], 0
  v_mfma_f32_32x32x16_bf16 v[144:159], v[52:55], v[20:23], v[144:159]
  s_nop 7
  s_nop 3
  v_mfma_f32_32x32x16_bf16 v[160:175], v[48:51], v[24:27], 0
  s_setprio 3
  buffer_load_dwordx4 v[64:67], v1, s[8:11], s16 offen offset:0 sc1
  buffer_load_dwordx4 v[68:71], v1, s[8:11], s16 offen offset:1024 sc1
  s_setprio 0
  s_add_u32 s16, s16, 2048
  s_and_b32 s16, s16, 0x7fff
  s_or_b32 s16, s16, s15
  v_exp_f32 v144, v144
  v_exp_f32 v145, v145
  v_exp_f32 v146, v146
  v_exp_f32 v147, v147
  v_exp_f32 v148, v148
  v_exp_f32 v149, v149
  v_exp_f32 v150, v150
  v_exp_f32 v151, v151
  v_cvt_pk_bf16_f32 v176, v144, v145
  v_cvt_pk_bf16_f32 v177, v146, v147
  v_mfma_f32_32x32x16_bf16 v[160:175], v[52:55], v[28:31], v[160:175]
  v_exp_f32 v152, v152
  v_exp_f32 v153, v153
  v_exp_f32 v154, v154
  v_exp_f32 v155, v155
  v_cvt_pk_bf16_f32 v178, v148, v149
  v_cvt_pk_bf16_f32 v179, v150, v151
  v_exp_f32 v156, v156
  v_exp_f32 v157, v157
  v_exp_f32 v158, v158
  v_exp_f32 v159, v159
  v_cvt_pk_bf16_f32 v180, v152, v153
  v_cvt_pk_bf16_f32 v181, v154, v155
  v_cvt_pk_bf16_f32 v182, v156, v157
  v_cvt_pk_bf16_f32 v183, v158, v159
  v_mfma_f32_32x32x16_bf16 v[144:159], v[48:51], v[32:35], 0
  v_exp_f32 v160, v160
  v_exp_f32 v161, v161
  v_exp_f32 v162, v162
  v_exp_f32 v163, v163
  s_waitcnt vmcnt(6)
  v_mfma_f32_32x32x16_bf16 v[192:207], v[96:99], v[176:179], v[192:207]
  s_setprio 3
  buffer_load_dwordx4 v[112:115], v1, s[8:11], s17 offen offset:0 sc1
  buffer_load_dwordx4 v[116:119], v1, s[8:11], s17 offen offset:1024 sc1
  s_setprio 0
  s_add_u32 s17, s17, 2048
  s_and_b32 s17, s17, 0x7fff
  s_or_b32 s17, s17, s18
  v_exp_f32 v164, v164
  v_exp_f32 v165, v165
  v_exp_f32 v166, v166
  v_exp_f32 v167, v167
  v_cvt_pk_bf16_f32 v184, v160, v161
  v_cvt_pk_bf16_f32 v185, v162, v163
  v_mfma_f32_32x32x16_bf16 v[144:159], v[52:55], v[36:39], v[144:159]
  v_exp_f32 v168, v168
  v_exp_f32 v169, v169
  v_exp_f32 v170, v170
  v_exp_f32 v171, v171
  v_cvt_pk_bf16_f32 v186, v164, v165
  v_cvt_pk_bf16_f32 v187, v166, v167
  v_mfma_f32_32x32x16_bf16 v[192:207], v[100:103], v[180:183], v[192:207]
  v_exp_f32 v172, v172
  v_exp_f32 v173, v173
  v_exp_f32 v174, v174
  v_exp_f32 v175, v175
  v_cvt_pk_bf16_f32 v188, v168, v169
  v_cvt_pk_bf16_f32 v189, v170, v171
  v_cvt_pk_bf16_f32 v190, v172, v173
  v_cvt_pk_bf16_f32 v191, v174, v175
  v_mfma_f32_32x32x16_bf16 v[160:175], v[48:51], v[40:43], 0
  v_exp_f32 v144, v144
  v_exp_f32 v145, v145
  v_exp_f32 v146, v146
  v_exp_f32 v147, v147
  v_mfma_f32_32x32x16_bf16 v[208:223], v[96:99], v[184:187], v[208:223]
  v_exp_f32 v148, v148
  v_exp_f32 v149, v149
  v_exp_f32 v150, v150
  v_exp_f32 v151, v151
  v_cvt_pk_bf16_f32 v176, v144, v145
  v_cvt_pk_bf16_f32 v177, v146, v147
  v_mfma_f32_32x32x16_bf16 v[160:175], v[52:55], v[44:47], v[160:175]
  v_exp_f32 v152, v152
  v_exp_f32 v153, v153
  v_exp_f32 v154, v154
  v_exp_f32 v155, v155
  v_cvt_pk_bf16_f32 v178, v148, v149
  v_cvt_pk_bf16_f32 v179, v150, v151
  v_mfma_f32_32x32x16_bf16 v[208:223], v[100:103], v[188:191], v[208:223]
  v_exp_f32 v156, v156
  v_exp_f32 v157, v157
  v_exp_f32 v158, v158
  v_exp_f32 v159, v159
  v_cvt_pk_bf16_f32 v180, v152, v153
  v_cvt_pk_bf16_f32 v181, v154, v155
  v_cvt_pk_bf16_f32 v182, v156, v157
  v_cvt_pk_bf16_f32 v183, v158, v159
  s_waitcnt vmcnt(6)
  v_mfma_f32_32x32x16_bf16 v[144:159], v[56:59], v[16:19], 0
  v_exp_f32 v160, v160
  v_exp_f32 v161, v161
  v_exp_f32 v162, v162
  v_exp_f32 v163, v163
  v_mfma_f32_32x32x16_bf16 v[224:239], v[96:99], v[176:179], v[224:239]
  v_exp_f32 v164, v164
  v_exp_f32 v165, v165
  v_exp_f32 v166, v166
  v_exp_f32 v167, v167
  v_cvt_pk_bf16_f32 v184, v160, v161
  v_cvt_pk_bf16_f32 v185, v162, v163
  v_mfma_f32_32x32x16_bf16 v[144:159], v[60:63], v[20:23], v[144:159]
  v_exp_f32 v168, v168
  v_exp_f32 v169, v169
  v_exp_f32 v170, v170
  v_exp_f32 v171, v171
  v_cvt_pk_bf16_f32 v186, v164, v165
  v_cvt_pk_bf16_f32 v187, v166, v167
  v_mfma_f32_32x32x16_bf16 v[224:239], v[100:103], v[180:183], v[224:239]
  v_exp_f32 v172, v172
  v_exp_f32 v173, v173
  v_exp_f32 v174, v174
  v_exp_f32 v175, v175
  v_cvt_pk_bf16_f32 v188, v168, v169
  v_cvt_pk_bf16_f32 v189, v170, v171
  v_cvt_pk_bf16_f32 v190, v172, v173
  v_cvt_pk_bf16_f32 v191, v174, v175
  v_mfma_f32_32x32x16_bf16 v[160:175], v[56:59], v[24:27], 0
  s_setprio 3
  buffer_load_dwordx4 v[72:75], v1, s[8:11], s16 offen offset:0 sc1
  buffer_load_dwordx4 v[76:79], v1, s[8:11], s16 offen offset:1024 sc1
  s_setprio 0
  s_add_u32 s16, s16, 2048
  s_and_b32 s16, s16, 0x7fff
  s_or_b32 s16, s16, s15
  v_exp_f32 v144, v144
  v_exp_f32 v145, v145
  v_exp_f32 v146, v146
  v_exp_f32 v147, v147
  v_mfma_f32_32x32x16_bf16 v[240:255], v[96:99], v[184:187], v[240:255]
  v_exp_f32 v148, v148
  v_exp_f32 v149, v149
  v_exp_f32 v150, v150
  v_exp_f32 v151, v151
  v_cvt_pk_bf16_f32 v176, v144, v145
  v_cvt_pk_bf16_f32 v177, v146, v147
  v_mfma_f32_32x32x16_bf16 v[160:175], v[60:63], v[28:31], v[160:175]
  v_exp_f32 v152, v152
  v_exp_f32 v153, v153
  v_exp_f32 v154, v154
  v_exp_f32 v155, v155
  v_cvt_pk_bf16_f32 v178, v148, v149
  v_cvt_pk_bf16_f32 v179, v150, v151
  v_mfma_f32_32x32x16_bf16 v[240:255], v[100:103], v[188:191], v[240:255]
  v_exp_f32 v156, v156
  v_exp_f32 v157, v157
  v_exp_f32 v158, v158
  v_exp_f32 v159, v159
  v_cvt_pk_bf16_f32 v180, v152, v153
  v_cvt_pk_bf16_f32 v181, v154, v155
  v_cvt_pk_bf16_f32 v182, v156, v157
  v_cvt_pk_bf16_f32 v183, v158, v159
  v_mfma_f32_32x32x16_bf16 v[144:159], v[56:59], v[32:35], 0
  v_exp_f32 v160, v160
  v_exp_f32 v161, v161
  v_exp_f32 v162, v162
  v_exp_f32 v163, v163
  s_waitcnt vmcnt(6)
  v_mfma_f32_32x32x16_bf16 v[192:207], v[104:107], v[176:179], v[192:207]
  s_setprio 3
  buffer_load_dwordx4 v[120:123], v1, s[8:11], s17 offen offset:0 sc1
  buffer_load_dwordx4 v[124:127], v1, s[8:11], s17 offen offset:1024 sc1
  s_setprio 0
  s_add_u32 s17, s17, 2048
  s_and_b32 s17, s17, 0x7fff
  s_or_b32 s17, s17, s18
  v_exp_f32 v164, v164
  v_exp_f32 v165, v165
  v_exp_f32 v166, v166
  v_exp_f32 v167, v167
  v_cvt_pk_bf16_f32 v184, v160, v161
  v_cvt_pk_bf16_f32 v185, v162, v163
  v_mfma_f32_32x32x16_bf16 v[144:159], v[60:63], v[36:39], v[144:159]
  v_exp_f32 v168, v168
  v_exp_f32 v169, v169
  v_exp_f32 v170, v170
  v_exp_f32 v171, v171
  v_cvt_pk_bf16_f32 v186, v164, v165
  v_cvt_pk_bf16_f32 v187, v166, v167
  v_mfma_f32_32x32x16_bf16 v[192:207], v[108:111], v[180:183], v[192:207]
  v_exp_f32 v172, v172
  v_exp_f32 v173, v173
  v_exp_f32 v174, v174
  v_exp_f32 v175, v175
  v_cvt_pk_bf16_f32 v188, v168, v169
  v_cvt_pk_bf16_f32 v189, v170, v171
  v_cvt_pk_bf16_f32 v190, v172, v173
  v_cvt_pk_bf16_f32 v191, v174, v175
  v_mfma_f32_32x32x16_bf16 v[160:175], v[56:59], v[40:43], 0
  v_exp_f32 v144, v144
  v_exp_f32 v145, v145
  v_exp_f32 v146, v146
  v_exp_f32 v147, v147
  v_mfma_f32_32x32x16_bf16 v[208:223], v[104:107], v[184:187], v[208:223]
  v_exp_f32 v148, v148
  v_exp_f32 v149, v149
  v_exp_f32 v150, v150
  v_exp_f32 v151, v151
  v_cvt_pk_bf16_f32 v176, v144, v145
  v_cvt_pk_bf16_f32 v177, v146, v147
  v_mfma_f32_32x32x16_bf16 v[160:175], v[60:63], v[44:47], v[160:175]
  v_exp_f32 v152, v152
  v_exp_f32 v153, v153
  v_exp_f32 v154, v154
  v_exp_f32 v155, v155
  v_cvt_pk_bf16_f32 v178, v148, v149
  v_cvt_pk_bf16_f32 v179, v150, v151
  v_mfma_f32_32x32x16_bf16 v[208:223], v[108:111], v[188:191], v[208:223]
  v_exp_f32 v156, v156
  v_exp_f32 v157, v157
  v_exp_f32 v158, v158
  v_exp_f32 v159, v159
  v_cvt_pk_bf16_f32 v180, v152, v153
  v_cvt_pk_bf16_f32 v181, v154, v155
  v_cvt_pk_bf16_f32 v182, v156, v157
  v_cvt_pk_bf16_f32 v183, v158, v159
  s_waitcnt vmcnt(6)
  v_mfma_f32_32x32x16_bf16 v[144:159], v[64:67], v[16:19], 0
  v_exp_f32 v160, v160
  v_exp_f32 v161, v161
  v_exp_f32 v162, v162
  v_exp_f32 v163, v163
  v_mfma_f32_32x32x16_bf16 v[224:239], v[104:107], v[176:179], v[224:239]
  v_exp_f32 v164, v164
  v_exp_f32 v165, v165
  v_exp_f32 v166, v166
  v_exp_f32 v167, v167
  v_cvt_pk_bf16_f32 v184, v160, v161
  v_cvt_pk_bf16_f32 v185, v162, v163
  v_mfma_f32_32x32x16_bf16 v[144:159], v[68:71], v[20:23], v[144:159]
  v_exp_f32 v168, v168
  v_exp_f32 v169, v169
  v_exp_f32 v170, v170
  v_exp_f32 v171, v171
  v_cvt_pk_bf16_f32 v186, v164, v165
  v_cvt_pk_bf16_f32 v187, v166, v167
  v_mfma_f32_32x32x16_bf16 v[224:239], v[108:111], v[180:183], v[224:239]
  v_exp_f32 v172, v172
  v_exp_f32 v173, v173
  v_exp_f32 v174, v174
  v_exp_f32 v175, v175
  v_cvt_pk_bf16_f32 v188, v168, v169
  v_cvt_pk_bf16_f32 v189, v170, v171
  v_cvt_pk_bf16_f32 v190, v172, v173
  v_cvt_pk_bf16_f32 v191, v174, v175
  v_mfma_f32_32x32x16_bf16 v[160:175], v[64:67], v[24:27], 0
  s_setprio 3
  buffer_load_dwordx4 v[80:83], v1, s[8:11], s16 offen offset:0 sc1
  buffer_load_dwordx4 v[84:87], v1, s[8:11], s16 offen offset:1024 sc1
  s_setprio 0
  s_add_u32 s16, s16, 2048
  s_and_b32 s16, s16, 0x7fff
  s_or_b32 s16, s16, s15
  v_exp_f32 v144, v144
  v_exp_f32 v145, v145
  v_exp_f32 v146, v146
  v_exp_f32 v147, v147
  v_mfma_f32_32x32x16_bf16 v[240:255], v[104:107], v[184:187], v[240:255]
  v_exp_f32 v148, v148
  v_exp_f32 v149, v149
  v_exp_f32 v150, v150
  v_exp_f32 v151, v151
  v_cvt_pk_bf16_f32 v176, v144, v145
  v_cvt_pk_bf16_f32 v177, v146, v147
  v_mfma_f32_32x32x16_bf16 v[160:175], v[68:71], v[28:31], v[160:175]
  v_exp_f32 v152, v152
  v_exp_f32 v153, v153
  v_exp_f32 v154, v154
  v_exp_f32 v155, v155
  v_cvt_pk_bf16_f32 v178, v148, v149
  v_cvt_pk_bf16_f32 v179, v150, v151
  v_mfma_f32_32x32x16_bf16 v[240:255], v[108:111], v[188:191], v[240:255]
  v_exp_f32 v156, v156
  v_exp_f32 v157, v157
  v_exp_f32 v158, v158
  v_exp_f32 v159, v159
  v_cvt_pk_bf16_f32 v180, v152, v153
  v_cvt_pk_bf16_f32 v181, v154, v155
  v_cvt_pk_bf16_f32 v182, v156, v157
  v_cvt_pk_bf16_f32 v183, v158, v159
  v_mfma_f32_32x32x16_bf16 v[144:159], v[64:67], v[32:35], 0
  v_exp_f32 v160, v160
  v_exp_f32 v161, v161
  v_exp_f32 v162, v162
  v_exp_f32 v163, v163
  s_waitcnt vmcnt(6)
  v_mfma_f32_32x32x16_bf16 v[192:207], v[112:115], v[176:179], v[192:207]
  s_setprio 3
  buffer_load_dwordx4 v[128:131], v1, s[8:11], s17 offen offset:0 sc1
  buffer_load_dwordx4 v[132:135], v1, s[8:11], s17 offen offset:1024 sc1
  s_setprio 0
  s_add_u32 s17, s17, 2048
  s_and_b32 s17, s17, 0x7fff
  s_or_b32 s17, s17, s18
  v_exp_f32 v164, v164
  v_exp_f32 v165, v165
  v_exp_f32 v166, v166
  v_exp_f32 v167, v167
  v_cvt_pk_bf16_f32 v184, v160, v161
  v_cvt_pk_bf16_f32 v185, v162, v163
  v_mfma_f32_32x32x16_bf16 v[144:159], v[68:71], v[36:39], v[144:159]
  v_exp_f32 v168, v168
  v_exp_f32 v169, v169
  v_exp_f32 v170, v170
  v_exp_f32 v171, v171
  v_cvt_pk_bf16_f32 v186, v164, v165
  v_cvt_pk_bf16_f32 v187, v166, v167
  v_mfma_f32_32x32x16_bf16 v[192:207], v[116:119], v[180:183], v[192:207]
  v_exp_f32 v172, v172
  v_exp_f32 v173, v173
  v_exp_f32 v174, v174
  v_exp_f32 v175, v175
  v_cvt_pk_bf16_f32 v188, v168, v169
  v_cvt_pk_bf16_f32 v189, v170, v171
  v_cvt_pk_bf16_f32 v190, v172, v173
  v_cvt_pk_bf16_f32 v191, v174, v175
  v_mfma_f32_32x32x16_bf16 v[160:175], v[64:67], v[40:43], 0
  v_exp_f32 v144, v144
  v_exp_f32 v145, v145
  v_exp_f32 v146, v146
  v_exp_f32 v147, v147
  v_mfma_f32_32x32x16_bf16 v[208:223], v[112:115], v[184:187], v[208:223]
  v_exp_f32 v148, v148
  v_exp_f32 v149, v149
  v_exp_f32 v150, v150
  v_exp_f32 v151, v151
  v_cvt_pk_bf16_f32 v176, v144, v145
  v_cvt_pk_bf16_f32 v177, v146, v147
  v_mfma_f32_32x32x16_bf16 v[160:175], v[68:71], v[44:47], v[160:175]
  v_exp_f32 v152, v152
  v_exp_f32 v153, v153
  v_exp_f32 v154, v154
  v_exp_f32 v155, v155
  v_cvt_pk_bf16_f32 v178, v148, v149
  v_cvt_pk_bf16_f32 v179, v150, v151
  v_mfma_f32_32x32x16_bf16 v[208:223], v[116:119], v[188:191], v[208:223]
  v_exp_f32 v156, v156
  v_exp_f32 v157, v157
  v_exp_f32 v158, v158
  v_exp_f32 v159, v159
  v_cvt_pk_bf16_f32 v180, v152, v153
  v_cvt_pk_bf16_f32 v181, v154, v155
  v_cvt_pk_bf16_f32 v182, v156, v157
  v_cvt_pk_bf16_f32 v183, v158, v159
  s_waitcnt vmcnt(6)
  v_mfma_f32_32x32x16_bf16 v[144:159], v[72:75], v[16:19], 0
  v_exp_f32 v160, v160
  v_exp_f32 v161, v161
  v_exp_f32 v162, v162
  v_exp_f32 v163, v163
  v_mfma_f32_32x32x16_bf16 v[224:239], v[112:115], v[176:179], v[224:239]
  v_exp_f32 v164, v164
  v_exp_f32 v165, v165
  v_exp_f32 v166, v166
  v_exp_f32 v167, v167
  v_cvt_pk_bf16_f32 v184, v160, v161
  v_cvt_pk_bf16_f32 v185, v162, v163
  v_mfma_f32_32x32x16_bf16 v[144:159], v[76:79], v[20:23], v[144:159]
  v_exp_f32 v168, v168
  v_exp_f32 v169, v169
  v_exp_f32 v170, v170
  v_exp_f32 v171, v171
  v_cvt_pk_bf16_f32 v186, v164, v165
  v_cvt_pk_bf16_f32 v187, v166, v167
  v_mfma_f32_32x32x16_bf16 v[224:239], v[116:119], v[180:183], v[224:239]
  v_exp_f32 v172, v172
  v_exp_f32 v173, v173
  v_exp_f32 v174, v174
  v_exp_f32 v175, v175
  v_cvt_pk_bf16_f32 v188, v168, v169
  v_cvt_pk_bf16_f32 v189, v170, v171
  v_cvt_pk_bf16_f32 v190, v172, v173
  v_cvt_pk_bf16_f32 v191, v174, v175
  v_mfma_f32_32x32x16_bf16 v[160:175], v[72:75], v[24:27], 0
  s_setprio 3
  buffer_load_dwordx4 v[88:91], v1, s[8:11], s16 offen offset:0 sc1
  buffer_load_dwordx4 v[92:95], v1, s[8:11], s16 offen offset:1024 sc1
  s_setprio 0
  s_add_u32 s16, s16, 2048
  s_and_b32 s16, s16, 0x7fff
  s_or_b32 s16, s16, s15
  v_exp_f32 v144, v144
  v_exp_f32 v145, v145
  v_exp_f32 v146, v146
  v_exp_f32 v147, v147
  v_mfma_f32_32x32x16_bf16 v[240:255], v[112:115], v[184:187], v[240:255]
  v_exp_f32 v148, v148
  v_exp_f32 v149, v149
  v_exp_f32 v150, v150
  v_exp_f32 v151, v151
  v_cvt_pk_bf16_f32 v176, v144, v145
  v_cvt_pk_bf16_f32 v177, v146, v147
  v_mfma_f32_32x32x16_bf16 v[160:175], v[76:79], v[28:31], v[160:175]
  v_exp_f32 v152, v152
  v_exp_f32 v153, v153
  v_exp_f32 v154, v154
  v_exp_f32 v155, v155
  v_cvt_pk_bf16_f32 v178, v148, v149
  v_cvt_pk_bf16_f32 v179, v150, v151
  v_mfma_f32_32x32x16_bf16 v[240:255], v[116:119], v[188:191], v[240:255]
  v_exp_f32 v156, v156
  v_exp_f32 v157, v157
  v_exp_f32 v158, v158
  v_exp_f32 v159, v159
  v_cvt_pk_bf16_f32 v180, v152, v153
  v_cvt_pk_bf16_f32 v181, v154, v155
  v_cvt_pk_bf16_f32 v182, v156, v157
  v_cvt_pk_bf16_f32 v183, v158, v159
  v_mfma_f32_32x32x16_bf16 v[144:159], v[72:75], v[32:35], 0
  v_exp_f32 v160, v160
  v_exp_f32 v161, v161
  v_exp_f32 v162, v162
  v_exp_f32 v163, v163
  s_waitcnt vmcnt(6)
  v_mfma_f32_32x32x16_bf16 v[192:207], v[120:123], v[176:179], v[192:207]
  s_setprio 3
  buffer_load_dwordx4 v[136:139], v1, s[8:11], s17 offen offset:0 sc1
  buffer_load_dwordx4 v[140:143], v1, s[8:11], s17 offen offset:1024 sc1
  s_setprio 0
  s_add_u32 s17, s17, 2048
  s_and_b32 s17, s17, 0x7fff
  s_or_b32 s17, s17, s18
  v_exp_f32 v164, v164
  v_exp_f32 v165, v165
  v_exp_f32 v166, v166
  v_exp_f32 v167, v167
  v_cvt_pk_bf16_f32 v184, v160, v161
  v_cvt_pk_bf16_f32 v185, v162, v163
  v_mfma_f32_32x32x16_bf16 v[144:159], v[76:79], v[36:39], v[144:159]
  v_exp_f32 v168, v168
  v_exp_f32 v169, v169
  v_exp_f32 v170, v170
  v_exp_f32 v171, v171
  v_cvt_pk_bf16_f32 v186, v164, v165
  v_cvt_pk_bf16_f32 v187, v166, v167
  v_mfma_f32_32x32x16_bf16 v[192:207], v[124:127], v[180:183], v[192:207]
  v_exp_f32 v172, v172
  v_exp_f32 v173, v173
  v_exp_f32 v174, v174
  v_exp_f32 v175, v175
  v_cvt_pk_bf16_f32 v188, v168, v169
  v_cvt_pk_bf16_f32 v189, v170, v171
  v_cvt_pk_bf16_f32 v190, v172, v173
  v_cvt_pk_bf16_f32 v191, v174, v175
  v_mfma_f32_32x32x16_bf16 v[160:175], v[72:75], v[40:43], 0
  v_exp_f32 v144, v144
  v_exp_f32 v145, v145
  v_exp_f32 v146, v146
  v_exp_f32 v147, v147
  v_mfma_f32_32x32x16_bf16 v[208:223], v[120:123], v[184:187], v[208:223]
  v_exp_f32 v148, v148
  v_exp_f32 v149, v149
  v_exp_f32 v150, v150
  v_exp_f32 v151, v151
  v_cvt_pk_bf16_f32 v176, v144, v145
  v_cvt_pk_bf16_f32 v177, v146, v147
  v_mfma_f32_32x32x16_bf16 v[160:175], v[76:79], v[44:47], v[160:175]
  v_exp_f32 v152, v152
  v_exp_f32 v153, v153
  v_exp_f32 v154, v154
  v_exp_f32 v155, v155
  v_cvt_pk_bf16_f32 v178, v148, v149
  v_cvt_pk_bf16_f32 v179, v150, v151
  v_mfma_f32_32x32x16_bf16 v[208:223], v[124:127], v[188:191], v[208:223]
  v_exp_f32 v156, v156
  v_exp_f32 v157, v157
  v_exp_f32 v158, v158
  v_exp_f32 v159, v159
  v_cvt_pk_bf16_f32 v180, v152, v153
  v_cvt_pk_bf16_f32 v181, v154, v155
  v_cvt_pk_bf16_f32 v182, v156, v157
  v_cvt_pk_bf16_f32 v183, v158, v159
  s_waitcnt vmcnt(6)
  v_mfma_f32_32x32x16_bf16 v[144:159], v[80:83], v[16:19], 0
  v_exp_f32 v160, v160
  v_exp_f32 v161, v161
  v_exp_f32 v162, v162
  v_exp_f32 v163, v163
  v_mfma_f32_32x32x16_bf16 v[224:239], v[120:123], v[176:179], v[224:239]
  v_exp_f32 v164, v164
  v_exp_f32 v165, v165
  v_exp_f32 v166, v166
  v_exp_f32 v167, v167
  v_cvt_pk_bf16_f32 v184, v160, v161
  v_cvt_pk_bf16_f32 v185, v162, v163
  v_mfma_f32_32x32x16_bf16 v[144:159], v[84:87], v[20:23], v[144:159]
  v_exp_f32 v168, v168
  v_exp_f32 v169, v169
  v_exp_f32 v170, v170
  v_exp_f32 v171, v171
  v_cvt_pk_bf16_f32 v186, v164, v165
  v_cvt_pk_bf16_f32 v187, v166, v167
  v_mfma_f32_32x32x16_bf16 v[224:239], v[124:127], v[180:183], v[224:239]
  v_exp_f32 v172, v172
  v_exp_f32 v173, v173
  v_exp_f32 v174, v174
  v_exp_f32 v175, v175
  v_cvt_pk_bf16_f32 v188, v168, v169
  v_cvt_pk_bf16_f32 v189, v170, v171
  v_cvt_pk_bf16_f32 v190, v172, v173
  v_cvt_pk_bf16_f32 v191, v174, v175
  v_mfma_f32_32x32x16_bf16 v[160:175], v[80:83], v[24:27], 0
  s_setprio 3
  buffer_load_dwordx4 v[48:51], v1, s[8:11], s16 offen offset:0 sc1
  buffer_load_dwordx4 v[52:55], v1, s[8:11], s16 offen offset:1024 sc1
  s_setprio 0
  s_add_u32 s16, s16, 2048
  s_and_b32 s16, s16, 0x7fff
  s_or_b32 s16, s16, s15
  v_exp_f32 v144, v144
  v_exp_f32 v145, v145
  v_exp_f32 v146, v146
  v_exp_f32 v147, v147
  v_mfma_f32_32x32x16_bf16 v[240:255], v[120:123], v[184:187], v[240:255]
  v_exp_f32 v148, v148
  v_exp_f32 v149, v149
  v_exp_f32 v150, v150
  v_exp_f32 v151, v151
  v_cvt_pk_bf16_f32 v176, v144, v145
  v_cvt_pk_bf16_f32 v177, v146, v147
  v_mfma_f32_32x32x16_bf16 v[160:175], v[84:87], v[28:31], v[160:175]
  v_exp_f32 v152, v152
  v_exp_f32 v153, v153
  v_exp_f32 v154, v154
  v_exp_f32 v155, v155
  v_cvt_pk_bf16_f32 v178, v148, v149
  v_cvt_pk_bf16_f32 v179, v150, v151
  v_mfma_f32_32x32x16_bf16 v[240:255], v[124:127], v[188:191], v[240:255]
  v_exp_f32 v156, v156
  v_exp_f32 v157, v157
  v_exp_f32 v158, v158
  v_exp_f32 v159, v159
  v_cvt_pk_bf16_f32 v180, v152, v153
  v_cvt_pk_bf16_f32 v181, v154, v155
  v_cvt_pk_bf16_f32 v182, v156, v157
  v_cvt_pk_bf16_f32 v183, v158, v159
  v_mfma_f32_32x32x16_bf16 v[144:159], v[80:83], v[32:35], 0
  v_exp_f32 v160, v160
  v_exp_f32 v161, v161
  v_exp_f32 v162, v162
  v_exp_f32 v163, v163
  s_waitcnt vmcnt(6)
  v_mfma_f32_32x32x16_bf16 v[192:207], v[128:131], v[176:179], v[192:207]
  s_setprio 3
  buffer_load_dwordx4 v[96:99], v1, s[8:11], s17 offen offset:0 sc1
  buffer_load_dwordx4 v[100:103], v1, s[8:11], s17 offen offset:1024 sc1
  s_setprio 0
  s_add_u32 s17, s17, 2048
  s_and_b32 s17, s17, 0x7fff
  s_or_b32 s17, s17, s18
  v_exp_f32 v164, v164
  v_exp_f32 v165, v165
  v_exp_f32 v166, v166
  v_exp_f32 v167, v167
  v_cvt_pk_bf16_f32 v184, v160, v161
  v_cvt_pk_bf16_f32 v185, v162, v163
  v_mfma_f32_32x32x16_bf16 v[144:159], v[84:87], v[36:39], v[144:159]
  v_exp_f32 v168, v168
  v_exp_f32 v169, v169
  v_exp_f32 v170, v170
  v_exp_f32 v171, v171
  v_cvt_pk_bf16_f32 v186, v164, v165
  v_cvt_pk_bf16_f32 v187, v166, v167
  v_mfma_f32_32x32x16_bf16 v[192:207], v[132:135], v[180:183], v[192:207]
  v_exp_f32 v172, v172
  v_exp_f32 v173, v173
  v_exp_f32 v174, v174
  v_exp_f32 v175, v175
  v_cvt_pk_bf16_f32 v188, v168, v169
  v_cvt_pk_bf16_f32 v189, v170, v171
  v_cvt_pk_bf16_f32 v190, v172, v173
  v_cvt_pk_bf16_f32 v191, v174, v175
  v_mfma_f32_32x32x16_bf16 v[160:175], v[80:83], v[40:43], 0
  v_exp_f32 v144, v144
  v_exp_f32 v145, v145
  v_exp_f32 v146, v146
  v_exp_f32 v147, v147
  v_mfma_f32_32x32x16_bf16 v[208:223], v[128:131], v[184:187], v[208:223]
  v_exp_f32 v148, v148
  v_exp_f32 v149, v149
  v_exp_f32 v150, v150
  v_exp_f32 v151, v151
  v_cvt_pk_bf16_f32 v176, v144, v145
  v_cvt_pk_bf16_f32 v177, v146, v147
  v_mfma_f32_32x32x16_bf16 v[160:175], v[84:87], v[44:47], v[160:175]
  v_exp_f32 v152, v152
  v_exp_f32 v153, v153
  v_exp_f32 v154, v154
  v_exp_f32 v155, v155
  v_cvt_pk_bf16_f32 v178, v148, v149
  v_cvt_pk_bf16_f32 v179, v150, v151
  v_mfma_f32_32x32x16_bf16 v[208:223], v[132:135], v[188:191], v[208:223]
  v_exp_f32 v156, v156
  v_exp_f32 v157, v157
  v_exp_f32 v158, v158
  v_exp_f32 v159, v159
  v_cvt_pk_bf16_f32 v180, v152, v153
  v_cvt_pk_bf16_f32 v181, v154, v155
  v_cvt_pk_bf16_f32 v182, v156, v157
  v_cvt_pk_bf16_f32 v183, v158, v159
  s_waitcnt vmcnt(6)
  v_mfma_f32_32x32x16_bf16 v[144:159], v[88:91], v[16:19], 0
  v_exp_f32 v160, v160
  v_exp_f32 v161, v161
  v_exp_f32 v162, v162
  v_exp_f32 v163, v163
  v_mfma_f32_32x32x16_bf16 v[224:239], v[128:131], v[176:179], v[224:239]
  v_exp_f32 v164, v164
  v_exp_f32 v165, v165
  v_exp_f32 v166, v166
  v_exp_f32 v167, v167
  v_cvt_pk_bf16_f32 v184, v160, v161
  v_cvt_pk_bf16_f32 v185, v162, v163
  v_mfma_f32_32x32x16_bf16 v[144:159], v[92:95], v[20:23], v[144:159]
  v_exp_f32 v168, v168
  v_exp_f32 v169, v169
  v_exp_f32 v170, v170
  v_exp_f32 v171, v171
  v_cvt_pk_bf16_f32 v186, v164, v165
  v_cvt_pk_bf16_f32 v187, v166, v167
  v_mfma_f32_32x32x16_bf16 v[224:239], v[132:135], v[180:183], v[224:239]
  v_exp_f32 v172, v172
  v_exp_f32 v173, v173
  v_exp_f32 v174, v174
  v_exp_f32 v175, v175
  v_cvt_pk_bf16_f32 v188, v168, v169
  v_cvt_pk_bf16_f32 v189, v170, v171
  v_cvt_pk_bf16_f32 v190, v172, v173
  v_cvt_pk_bf16_f32 v191, v174, v175
  v_mfma_f32_32x32x16_bf16 v[160:175], v[88:91], v[24:27], 0
  s_setprio 3
  buffer_load_dwordx4 v[56:59], v1, s[8:11], s16 offen offset:0 sc1
  buffer_load_dwordx4 v[60:63], v1, s[8:11], s16 offen offset:1024 sc1
  s_setprio 0
  s_add_u32 s16, s16, 2048
  s_and_b32 s16, s16, 0x7fff
  s_or_b32 s16, s16, s15
  v_exp_f32 v144, v144
  v_exp_f32 v145, v145
  v_exp_f32 v146, v146
  v_exp_f32 v147, v147
  v_mfma_f32_32x32x16_bf16 v[240:255], v[128:131], v[184:187], v[240:255]
  v_exp_f32 v148, v148
  v_exp_f32 v149, v149
  v_exp_f32 v150, v150
  v_exp_f32 v151, v151
  v_cvt_pk_bf16_f32 v176, v144, v145
  v_cvt_pk_bf16_f32 v177, v146, v147
  v_mfma_f32_32x32x16_bf16 v[160:175], v[92:95], v[28:31], v[160:175]
  v_exp_f32 v152, v152
  v_exp_f32 v153, v153
  v_exp_f32 v154, v154
  v_exp_f32 v155, v155
  v_cvt_pk_bf16_f32 v178, v148, v149
  v_cvt_pk_bf16_f32 v179, v150, v151
  v_mfma_f32_32x32x16_bf16 v[240:255], v[132:135], v[188:191], v[240:255]
  v_exp_f32 v156, v156
  v_exp_f32 v157, v157
  v_exp_f32 v158, v158
  v_exp_f32 v159, v159
  v_cvt_pk_bf16_f32 v180, v152, v153
  v_cvt_pk_bf16_f32 v181, v154, v155
  v_cvt_pk_bf16_f32 v182, v156, v157
  v_cvt_pk_bf16_f32 v183, v158, v159
  v_mfma_f32_32x32x16_bf16 v[144:159], v[88:91], v[32:35], 0
  v_exp_f32 v160, v160
  v_exp_f32 v161, v161
  v_exp_f32 v162, v162
  v_exp_f32 v163, v163
  s_waitcnt vmcnt(6)
  v_mfma_f32_32x32x16_bf16 v[192:207], v[136:139], v[176:179], v[192:207]
  s_setprio 3
  buffer_load_dwordx4 v[104:107], v1, s[8:11], s17 offen offset:0 sc1
  buffer_load_dwordx4 v[108:111], v1, s[8:11], s17 offen offset:1024 sc1
  s_setprio 0
  s_add_u32 s17, s17, 2048
  s_and_b32 s17, s17, 0x7fff
  s_or_b32 s17, s17, s18
  v_exp_f32 v164, v164
  v_exp_f32 v165, v165
  v_exp_f32 v166, v166
  v_exp_f32 v167, v167
  v_cvt_pk_bf16_f32 v184, v160, v161
  v_cvt_pk_bf16_f32 v185, v162, v163
  v_mfma_f32_32x32x16_bf16 v[144:159], v[92:95], v[36:39], v[144:159]
  v_exp_f32 v168, v168
  v_exp_f32 v169, v169
  v_exp_f32 v170, v170
  v_exp_f32 v171, v171
  v_cvt_pk_bf16_f32 v186, v164, v165
  v_cvt_pk_bf16_f32 v187, v166, v167
  v_mfma_f32_32x32x16_bf16 v[192:207], v[140:143], v[180:183], v[192:207]
  v_exp_f32 v172, v172
  v_exp_f32 v173, v173
  v_exp_f32 v174, v174
  v_exp_f32 v175, v175
  v_cvt_pk_bf16_f32 v188, v168, v169
  v_cvt_pk_bf16_f32 v189, v170, v171
  v_cvt_pk_bf16_f32 v190, v172, v173
  v_cvt_pk_bf16_f32 v191, v174, v175
  v_mfma_f32_32x32x16_bf16 v[160:175], v[88:91], v[40:43], 0
  v_exp_f32 v144, v144
  v_exp_f32 v145, v145
  v_exp_f32 v146, v146
  v_exp_f32 v147, v147
  v_mfma_f32_32x32x16_bf16 v[208:223], v[136:139], v[184:187], v[208:223]
  v_exp_f32 v148, v148
  v_exp_f32 v149, v149
  v_exp_f32 v150, v150
  v_exp_f32 v151, v151
  v_cvt_pk_bf16_f32 v176, v144, v145
  v_cvt_pk_bf16_f32 v177, v146, v147
  v_mfma_f32_32x32x16_bf16 v[160:175], v[92:95], v[44:47], v[160:175]
  v_exp_f32 v152, v152
  v_exp_f32 v153, v153
  v_exp_f32 v154, v154
  v_exp_f32 v155, v155
  v_cvt_pk_bf16_f32 v178, v148, v149
  v_cvt_pk_bf16_f32 v179, v150, v151
  v_mfma_f32_32x32x16_bf16 v[208:223], v[140:143], v[188:191], v[208:223]
  v_exp_f32 v156, v156
  v_exp_f32 v157, v157
  v_exp_f32 v158, v158
  v_exp_f32 v159, v159
  v_cvt_pk_bf16_f32 v180, v152, v153
  v_cvt_pk_bf16_f32 v181, v154, v155
  v_cvt_pk_bf16_f32 v182, v156, v157
  v_cvt_pk_bf16_f32 v183, v158, v159
  s_waitcnt vmcnt(6)
  v_mfma_f32_32x32x16_bf16 v[144:159], v[48:51], v[16:19], 0
  v_exp_f32 v160, v160
  v_exp_f32 v161, v161
  v_exp_f32 v162, v162
  v_exp_f32 v163, v163
  v_mfma_f32_32x32x16_bf16 v[224:239], v[136:139], v[176:179], v[224:239]
  v_exp_f32 v164, v164
  v_exp_f32 v165, v165
  v_exp_f32 v166, v166
  v_exp_f32 v167, v167
  v_cvt_pk_bf16_f32 v184, v160, v161
  v_cvt_pk_bf16_f32 v185, v162, v163
  v_mfma_f32_32x32x16_bf16 v[144:159], v[52:55], v[20:23], v[144:159]
  v_exp_f32 v168, v168
  v_exp_f32 v169, v169
  v_exp_f32 v170, v170
  v_exp_f32 v171, v171
  v_cvt_pk_bf16_f32 v186, v164, v165
  v_cvt_pk_bf16_f32 v187, v166, v167
  v_mfma_f32_32x32x16_bf16 v[224:239], v[140:143], v[180:183], v[224:239]
  v_exp_f32 v172, v172
  v_exp_f32 v173, v173
  v_exp_f32 v174, v174
  v_exp_f32 v175, v175
  v_cvt_pk_bf16_f32 v188, v168, v169
  v_cvt_pk_bf16_f32 v189, v170, v171
  v_cvt_pk_bf16_f32 v190, v172, v173
  v_cvt_pk_bf16_f32 v191, v174, v175
  v_mfma_f32_32x32x16_bf16 v[160:175], v[48:51], v[24:27], 0
  s_setprio 3
  buffer_load_dwordx4 v[64:67], v1, s[8:11], s16 offen offset:0 sc1
  buffer_load_dwordx4 v[68:71], v1, s[8:11], s16 offen offset:1024 sc1
  s_setprio 0
  s_add_u32 s16, s16, 2048
  s_and_b32 s16, s16, 0x7fff
  s_or_b32 s16, s16, s15
  v_exp_f32 v144, v144
  v_exp_f32 v145, v145
  v_exp_f32 v146, v146
  v_exp_f32 v147, v147
  v_mfma_f32_32x32x16_bf16 v[240:255], v[136:139], v[184:187], v[240:255]
  v_exp_f32 v148, v148
  v_exp_f32 v149, v149
  v_exp_f32 v150, v150
  v_exp_f32 v151, v151
  v_cvt_pk_bf16_f32 v176, v144, v145
  v_cvt_pk_bf16_f32 v177, v146, v147
  v_mfma_f32_32x32x16_bf16 v[160:175], v[52:55], v[28:31], v[160:175]
  v_exp_f32 v152, v152
  v_exp_f32 v153, v153
  v_exp_f32 v154, v154
  v_exp_f32 v155, v155
  v_cvt_pk_bf16_f32 v178, v148, v149
  v_cvt_pk_bf16_f32 v179, v150, v151
  v_mfma_f32_32x32x16_bf16 v[240:255], v[140:143], v[188:191], v[240:255]
  v_exp_f32 v156, v156
  v_exp_f32 v157, v157
  v_exp_f32 v158, v158
  v_exp_f32 v159, v159
  v_cvt_pk_bf16_f32 v180, v152, v153
  v_cvt_pk_bf16_f32 v181, v154, v155
  v_cvt_pk_bf16_f32 v182, v156, v157
  v_cvt_pk_bf16_f32 v183, v158, v159
  v_mfma_f32_32x32x16_bf16 v[144:159], v[48:51], v[32:35], 0
  v_exp_f32 v160, v160
  v_exp_f32 v161, v161
  v_exp_f32 v162, v162
  v_exp_f32 v163, v163
  s_waitcnt vmcnt(6)
  v_mfma_f32_32x32x16_bf16 v[192:207], v[96:99], v[176:179], v[192:207]
  s_setprio 3
  buffer_load_dwordx4 v[112:115], v1, s[8:11], s17 offen offset:0 sc1
  buffer_load_dwordx4 v[116:119], v1, s[8:11], s17 offen offset:1024 sc1
  s_setprio 0
  s_add_u32 s17, s17, 2048
  s_and_b32 s17, s17, 0x7fff
  s_or_b32 s17, s17, s18
  v_exp_f32 v164, v164
  v_exp_f32 v165, v165
  v_exp_f32 v166, v166
  v_exp_f32 v167, v167
  v_cvt_pk_bf16_f32 v184, v160, v161
  v_cvt_pk_bf16_f32 v185, v162, v163
  v_mfma_f32_32x32x16_bf16 v[144:159], v[52:55], v[36:39], v[144:159]
  v_exp_f32 v168, v168
  v_exp_f32 v169, v169
  v_exp_f32 v170, v170
  v_exp_f32 v171, v171
  v_cvt_pk_bf16_f32 v186, v164, v165
  v_cvt_pk_bf16_f32 v187, v166, v167
  v_mfma_f32_32x32x16_bf16 v[192:207], v[100:103], v[180:183], v[192:207]
  v_exp_f32 v172, v172
  v_exp_f32 v173, v173
  v_exp_f32 v174, v174
  v_exp_f32 v175, v175
  v_cvt_pk_bf16_f32 v188, v168, v169
  v_cvt_pk_bf16_f32 v189, v170, v171
  v_cvt_pk_bf16_f32 v190, v172, v173
  v_cvt_pk_bf16_f32 v191, v174, v175
  v_mfma_f32_32x32x16_bf16 v[160:175], v[48:51], v[40:43], 0
  v_exp_f32 v144, v144
  v_exp_f32 v145, v145
  v_exp_f32 v146, v146
  v_exp_f32 v147, v147
  v_mfma_f32_32x32x16_bf16 v[208:223], v[96:99], v[184:187], v[208:223]
  v_exp_f32 v148, v148
  v_exp_f32 v149, v149
  v_exp_f32 v150, v150
  v_exp_f32 v151, v151
  v_cvt_pk_bf16_f32 v176, v144, v145
  v_cvt_pk_bf16_f32 v177, v146, v147
  v_mfma_f32_32x32x16_bf16 v[160:175], v[52:55], v[44:47], v[160:175]
  v_exp_f32 v152, v152
  v_exp_f32 v153, v153
  v_exp_f32 v154, v154
  v_exp_f32 v155, v155
  v_cvt_pk_bf16_f32 v178, v148, v149
  v_cvt_pk_bf16_f32 v179, v150, v151
  v_mfma_f32_32x32x16_bf16 v[208:223], v[100:103], v[188:191], v[208:223]
  v_exp_f32 v156, v156
  v_exp_f32 v157, v157
  v_exp_f32 v158, v158
  v_exp_f32 v159, v159
  v_cvt_pk_bf16_f32 v180, v152, v153
  v_cvt_pk_bf16_f32 v181, v154, v155
  v_cvt_pk_bf16_f32 v182, v156, v157
  v_cvt_pk_bf16_f32 v183, v158, v159
  s_waitcnt vmcnt(6)
  v_mfma_f32_32x32x16_bf16 v[144:159], v[56:59], v[16:19], 0
  v_exp_f32 v160, v160
  v_exp_f32 v161, v161
  v_exp_f32 v162, v162
  v_exp_f32 v163, v163
  v_mfma_f32_32x32x16_bf16 v[224:239], v[96:99], v[176:179], v[224:239]
  v_exp_f32 v164, v164
  v_exp_f32 v165, v165
  v_exp_f32 v166, v166
  v_exp_f32 v167, v167
  v_cvt_pk_bf16_f32 v184, v160, v161
  v_cvt_pk_bf16_f32 v185, v162, v163
  v_mfma_f32_32x32x16_bf16 v[144:159], v[60:63], v[20:23], v[144:159]
  v_exp_f32 v168, v168
  v_exp_f32 v169, v169
  v_exp_f32 v170, v170
  v_exp_f32 v171, v171
  v_cvt_pk_bf16_f32 v186, v164, v165
  v_cvt_pk_bf16_f32 v187, v166, v167
  v_mfma_f32_32x32x16_bf16 v[224:239], v[100:103], v[180:183], v[224:239]
  v_exp_f32 v172, v172
  v_exp_f32 v173, v173
  v_exp_f32 v174, v174
  v_exp_f32 v175, v175
  v_cvt_pk_bf16_f32 v188, v168, v169
  v_cvt_pk_bf16_f32 v189, v170, v171
  v_cvt_pk_bf16_f32 v190, v172, v173
  v_cvt_pk_bf16_f32 v191, v174, v175
  v_mfma_f32_32x32x16_bf16 v[160:175], v[56:59], v[24:27], 0
  s_setprio 3
  buffer_load_dwordx4 v[72:75], v1, s[8:11], s16 offen offset:0 sc1
  buffer_load_dwordx4 v[76:79], v1, s[8:11], s16 offen offset:1024 sc1
  s_setprio 0
  s_add_u32 s16, s16, 2048
  s_and_b32 s16, s16, 0x7fff
  s_or_b32 s16, s16, s15
  v_exp_f32 v144, v144
  v_exp_f32 v145, v145
  v_exp_f32 v146, v146
  v_exp_f32 v147, v147
  v_mfma_f32_32x32x16_bf16 v[240:255], v[96:99], v[184:187], v[240:255]
  v_exp_f32 v148, v148
  v_exp_f32 v149, v149
  v_exp_f32 v150, v150
  v_exp_f32 v151, v151
  v_cvt_pk_bf16_f32 v176, v144, v145
  v_cvt_pk_bf16_f32 v177, v146, v147
  v_mfma_f32_32x32x16_bf16 v[160:175], v[60:63], v[28:31], v[160:175]
  v_exp_f32 v152, v152
  v_exp_f32 v153, v153
  v_exp_f32 v154, v154
  v_exp_f32 v155, v155
  v_cvt_pk_bf16_f32 v178, v148, v149
  v_cvt_pk_bf16_f32 v179, v150, v151
  v_mfma_f32_32x32x16_bf16 v[240:255], v[100:103], v[188:191], v[240:255]
  v_exp_f32 v156, v156
  v_exp_f32 v157, v157
  v_exp_f32 v158, v158
  v_exp_f32 v159, v159
  v_cvt_pk_bf16_f32 v180, v152, v153
  v_cvt_pk_bf16_f32 v181, v154, v155
  v_cvt_pk_bf16_f32 v182, v156, v157
  v_cvt_pk_bf16_f32 v183, v158, v159
  v_mfma_f32_32x32x16_bf16 v[144:159], v[56:59], v[32:35], 0
  v_exp_f32 v160, v160
  v_exp_f32 v161, v161
  v_exp_f32 v162, v162
  v_exp_f32 v163, v163
  s_waitcnt vmcnt(6)
  v_mfma_f32_32x32x16_bf16 v[192:207], v[104:107], v[176:179], v[192:207]
  s_setprio 3
  buffer_load_dwordx4 v[120:123], v1, s[8:11], s17 offen offset:0 sc1
  buffer_load_dwordx4 v[124:127], v1, s[8:11], s17 offen offset:1024 sc1
  s_setprio 0
  s_add_u32 s17, s17, 2048
  s_and_b32 s17, s17, 0x7fff
  s_or_b32 s17, s17, s18
  v_exp_f32 v164, v164
  v_exp_f32 v165, v165
  v_exp_f32 v166, v166
  v_exp_f32 v167, v167
  v_cvt_pk_bf16_f32 v184, v160, v161
  v_cvt_pk_bf16_f32 v185, v162, v163
  v_mfma_f32_32x32x16_bf16 v[144:159], v[60:63], v[36:39], v[144:159]
  v_exp_f32 v168, v168
  v_exp_f32 v169, v169
  v_exp_f32 v170, v170
  v_exp_f32 v171, v171
  v_cvt_pk_bf16_f32 v186, v164, v165
  v_cvt_pk_bf16_f32 v187, v166, v167
  v_mfma_f32_32x32x16_bf16 v[192:207], v[108:111], v[180:183], v[192:207]
  v_exp_f32 v172, v172
  v_exp_f32 v173, v173
  v_exp_f32 v174, v174
  v_exp_f32 v175, v175
  v_cvt_pk_bf16_f32 v188, v168, v169
  v_cvt_pk_bf16_f32 v189, v170, v171
  v_cvt_pk_bf16_f32 v190, v172, v173
  v_cvt_pk_bf16_f32 v191, v174, v175
  v_mfma_f32_32x32x16_bf16 v[160:175], v[56:59], v[40:43], 0
  v_exp_f32 v144, v144
  v_exp_f32 v145, v145
  v_exp_f32 v146, v146
  v_exp_f32 v147, v147
  v_mfma_f32_32x32x16_bf16 v[208:223], v[104:107], v[184:187], v[208:223]
  v_exp_f32 v148, v148
  v_exp_f32 v149, v149
  v_exp_f32 v150, v150
  v_exp_f32 v151, v151
  v_cvt_pk_bf16_f32 v176, v144, v145
  v_cvt_pk_bf16_f32 v177, v146, v147
  v_mfma_f32_32x32x16_bf16 v[160:175], v[60:63], v[44:47], v[160:175]
  v_exp_f32 v152, v152
  v_exp_f32 v153, v153
  v_exp_f32 v154, v154
  v_exp_f32 v155, v155
  v_cvt_pk_bf16_f32 v178, v148, v149
  v_cvt_pk_bf16_f32 v179, v150, v151
  v_mfma_f32_32x32x16_bf16 v[208:223], v[108:111], v[188:191], v[208:223]
  v_exp_f32 v156, v156
  v_exp_f32 v157, v157
  v_exp_f32 v158, v158
  v_exp_f32 v159, v159
  v_cvt_pk_bf16_f32 v180, v152, v153
  v_cvt_pk_bf16_f32 v181, v154, v155
  v_cvt_pk_bf16_f32 v182, v156, v157
  v_cvt_pk_bf16_f32 v183, v158, v159
  s_waitcnt vmcnt(6)
  v_mfma_f32_32x32x16_bf16 v[144:159], v[64:67], v[16:19], 0
  v_exp_f32 v160, v160
  v_exp_f32 v161, v161
  v_exp_f32 v162, v162
  v_exp_f32 v163, v163
  v_mfma_f32_32x32x16_bf16 v[224:239], v[104:107], v[176:179], v[224:239]
  v_exp_f32 v164, v164
  v_exp_f32 v165, v165
  v_exp_f32 v166, v166
  v_exp_f32 v167, v167
  v_cvt_pk_bf16_f32 v184, v160, v161
  v_cvt_pk_bf16_f32 v185, v162, v163
  v_mfma_f32_32x32x16_bf16 v[144:159], v[68:71], v[20:23], v[144:159]
  v_exp_f32 v168, v168
  v_exp_f32 v169, v169
  v_exp_f32 v170, v170
  v_exp_f32 v171, v171
  v_cvt_pk_bf16_f32 v186, v164, v165
  v_cvt_pk_bf16_f32 v187, v166, v167
  v_mfma_f32_32x32x16_bf16 v[224:239], v[108:111], v[180:183], v[224:239]
  v_exp_f32 v172, v172
  v_exp_f32 v173, v173
  v_exp_f32 v174, v174
  v_exp_f32 v175, v175
  v_cvt_pk_bf16_f32 v188, v168, v169
  v_cvt_pk_bf16_f32 v189, v170, v171
  v_cvt_pk_bf16_f32 v190, v172, v173
  v_cvt_pk_bf16_f32 v191, v174, v175
  v_mfma_f32_32x32x16_bf16 v[160:175], v[64:67], v[24:27], 0
  s_setprio 3
  buffer_load_dwordx4 v[80:83], v1, s[8:11], s16 offen offset:0 sc1
  buffer_load_dwordx4 v[84:87], v1, s[8:11], s16 offen offset:1024 sc1
  s_setprio 0
  s_add_u32 s16, s16, 2048
  s_and_b32 s16, s16, 0x7fff
  s_or_b32 s16, s16, s15
  v_exp_f32 v144, v144
  v_exp_f32 v145, v145
  v_exp_f32 v146, v146
  v_exp_f32 v147, v147
  v_mfma_f32_32x32x16_bf16 v[240:255], v[104:107], v[184:187], v[240:255]
  v_exp_f32 v148, v148
  v_exp_f32 v149, v149
  v_exp_f32 v150, v150
  v_exp_f32 v151, v151
  v_cvt_pk_bf16_f32 v176, v144, v145
  v_cvt_pk_bf16_f32 v177, v146, v147
  v_mfma_f32_32x32x16_bf16 v[160:175], v[68:71], v[28:31], v[160:175]
  v_exp_f32 v152, v152
  v_exp_f32 v153, v153
  v_exp_f32 v154, v154
  v_exp_f32 v155, v155
  v_cvt_pk_bf16_f32 v178, v148, v149
  v_cvt_pk_bf16_f32 v179, v150, v151
  v_mfma_f32_32x32x16_bf16 v[240:255], v[108:111], v[188:191], v[240:255]
  v_exp_f32 v156, v156
  v_exp_f32 v157, v157
  v_exp_f32 v158, v158
  v_exp_f32 v159, v159
  v_cvt_pk_bf16_f32 v180, v152, v153
  v_cvt_pk_bf16_f32 v181, v154, v155
  v_cvt_pk_bf16_f32 v182, v156, v157
  v_cvt_pk_bf16_f32 v183, v158, v159
  v_mfma_f32_32x32x16_bf16 v[144:159], v[64:67], v[32:35], 0
  v_exp_f32 v160, v160
  v_exp_f32 v161, v161
  v_exp_f32 v162, v162
  v_exp_f32 v163, v163
  s_waitcnt vmcnt(6)
  v_mfma_f32_32x32x16_bf16 v[192:207], v[112:115], v[176:179], v[192:207]
  s_setprio 3
  buffer_load_dwordx4 v[128:131], v1, s[8:11], s17 offen offset:0 sc1
  buffer_load_dwordx4 v[132:135], v1, s[8:11], s17 offen offset:1024 sc1
  s_setprio 0
  s_add_u32 s17, s17, 2048
  s_and_b32 s17, s17, 0x7fff
  s_or_b32 s17, s17, s18
  v_exp_f32 v164, v164
  v_exp_f32 v165, v165
  v_exp_f32 v166, v166
  v_exp_f32 v167, v167
  v_cvt_pk_bf16_f32 v184, v160, v161
  v_cvt_pk_bf16_f32 v185, v162, v163
  v_mfma_f32_32x32x16_bf16 v[144:159], v[68:71], v[36:39], v[144:159]
  v_exp_f32 v168, v168
  v_exp_f32 v169, v169
  v_exp_f32 v170, v170
  v_exp_f32 v171, v171
  v_cvt_pk_bf16_f32 v186, v164, v165
  v_cvt_pk_bf16_f32 v187, v166, v167
  v_mfma_f32_32x32x16_bf16 v[192:207], v[116:119], v[180:183], v[192:207]
  v_exp_f32 v172, v172
  v_exp_f32 v173, v173
  v_exp_f32 v174, v174
  v_exp_f32 v175, v175
  v_cvt_pk_bf16_f32 v188, v168, v169
  v_cvt_pk_bf16_f32 v189, v170, v171
  v_cvt_pk_bf16_f32 v190, v172, v173
  v_cvt_pk_bf16_f32 v191, v174, v175
  v_mfma_f32_32x32x16_bf16 v[160:175], v[64:67], v[40:43], 0
  v_exp_f32 v144, v144
  v_exp_f32 v145, v145
  v_exp_f32 v146, v146
  v_exp_f32 v147, v147
  v_mfma_f32_32x32x16_bf16 v[208:223], v[112:115], v[184:187], v[208:223]
  v_exp_f32 v148, v148
  v_exp_f32 v149, v149
  v_exp_f32 v150, v150
  v_exp_f32 v151, v151
  v_cvt_pk_bf16_f32 v176, v144, v145
  v_cvt_pk_bf16_f32 v177, v146, v147
  v_mfma_f32_32x32x16_bf16 v[160:175], v[68:71], v[44:47], v[160:175]
  v_exp_f32 v152, v152
  v_exp_f32 v153, v153
  v_exp_f32 v154, v154
  v_exp_f32 v155, v155
  v_cvt_pk_bf16_f32 v178, v148, v149
  v_cvt_pk_bf16_f32 v179, v150, v151
  v_mfma_f32_32x32x16_bf16 v[208:223], v[116:119], v[188:191], v[208:223]
  v_exp_f32 v156, v156
  v_exp_f32 v157, v157
  v_exp_f32 v158, v158
  v_exp_f32 v159, v159
  v_cvt_pk_bf16_f32 v180, v152, v153
  v_cvt_pk_bf16_f32 v181, v154, v155
  v_cvt_pk_bf16_f32 v182, v156, v157
  v_cvt_pk_bf16_f32 v183, v158, v159
  s_waitcnt vmcnt(6)
  v_mfma_f32_32x32x16_bf16 v[144:159], v[72:75], v[16:19], 0
  v_exp_f32 v160, v160
  v_exp_f32 v161, v161
  v_exp_f32 v162, v162
  v_exp_f32 v163, v163
  v_mfma_f32_32x32x16_bf16 v[224:239], v[112:115], v[176:179], v[224:239]
  v_exp_f32 v164, v164
  v_exp_f32 v165, v165
  v_exp_f32 v166, v166
  v_exp_f32 v167, v167
  v_cvt_pk_bf16_f32 v184, v160, v161
  v_cvt_pk_bf16_f32 v185, v162, v163
  v_mfma_f32_32x32x16_bf16 v[144:159], v[76:79], v[20:23], v[144:159]
  v_exp_f32 v168, v168
  v_exp_f32 v169, v169
  v_exp_f32 v170, v170
  v_exp_f32 v171, v171
  v_cvt_pk_bf16_f32 v186, v164, v165
  v_cvt_pk_bf16_f32 v187, v166, v167
  v_mfma_f32_32x32x16_bf16 v[224:239], v[116:119], v[180:183], v[224:239]
  v_exp_f32 v172, v172
  v_exp_f32 v173, v173
  v_exp_f32 v174, v174
  v_exp_f32 v175, v175
  v_cvt_pk_bf16_f32 v188, v168, v169
  v_cvt_pk_bf16_f32 v189, v170, v171
  v_cvt_pk_bf16_f32 v190, v172, v173
  v_cvt_pk_bf16_f32 v191, v174, v175
  v_mfma_f32_32x32x16_bf16 v[160:175], v[72:75], v[24:27], 0
  s_setprio 3
  buffer_load_dwordx4 v[88:91], v1, s[8:11], s16 offen offset:0 sc1
  buffer_load_dwordx4 v[92:95], v1, s[8:11], s16 offen offset:1024 sc1
  s_setprio 0
  s_add_u32 s16, s16, 2048
  s_and_b32 s16, s16, 0x7fff
  s_or_b32 s16, s16, s15
  v_exp_f32 v144, v144
  v_exp_f32 v145, v145
  v_exp_f32 v146, v146
  v_exp_f32 v147, v147
  v_mfma_f32_32x32x16_bf16 v[240:255], v[112:115], v[184:187], v[240:255]
  v_exp_f32 v148, v148
  v_exp_f32 v149, v149
  v_exp_f32 v150, v150
  v_exp_f32 v151, v151
  v_cvt_pk_bf16_f32 v176, v144, v145
  v_cvt_pk_bf16_f32 v177, v146, v147
  v_mfma_f32_32x32x16_bf16 v[160:175], v[76:79], v[28:31], v[160:175]
  v_exp_f32 v152, v152
  v_exp_f32 v153, v153
  v_exp_f32 v154, v154
  v_exp_f32 v155, v155
  v_cvt_pk_bf16_f32 v178, v148, v149
  v_cvt_pk_bf16_f32 v179, v150, v151
  v_mfma_f32_32x32x16_bf16 v[240:255], v[116:119], v[188:191], v[240:255]
  v_exp_f32 v156, v156
  v_exp_f32 v157, v157
  v_exp_f32 v158, v158
  v_exp_f32 v159, v159
  v_cvt_pk_bf16_f32 v180, v152, v153
  v_cvt_pk_bf16_f32 v181, v154, v155
  v_cvt_pk_bf16_f32 v182, v156, v157
  v_cvt_pk_bf16_f32 v183, v158, v159
  v_mfma_f32_32x32x16_bf16 v[144:159], v[72:75], v[32:35], 0
  v_exp_f32 v160, v160
  v_exp_f32 v161, v161
  v_exp_f32 v162, v162
  v_exp_f32 v163, v163
  s_waitcnt vmcnt(6)
  v_mfma_f32_32x32x16_bf16 v[192:207], v[120:123], v[176:179], v[192:207]
  s_setprio 3
  buffer_load_dwordx4 v[136:139], v1, s[8:11], s17 offen offset:0 sc1
  buffer_load_dwordx4 v[140:143], v1, s[8:11], s17 offen offset:1024 sc1
  s_setprio 0
  s_add_u32 s17, s17, 2048
  s_and_b32 s17, s17, 0x7fff
  s_or_b32 s17, s17, s18
  v_exp_f32 v164, v164
  v_exp_f32 v165, v165
  v_exp_f32 v166, v166
  v_exp_f32 v167, v167
  v_cvt_pk_bf16_f32 v184, v160, v161
  v_cvt_pk_bf16_f32 v185, v162, v163
  v_mfma_f32_32x32x16_bf16 v[144:159], v[76:79], v[36:39], v[144:159]
  v_exp_f32 v168, v168
  v_exp_f32 v169, v169
  v_exp_f32 v170, v170
  v_exp_f32 v171, v171
  v_cvt_pk_bf16_f32 v186, v164, v165
  v_cvt_pk_bf16_f32 v187, v166, v167
  v_mfma_f32_32x32x16_bf16 v[192:207], v[124:127], v[180:183], v[192:207]
  v_exp_f32 v172, v172
  v_exp_f32 v173, v173
  v_exp_f32 v174, v174
  v_exp_f32 v175, v175
  v_cvt_pk_bf16_f32 v188, v168, v169
  v_cvt_pk_bf16_f32 v189, v170, v171
  v_cvt_pk_bf16_f32 v190, v172, v173
  v_cvt_pk_bf16_f32 v191, v174, v175
  v_mfma_f32_32x32x16_bf16 v[160:175], v[72:75], v[40:43], 0
  v_exp_f32 v144, v144
  v_exp_f32 v145, v145
  v_exp_f32 v146, v146
  v_exp_f32 v147, v147
  v_mfma_f32_32x32x16_bf16 v[208:223], v[120:123], v[184:187], v[208:223]
  v_exp_f32 v148, v148
  v_exp_f32 v149, v149
  v_exp_f32 v150, v150
  v_exp_f32 v151, v151
  v_cvt_pk_bf16_f32 v176, v144, v145
  v_cvt_pk_bf16_f32 v177, v146, v147
  v_mfma_f32_32x32x16_bf16 v[160:175], v[76:79], v[44:47], v[160:175]
  v_exp_f32 v152, v152
  v_exp_f32 v153, v153
  v_exp_f32 v154, v154
  v_exp_f32 v155, v155
  v_cvt_pk_bf16_f32 v178, v148, v149
  v_cvt_pk_bf16_f32 v179, v150, v151
  v_mfma_f32_32x32x16_bf16 v[208:223], v[124:127], v[188:191], v[208:223]
  v_exp_f32 v156, v156
  v_exp_f32 v157, v157
  v_exp_f32 v158, v158
  v_exp_f32 v159, v159
  v_cvt_pk_bf16_f32 v180, v152, v153
  v_cvt_pk_bf16_f32 v181, v154, v155
  v_cvt_pk_bf16_f32 v182, v156, v157
  v_cvt_pk_bf16_f32 v183, v158, v159
  s_waitcnt vmcnt(6)
  v_mfma_f32_32x32x16_bf16 v[144:159], v[80:83], v[16:19], 0
  v_exp_f32 v160, v160
  v_exp_f32 v161, v161
  v_exp_f32 v162, v162
  v_exp_f32 v163, v163
  v_mfma_f32_32x32x16_bf16 v[224:239], v[120:123], v[176:179], v[224:239]
  v_exp_f32 v164, v164
  v_exp_f32 v165, v165
  v_exp_f32 v166, v166
  v_exp_f32 v167, v167
  v_cvt_pk_bf16_f32 v184, v160, v161
  v_cvt_pk_bf16_f32 v185, v162, v163
  v_mfma_f32_32x32x16_bf16 v[144:159], v[84:87], v[20:23], v[144:159]
  v_exp_f32 v168, v168
  v_exp_f32 v169, v169
  v_exp_f32 v170, v170
  v_exp_f32 v171, v171
  v_cvt_pk_bf16_f32 v186, v164, v165
  v_cvt_pk_bf16_f32 v187, v166, v167
  v_mfma_f32_32x32x16_bf16 v[224:239], v[124:127], v[180:183], v[224:239]
  v_exp_f32 v172, v172
  v_exp_f32 v173, v173
  v_exp_f32 v174, v174
  v_exp_f32 v175, v175
  v_cvt_pk_bf16_f32 v188, v168, v169
  v_cvt_pk_bf16_f32 v189, v170, v171
  v_cvt_pk_bf16_f32 v190, v172, v173
  v_cvt_pk_bf16_f32 v191, v174, v175
  v_mfma_f32_32x32x16_bf16 v[160:175], v[80:83], v[24:27], 0
  s_setprio 3
  buffer_load_dwordx4 v[48:51], v1, s[8:11], s16 offen offset:0 sc1
  buffer_load_dwordx4 v[52:55], v1, s[8:11], s16 offen offset:1024 sc1
  s_setprio 0
  s_add_u32 s16, s16, 2048
  s_and_b32 s16, s16, 0x7fff
  s_or_b32 s16, s16, s15
  v_exp_f32 v144, v144
  v_exp_f32 v145, v145
  v_exp_f32 v146, v146
  v_exp_f32 v147, v147
  v_mfma_f32_32x32x16_bf16 v[240:255], v[120:123], v[184:187], v[240:255]
  v_exp_f32 v148, v148
  v_exp_f32 v149, v149
  v_exp_f32 v150, v150
  v_exp_f32 v151, v151
  v_cvt_pk_bf16_f32 v176, v144, v145
  v_cvt_pk_bf16_f32 v177, v146, v147
  v_mfma_f32_32x32x16_bf16 v[160:175], v[84:87], v[28:31], v[160:175]
  v_exp_f32 v152, v152
  v_exp_f32 v153, v153
  v_exp_f32 v154, v154
  v_exp_f32 v155, v155
  v_cvt_pk_bf16_f32 v178, v148, v149
  v_cvt_pk_bf16_f32 v179, v150, v151
  v_mfma_f32_32x32x16_bf16 v[240:255], v[124:127], v[188:191], v[240:255]
  v_exp_f32 v156, v156
  v_exp_f32 v157, v157
  v_exp_f32 v158, v158
  v_exp_f32 v159, v159
  v_cvt_pk_bf16_f32 v180, v152, v153
  v_cvt_pk_bf16_f32 v181, v154, v155
  v_cvt_pk_bf16_f32 v182, v156, v157
  v_cvt_pk_bf16_f32 v183, v158, v159
  v_mfma_f32_32x32x16_bf16 v[144:159], v[80:83], v[32:35], 0
  v_exp_f32 v160, v160
  v_exp_f32 v161, v161
  v_exp_f32 v162, v162
  v_exp_f32 v163, v163
  s_waitcnt vmcnt(6)
  v_mfma_f32_32x32x16_bf16 v[192:207], v[128:131], v[176:179], v[192:207]
  s_setprio 3
  buffer_load_dwordx4 v[96:99], v1, s[8:11], s17 offen offset:0 sc1
  buffer_load_dwordx4 v[100:103], v1, s[8:11], s17 offen offset:1024 sc1
  s_setprio 0
  s_add_u32 s17, s17, 2048
  s_and_b32 s17, s17, 0x7fff
  s_or_b32 s17, s17, s18
  v_exp_f32 v164, v164
  v_exp_f32 v165, v165
  v_exp_f32 v166, v166
  v_exp_f32 v167, v167
  v_cvt_pk_bf16_f32 v184, v160, v161
  v_cvt_pk_bf16_f32 v185, v162, v163
  v_mfma_f32_32x32x16_bf16 v[144:159], v[84:87], v[36:39], v[144:159]
  v_exp_f32 v168, v168
  v_exp_f32 v169, v169
  v_exp_f32 v170, v170
  v_exp_f32 v171, v171
  v_cvt_pk_bf16_f32 v186, v164, v165
  v_cvt_pk_bf16_f32 v187, v166, v167
  v_mfma_f32_32x32x16_bf16 v[192:207], v[132:135], v[180:183], v[192:207]
  v_exp_f32 v172, v172
  v_exp_f32 v173, v173
  v_exp_f32 v174, v174
  v_exp_f32 v175, v175
  v_cvt_pk_bf16_f32 v188, v168, v169
  v_cvt_pk_bf16_f32 v189, v170, v171
  v_cvt_pk_bf16_f32 v190, v172, v173
  v_cvt_pk_bf16_f32 v191, v174, v175
  v_mfma_f32_32x32x16_bf16 v[160:175], v[80:83], v[40:43], 0
  v_exp_f32 v144, v144
  v_exp_f32 v145, v145
  v_exp_f32 v146, v146
  v_exp_f32 v147, v147
  v_mfma_f32_32x32x16_bf16 v[208:223], v[128:131], v[184:187], v[208:223]
  v_exp_f32 v148, v148
  v_exp_f32 v149, v149
  v_exp_f32 v150, v150
  v_exp_f32 v151, v151
  v_cvt_pk_bf16_f32 v176, v144, v145
  v_cvt_pk_bf16_f32 v177, v146, v147
  v_mfma_f32_32x32x16_bf16 v[160:175], v[84:87], v[44:47], v[160:175]
  v_exp_f32 v152, v152
  v_exp_f32 v153, v153
  v_exp_f32 v154, v154
  v_exp_f32 v155, v155
  v_cvt_pk_bf16_f32 v178, v148, v149
  v_cvt_pk_bf16_f32 v179, v150, v151
  v_mfma_f32_32x32x16_bf16 v[208:223], v[132:135], v[188:191], v[208:223]
  v_exp_f32 v156, v156
  v_exp_f32 v157, v157
  v_exp_f32 v158, v158
  v_exp_f32 v159, v159
  v_cvt_pk_bf16_f32 v180, v152, v153
  v_cvt_pk_bf16_f32 v181, v154, v155
  v_cvt_pk_bf16_f32 v182, v156, v157
  v_cvt_pk_bf16_f32 v183, v158, v159
  s_waitcnt vmcnt(6)
  v_mfma_f32_32x32x16_bf16 v[144:159], v[88:91], v[16:19], 0
  v_exp_f32 v160, v160
  v_exp_f32 v161, v161
  v_exp_f32 v162, v162
  v_exp_f32 v163, v163
  v_mfma_f32_32x32x16_bf16 v[224:239], v[128:131], v[176:179], v[224:239]
  v_exp_f32 v164, v164
  v_exp_f32 v165, v165
  v_exp_f32 v166, v166
  v_exp_f32 v167, v167
  v_cvt_pk_bf16_f32 v184, v160, v161
  v_cvt_pk_bf16_f32 v185, v162, v163
  v_mfma_f32_32x32x16_bf16 v[144:159], v[92:95], v[20:23], v[144:159]
  v_exp_f32 v168, v168
  v_exp_f32 v169, v169
  v_exp_f32 v170, v170
  v_exp_f32 v171, v171
  v_cvt_pk_bf16_f32 v186, v164, v165
  v_cvt_pk_bf16_f32 v187, v166, v167
  v_mfma_f32_32x32x16_bf16 v[224:239], v[132:135], v[180:183], v[224:239]
  v_exp_f32 v172, v172
  v_exp_f32 v173, v173
  v_exp_f32 v174, v174
  v_exp_f32 v175, v175
  v_cvt_pk_bf16_f32 v188, v168, v169
  v_cvt_pk_bf16_f32 v189, v170, v171
  v_cvt_pk_bf16_f32 v190, v172, v173
  v_cvt_pk_bf16_f32 v191, v174, v175
  v_mfma_f32_32x32x16_bf16 v[160:175], v[88:91], v[24:27], 0
  s_setprio 3
  buffer_load_dwordx4 v[56:59], v1, s[8:11], s16 offen offset:0 sc1
  buffer_load_dwordx4 v[60:63], v1, s[8:11], s16 offen offset:1024 sc1
  s_setprio 0
  s_add_u32 s16, s16, 2048
  s_and_b32 s16, s16, 0x7fff
  s_or_b32 s16, s16, s15
  v_exp_f32 v144, v144
  v_exp_f32 v145, v145
  v_exp_f32 v146, v146
  v_exp_f32 v147, v147
  v_mfma_f32_32x32x16_bf16 v[240:255], v[128:131], v[184:187], v[240:255]
  v_exp_f32 v148, v148
  v_exp_f32 v149, v149
  v_exp_f32 v150, v150
  v_exp_f32 v151, v151
  v_cvt_pk_bf16_f32 v176, v144, v145
  v_cvt_pk_bf16_f32 v177, v146, v147
  v_mfma_f32_32x32x16_bf16 v[160:175], v[92:95], v[28:31], v[160:175]
  v_exp_f32 v152, v152
  v_exp_f32 v153, v153
  v_exp_f32 v154, v154
  v_exp_f32 v155, v155
  v_cvt_pk_bf16_f32 v178, v148, v149
  v_cvt_pk_bf16_f32 v179, v150, v151
  v_mfma_f32_32x32x16_bf16 v[240:255], v[132:135], v[188:191], v[240:255]
  v_exp_f32 v156, v156
  v_exp_f32 v157, v157
  v_exp_f32 v158, v158
  v_exp_f32 v159, v159
  v_cvt_pk_bf16_f32 v180, v152, v153
  v_cvt_pk_bf16_f32 v181, v154, v155
  v_cvt_pk_bf16_f32 v182, v156, v157
  v_cvt_pk_bf16_f32 v183, v158, v159
  v_mfma_f32_32x32x16_bf16 v[144:159], v[88:91], v[32:35], 0
  v_exp_f32 v160, v160
  v_exp_f32 v161, v161
  v_exp_f32 v162, v162
  v_exp_f32 v163, v163
  s_waitcnt vmcnt(6)
  v_mfma_f32_32x32x16_bf16 v[192:207], v[136:139], v[176:179], v[192:207]
  s_setprio 3
  buffer_load_dwordx4 v[104:107], v1, s[8:11], s17 offen offset:0 sc1
  buffer_load_dwordx4 v[108:111], v1, s[8:11], s17 offen offset:1024 sc1
  s_setprio 0
  s_add_u32 s17, s17, 2048
  s_and_b32 s17, s17, 0x7fff
  s_or_b32 s17, s17, s18
  v_exp_f32 v164, v164
  v_exp_f32 v165, v165
  v_exp_f32 v166, v166
  v_exp_f32 v167, v167
  v_cvt_pk_bf16_f32 v184, v160, v161
  v_cvt_pk_bf16_f32 v185, v162, v163
  v_mfma_f32_32x32x16_bf16 v[144:159], v[92:95], v[36:39], v[144:159]
  v_exp_f32 v168, v168
  v_exp_f32 v169, v169
  v_exp_f32 v170, v170
  v_exp_f32 v171, v171
  v_cvt_pk_bf16_f32 v186, v164, v165
  v_cvt_pk_bf16_f32 v187, v166, v167
  v_mfma_f32_32x32x16_bf16 v[192:207], v[140:143], v[180:183], v[192:207]
  v_exp_f32 v172, v172
  v_exp_f32 v173, v173
  v_exp_f32 v174, v174
  v_exp_f32 v175, v175
  v_cvt_pk_bf16_f32 v188, v168, v169
  v_cvt_pk_bf16_f32 v189, v170, v171
  v_cvt_pk_bf16_f32 v190, v172, v173
  v_cvt_pk_bf16_f32 v191, v174, v175
  v_mfma_f32_32x32x16_bf16 v[160:175], v[88:91], v[40:43], 0
  v_exp_f32 v144, v144
  v_exp_f32 v145, v145
  v_exp_f32 v146, v146
  v_exp_f32 v147, v147
  v_mfma_f32_32x32x16_bf16 v[208:223], v[136:139], v[184:187], v[208:223]
  v_exp_f32 v148, v148
  v_exp_f32 v149, v149
  v_exp_f32 v150, v150
  v_exp_f32 v151, v151
  v_cvt_pk_bf16_f32 v176, v144, v145
  v_cvt_pk_bf16_f32 v177, v146, v147
  v_mfma_f32_32x32x16_bf16 v[160:175], v[92:95], v[44:47], v[160:175]
  v_exp_f32 v152, v152
  v_exp_f32 v153, v153
  v_exp_f32 v154, v154
  v_exp_f32 v155, v155
  v_cvt_pk_bf16_f32 v178, v148, v149
  v_cvt_pk_bf16_f32 v179, v150, v151
  v_mfma_f32_32x32x16_bf16 v[208:223], v[140:143], v[188:191], v[208:223]
  v_exp_f32 v156, v156
  v_exp_f32 v157, v157
  v_exp_f32 v158, v158
  v_exp_f32 v159, v159
  v_cvt_pk_bf16_f32 v180, v152, v153
  v_cvt_pk_bf16_f32 v181, v154, v155
  v_cvt_pk_bf16_f32 v182, v156, v157
  v_cvt_pk_bf16_f32 v183, v158, v159
  s_waitcnt vmcnt(6)
  v_mfma_f32_32x32x16_bf16 v[144:159], v[48:51], v[16:19], 0
  v_exp_f32 v160, v160
  v_exp_f32 v161, v161
  v_exp_f32 v162, v162
  v_exp_f32 v163, v163
  v_mfma_f32_32x32x16_bf16 v[224:239], v[136:139], v[176:179], v[224:239]
  v_exp_f32 v164, v164
  v_exp_f32 v165, v165
  v_exp_f32 v166, v166
  v_exp_f32 v167, v167
  v_cvt_pk_bf16_f32 v184, v160, v161
  v_cvt_pk_bf16_f32 v185, v162, v163
  v_mfma_f32_32x32x16_bf16 v[144:159], v[52:55], v[20:23], v[144:159]
  v_exp_f32 v168, v168
  v_exp_f32 v169, v169
  v_exp_f32 v170, v170
  v_exp_f32 v171, v171
  v_cvt_pk_bf16_f32 v186, v164, v165
  v_cvt_pk_bf16_f32 v187, v166, v167
  v_mfma_f32_32x32x16_bf16 v[224:239], v[140:143], v[180:183], v[224:239]
  v_exp_f32 v172, v172
  v_exp_f32 v173, v173
  v_exp_f32 v174, v174
  v_exp_f32 v175, v175
  v_cvt_pk_bf16_f32 v188, v168, v169
  v_cvt_pk_bf16_f32 v189, v170, v171
  v_cvt_pk_bf16_f32 v190, v172, v173
  v_cvt_pk_bf16_f32 v191, v174, v175
  v_mfma_f32_32x32x16_bf16 v[160:175], v[48:51], v[24:27], 0
  s_setprio 3
  buffer_load_dwordx4 v[64:67], v1, s[8:11], s16 offen offset:0 sc1
  buffer_load_dwordx4 v[68:71], v1, s[8:11], s16 offen offset:1024 sc1
  s_setprio 0
  s_add_u32 s16, s16, 2048
  s_and_b32 s16, s16, 0x7fff
  s_or_b32 s16, s16, s15
  v_exp_f32 v144, v144
  v_exp_f32 v145, v145
  v_exp_f32 v146, v146
  v_exp_f32 v147, v147
  v_mfma_f32_32x32x16_bf16 v[240:255], v[136:139], v[184:187], v[240:255]
  v_exp_f32 v148, v148
  v_exp_f32 v149, v149
  v_exp_f32 v150, v150
  v_exp_f32 v151, v151
  v_cvt_pk_bf16_f32 v176, v144, v145
  v_cvt_pk_bf16_f32 v177, v146, v147
  v_mfma_f32_32x32x16_bf16 v[160:175], v[52:55], v[28:31], v[160:175]
  v_exp_f32 v152, v152
  v_exp_f32 v153, v153
  v_exp_f32 v154, v154
  v_exp_f32 v155, v155
  v_cvt_pk_bf16_f32 v178, v148, v149
  v_cvt_pk_bf16_f32 v179, v150, v151
  v_mfma_f32_32x32x16_bf16 v[240:255], v[140:143], v[188:191], v[240:255]
  v_exp_f32 v156, v156
  v_exp_f32 v157, v157
  v_exp_f32 v158, v158
  v_exp_f32 v159, v159
  v_cvt_pk_bf16_f32 v180, v152, v153
  v_cvt_pk_bf16_f32 v181, v154, v155
  v_cvt_pk_bf16_f32 v182, v156, v157
  v_cvt_pk_bf16_f32 v183, v158, v159
  v_mfma_f32_32x32x16_bf16 v[144:159], v[48:51], v[32:35], 0
  v_exp_f32 v160, v160
  v_exp_f32 v161, v161
  v_exp_f32 v162, v162
  v_exp_f32 v163, v163
  s_waitcnt vmcnt(6)
  v_mfma_f32_32x32x16_bf16 v[192:207], v[96:99], v[176:179], v[192:207]
  s_setprio 3
  buffer_load_dwordx4 v[112:115], v1, s[8:11], s17 offen offset:0 sc1
  buffer_load_dwordx4 v[116:119], v1, s[8:11], s17 offen offset:1024 sc1
  s_setprio 0
  s_add_u32 s17, s17, 2048
  s_and_b32 s17, s17, 0x7fff
  s_or_b32 s17, s17, s18
  v_exp_f32 v164, v164
  v_exp_f32 v165, v165
  v_exp_f32 v166, v166
  v_exp_f32 v167, v167
  v_cvt_pk_bf16_f32 v184, v160, v161
  v_cvt_pk_bf16_f32 v185, v162, v163
  v_mfma_f32_32x32x16_bf16 v[144:159], v[52:55], v[36:39], v[144:159]
  v_exp_f32 v168, v168
  v_exp_f32 v169, v169
  v_exp_f32 v170, v170
  v_exp_f32 v171, v171
  v_cvt_pk_bf16_f32 v186, v164, v165
  v_cvt_pk_bf16_f32 v187, v166, v167
  v_mfma_f32_32x32x16_bf16 v[192:207], v[100:103], v[180:183], v[192:207]
  v_exp_f32 v172, v172
  v_exp_f32 v173, v173
  v_exp_f32 v174, v174
  v_exp_f32 v175, v175
  v_cvt_pk_bf16_f32 v188, v168, v169
  v_cvt_pk_bf16_f32 v189, v170, v171
  v_cvt_pk_bf16_f32 v190, v172, v173
  v_cvt_pk_bf16_f32 v191, v174, v175
  v_mfma_f32_32x32x16_bf16 v[160:175], v[48:51], v[40:43], 0
  v_exp_f32 v144, v144
  v_exp_f32 v145, v145
  v_exp_f32 v146, v146
  v_exp_f32 v147, v147
  v_mfma_f32_32x32x16_bf16 v[208:223], v[96:99], v[184:187], v[208:223]
  v_exp_f32 v148, v148
  v_exp_f32 v149, v149
  v_exp_f32 v150, v150
  v_exp_f32 v151, v151
  v_cvt_pk_bf16_f32 v176, v144, v145
  v_cvt_pk_bf16_f32 v177, v146, v147
  v_mfma_f32_32x32x16_bf16 v[160:175], v[52:55], v[44:47], v[160:175]
  v_exp_f32 v152, v152
  v_exp_f32 v153, v153
  v_exp_f32 v154, v154
  v_exp_f32 v155, v155
  v_cvt_pk_bf16_f32 v178, v148, v149
  v_cvt_pk_bf16_f32 v179, v150, v151
  v_mfma_f32_32x32x16_bf16 v[208:223], v[100:103], v[188:191], v[208:223]
  v_exp_f32 v156, v156
  v_exp_f32 v157, v157
  v_exp_f32 v158, v158
  v_exp_f32 v159, v159
  v_cvt_pk_bf16_f32 v180, v152, v153
  v_cvt_pk_bf16_f32 v181, v154, v155
  v_cvt_pk_bf16_f32 v182, v156, v157
  v_cvt_pk_bf16_f32 v183, v158, v159
  s_waitcnt vmcnt(6)
  v_mfma_f32_32x32x16_bf16 v[144:159], v[56:59], v[16:19], 0
  v_exp_f32 v160, v160
  v_exp_f32 v161, v161
  v_exp_f32 v162, v162
  v_exp_f32 v163, v163
  v_mfma_f32_32x32x16_bf16 v[224:239], v[96:99], v[176:179], v[224:239]
  v_exp_f32 v164, v164
  v_exp_f32 v165, v165
  v_exp_f32 v166, v166
  v_exp_f32 v167, v167
  v_cvt_pk_bf16_f32 v184, v160, v161
  v_cvt_pk_bf16_f32 v185, v162, v163
  v_mfma_f32_32x32x16_bf16 v[144:159], v[60:63], v[20:23], v[144:159]
  v_exp_f32 v168, v168
  v_exp_f32 v169, v169
  v_exp_f32 v170, v170
  v_exp_f32 v171, v171
  v_cvt_pk_bf16_f32 v186, v164, v165
  v_cvt_pk_bf16_f32 v187, v166, v167
  v_mfma_f32_32x32x16_bf16 v[224:239], v[100:103], v[180:183], v[224:239]
  v_exp_f32 v172, v172
  v_exp_f32 v173, v173
  v_exp_f32 v174, v174
  v_exp_f32 v175, v175
  v_cvt_pk_bf16_f32 v188, v168, v169
  v_cvt_pk_bf16_f32 v189, v170, v171
  v_cvt_pk_bf16_f32 v190, v172, v173
  v_cvt_pk_bf16_f32 v191, v174, v175
  v_mfma_f32_32x32x16_bf16 v[160:175], v[56:59], v[24:27], 0
  s_setprio 3
  buffer_load_dwordx4 v[72:75], v1, s[8:11], s16 offen offset:0 sc1
  buffer_load_dwordx4 v[76:79], v1, s[8:11], s16 offen offset:1024 sc1
  s_setprio 0
  s_add_u32 s16, s16, 2048
  s_and_b32 s16, s16, 0x7fff
  s_or_b32 s16, s16, s15
  v_exp_f32 v144, v144
  v_exp_f32 v145, v145
  v_exp_f32 v146, v146
  v_exp_f32 v147, v147
  v_mfma_f32_32x32x16_bf16 v[240:255], v[96:99], v[184:187], v[240:255]
  v_exp_f32 v148, v148
  v_exp_f32 v149, v149
  v_exp_f32 v150, v150
  v_exp_f32 v151, v151
  v_cvt_pk_bf16_f32 v176, v144, v145
  v_cvt_pk_bf16_f32 v177, v146, v147
  v_mfma_f32_32x32x16_bf16 v[160:175], v[60:63], v[28:31], v[160:175]
  v_exp_f32 v152, v152
  v_exp_f32 v153, v153
  v_exp_f32 v154, v154
  v_exp_f32 v155, v155
  v_cvt_pk_bf16_f32 v178, v148, v149
  v_cvt_pk_bf16_f32 v179, v150, v151
  v_mfma_f32_32x32x16_bf16 v[240:255], v[100:103], v[188:191], v[240:255]
  v_exp_f32 v156, v156
  v_exp_f32 v157, v157
  v_exp_f32 v158, v158
  v_exp_f32 v159, v159
  v_cvt_pk_bf16_f32 v180, v152, v153
  v_cvt_pk_bf16_f32 v181, v154, v155
  v_cvt_pk_bf16_f32 v182, v156, v157
  v_cvt_pk_bf16_f32 v183, v158, v159
  v_mfma_f32_32x32x16_bf16 v[144:159], v[56:59], v[32:35], 0
  v_exp_f32 v160, v160
  v_exp_f32 v161, v161
  v_exp_f32 v162, v162
  v_exp_f32 v163, v163
  s_waitcnt vmcnt(6)
  v_mfma_f32_32x32x16_bf16 v[192:207], v[104:107], v[176:179], v[192:207]
  s_setprio 3
  buffer_load_dwordx4 v[120:123], v1, s[8:11], s17 offen offset:0 sc1
  buffer_load_dwordx4 v[124:127], v1, s[8:11], s17 offen offset:1024 sc1
  s_setprio 0
  s_add_u32 s17, s17, 2048
  s_and_b32 s17, s17, 0x7fff
  s_or_b32 s17, s17, s18
  v_exp_f32 v164, v164
  v_exp_f32 v165, v165
  v_exp_f32 v166, v166
  v_exp_f32 v167, v167
  v_cvt_pk_bf16_f32 v184, v160, v161
  v_cvt_pk_bf16_f32 v185, v162, v163
  v_mfma_f32_32x32x16_bf16 v[144:159], v[60:63], v[36:39], v[144:159]
  v_exp_f32 v168, v168
  v_exp_f32 v169, v169
  v_exp_f32 v170, v170
  v_exp_f32 v171, v171
  v_cvt_pk_bf16_f32 v186, v164, v165
  v_cvt_pk_bf16_f32 v187, v166, v167
  v_mfma_f32_32x32x16_bf16 v[192:207], v[108:111], v[180:183], v[192:207]
  v_exp_f32 v172, v172
  v_exp_f32 v173, v173
  v_exp_f32 v174, v174
  v_exp_f32 v175, v175
  v_cvt_pk_bf16_f32 v188, v168, v169
  v_cvt_pk_bf16_f32 v189, v170, v171
  v_cvt_pk_bf16_f32 v190, v172, v173
  v_cvt_pk_bf16_f32 v191, v174, v175
  v_mfma_f32_32x32x16_bf16 v[160:175], v[56:59], v[40:43], 0
  v_exp_f32 v144, v144
  v_exp_f32 v145, v145
  v_exp_f32 v146, v146
  v_exp_f32 v147, v147
  v_mfma_f32_32x32x16_bf16 v[208:223], v[104:107], v[184:187], v[208:223]
  v_exp_f32 v148, v148
  v_exp_f32 v149, v149
  v_exp_f32 v150, v150
  v_exp_f32 v151, v151
  v_cvt_pk_bf16_f32 v176, v144, v145
  v_cvt_pk_bf16_f32 v177, v146, v147
  v_mfma_f32_32x32x16_bf16 v[160:175], v[60:63], v[44:47], v[160:175]
  v_exp_f32 v152, v152
  v_exp_f32 v153, v153
  v_exp_f32 v154, v154
  v_exp_f32 v155, v155
  v_cvt_pk_bf16_f32 v178, v148, v149
  v_cvt_pk_bf16_f32 v179, v150, v151
  v_mfma_f32_32x32x16_bf16 v[208:223], v[108:111], v[188:191], v[208:223]
  v_exp_f32 v156, v156
  v_exp_f32 v157, v157
  v_exp_f32 v158, v158
  v_exp_f32 v159, v159
  v_cvt_pk_bf16_f32 v180, v152, v153
  v_cvt_pk_bf16_f32 v181, v154, v155
  v_cvt_pk_bf16_f32 v182, v156, v157
  v_cvt_pk_bf16_f32 v183, v158, v159
  s_waitcnt vmcnt(6)
  v_mfma_f32_32x32x16_bf16 v[144:159], v[64:67], v[16:19], 0
  v_exp_f32 v160, v160
  v_exp_f32 v161, v161
  v_exp_f32 v162, v162
  v_exp_f32 v163, v163
  v_mfma_f32_32x32x16_bf16 v[224:239], v[104:107], v[176:179], v[224:239]
  v_exp_f32 v164, v164
  v_exp_f32 v165, v165
  v_exp_f32 v166, v166
  v_exp_f32 v167, v167
  v_cvt_pk_bf16_f32 v184, v160, v161
  v_cvt_pk_bf16_f32 v185, v162, v163
  v_mfma_f32_32x32x16_bf16 v[144:159], v[68:71], v[20:23], v[144:159]
  v_exp_f32 v168, v168
  v_exp_f32 v169, v169
  v_exp_f32 v170, v170
  v_exp_f32 v171, v171
  v_cvt_pk_bf16_f32 v186, v164, v165
  v_cvt_pk_bf16_f32 v187, v166, v167
  v_mfma_f32_32x32x16_bf16 v[224:239], v[108:111], v[180:183], v[224:239]
  v_exp_f32 v172, v172
  v_exp_f32 v173, v173
  v_exp_f32 v174, v174
  v_exp_f32 v175, v175
  v_cvt_pk_bf16_f32 v188, v168, v169
  v_cvt_pk_bf16_f32 v189, v170, v171
  v_cvt_pk_bf16_f32 v190, v172, v173
  v_cvt_pk_bf16_f32 v191, v174, v175
  v_mfma_f32_32x32x16_bf16 v[160:175], v[64:67], v[24:27], 0
  v_exp_f32 v144, v144
  v_exp_f32 v145, v145
  v_exp_f32 v146, v146
  v_exp_f32 v147, v147
  v_mfma_f32_32x32x16_bf16 v[240:255], v[104:107], v[184:187], v[240:255]
  v_exp_f32 v148, v148
  v_exp_f32 v149, v149
  v_exp_f32 v150, v150
  v_exp_f32 v151, v151
  v_cvt_pk_bf16_f32 v176, v144, v145
  v_cvt_pk_bf16_f32 v177, v146, v147
  v_mfma_f32_32x32x16_bf16 v[160:175], v[68:71], v[28:31], v[160:175]
  v_exp_f32 v152, v152
  v_exp_f32 v153, v153
  v_exp_f32 v154, v154
  v_exp_f32 v155, v155
  v_cvt_pk_bf16_f32 v178, v148, v149
  v_cvt_pk_bf16_f32 v179, v150, v151
  v_mfma_f32_32x32x16_bf16 v[240:255], v[108:111], v[188:191], v[240:255]
  v_exp_f32 v156, v156
  v_exp_f32 v157, v157
  v_exp_f32 v158, v158
  v_exp_f32 v159, v159
  v_cvt_pk_bf16_f32 v180, v152, v153
  v_cvt_pk_bf16_f32 v181, v154, v155
  v_cvt_pk_bf16_f32 v182, v156, v157
  v_cvt_pk_bf16_f32 v183, v158, v159
  v_mfma_f32_32x32x16_bf16 v[144:159], v[64:67], v[32:35], 0
  v_exp_f32 v160, v160
  v_exp_f32 v161, v161
  v_exp_f32 v162, v162
  v_exp_f32 v163, v163
  s_waitcnt vmcnt(4)
  v_mfma_f32_32x32x16_bf16 v[192:207], v[112:115], v[176:179], v[192:207]
  v_exp_f32 v164, v164
  v_exp_f32 v165, v165
  v_exp_f32 v166, v166
  v_exp_f32 v167, v167
  v_cvt_pk_bf16_f32 v184, v160, v161
  v_cvt_pk_bf16_f32 v185, v162, v163
  v_mfma_f32_32x32x16_bf16 v[144:159], v[68:71], v[36:39], v[144:159]
  v_exp_f32 v168, v168
  v_exp_f32 v169, v169
  v_exp_f32 v170, v170
  v_exp_f32 v171, v171
  v_cvt_pk_bf16_f32 v186, v164, v165
  v_cvt_pk_bf16_f32 v187, v166, v167
  v_mfma_f32_32x32x16_bf16 v[192:207], v[116:119], v[180:183], v[192:207]
  v_exp_f32 v172, v172
  v_exp_f32 v173, v173
  v_exp_f32 v174, v174
  v_exp_f32 v175, v175
  v_cvt_pk_bf16_f32 v188, v168, v169
  v_cvt_pk_bf16_f32 v189, v170, v171
  v_cvt_pk_bf16_f32 v190, v172, v173
  v_cvt_pk_bf16_f32 v191, v174, v175
  v_mfma_f32_32x32x16_bf16 v[160:175], v[64:67], v[40:43], 0
  v_exp_f32 v144, v144
  v_exp_f32 v145, v145
  v_exp_f32 v146, v146
  v_exp_f32 v147, v147
  v_mfma_f32_32x32x16_bf16 v[208:223], v[112:115], v[184:187], v[208:223]
  v_exp_f32 v148, v148
  v_exp_f32 v149, v149
  v_exp_f32 v150, v150
  v_exp_f32 v151, v151
  v_cvt_pk_bf16_f32 v176, v144, v145
  v_cvt_pk_bf16_f32 v177, v146, v147
  v_mfma_f32_32x32x16_bf16 v[160:175], v[68:71], v[44:47], v[160:175]
  v_exp_f32 v152, v152
  v_exp_f32 v153, v153
  v_exp_f32 v154, v154
  v_exp_f32 v155, v155
  v_cvt_pk_bf16_f32 v178, v148, v149
  v_cvt_pk_bf16_f32 v179, v150, v151
  v_mfma_f32_32x32x16_bf16 v[208:223], v[116:119], v[188:191], v[208:223]
  v_exp_f32 v156, v156
  v_exp_f32 v157, v157
  v_exp_f32 v158, v158
  v_exp_f32 v159, v159
  v_cvt_pk_bf16_f32 v180, v152, v153
  v_cvt_pk_bf16_f32 v181, v154, v155
  v_cvt_pk_bf16_f32 v182, v156, v157
  v_cvt_pk_bf16_f32 v183, v158, v159
  s_waitcnt vmcnt(2)
  v_mfma_f32_32x32x16_bf16 v[144:159], v[72:75], v[16:19], 0
  v_exp_f32 v160, v160
  v_exp_f32 v161, v161
  v_exp_f32 v162, v162
  v_exp_f32 v163, v163
  v_mfma_f32_32x32x16_bf16 v[224:239], v[112:115], v[176:179], v[224:239]
  v_exp_f32 v164, v164
  v_exp_f32 v165, v165
  v_exp_f32 v166, v166
  v_exp_f32 v167, v167
  v_cvt_pk_bf16_f32 v184, v160, v161
  v_cvt_pk_bf16_f32 v185, v162, v163
  v_mfma_f32_32x32x16_bf16 v[144:159], v[76:79], v[20:23], v[144:159]
  v_exp_f32 v168, v168
  v_exp_f32 v169, v169
  v_exp_f32 v170, v170
  v_exp_f32 v171, v171
  v_cvt_pk_bf16_f32 v186, v164, v165
  v_cvt_pk_bf16_f32 v187, v166, v167
  v_mfma_f32_32x32x16_bf16 v[224:239], v[116:119], v[180:183], v[224:239]
  v_exp_f32 v172, v172
  v_exp_f32 v173, v173
  v_exp_f32 v174, v174
  v_exp_f32 v175, v175
  v_cvt_pk_bf16_f32 v188, v168, v169
  v_cvt_pk_bf16_f32 v189, v170, v171
  v_cvt_pk_bf16_f32 v190, v172, v173
  v_cvt_pk_bf16_f32 v191, v174, v175
  v_mfma_f32_32x32x16_bf16 v[160:175], v[72:75], v[24:27], 0
  v_exp_f32 v144, v144
  v_exp_f32 v145, v145
  v_exp_f32 v146, v146
  v_exp_f32 v147, v147
  v_mfma_f32_32x32x16_bf16 v[240:255], v[112:115], v[184:187], v[240:255]
  v_exp_f32 v148, v148
  v_exp_f32 v149, v149
  v_exp_f32 v150, v150
  v_exp_f32 v151, v151
  v_cvt_pk_bf16_f32 v176, v144, v145
  v_cvt_pk_bf16_f32 v177, v146, v147
  v_mfma_f32_32x32x16_bf16 v[160:175], v[76:79], v[28:31], v[160:175]
  v_exp_f32 v152, v152
  v_exp_f32 v153, v153
  v_exp_f32 v154, v154
  v_exp_f32 v155, v155
  v_cvt_pk_bf16_f32 v178, v148, v149
  v_cvt_pk_bf16_f32 v179, v150, v151
  v_mfma_f32_32x32x16_bf16 v[240:255], v[116:119], v[188:191], v[240:255]
  v_exp_f32 v156, v156
  v_exp_f32 v157, v157
  v_exp_f32 v158, v158
  v_exp_f32 v159, v159
  v_cvt_pk_bf16_f32 v180, v152, v153
  v_cvt_pk_bf16_f32 v181, v154, v155
  v_cvt_pk_bf16_f32 v182, v156, v157
  v_cvt_pk_bf16_f32 v183, v158, v159
  v_mfma_f32_32x32x16_bf16 v[144:159], v[72:75], v[32:35], 0
  v_exp_f32 v160, v160
  v_exp_f32 v161, v161
  v_exp_f32 v162, v162
  v_exp_f32 v163, v163
  s_waitcnt vmcnt(0)
  v_mfma_f32_32x32x16_bf16 v[192:207], v[120:123], v[176:179], v[192:207]
  v_exp_f32 v164, v164
  v_exp_f32 v165, v165
  v_exp_f32 v166, v166
  v_exp_f32 v167, v167
  v_cvt_pk_bf16_f32 v184, v160, v161
  v_cvt_pk_bf16_f32 v185, v162, v163
  v_mfma_f32_32x32x16_bf16 v[144:159], v[76:79], v[36:39], v[144:159]
  v_exp_f32 v168, v168
  v_exp_f32 v169, v169
  v_exp_f32 v170, v170
  v_exp_f32 v171, v171
  v_cvt_pk_bf16_f32 v186, v164, v165
  v_cvt_pk_bf16_f32 v187, v166, v167
  v_mfma_f32_32x32x16_bf16 v[192:207], v[124:127], v[180:183], v[192:207]
  v_exp_f32 v172, v172
  v_exp_f32 v173, v173
  v_exp_f32 v174, v174
  v_exp_f32 v175, v175
  v_cvt_pk_bf16_f32 v188, v168, v169
  v_cvt_pk_bf16_f32 v189, v170, v171
  v_cvt_pk_bf16_f32 v190, v172, v173
  v_cvt_pk_bf16_f32 v191, v174, v175
  v_mfma_f32_32x32x16_bf16 v[160:175], v[72:75], v[40:43], 0
  v_exp_f32 v144, v144
  v_exp_f32 v145, v145
  v_exp_f32 v146, v146
  v_exp_f32 v147, v147
  v_mfma_f32_32x32x16_bf16 v[208:223], v[120:123], v[184:187], v[208:223]
  v_exp_f32 v148, v148
  v_exp_f32 v149, v149
  v_exp_f32 v150, v150
  v_exp_f32 v151, v151
  v_cvt_pk_bf16_f32 v176, v144, v145
  v_cvt_pk_bf16_f32 v177, v146, v147
  v_mfma_f32_32x32x16_bf16 v[160:175], v[76:79], v[44:47], v[160:175]
  v_exp_f32 v152, v152
  v_exp_f32 v153, v153
  v_exp_f32 v154, v154
  v_exp_f32 v155, v155
  v_cvt_pk_bf16_f32 v178, v148, v149
  v_cvt_pk_bf16_f32 v179, v150, v151
  v_mfma_f32_32x32x16_bf16 v[208:223], v[124:127], v[188:191], v[208:223]
  v_exp_f32 v156, v156
  v_exp_f32 v157, v157
  v_exp_f32 v158, v158
  v_exp_f32 v159, v159
  v_cvt_pk_bf16_f32 v180, v152, v153
  v_cvt_pk_bf16_f32 v181, v154, v155
  v_cvt_pk_bf16_f32 v182, v156, v157
  v_cvt_pk_bf16_f32 v183, v158, v159
  v_exp_f32 v160, v160
  v_exp_f32 v161, v161
  v_exp_f32 v162, v162
  v_exp_f32 v163, v163
  v_mfma_f32_32x32x16_bf16 v[224:239], v[120:123], v[176:179], v[224:239]
  v_exp_f32 v164, v164
  v_exp_f32 v165, v165
  v_exp_f32 v166, v166
  v_exp_f32 v167, v167
  v_cvt_pk_bf16_f32 v184, v160, v161
  v_cvt_pk_bf16_f32 v185, v162, v163
  v_exp_f32 v168, v168
  v_exp_f32 v169, v169
  v_exp_f32 v170, v170
  v_exp_f32 v171, v171
  v_cvt_pk_bf16_f32 v186, v164, v165
  v_cvt_pk_bf16_f32 v187, v166, v167
  v_mfma_f32_32x32x16_bf16 v[224:239], v[124:127], v[180:183], v[224:239]
  v_exp_f32 v172, v172
  v_exp_f32 v173, v173
  v_exp_f32 v174, v174
  v_exp_f32 v175, v175
  v_cvt_pk_bf16_f32 v188, v168, v169
  v_cvt_pk_bf16_f32 v189, v170, v171
  v_cvt_pk_bf16_f32 v190, v172, v173
  v_cvt_pk_bf16_f32 v191, v174, v175
parallel_sum__softmax_full_mha__mixer_s_mlp__prompt_kernel_are:
  s_nop 1
  v_mfma_f32_32x32x16_bf16 v[240:255], v[120:123], v[184:187], v[240:255]
  v_mfma_f32_32x32x16_bf16 v[240:255], v[124:127], v[188:191], v[240:255]
  s_setprio 3
  v_mov_b32 v12, 159752
  s_mov_b32 s35, 0
lw_50:
  ds_read_b32 v13, v12
  s_add_u32 s35, s35, 1
  s_waitcnt lgkmcnt(0)
  v_readfirstlane_b32 s34, v13
  s_cmp_gt_u32 s35, 1048576
  s_cbranch_scc1 lwx_51
  s_cmp_lt_u32 s34, 4
  s_cbranch_scc1 lw_50
lwx_51:
  s_xor_b32 s22, s32, 2
  s_lshl_b32 s22, s22, 13
  v_add_u32 v3, s22, v1
  s_lshl_b32 s22, s32, 13
  v_add_u32 v4, s22, v1
  s_xor_b32 s22, s32, 1
  s_lshl_b32 s22, s22, 13
  v_add_u32 v5, s22, v1
  s_nop 3
  ds_write_b128 v3, v[224:227] offset:0
  ds_write_b128 v3, v[228:231] offset:1024
  ds_write_b128 v3, v[232:235] offset:2048
  ds_write_b128 v3, v[236:239] offset:3072
  s_nop 7
  ds_write_b128 v3, v[240:243] offset:4096
  ds_write_b128 v3, v[244:247] offset:5120
  ds_write_b128 v3, v[248:251] offset:6144
  ds_write_b128 v3, v[252:255] offset:7168
  v_mov_b32 v12, 159744
  v_mov_b32 v13, 1
  s_add_u32 s33, s33, 4
  s_waitcnt lgkmcnt(0)
  s_mov_b32 exec_lo, 1
  s_mov_b32 exec_hi, 0
  ds_add_u32 v12, v13
  s_mov_b32 exec_lo, -1
  s_mov_b32 exec_hi, -1
  s_mov_b32 s35, 0
sb_52:
  ds_read_b32 v13, v12
  s_add_u32 s35, s35, 1
  s_waitcnt lgkmcnt(0)
  v_readfirstlane_b32 s34, v13
  s_cmp_gt_u32 s35, 1048576
  s_cbranch_scc1 sbx_53
  s_cmp_lt_u32 s34, s33
  s_cbranch_scc1 sb_52
sbx_53:
  ds_read_b128 v[48:51], v4 offset:0
  ds_read_b128 v[52:55], v4 offset:1024
  ds_read_b128 v[56:59], v4 offset:2048
  ds_read_b128 v[60:63], v4 offset:3072
  ds_read_b128 v[64:67], v4 offset:4096
  ds_read_b128 v[68:71], v4 offset:5120
  ds_read_b128 v[72:75], v4 offset:6144
  ds_read_b128 v[76:79], v4 offset:7168
  s_waitcnt lgkmcnt(4)
  v_add_f32 v192, v192, v48
  v_add_f32 v193, v193, v49
  v_add_f32 v194, v194, v50
  v_add_f32 v195, v195, v51
  v_add_f32 v196, v196, v52
  v_add_f32 v197, v197, v53
  v_add_f32 v198, v198, v54
  v_add_f32 v199, v199, v55
  v_add_f32 v200, v200, v56
  v_add_f32 v201, v201, v57
  v_add_f32 v202, v202, v58
  v_add_f32 v203, v203, v59
  v_add_f32 v204, v204, v60
  v_add_f32 v205, v205, v61
  v_add_f32 v206, v206, v62
  v_add_f32 v207, v207, v63
  s_waitcnt lgkmcnt(0)
  v_add_f32 v208, v208, v64
  v_add_f32 v209, v209, v65
  v_add_f32 v210, v210, v66
  v_add_f32 v211, v211, v67
  v_add_f32 v212, v212, v68
  v_add_f32 v213, v213, v69
  v_add_f32 v214, v214, v70
  v_add_f32 v215, v215, v71
  v_add_f32 v216, v216, v72
  v_add_f32 v217, v217, v73
  v_add_f32 v218, v218, v74
  v_add_f32 v219, v219, v75
  v_add_f32 v220, v220, v76
  v_add_f32 v221, v221, v77
  v_add_f32 v222, v222, v78
  v_add_f32 v223, v223, v79
  ds_write_b128 v4, v[208:211] offset:0
  ds_write_b128 v4, v[212:215] offset:1024
  ds_write_b128 v4, v[216:219] offset:2048
  ds_write_b128 v4, v[220:223] offset:3072
  v_mov_b32 v12, 159744
  v_mov_b32 v13, 1
  s_add_u32 s33, s33, 4
  s_waitcnt lgkmcnt(0)
  s_mov_b32 exec_lo, 1
  s_mov_b32 exec_hi, 0
  ds_add_u32 v12, v13
  s_mov_b32 exec_lo, -1
  s_mov_b32 exec_hi, -1
  s_mov_b32 s35, 0
sb_54:
  ds_read_b32 v13, v12
  s_add_u32 s35, s35, 1
  s_waitcnt lgkmcnt(0)
  v_readfirstlane_b32 s34, v13
  s_cmp_gt_u32 s35, 1048576
  s_cbranch_scc1 sbx_55
  s_cmp_lt_u32 s34, s33
  s_cbranch_scc1 sb_54
sbx_55:
  ds_read_b128 v[48:51], v5 offset:0
  ds_read_b128 v[52:55], v5 offset:1024
  ds_read_b128 v[56:59], v5 offset:2048
  ds_read_b128 v[60:63], v5 offset:3072
  s_waitcnt lgkmcnt(0)
  v_add_f32 v192, v192, v48
  v_add_f32 v193, v193, v49
  v_add_f32 v194, v194, v50
  v_add_f32 v195, v195, v51
  v_add_f32 v196, v196, v52
  v_add_f32 v197, v197, v53
  v_add_f32 v198, v198, v54
  v_add_f32 v199, v199, v55
  v_add_f32 v200, v200, v56
  v_add_f32 v201, v201, v57
  v_add_f32 v202, v202, v58
  v_add_f32 v203, v203, v59
  v_add_f32 v204, v204, v60
  v_add_f32 v205, v205, v61
  v_add_f32 v206, v206, v62
  v_add_f32 v207, v207, v63
  v_mov_b32 v7, v204
  v_mov_b32 v8, v204
  v_mov_b32 v9, 0
  s_nop 0
  v_permlane32_swap_b32 v7, v8
  v_fma_f32 v9, v192, 0, v9
  v_fma_f32 v9, v193, 0, v9
  v_fma_f32 v9, v194, 0, v9
  v_fma_f32 v9, v195, 0, v9
  v_fma_f32 v9, v196, 0, v9
  v_fma_f32 v9, v197, 0, v9
  v_fma_f32 v9, v198, 0, v9
  v_fma_f32 v9, v199, 0, v9
  v_fma_f32 v9, v200, 0, v9
  v_fma_f32 v9, v201, 0, v9
  v_fma_f32 v9, v202, 0, v9
  v_fma_f32 v9, v203, 0, v9
  v_fma_f32 v9, v204, 0, v9
  v_fma_f32 v9, v205, 0, v9
  v_fma_f32 v9, v206, 0, v9
  v_fma_f32 v9, v207, 0, v9
  v_rcp_f32 v7, v8
  s_mov_b32 s28, 0x21800000
  s_mov_b32 s29, 0x5d800000
  v_cmp_le_f32 s[22:23], s28, v8
  v_cmp_ge_f32 s[24:25], s29, v8
  v_cmp_eq_f32 vcc, v9, v9
  v_mul_f32 v192, v192, v7
  v_mul_f32 v193, v193, v7
  v_mul_f32 v194, v194, v7
  v_mul_f32 v195, v195, v7
  v_mul_f32 v196, v196, v7
  v_mul_f32 v197, v197, v7
  v_mul_f32 v198, v198, v7
  v_mul_f32 v199, v199, v7
  v_mul_f32 v200, v200, v7
  v_mul_f32 v201, v201, v7
  v_mul_f32 v202, v202, v7
  v_mul_f32 v203, v203, v7
  v_mul_f32 v204, v204, v7
  v_mul_f32 v205, v205, v7
  v_mul_f32 v206, v206, v7
  v_mul_f32 v207, v207, v7
  v_cvt_pk_bf16_f32 v176, v192, v193
  v_cvt_pk_bf16_f32 v177, v194, v195
  v_cvt_pk_bf16_f32 v178, v196, v197
  v_cvt_pk_bf16_f32 v179, v198, v199
  v_cvt_pk_bf16_f32 v180, v200, v201
  v_cvt_pk_bf16_f32 v181, v202, v203
  v_cvt_pk_bf16_f32 v182, v204, v205
  v_cvt_pk_bf16_f32 v183, v206, v207
  s_and_b64 s[22:23], s[22:23], s[24:25]
  s_and_b64 s[22:23], s[22:23], vcc
  s_mov_b32 exec_lo, 0
  v_mov_b32 v182, 0
  v_mov_b32 v183, 0
  s_mov_b32 exec_lo, -1
  s_cmp_eq_u32 s21, 1
  s_cbranch_scc1 avote_57
  s_cmp_eq_u32 s20, 1
  s_cselect_b64 s[22:23], -1, s[22:23]
  s_cmp_lg_u64 s[22:23], -1
  s_cbranch_scc1 abad_56
parallel_sum__softmax_full_mha__mixer_s_mlp__prompt_kernel_apub:
  s_lshl_b32 s26, s13, 2
  s_add_u32 s26, s26, s32
  s_lshl_b32 s27, s26, 15
  s_lshl_b32 s24, s12, 11
  s_add_u32 s27, s27, s24
  s_add_u32 s27, s27, 11534336
  v_min_u32 v176, -2, v176
  v_min_u32 v177, -2, v177
  v_min_u32 v178, -2, v178
  v_min_u32 v179, -2, v179
  v_min_u32 v180, -2, v180
  v_min_u32 v181, -2, v181
  v_min_u32 v182, -2, v182
  v_min_u32 v183, -2, v183
  buffer_store_dwordx4 v[176:179], v1, s[8:11], s27 offen offset:0 sc1
  buffer_store_dwordx4 v[180:183], v1, s[8:11], s27 offen offset:1024 sc1
  s_mov_b32 s21, 1
  s_branch avote_57
abad_56:
  v_mov_b32 v3, 159760
  v_mov_b32 v4, 1
  ds_write_b32 v3, v4
avote_57:
  s_cmp_eq_u32 s20, 1
  s_cbranch_scc1 parallel_sum__softmax_full_mha__mixer_s_mlp__prompt_kernel_adone
  v_mov_b32 v12, 159744
  v_mov_b32 v13, 1
  s_add_u32 s33, s33, 4
  s_waitcnt lgkmcnt(0)
  s_mov_b32 exec_lo, 1
  s_mov_b32 exec_hi, 0
  ds_add_u32 v12, v13
  s_mov_b32 exec_lo, -1
  s_mov_b32 exec_hi, -1
  s_mov_b32 s35, 0
sb_58:
  ds_read_b32 v13, v12
  s_add_u32 s35, s35, 1
  s_waitcnt lgkmcnt(0)
  v_readfirstlane_b32 s34, v13
  s_cmp_gt_u32 s35, 1048576
  s_cbranch_scc1 sbx_59
  s_cmp_lt_u32 s34, s33
  s_cbranch_scc1 sb_58
sbx_59:
  v_mov_b32 v3, 159760
  ds_read_b32 v4, v3
  s_waitcnt lgkmcnt(0)
  v_readfirstlane_b32 s22, v4
  s_nop 3
  s_cmp_eq_u32 s22, 0
  s_cbranch_scc1 parallel_sum__softmax_full_mha__mixer_s_mlp__prompt_kernel_adone
  v_mov_b32 v96, 0xff800000
  v_mov_b32 v97, 0xff800000
  v_mov_b32 v98, 0xff800000
  v_mov_b32 v99, 0xff800000
  s_mov_b32 s16, s15
  s_mov_b32 s17, 0
amax_60:
  buffer_load_dwordx4 v[48:51], v1, s[8:11], s16 offen offset:0 sc1
  buffer_load_dwordx4 v[52:55], v1, s[8:11], s16 offen offset:1024 sc1
  s_waitcnt vmcnt(0)
  v_mfma_f32_32x32x16_bf16 v[144:159], v[48:51], v[16:19], 0
  v_mfma_f32_32x32x16_bf16 v[144:159], v[52:55], v[20:23], v[144:159]
  s_nop 7
  s_nop 3
  v_max3_f32 v96, v144, v145, v96
  v_max3_f32 v96, v146, v147, v96
  v_max3_f32 v96, v148, v149, v96
  v_max3_f32 v96, v150, v151, v96
  v_max3_f32 v96, v152, v153, v96
  v_max3_f32 v96, v154, v155, v96
  v_max3_f32 v96, v156, v157, v96
  v_max3_f32 v96, v158, v159, v96
  v_mfma_f32_32x32x16_bf16 v[144:159], v[48:51], v[24:27], 0
  v_mfma_f32_32x32x16_bf16 v[144:159], v[52:55], v[28:31], v[144:159]
  s_nop 7
  s_nop 3
  v_max3_f32 v97, v144, v145, v97
  v_max3_f32 v97, v146, v147, v97
  v_max3_f32 v97, v148, v149, v97
  v_max3_f32 v97, v150, v151, v97
  v_max3_f32 v97, v152, v153, v97
  v_max3_f32 v97, v154, v155, v97
  v_max3_f32 v97, v156, v157, v97
  v_max3_f32 v97, v158, v159, v97
  v_mfma_f32_32x32x16_bf16 v[144:159], v[48:51], v[32:35], 0
  v_mfma_f32_32x32x16_bf16 v[144:159], v[52:55], v[36:39], v[144:159]
  s_nop 7
  s_nop 3
  v_max3_f32 v98, v144, v145, v98
  v_max3_f32 v98, v146, v147, v98
  v_max3_f32 v98, v148, v149, v98
  v_max3_f32 v98, v150, v151, v98
  v_max3_f32 v98, v152, v153, v98
  v_max3_f32 v98, v154, v155, v98
  v_max3_f32 v98, v156, v157, v98
  v_max3_f32 v98, v158, v159, v98
  v_mfma_f32_32x32x16_bf16 v[144:159], v[48:51], v[40:43], 0
  v_mfma_f32_32x32x16_bf16 v[144:159], v[52:55], v[44:47], v[144:159]
  s_nop 7
  s_nop 3
  v_max3_f32 v99, v144, v145, v99
  v_max3_f32 v99, v146, v147, v99
  v_max3_f32 v99, v148, v149, v99
  v_max3_f32 v99, v150, v151, v99
  v_max3_f32 v99, v152, v153, v99
  v_max3_f32 v99, v154, v155, v99
  v_max3_f32 v99, v156, v157, v99
  v_max3_f32 v99, v158, v159, v99
  s_add_u32 s16, s16, 2048
  s_add_u32 s17, s17, 1
  s_cmp_lt_u32 s17, 16
  s_cbranch_scc1 amax_60
  v_lshrrev_b32 v6, 2, v1
  v_mov_b32 v7, v96
  s_nop 1
  v_permlane32_swap_b32 v7, v96
  s_nop 1
  v_max_f32 v96, v96, v7
  s_xor_b32 s22, s32, 0
  s_lshl_b32 s22, s22, 10
  s_lshl_b32 s23, s32, 8
  s_add_u32 s22, s22, s23
  s_add_u32 s22, s22, 0
  v_add_u32 v7, s22, v6
  ds_write_b32 v7, v96
  v_mov_b32 v7, v97
  s_nop 1
  v_permlane32_swap_b32 v7, v97
  s_nop 1
  v_max_f32 v97, v97, v7
  s_xor_b32 s22, s32, 1
  s_lshl_b32 s22, s22, 10
  s_lshl_b32 s23, s32, 8
  s_add_u32 s22, s22, s23
  s_add_u32 s22, s22, 0
  v_add_u32 v7, s22, v6
  ds_write_b32 v7, v97
  v_mov_b32 v7, v98
  s_nop 1
  v_permlane32_swap_b32 v7, v98
  s_nop 1
  v_max_f32 v98, v98, v7
  s_xor_b32 s22, s32, 2
  s_lshl_b32 s22, s22, 10
  s_lshl_b32 s23, s32, 8
  s_add_u32 s22, s22, s23
  s_add_u32 s22, s22, 0
  v_add_u32 v7, s22, v6
  ds_write_b32 v7, v98
  v_mov_b32 v7, v99
  s_nop 1
  v_permlane32_swap_b32 v7, v99
  s_nop 1
  v_max_f32 v99, v99, v7
  s_xor_b32 s22, s32, 3
  s_lshl_b32 s22, s22, 10
  s_lshl_b32 s23, s32, 8
  s_add_u32 s22, s22, s23
  s_add_u32 s22, s22, 0
  v_add_u32 v7, s22, v6
  ds_write_b32 v7, v99
  v_mov_b32 v12, 159744
  v_mov_b32 v13, 1
  s_add_u32 s33, s33, 4
  s_waitcnt lgkmcnt(0)
  s_mov_b32 exec_lo, 1
  s_mov_b32 exec_hi, 0
  ds_add_u32 v12, v13
  s_mov_b32 exec_lo, -1
  s_mov_b32 exec_hi, -1
  s_mov_b32 s35, 0
sb_61:
  ds_read_b32 v13, v12
  s_add_u32 s35, s35, 1
  s_waitcnt lgkmcnt(0)
  v_readfirstlane_b32 s34, v13
  s_cmp_gt_u32 s35, 1048576
  s_cbranch_scc1 sbx_62
  s_cmp_lt_u32 s34, s33
  s_cbranch_scc1 sb_61
sbx_62:
  s_xor_b32 s22, s32, 0
  s_lshl_b32 s22, s22, 10
  s_add_u32 s22, s22, 0
  v_add_u32 v7, s22, v6
  ds_read_b32 v100, v7 offset:0
  ds_read_b32 v101, v7 offset:256
  ds_read_b32 v102, v7 offset:512
  ds_read_b32 v103, v7 offset:768
  s_waitcnt lgkmcnt(0)
  v_max3_f32 v8, v100, v101, v102
  v_max_f32 v8, v8, v103
  v_sub_f32 v8, 0, v8
  v_and_b32 v9, 0xffff0000, v8
  v_sub_f32 v8, v8, v9
  v_and_b32 v10, 0xffff0000, v8
  v_sub_f32 v8, v8, v10
  v_lshrrev_b32 v9, 16, v9
  v_or_b32 v9, v9, v10
  v_lshrrev_b32 v8, 16, v8
  s_mov_b32 exec_lo, 0
  v_mov_b32 v22, v9
  v_mov_b32 v23, v8
  s_mov_b32 exec_lo, -1
  s_xor_b32 s22, s32, 1
  s_lshl_b32 s22, s22, 10
  s_add_u32 s22, s22, 0
  v_add_u32 v7, s22, v6
  ds_read_b32 v100, v7 offset:0
  ds_read_b32 v101, v7 offset:256
  ds_read_b32 v102, v7 offset:512
  ds_read_b32 v103, v7 offset:768
  s_waitcnt lgkmcnt(0)
  v_max3_f32 v8, v100, v101, v102
  v_max_f32 v8, v8, v103
  v_sub_f32 v8, 0, v8
  v_and_b32 v9, 0xffff0000, v8
  v_sub_f32 v8, v8, v9
  v_and_b32 v10, 0xffff0000, v8
  v_sub_f32 v8, v8, v10
  v_lshrrev_b32 v9, 16, v9
  v_or_b32 v9, v9, v10
  v_lshrrev_b32 v8, 16, v8
  s_mov_b32 exec_lo, 0
  v_mov_b32 v30, v9
  v_mov_b32 v31, v8
  s_mov_b32 exec_lo, -1
  s_xor_b32 s22, s32, 2
  s_lshl_b32 s22, s22, 10
  s_add_u32 s22, s22, 0
  v_add_u32 v7, s22, v6
  ds_read_b32 v100, v7 offset:0
  ds_read_b32 v101, v7 offset:256
  ds_read_b32 v102, v7 offset:512
  ds_read_b32 v103, v7 offset:768
  s_waitcnt lgkmcnt(0)
  v_max3_f32 v8, v100, v101, v102
  v_max_f32 v8, v8, v103
  v_sub_f32 v8, 0, v8
  v_and_b32 v9, 0xffff0000, v8
  v_sub_f32 v8, v8, v9
  v_and_b32 v10, 0xffff0000, v8
  v_sub_f32 v8, v8, v10
  v_lshrrev_b32 v9, 16, v9
  v_or_b32 v9, v9, v10
  v_lshrrev_b32 v8, 16, v8
  s_mov_b32 exec_lo, 0
  v_mov_b32 v38, v9
  v_mov_b32 v39, v8
  s_mov_b32 exec_lo, -1
  s_xor_b32 s22, s32, 3
  s_lshl_b32 s22, s22, 10
  s_add_u32 s22, s22, 0
  v_add_u32 v7, s22, v6
  ds_read_b32 v100, v7 offset:0
  ds_read_b32 v101, v7 offset:256
  ds_read_b32 v102, v7 offset:512
  ds_read_b32 v103, v7 offset:768
  s_waitcnt lgkmcnt(0)
  v_max3_f32 v8, v100, v101, v102
  v_max_f32 v8, v8, v103
  v_sub_f32 v8, 0, v8
  v_and_b32 v9, 0xffff0000, v8
  v_sub_f32 v8, v8, v9
  v_and_b32 v10, 0xffff0000, v8
  v_sub_f32 v8, v8, v10
  v_lshrrev_b32 v9, 16, v9
  v_or_b32 v9, v9, v10
  v_lshrrev_b32 v8, 16, v8
  s_mov_b32 exec_lo, 0
  v_mov_b32 v46, v9
  v_mov_b32 v47, v8
  s_mov_b32 exec_lo, -1
  v_mov_b32 v12, 159744
  v_mov_b32 v13, 1
  s_add_u32 s33, s33, 4
  s_waitcnt lgkmcnt(0)
  s_mov_b32 exec_lo, 1
  s_mov_b32 exec_hi, 0
  ds_add_u32 v12, v13
  s_mov_b32 exec_lo, -1
  s_mov_b32 exec_hi, -1
  s_mov_b32 s35, 0
sb_63:
  ds_read_b32 v13, v12
  s_add_u32 s35, s35, 1
  s_waitcnt lgkmcnt(0)
  v_readfirstlane_b32 s34, v13
  s_cmp_gt_u32 s35, 1048576
  s_cbranch_scc1 sbx_64
  s_cmp_lt_u32 s34, s33
  s_cbranch_scc1 sb_63
sbx_64:
  s_mov_b32 s20, 1
  s_branch parallel_sum__softmax_full_mha__mixer_s_mlp__prompt_kernel_astart
parallel_sum__softmax_full_mha__mixer_s_mlp__prompt_kernel_adone:
parallel_sum__softmax_full_mha__mixer_s_mlp__prompt_kernel_done:
  s_endpgm
.section .rodata,"a"
.p2align 6
.amdhsa_kernel parallel_sum__softmax_full_mha__mixer_s_mlp__prompt_kernel
  .amdhsa_next_free_vgpr 256
  .amdhsa_next_free_sgpr 102
  .amdhsa_accum_offset 256
  .amdhsa_group_segment_fixed_size 0
  .amdhsa_kernarg_size 88
  .amdhsa_user_sgpr_count 2
  .amdhsa_user_sgpr_kernarg_segment_ptr 1
  .amdhsa_system_sgpr_workgroup_id_x 1
.end_amdhsa_kernel
```
